```python
import torch

def _softmax(x, axis=-1):
    return torch.softmax(x, dim=axis)
def _gelu(x):
    return torch.nn.functional.gelu(x, approximate="tanh")
def _silu(x):
    return torch.nn.functional.silu(x)
def _sigmoid(x):
    return torch.sigmoid(x)
def _layernorm(x, axis=-1, eps=1e-5):
    m = x.mean(dim=axis, keepdim=True)
    v = x.var(dim=axis, keepdim=True, unbiased=False)
    return (x - m) / torch.sqrt(v + eps)
def _scatter_add(tgt, idx, src, axis=0):
    return tgt.clone().index_add_(axis, idx, src)
def _segment_sum(src, seg, n):
    out = torch.zeros((n,) + src.shape[1:], dtype=src.dtype)
    return out.index_add_(0, seg, src)
def _pad(x, pw):
    flat = tuple(v for pair in reversed(pw) for v in pair)
    return torch.nn.functional.pad(x, flat)

kernel_name = 'sequential_preLN__compressed_kv_cla__glu_gated_bilinear__prompt'

def setup_inputs():

    _w = (lambda a: (lambda t: t.to(torch.bfloat16) if t.is_floating_point() else t)(torch.as_tensor(a)))
    def _A_setup():
        B, H, Sq, Sk, D, M = 1, 32, 2048, 2048, 128, 512
        Dc = 4 * D
        return {
            "x": _w((lambda *s: torch.randn(*s, dtype=torch.bfloat16) * 0.05)(B, Sq, M)),
            "c_kv": _w((lambda *s: torch.randn(*s, dtype=torch.bfloat16) * 0.4)(B, Sk, Dc)),
            "w_q": _w((lambda *s: torch.randn(*s, dtype=torch.bfloat16) * 1.6)(M, H, D) * (M ** -0.5)),
            "w_uk": _w((lambda *s: torch.randn(*s, dtype=torch.bfloat16) * 1.6)(Dc, H, D) * (Dc ** -0.5)),
            "w_uv": _w((lambda *s: torch.randn(*s, dtype=torch.bfloat16) * 0.4)(Dc, H, D) * (Dc ** -0.5)),
            "w_o": _w((lambda *s: torch.randn(*s, dtype=torch.bfloat16) * 0.4)(H, D, M) * ((H * D) ** -0.5)),
        }
    _A_in = _A_setup()

    def _B_setup():
        B, S, D, F = 1, 2048, 512, 1792
        return {
            "x": _w((lambda *s: torch.randn(*s, dtype=torch.bfloat16) * 0.05)(B, S, D)),
            "w_gate": _w((lambda *s: torch.randn(*s, dtype=torch.bfloat16) * 0.4)(D, F) * (D ** -0.5)),
            "w_up": _w((lambda *s: torch.randn(*s, dtype=torch.bfloat16) * 0.4)(D, F) * (D ** -0.5)),
            "w_down": _w((lambda *s: torch.randn(*s, dtype=torch.bfloat16) * 0.4)(F, D) * (F ** -0.5)),
        }
    _B_in = _B_setup()

    return {
        "A_x": _A_in["x"],
        "A_c_kv": _A_in["c_kv"],
        "A_w_q": _A_in["w_q"],
        "A_w_uk": _A_in["w_uk"],
        "A_w_uv": _A_in["w_uv"],
        "A_w_o": _A_in["w_o"],
        "B_x": _B_in["x"],
        "B_w_gate": _B_in["w_gate"],
        "B_w_up": _B_in["w_up"],
        "B_w_down": _B_in["w_down"],
    }

def reference(A_x, A_c_kv, A_w_q, A_w_uk, A_w_uv, A_w_o, B_x, B_w_gate, B_w_up, B_w_down):
    def _A_ref(x, c_kv, w_q, w_uk, w_uv, w_o):
        B, Sq, M = x.shape[0], x.shape[1], x.shape[2]
        Sk = c_kv.shape[1]
        H, D = w_q.shape[1], w_q.shape[2]
        q = torch.einsum("bqm,mhd->bhqd", x, w_q)
        k = torch.einsum("bkc,chd->bhkd", c_kv, w_uk)
        v = torch.einsum("bkc,chd->bhkd", c_kv, w_uv)
        scores = torch.einsum("bhqd,bhkd->bhqk", q, k) * (D ** -0.5)
        off = Sk - Sq
        qi = torch.arange(Sq)[:, None]
        kj = torch.arange(Sk)[None, :]
        cmask = kj <= (qi + off)
        scores = torch.where(cmask[None, None], scores, -1e9)
        p = _softmax(scores, axis=-1)
        ctx = torch.einsum("bhqk,bhkd->bhqd", p, v)
        return torch.einsum("bhqd,hdm->bqm", ctx, w_o)

    def _B_ref(x, w_gate, w_up, w_down):
        g = torch.einsum("bsd,df->bsf", x, w_gate)
        u = torch.einsum("bsd,df->bsf", x, w_up)
        h = g * u
        return torch.einsum("bsf,fd->bsd", h, w_down)

    x = A_x
    h = x + _A_ref(_layernorm(x, axis=-1), A_c_kv, A_w_q, A_w_uk, A_w_uv, A_w_o)
    h2 = h + _B_ref(_layernorm(h, axis=-1), B_w_gate, B_w_up, B_w_down)
    return h2
```

```asm
; @launch grid=(256,1,1) block=(256,1,1) lds=163840
.amdgcn_target "amdgcn-amd-amdhsa--gfx950"
.text
.globl sequential_preLN__compressed_kv_cla__glu_gated_bilinear__prompt_kernel
.p2align 8
.type sequential_preLN__compressed_kv_cla__glu_gated_bilinear__prompt_kernel,@function
sequential_preLN__compressed_kv_cla__glu_gated_bilinear__prompt_kernel:
    s_cmp_ge_u32 s2, 256
    s_cbranch_scc1 KB_END
    s_load_dwordx8 s[4:11], s[0:1], 0
    s_load_dwordx2 s[12:13], s[0:1], 32
    s_load_dwordx2 s[78:79], s[0:1], 96
    s_getpc_b64 s[44:45]
    s_lshr_b32 s46, s2, 3
    s_lshl_b32 s46, s46, 9
    v_lshrrev_b32 v213, 6, v0
    v_and_b32 v212, 63, v0
    v_min_u32 v212, 4, v212
    v_lshlrev_b32 v212, 14, v212
    v_lshl_add_u32 v212, v213, 7, v212
    v_add_u32 v212, s46, v212
    global_load_dword v213, v212, s[44:45]
    v_min_u32 v1, 1, v0
    v_lshlrev_b32 v1, 30, v1
    v_lshrrev_b32 v13, 6, v0
    v_and_b32 v0, 63, v0
    s_nop 0
    v_readfirstlane_b32 s14, v13
    s_and_b32 s15, s2, 31
    s_lshr_b32 s16, s2, 5
    s_bfe_u32 s37, s2, 0x20003
    s_lshl_b32 s72, s37, 1
    s_add_u32 s72, s72, s16
    s_cmp_ge_u32 s72, 7
    s_cselect_b32 s38, 7, 0
    s_sub_u32 s72, s72, s38
    s_cmp_ge_u32 s72, 7
    s_cselect_b32 s38, 7, 0
    s_sub_u32 s72, s72, s38
    s_sub_u32 s50, 15, s16
    s_cmp_lt_u32 s15, 16
    s_cselect_b32 s50, s16, s50
    s_lshl_b32 s50, s50, 7
    s_and_b32 s51, s15, 15
    s_lshl_b32 s51, s51, 3
    s_add_u32 s50, s50, s51
    s_lshl_b32 s51, s14, 1
    s_add_u32 s50, s50, s51
    s_lshl_b32 s68, s16, 12
    s_add_u32 s68, s68, 5242880
    s_lshl_b32 s69, s15, 10
    s_add_u32 s69, s69, 5308416
    s_lshl_b32 s51, s50, 10
    v_lshrrev_b32 v15, 3, v0
    v_lshlrev_b32 v15, 10, v15
    v_lshrrev_b32 v13, 4, v0
    v_and_b32 v14, 7, v0
    v_xor_b32 v13, v13, v14
    v_xor_b32 v14, 0, v13
    v_lshl_add_u32 v28, v14, 4, v15
    v_xor_b32 v14, 4, v13
    v_lshl_add_u32 v29, v14, 4, v15
    v_add_u32 v29, 7168, v29
    v_xor_b32 v14, 0, v13
    v_lshl_add_u32 v30, v14, 4, v15
    v_add_u32 v30, 14336, v30
    v_xor_b32 v14, 4, v13
    v_lshl_add_u32 v31, v14, 4, v15
    v_add_u32 v31, 21504, v31
    v_lshrrev_b32 v15, 4, v0
    v_bfe_u32 v13, v0, 1, 3
    v_xor_b32 v13, v13, v15
    v_lshlrev_b32 v13, 5, v13
    v_and_b32 v14, 1, v0
    v_lshl_add_u32 v13, v14, 4, v13
    v_lshlrev_b32 v15, 13, v15
    s_lshl_b32 s37, s14, 17
    v_add_u32 v15, s37, v15
    v_xor_b32 v14, 0, v13
    v_add_u32 v16, v14, v15
    v_xor_b32 v14, 0, v13
    v_add_u32 v17, v14, v15
    v_add_u32 v17, 31744, v17
    v_xor_b32 v14, 128, v13
    v_add_u32 v18, v14, v15
    v_add_u32 v18, 63488, v18
    v_xor_b32 v14, 128, v13
    v_add_u32 v19, v14, v15
    v_add_u32 v19, 95232, v19
    s_lshl_b32 s73, s16, 18
    s_lshl_b32 s37, s14, 16
    s_add_u32 s73, s73, s37
    s_mul_i32 s74, s14, 24576
    s_lshl_b32 s33, s14, 12
    s_lshl_b32 s42, s15, 8
    s_waitcnt lgkmcnt(0)
    s_mov_b32 s64, s4
    s_mov_b32 s65, s5
    s_mov_b32 s66, 0x200000
    s_mov_b32 s67, 0x00020000
    s_mov_b32 s56, s6
    s_mov_b32 s57, s7
    s_mov_b32 s58, 0x200000
    s_mov_b32 s59, 0x00020000
    s_mov_b32 s52, s10
    s_mov_b32 s53, s11
    s_mov_b32 s54, 0x400000
    s_mov_b32 s55, 0x00020000
    v_lshrrev_b32 v204, 5, v0
    v_and_b32 v205, 31, v0
    v_lshlrev_b32 v206, 4, v205
    v_lshl_add_u32 v206, v204, 10, v206
    buffer_load_dwordx4 v[160:163], v206, s[64:67], s51 offen
    buffer_load_dwordx4 v[164:167], v206, s[64:67], s51 offen offset:512
    s_mov_b32 s37, 0
    s_add_u32 m0, s33, 131072
    s_add_u32 s37, s37, s42
    buffer_load_dwordx4 v16, s[52:55], s37 offen lds
    buffer_load_dwordx4 v17, s[52:55], s37 offen offset:1024 lds
    buffer_load_dwordx4 v18, s[52:55], s37 offen offset:2048 lds
    buffer_load_dwordx4 v19, s[52:55], s37 offen offset:3072 lds
    s_add_u32 m0, s74, 0
    s_mov_b32 s38, 0
    s_add_u32 s38, s38, s73
    buffer_load_dwordx4 v28, s[56:59], s38 offen lds
    buffer_load_dwordx4 v29, s[56:59], s38 offen offset:1024 lds
    buffer_load_dwordx4 v30, s[56:59], s38 offen offset:2048 lds
    buffer_load_dwordx4 v31, s[56:59], s38 offen offset:3072 lds
    s_add_u32 m0, s74, 4096
    s_add_u32 s38, s38, 32768
    buffer_load_dwordx4 v28, s[56:59], s38 offen lds
    buffer_load_dwordx4 v29, s[56:59], s38 offen offset:1024 lds
    buffer_load_dwordx4 v30, s[56:59], s38 offen offset:2048 lds
    buffer_load_dwordx4 v31, s[56:59], s38 offen offset:3072 lds
    s_mov_b32 s20, s8
    s_mov_b32 s21, s9
    s_mov_b32 s22, 0x400000
    s_mov_b32 s23, 0x00020000
    s_mov_b32 s60, s12
    s_mov_b32 s61, s13
    s_mov_b32 s62, 0x400000
    s_mov_b32 s63, 0x00020000
    s_mov_b32 s24, s78
    s_mov_b32 s25, s79
    s_mov_b32 s26, 0x4000000
    s_mov_b32 s27, 0x00020000
    s_load_dwordx2 s[4:5], s[0:1], 40
    s_load_dwordx4 s[8:11], s[0:1], 56
    s_load_dwordx2 s[12:13], s[0:1], 72
    s_lshr_b32 s17, s14, 1
    s_and_b32 s18, s14, 1
    s_lshl_b32 s33, s14, 12
    v_lshlrev_b32 v6, 4, v0
    v_add_u32 v5, s33, v6
    s_xor_b32 s37, s14, s17
    s_lshl_b32 s37, s37, 12
    v_add_u32 v4, s37, v6
    s_lshl_b32 s37, s18, 13
    v_add_u32 v2, s37, v6
    s_lshl_b32 s37, s14, 13
    s_add_u32 s37, s37, 131072
    v_add_u32 v7, s37, v6
    v_xor_b32 v8, 0x2000, v7
    v_and_b32 v12, 0xffffdfff, v7
    s_mov_b32 s39, 0x40004000
    s_mov_b32 s35, s16
    s_sub_u32 s34, 15, s16
    s_mov_b32 s3, 0x60006000
    s_lshl_b32 s38, s15, 12
    s_lshl_b32 s37, s18, 11
    s_add_u32 s38, s38, s37
    s_add_u32 s38, s38, 50331648
    s_lshl_b32 s37, s35, 2
    s_add_u32 s44, s37, s17
    s_add_u32 s45, s37, 3
    s_sub_u32 s45, s45, s17
    s_lshl_b32 s37, s34, 2
    s_add_u32 s46, s37, s17
    s_add_u32 s47, s37, 3
    s_sub_u32 s47, s47, s17
    s_cmp_eq_u32 s18, 0
    s_cselect_b32 s40, s44, s45
    s_cselect_b32 s41, s46, s47
    s_lshl_b32 s40, s40, 15
    s_lshl_b32 s41, s41, 15
    s_lshl_b32 s44, s44, 18
    s_add_u32 s44, s44, s38
    s_lshl_b32 s45, s45, 18
    s_add_u32 s45, s45, s38
    s_lshl_b32 s46, s46, 18
    s_add_u32 s46, s46, s38
    s_lshl_b32 s47, s47, 18
    s_add_u32 s47, s47, s38
    s_mul_i32 s31, s15, 524288
    s_add_u32 s31, s31, 16777216
    s_add_u32 s37, s35, 1
    s_mul_i32 s37, s37, 32768
    s_add_u32 s30, s31, s37
    s_add_u32 s37, s34, 1
    s_mul_i32 s37, s37, 32768
    s_add_u32 s19, s31, s37
    s_cmp_eq_u32 s16, 0
    s_cselect_b32 s30, s19, s30
    s_cselect_b32 s37, 0, 32768
    s_add_u32 s29, s31, s37
    s_add_u32 s28, s29, 16384
    s_add_u32 s29, s29, 16777216
    s_mov_b32 s32, 98304
    s_mov_b32 s36, 0
    v_bfe_u32 v15, v0, 2, 2
    v_lshrrev_b32 v13, 4, v0
    v_lshl_add_u32 v13, v13, 3, v15
    v_lshlrev_b32 v13, 8, v13
    v_and_b32 v14, 3, v0
    v_lshl_add_u32 v13, v14, 3, v13
    v_add_u32 v13, 98304, v13
    v_bfe_u32 v15, v0, 2, 3
    v_xor_b32 v14, 0, v15
    v_lshl_add_u32 v20, v14, 5, v13
    v_xor_b32 v14, 1, v15
    v_lshl_add_u32 v21, v14, 5, v13
    v_xor_b32 v14, 2, v15
    v_lshl_add_u32 v22, v14, 5, v13
    v_xor_b32 v14, 3, v15
    v_lshl_add_u32 v23, v14, 5, v13
    v_xor_b32 v14, 4, v15
    v_lshl_add_u32 v24, v14, 5, v13
    v_xor_b32 v14, 5, v15
    v_lshl_add_u32 v25, v14, 5, v13
    v_xor_b32 v14, 6, v15
    v_lshl_add_u32 v26, v14, 5, v13
    v_xor_b32 v14, 7, v15
    v_lshl_add_u32 v27, v14, 5, v13
    v_and_b32 v15, 15, v0
    v_bfe_u32 v13, v0, 1, 3
    v_lshrrev_b32 v14, 4, v0
    v_xor_b32 v13, v13, v14
    v_lshlrev_b32 v15, 7, v15
    v_add_u32 v15, s74, v15
    v_xor_b32 v14, 0, v13
    v_lshl_add_u32 v9, v14, 4, v15
    v_xor_b32 v14, 4, v13
    v_lshl_add_u32 v10, v14, 4, v15
    s_lshl_b32 s75, s16, 2
    s_add_u32 s75, s75, s14
    s_mul_i32 s75, s75, 16384
    s_add_u32 s75, s75, s31
    s_waitcnt lgkmcnt(0)
    s_waitcnt vmcnt(12)
    s_add_u32 s37, s72, 1
    s_cmp_ge_u32 s37, 8
    s_cselect_b32 s6, 7, 0
    s_sub_u32 s37, s37, s6
    s_mul_i32 s37, s37, 524288
    s_add_u32 m0, s33, 147456
    s_add_u32 s37, s37, s42
    buffer_load_dwordx4 v16, s[52:55], s37 offen lds
    v_lshlrev_b32 v168, 16, v160
    v_and_b32 v169, 0xffff0000, v160
    v_lshlrev_b32 v170, 16, v161
    v_and_b32 v171, 0xffff0000, v161
    v_lshlrev_b32 v172, 16, v162
    v_and_b32 v173, 0xffff0000, v162
    v_lshlrev_b32 v174, 16, v163
    v_and_b32 v175, 0xffff0000, v163
    v_lshlrev_b32 v176, 16, v164
    v_and_b32 v177, 0xffff0000, v164
    v_lshlrev_b32 v178, 16, v165
    v_and_b32 v179, 0xffff0000, v165
    v_lshlrev_b32 v180, 16, v166
    v_and_b32 v181, 0xffff0000, v166
    v_lshlrev_b32 v182, 16, v167
    v_and_b32 v183, 0xffff0000, v167
    v_add_f32 v200, v168, v169
    buffer_load_dwordx4 v17, s[52:55], s37 offen offset:1024 lds
    v_add_f32 v201, v170, v171
    v_add_f32 v200, v200, v172
    v_add_f32 v201, v201, v173
    v_add_f32 v200, v200, v174
    v_add_f32 v201, v201, v175
    v_add_f32 v200, v200, v176
    v_add_f32 v201, v201, v177
    v_add_f32 v200, v200, v178
    v_add_f32 v201, v201, v179
    v_add_f32 v200, v200, v180
    v_add_f32 v201, v201, v181
    v_add_f32 v200, v200, v182
    v_add_f32 v201, v201, v183
    v_add_f32 v200, v200, v201
    s_nop 1
    v_add_f32_dpp v200, v200, v200 quad_perm:[1,0,3,2] row_mask:0xf bank_mask:0xf
    s_nop 1
    buffer_load_dwordx4 v18, s[52:55], s37 offen offset:2048 lds
    v_add_f32_dpp v200, v200, v200 quad_perm:[2,3,0,1] row_mask:0xf bank_mask:0xf
    s_nop 1
    v_add_f32_dpp v200, v200, v200 row_half_mirror row_mask:0xf bank_mask:0xf
    s_nop 1
    v_add_f32_dpp v200, v200, v200 row_mirror row_mask:0xf bank_mask:0xf
    v_mov_b32 v201, v200
    s_nop 1
    v_permlane16_swap_b32 v200, v201
    v_add_f32 v200, v200, v201
    v_mul_f32 v200, 0x3b000000, v200
    v_sub_f32 v184, v168, v200
    v_sub_f32 v185, v169, v200
    v_sub_f32 v186, v170, v200
    v_sub_f32 v187, v171, v200
    v_sub_f32 v188, v172, v200
    v_sub_f32 v189, v173, v200
    v_sub_f32 v190, v174, v200
    buffer_load_dwordx4 v19, s[52:55], s37 offen offset:3072 lds
    v_sub_f32 v191, v175, v200
    v_sub_f32 v192, v176, v200
    v_sub_f32 v193, v177, v200
    v_sub_f32 v194, v178, v200
    v_sub_f32 v195, v179, v200
    v_sub_f32 v196, v180, v200
    v_sub_f32 v197, v181, v200
    v_sub_f32 v198, v182, v200
    v_sub_f32 v199, v183, v200
    v_mul_f32 v184, v184, v184
    v_mul_f32 v185, v185, v185
    v_mul_f32 v186, v186, v186
    v_mul_f32 v187, v187, v187
    v_mul_f32 v188, v188, v188
    v_mul_f32 v189, v189, v189
    v_mul_f32 v190, v190, v190
    v_mul_f32 v191, v191, v191
    s_add_u32 m0, s74, 8192
    s_add_u32 s38, s72, 1
    s_cmp_ge_u32 s38, 8
    s_cselect_b32 s6, 7, 0
    s_sub_u32 s38, s38, s6
    s_mul_i32 s38, s38, 128
    s_add_u32 s38, s38, s73
    buffer_load_dwordx4 v28, s[56:59], s38 offen lds
    v_mul_f32 v192, v192, v192
    v_mul_f32 v193, v193, v193
    v_mul_f32 v194, v194, v194
    v_mul_f32 v195, v195, v195
    v_mul_f32 v196, v196, v196
    v_mul_f32 v197, v197, v197
    v_mul_f32 v198, v198, v198
    v_mul_f32 v199, v199, v199
    v_add_f32 v202, v184, v185
    v_add_f32 v203, v186, v187
    v_add_f32 v202, v202, v188
    v_add_f32 v203, v203, v189
    v_add_f32 v202, v202, v190
    v_add_f32 v203, v203, v191
    v_add_f32 v202, v202, v192
    v_add_f32 v203, v203, v193
    v_add_f32 v202, v202, v194
    buffer_load_dwordx4 v29, s[56:59], s38 offen offset:1024 lds
    v_add_f32 v203, v203, v195
    v_add_f32 v202, v202, v196
    v_add_f32 v203, v203, v197
    v_add_f32 v202, v202, v198
    v_add_f32 v203, v203, v199
    v_add_f32 v202, v202, v203
    s_nop 1
    v_add_f32_dpp v202, v202, v202 quad_perm:[1,0,3,2] row_mask:0xf bank_mask:0xf
    s_nop 1
    v_add_f32_dpp v202, v202, v202 quad_perm:[2,3,0,1] row_mask:0xf bank_mask:0xf
    s_nop 1
    v_add_f32_dpp v202, v202, v202 row_half_mirror row_mask:0xf bank_mask:0xf
    s_nop 1
    v_add_f32_dpp v202, v202, v202 row_mirror row_mask:0xf bank_mask:0xf
    v_mov_b32 v203, v202
    s_nop 1
    v_permlane16_swap_b32 v202, v203
    buffer_load_dwordx4 v30, s[56:59], s38 offen offset:2048 lds
    v_add_f32 v202, v202, v203
    v_mul_f32 v202, 0x3b000000, v202
    v_cvt_pk_bf16_f32 v200, v200, v200
    v_lshlrev_b32 v200, 16, v200
    v_cvt_pk_bf16_f32 v202, v202, v202
    v_lshlrev_b32 v202, 16, v202
    v_add_f32 v202, 0x3727c5ac, v202
    v_cvt_pk_bf16_f32 v202, v202, v202
    v_lshlrev_b32 v202, 16, v202
    v_sqrt_f32 v202, v202
    s_nop 0
    v_cvt_pk_bf16_f32 v202, v202, v202
    v_lshlrev_b32 v202, 16, v202
    v_rcp_f32 v202, v202
    s_nop 0
    v_mul_f32 v202, 0x3e0293ee, v202
    v_sub_f32 v184, v168, v200
    buffer_load_dwordx4 v31, s[56:59], s38 offen offset:3072 lds
    v_sub_f32 v185, v169, v200
    v_sub_f32 v186, v170, v200
    v_sub_f32 v187, v171, v200
    v_sub_f32 v188, v172, v200
    v_sub_f32 v189, v173, v200
    v_sub_f32 v190, v174, v200
    v_sub_f32 v191, v175, v200
    v_sub_f32 v192, v176, v200
    v_sub_f32 v193, v177, v200
    v_sub_f32 v194, v178, v200
    v_sub_f32 v195, v179, v200
    v_sub_f32 v196, v180, v200
    v_sub_f32 v197, v181, v200
    v_sub_f32 v198, v182, v200
    v_sub_f32 v199, v183, v200
    v_cvt_pk_bf16_f32 v160, v184, v185
    v_cvt_pk_bf16_f32 v161, v186, v187
    s_add_u32 m0, s74, 12288
    s_add_u32 s38, s38, 32768
    buffer_load_dwordx4 v28, s[56:59], s38 offen lds
    v_cvt_pk_bf16_f32 v162, v188, v189
    v_cvt_pk_bf16_f32 v163, v190, v191
    v_cvt_pk_bf16_f32 v164, v192, v193
    v_cvt_pk_bf16_f32 v165, v194, v195
    v_cvt_pk_bf16_f32 v166, v196, v197
    v_cvt_pk_bf16_f32 v167, v198, v199
    v_lshlrev_b32 v184, 16, v160
    v_and_b32 v185, 0xffff0000, v160
    v_lshlrev_b32 v186, 16, v161
    v_and_b32 v187, 0xffff0000, v161
    v_lshlrev_b32 v188, 16, v162
    v_and_b32 v189, 0xffff0000, v162
    v_lshlrev_b32 v190, 16, v163
    v_and_b32 v191, 0xffff0000, v163
    v_lshlrev_b32 v192, 16, v164
    v_and_b32 v193, 0xffff0000, v164
    v_lshlrev_b32 v194, 16, v165
    buffer_load_dwordx4 v29, s[56:59], s38 offen offset:1024 lds
    v_and_b32 v195, 0xffff0000, v165
    v_lshlrev_b32 v196, 16, v166
    v_and_b32 v197, 0xffff0000, v166
    v_lshlrev_b32 v198, 16, v167
    v_and_b32 v199, 0xffff0000, v167
    v_mul_f32 v184, v184, v202
    v_mul_f32 v185, v185, v202
    v_mul_f32 v186, v186, v202
    v_mul_f32 v187, v187, v202
    v_mul_f32 v188, v188, v202
    v_mul_f32 v189, v189, v202
    v_mul_f32 v190, v190, v202
    v_mul_f32 v191, v191, v202
    v_mul_f32 v192, v192, v202
    v_mul_f32 v193, v193, v202
    v_mul_f32 v194, v194, v202
    v_mul_f32 v195, v195, v202
    buffer_load_dwordx4 v30, s[56:59], s38 offen offset:2048 lds
    v_mul_f32 v196, v196, v202
    v_mul_f32 v197, v197, v202
    v_mul_f32 v198, v198, v202
    v_mul_f32 v199, v199, v202
    v_cvt_pk_bf16_f32 v160, v184, v185
    v_cvt_pk_bf16_f32 v161, v186, v187
    v_cvt_pk_bf16_f32 v162, v188, v189
    v_cvt_pk_bf16_f32 v163, v190, v191
    v_cvt_pk_bf16_f32 v164, v192, v193
    v_cvt_pk_bf16_f32 v165, v194, v195
    v_cvt_pk_bf16_f32 v166, v196, v197
    v_cvt_pk_bf16_f32 v167, v198, v199
    s_lshl_b32 s43, s14, 5
    s_add_u32 s43, s43, 114688
    v_lshlrev_b32 v206, 7, v205
    v_lshl_add_u32 v206, v204, 4, v206
    v_add_u32 v206, s43, v206
    buffer_load_dwordx4 v31, s[56:59], s38 offen offset:3072 lds
    ds_write_b128 v206, v[160:163]
    ds_write_b128 v206, v[164:167] offset:4096
    s_lshl_b32 s43, s14, 11
    s_add_u32 s43, s43, 114688
    v_add_u32 v204, s43, v6
    v_lshrrev_b32 v205, 3, v0
    v_and_b32 v207, 7, v0
    v_lshlrev_b32 v207, 4, v207
    v_lshl_add_u32 v207, v205, 8, v207
    s_lshr_b32 s51, s50, 4
    s_lshl_b32 s51, s51, 14
    s_and_b32 s50, s50, 8
    s_lshl_b32 s50, s50, 4
    s_add_u32 s51, s51, s50
    s_add_u32 s51, s51, s33
    s_add_u32 s51, s51, 0
    s_waitcnt vmcnt(12) lgkmcnt(0)
    s_barrier
    ds_read_b64_tr_b16 v[224:225], v20 offset:32768
    ds_read_b64_tr_b16 v[226:227], v20 offset:33792
    ds_read_b64_tr_b16 v[228:229], v20 offset:40960
    ds_read_b64_tr_b16 v[230:231], v20 offset:41984
    ds_read_b64_tr_b16 v[232:233], v21 offset:32768
    ds_read_b64_tr_b16 v[234:235], v21 offset:33792
    ds_read_b64_tr_b16 v[236:237], v21 offset:40960
    ds_read_b64_tr_b16 v[238:239], v21 offset:41984
    ds_read_b128 a[0:3], v9 offset:0
    ds_read_b128 a[16:19], v10 offset:0
    ds_read_b128 a[4:7], v9 offset:2048
    ds_read_b128 a[20:23], v10 offset:2048
    ds_read_b128 a[8:11], v9 offset:4096
    ds_read_b128 a[24:27], v10 offset:4096
    ds_read_b128 a[12:15], v9 offset:6144
    ds_read_b128 a[28:31], v10 offset:6144
    ds_read_b128 v[160:163], v204 offset:0
    ds_read_b128 v[164:167], v204 offset:1024
    s_waitcnt lgkmcnt(0)
    v_mfma_f32_16x16x32_bf16 v[32:35], v[224:227], a[0:3], 0
    ds_read_b64_tr_b16 v[240:241], v22 offset:32768
    ds_read_b64_tr_b16 v[242:243], v22 offset:33792
    v_mfma_f32_16x16x32_bf16 v[32:35], v[228:231], a[16:19], v[32:35]
    s_add_u32 m0, s74, 16384
    s_add_u32 s38, s72, 2
    s_cmp_ge_u32 s38, 8
    s_cselect_b32 s6, 7, 0
    s_sub_u32 s38, s38, s6
    s_mul_i32 s38, s38, 128
    s_add_u32 s38, s38, s73
    buffer_load_dwordx4 v28, s[56:59], s38 offen lds
    v_mfma_f32_16x16x32_bf16 v[40:43], v[224:227], a[4:7], 0
    ds_read_b64_tr_b16 v[244:245], v22 offset:40960
    v_mfma_f32_16x16x32_bf16 v[40:43], v[228:231], a[20:23], v[40:43]
    ds_read_b64_tr_b16 v[246:247], v22 offset:41984
    v_mfma_f32_16x16x32_bf16 v[48:51], v[224:227], a[8:11], 0
    ds_read_b64_tr_b16 v[248:249], v23 offset:32768
    v_mfma_f32_16x16x32_bf16 v[48:51], v[228:231], a[24:27], v[48:51]
    v_mfma_f32_16x16x32_bf16 v[56:59], v[224:227], a[12:15], 0
    ds_read_b64_tr_b16 v[250:251], v23 offset:33792
    v_mfma_f32_16x16x32_bf16 v[56:59], v[228:231], a[28:31], v[56:59]
    buffer_load_dwordx4 v29, s[56:59], s38 offen offset:1024 lds
    v_mfma_f32_16x16x32_bf16 v[36:39], v[232:235], a[0:3], 0
    ds_read_b64_tr_b16 v[252:253], v23 offset:40960
    v_mfma_f32_16x16x32_bf16 v[36:39], v[236:239], a[16:19], v[36:39]
    ds_read_b64_tr_b16 v[254:255], v23 offset:41984
    v_mfma_f32_16x16x32_bf16 v[44:47], v[232:235], a[4:7], 0
    buffer_load_dwordx4 v30, s[56:59], s38 offen offset:2048 lds
    v_mfma_f32_16x16x32_bf16 v[44:47], v[236:239], a[20:23], v[44:47]
    v_mfma_f32_16x16x32_bf16 v[52:55], v[232:235], a[8:11], 0
    buffer_load_dwordx4 v31, s[56:59], s38 offen offset:3072 lds
    v_mfma_f32_16x16x32_bf16 v[52:55], v[236:239], a[24:27], v[52:55]
    v_mfma_f32_16x16x32_bf16 v[60:63], v[232:235], a[12:15], 0
    v_mfma_f32_16x16x32_bf16 v[60:63], v[236:239], a[28:31], v[60:63]
    s_waitcnt lgkmcnt(0)
    v_mfma_f32_16x16x32_bf16 v[64:67], v[240:243], a[0:3], 0
    ds_read_b64_tr_b16 v[224:225], v24 offset:32768
    ds_read_b64_tr_b16 v[226:227], v24 offset:33792
    v_mfma_f32_16x16x32_bf16 v[64:67], v[244:247], a[16:19], v[64:67]
    s_add_u32 m0, s74, 20480
    s_add_u32 s38, s38, 32768
    buffer_load_dwordx4 v28, s[56:59], s38 offen lds
    v_mfma_f32_16x16x32_bf16 v[72:75], v[240:243], a[4:7], 0
    ds_read_b64_tr_b16 v[228:229], v24 offset:40960
    v_mfma_f32_16x16x32_bf16 v[72:75], v[244:247], a[20:23], v[72:75]
    ds_read_b64_tr_b16 v[230:231], v24 offset:41984
    v_mfma_f32_16x16x32_bf16 v[80:83], v[240:243], a[8:11], 0
    buffer_load_dwordx4 v29, s[56:59], s38 offen offset:1024 lds
    v_mfma_f32_16x16x32_bf16 v[80:83], v[244:247], a[24:27], v[80:83]
    ds_read_b64_tr_b16 v[232:233], v25 offset:32768
    v_mfma_f32_16x16x32_bf16 v[88:91], v[240:243], a[12:15], 0
    buffer_load_dwordx4 v30, s[56:59], s38 offen offset:2048 lds
    v_mfma_f32_16x16x32_bf16 v[88:91], v[244:247], a[28:31], v[88:91]
    ds_read_b64_tr_b16 v[234:235], v25 offset:33792
    ds_read_b64_tr_b16 v[236:237], v25 offset:40960
    v_mfma_f32_16x16x32_bf16 v[68:71], v[248:251], a[0:3], 0
    buffer_load_dwordx4 v31, s[56:59], s38 offen offset:3072 lds
    v_mfma_f32_16x16x32_bf16 v[68:71], v[252:255], a[16:19], v[68:71]
    ds_read_b64_tr_b16 v[238:239], v25 offset:41984
    v_mfma_f32_16x16x32_bf16 v[76:79], v[248:251], a[4:7], 0
    buffer_store_dwordx4 v[160:163], v207, s[24:27], s51 offen offset:0 sc1
    v_mfma_f32_16x16x32_bf16 v[76:79], v[252:255], a[20:23], v[76:79]
    v_mfma_f32_16x16x32_bf16 v[84:87], v[248:251], a[8:11], 0
    buffer_store_dwordx4 v[164:167], v207, s[24:27], s51 offen offset:2048 sc1
    v_mfma_f32_16x16x32_bf16 v[84:87], v[252:255], a[24:27], v[84:87]
    v_mfma_f32_16x16x32_bf16 v[92:95], v[248:251], a[12:15], 0
    v_mfma_f32_16x16x32_bf16 v[92:95], v[252:255], a[28:31], v[92:95]
    s_waitcnt vmcnt(10) lgkmcnt(0)
    v_mfma_f32_16x16x32_bf16 v[96:99], v[224:227], a[0:3], 0
    ds_read_b64_tr_b16 v[240:241], v26 offset:32768
    ds_read_b64_tr_b16 v[242:243], v26 offset:33792
    v_mfma_f32_16x16x32_bf16 v[96:99], v[228:231], a[16:19], v[96:99]
    s_add_u32 s37, s72, 2
    s_cmp_ge_u32 s37, 8
    s_cselect_b32 s6, 7, 0
    s_sub_u32 s37, s37, s6
    s_mul_i32 s37, s37, 524288
    s_add_u32 m0, s33, 98304
    s_add_u32 s37, s37, s42
    buffer_load_dwordx4 v16, s[52:55], s37 offen lds
    v_mfma_f32_16x16x32_bf16 v[104:107], v[224:227], a[4:7], 0
    ds_read_b64_tr_b16 v[244:245], v26 offset:40960
    ds_read_b64_tr_b16 v[246:247], v26 offset:41984
    v_mfma_f32_16x16x32_bf16 v[104:107], v[228:231], a[20:23], v[104:107]
    ds_read_b64_tr_b16 v[248:249], v27 offset:32768
    ds_read_b64_tr_b16 v[250:251], v27 offset:33792
    v_mfma_f32_16x16x32_bf16 v[112:115], v[224:227], a[8:11], 0
    buffer_load_dwordx4 v17, s[52:55], s37 offen offset:1024 lds
    v_mfma_f32_16x16x32_bf16 v[112:115], v[228:231], a[24:27], v[112:115]
    ds_read_b64_tr_b16 v[252:253], v27 offset:40960
    ds_read_b64_tr_b16 v[254:255], v27 offset:41984
    v_mfma_f32_16x16x32_bf16 v[120:123], v[224:227], a[12:15], 0
    buffer_load_dwordx4 v18, s[52:55], s37 offen offset:2048 lds
    v_mfma_f32_16x16x32_bf16 v[120:123], v[228:231], a[28:31], v[120:123]
    ds_read_b128 a[32:35], v9 offset:8192
    ds_read_b128 a[48:51], v10 offset:8192
    v_mfma_f32_16x16x32_bf16 v[100:103], v[232:235], a[0:3], 0
    buffer_load_dwordx4 v19, s[52:55], s37 offen offset:3072 lds
    v_mfma_f32_16x16x32_bf16 v[100:103], v[236:239], a[16:19], v[100:103]
    ds_read_b128 a[36:39], v9 offset:10240
    v_and_b32 v13, 7, v0
    v_mfma_f32_16x16x32_bf16 v[108:111], v[232:235], a[4:7], 0
    ds_read_b128 a[52:55], v10 offset:10240
    v_lshlrev_b32 v13, 8, v13
    v_mfma_f32_16x16x32_bf16 v[108:111], v[236:239], a[20:23], v[108:111]
    buffer_load_dword v14, v13, s[24:27], s68 offen sc1
    v_mfma_f32_16x16x32_bf16 v[116:119], v[232:235], a[8:11], 0
    v_and_b32 v13, 0x300, v13
    v_mfma_f32_16x16x32_bf16 v[116:119], v[236:239], a[24:27], v[116:119]
    buffer_load_dword v15, v13, s[24:27], s69 offen sc1
    v_mfma_f32_16x16x32_bf16 v[124:127], v[232:235], a[12:15], 0
    v_mfma_f32_16x16x32_bf16 v[124:127], v[236:239], a[28:31], v[124:127]
    s_waitcnt vmcnt(24) lgkmcnt(0)
    v_mfma_f32_16x16x32_bf16 v[128:131], v[240:243], a[0:3], 0
    s_barrier
    ds_read_b64_tr_b16 v[224:225], v20 offset:49152
    ds_read_b64_tr_b16 v[226:227], v20 offset:50176
    v_mfma_f32_16x16x32_bf16 v[128:131], v[244:247], a[16:19], v[128:131]
    s_add_u32 s37, s72, 3
    s_cmp_ge_u32 s37, 8
    s_cselect_b32 s6, 7, 0
    s_sub_u32 s37, s37, s6
    s_mul_i32 s37, s37, 524288
    s_add_u32 m0, s33, 114688
    s_add_u32 s37, s37, s42
    buffer_load_dwordx4 v16, s[52:55], s37 offen lds
    v_mfma_f32_16x16x32_bf16 v[136:139], v[240:243], a[4:7], 0
    ds_read_b64_tr_b16 v[228:229], v20 offset:57344
    ds_read_b64_tr_b16 v[230:231], v20 offset:58368
    v_mfma_f32_16x16x32_bf16 v[136:139], v[244:247], a[20:23], v[136:139]
    ds_read_b64_tr_b16 v[232:233], v21 offset:49152
    ds_read_b64_tr_b16 v[234:235], v21 offset:50176
    v_mfma_f32_16x16x32_bf16 v[144:147], v[240:243], a[8:11], 0
    ds_read_b64_tr_b16 v[236:237], v21 offset:57344
    v_mfma_f32_16x16x32_bf16 v[144:147], v[244:247], a[24:27], v[144:147]
    ds_read_b64_tr_b16 v[238:239], v21 offset:58368
    v_mfma_f32_16x16x32_bf16 v[152:155], v[240:243], a[12:15], 0
    ds_read_b128 a[40:43], v9 offset:12288
    v_mfma_f32_16x16x32_bf16 v[152:155], v[244:247], a[28:31], v[152:155]
    buffer_load_dwordx4 v17, s[52:55], s37 offen offset:1024 lds
    v_mfma_f32_16x16x32_bf16 v[132:135], v[248:251], a[0:3], 0
    ds_read_b128 a[56:59], v10 offset:12288
    ds_read_b128 a[44:47], v9 offset:14336
    v_mfma_f32_16x16x32_bf16 v[132:135], v[252:255], a[16:19], v[132:135]
    ds_read_b128 a[60:63], v10 offset:14336
    v_mfma_f32_16x16x32_bf16 v[140:143], v[248:251], a[4:7], 0
    buffer_load_dwordx4 v18, s[52:55], s37 offen offset:2048 lds
    v_mfma_f32_16x16x32_bf16 v[140:143], v[252:255], a[20:23], v[140:143]
    v_mfma_f32_16x16x32_bf16 v[148:151], v[248:251], a[8:11], 0
    buffer_load_dwordx4 v19, s[52:55], s37 offen offset:3072 lds
    v_mfma_f32_16x16x32_bf16 v[148:151], v[252:255], a[24:27], v[148:151]
    v_mfma_f32_16x16x32_bf16 v[156:159], v[248:251], a[12:15], 0
    v_mfma_f32_16x16x32_bf16 v[156:159], v[252:255], a[28:31], v[156:159]
    s_waitcnt lgkmcnt(0)
    v_mfma_f32_16x16x32_bf16 v[32:35], v[224:227], a[32:35], v[32:35]
    ds_read_b64_tr_b16 v[240:241], v22 offset:49152
    ds_read_b64_tr_b16 v[242:243], v22 offset:50176
    v_mfma_f32_16x16x32_bf16 v[32:35], v[228:231], a[48:51], v[32:35]
    s_add_u32 m0, s74, 0
    s_add_u32 s38, s72, 3
    s_cmp_ge_u32 s38, 8
    s_cselect_b32 s6, 7, 0
    s_sub_u32 s38, s38, s6
    s_mul_i32 s38, s38, 128
    s_add_u32 s38, s38, s73
    buffer_load_dwordx4 v28, s[56:59], s38 offen lds
    v_mfma_f32_16x16x32_bf16 v[40:43], v[224:227], a[36:39], v[40:43]
    ds_read_b64_tr_b16 v[244:245], v22 offset:57344
    v_mfma_f32_16x16x32_bf16 v[40:43], v[228:231], a[52:55], v[40:43]
    ds_read_b64_tr_b16 v[246:247], v22 offset:58368
    v_mfma_f32_16x16x32_bf16 v[48:51], v[224:227], a[40:43], v[48:51]
    ds_read_b64_tr_b16 v[248:249], v23 offset:49152
    v_mfma_f32_16x16x32_bf16 v[48:51], v[228:231], a[56:59], v[48:51]
    v_mfma_f32_16x16x32_bf16 v[56:59], v[224:227], a[44:47], v[56:59]
    ds_read_b64_tr_b16 v[250:251], v23 offset:50176
    v_mfma_f32_16x16x32_bf16 v[56:59], v[228:231], a[60:63], v[56:59]
    buffer_load_dwordx4 v29, s[56:59], s38 offen offset:1024 lds
    v_mfma_f32_16x16x32_bf16 v[36:39], v[232:235], a[32:35], v[36:39]
    ds_read_b64_tr_b16 v[252:253], v23 offset:57344
    v_mfma_f32_16x16x32_bf16 v[36:39], v[236:239], a[48:51], v[36:39]
    ds_read_b64_tr_b16 v[254:255], v23 offset:58368
    v_mfma_f32_16x16x32_bf16 v[44:47], v[232:235], a[36:39], v[44:47]
    buffer_load_dwordx4 v30, s[56:59], s38 offen offset:2048 lds
    v_mfma_f32_16x16x32_bf16 v[44:47], v[236:239], a[52:55], v[44:47]
    v_mfma_f32_16x16x32_bf16 v[52:55], v[232:235], a[40:43], v[52:55]
    buffer_load_dwordx4 v31, s[56:59], s38 offen offset:3072 lds
    v_mfma_f32_16x16x32_bf16 v[52:55], v[236:239], a[56:59], v[52:55]
    v_mfma_f32_16x16x32_bf16 v[60:63], v[232:235], a[44:47], v[60:63]
    v_mfma_f32_16x16x32_bf16 v[60:63], v[236:239], a[60:63], v[60:63]
    s_waitcnt lgkmcnt(0)
    v_mfma_f32_16x16x32_bf16 v[64:67], v[240:243], a[32:35], v[64:67]
    ds_read_b64_tr_b16 v[224:225], v24 offset:49152
    ds_read_b64_tr_b16 v[226:227], v24 offset:50176
    v_mfma_f32_16x16x32_bf16 v[64:67], v[244:247], a[48:51], v[64:67]
    ds_read_b64_tr_b16 v[228:229], v24 offset:57344
    s_add_u32 m0, s74, 4096
    s_add_u32 s38, s38, 32768
    v_mfma_f32_16x16x32_bf16 v[72:75], v[240:243], a[36:39], v[72:75]
    buffer_load_dwordx4 v28, s[56:59], s38 offen lds
    v_mfma_f32_16x16x32_bf16 v[72:75], v[244:247], a[52:55], v[72:75]
    ds_read_b64_tr_b16 v[230:231], v24 offset:58368
    v_mfma_f32_16x16x32_bf16 v[80:83], v[240:243], a[40:43], v[80:83]
    ds_read_b64_tr_b16 v[232:233], v25 offset:49152
    v_mfma_f32_16x16x32_bf16 v[80:83], v[244:247], a[56:59], v[80:83]
    buffer_load_dwordx4 v29, s[56:59], s38 offen offset:1024 lds
    v_mfma_f32_16x16x32_bf16 v[88:91], v[240:243], a[44:47], v[88:91]
    ds_read_b64_tr_b16 v[234:235], v25 offset:50176
    v_mfma_f32_16x16x32_bf16 v[88:91], v[244:247], a[60:63], v[88:91]
    ds_read_b64_tr_b16 v[236:237], v25 offset:57344
    v_mfma_f32_16x16x32_bf16 v[68:71], v[248:251], a[32:35], v[68:71]
    buffer_load_dwordx4 v30, s[56:59], s38 offen offset:2048 lds
    v_mfma_f32_16x16x32_bf16 v[68:71], v[252:255], a[48:51], v[68:71]
    ds_read_b64_tr_b16 v[238:239], v25 offset:58368
    v_mfma_f32_16x16x32_bf16 v[76:79], v[248:251], a[36:39], v[76:79]
    v_mfma_f32_16x16x32_bf16 v[76:79], v[252:255], a[52:55], v[76:79]
    buffer_load_dwordx4 v31, s[56:59], s38 offen offset:3072 lds
    v_mfma_f32_16x16x32_bf16 v[84:87], v[248:251], a[40:43], v[84:87]
    v_mfma_f32_16x16x32_bf16 v[84:87], v[252:255], a[56:59], v[84:87]
    v_mfma_f32_16x16x32_bf16 v[92:95], v[248:251], a[44:47], v[92:95]
    v_mfma_f32_16x16x32_bf16 v[92:95], v[252:255], a[60:63], v[92:95]
    s_waitcnt vmcnt(20) lgkmcnt(0)
    v_mfma_f32_16x16x32_bf16 v[96:99], v[224:227], a[32:35], v[96:99]
    ds_read_b64_tr_b16 v[240:241], v26 offset:49152
    ds_read_b64_tr_b16 v[242:243], v26 offset:50176
    v_mfma_f32_16x16x32_bf16 v[96:99], v[228:231], a[48:51], v[96:99]
    s_add_u32 s37, s72, 4
    s_cmp_ge_u32 s37, 8
    s_cselect_b32 s6, 7, 0
    s_sub_u32 s37, s37, s6
    s_mul_i32 s37, s37, 524288
    s_add_u32 m0, s33, 131072
    s_add_u32 s37, s37, s42
    buffer_load_dwordx4 v16, s[52:55], s37 offen lds
    v_mfma_f32_16x16x32_bf16 v[104:107], v[224:227], a[36:39], v[104:107]
    ds_read_b64_tr_b16 v[244:245], v26 offset:57344
    ds_read_b64_tr_b16 v[246:247], v26 offset:58368
    v_mfma_f32_16x16x32_bf16 v[104:107], v[228:231], a[52:55], v[104:107]
    ds_read_b64_tr_b16 v[248:249], v27 offset:49152
    ds_read_b64_tr_b16 v[250:251], v27 offset:50176
    v_mfma_f32_16x16x32_bf16 v[112:115], v[224:227], a[40:43], v[112:115]
    ds_read_b64_tr_b16 v[252:253], v27 offset:57344
    v_mfma_f32_16x16x32_bf16 v[112:115], v[228:231], a[56:59], v[112:115]
    ds_read_b64_tr_b16 v[254:255], v27 offset:58368
    v_mfma_f32_16x16x32_bf16 v[120:123], v[224:227], a[44:47], v[120:123]
    ds_read_b128 a[64:67], v9 offset:16384
    v_mfma_f32_16x16x32_bf16 v[120:123], v[228:231], a[60:63], v[120:123]
    ds_read_b128 a[80:83], v10 offset:16384
    v_mfma_f32_16x16x32_bf16 v[100:103], v[232:235], a[32:35], v[100:103]
    ds_read_b128 a[68:71], v9 offset:18432
    v_mfma_f32_16x16x32_bf16 v[100:103], v[236:239], a[48:51], v[100:103]
    buffer_load_dwordx4 v17, s[52:55], s37 offen offset:1024 lds
    v_mfma_f32_16x16x32_bf16 v[108:111], v[232:235], a[36:39], v[108:111]
    ds_read_b128 a[84:87], v10 offset:18432
    v_mfma_f32_16x16x32_bf16 v[108:111], v[236:239], a[52:55], v[108:111]
    buffer_load_dwordx4 v18, s[52:55], s37 offen offset:2048 lds
    v_mfma_f32_16x16x32_bf16 v[116:119], v[232:235], a[40:43], v[116:119]
    v_mfma_f32_16x16x32_bf16 v[116:119], v[236:239], a[56:59], v[116:119]
    v_mfma_f32_16x16x32_bf16 v[124:127], v[232:235], a[44:47], v[124:127]
    v_mfma_f32_16x16x32_bf16 v[124:127], v[236:239], a[60:63], v[124:127]
    s_waitcnt vmcnt(17) lgkmcnt(0)
    v_mfma_f32_16x16x32_bf16 v[128:131], v[240:243], a[32:35], v[128:131]
    s_barrier
    ds_read_b64_tr_b16 v[224:225], v20 offset:0
    ds_read_b64_tr_b16 v[226:227], v20 offset:1024
    v_mfma_f32_16x16x32_bf16 v[128:131], v[244:247], a[48:51], v[128:131]
    buffer_load_dwordx4 v19, s[52:55], s37 offen offset:3072 lds
    v_mfma_f32_16x16x32_bf16 v[136:139], v[240:243], a[36:39], v[136:139]
    ds_read_b64_tr_b16 v[228:229], v20 offset:8192
    ds_read_b64_tr_b16 v[230:231], v20 offset:9216
    v_mfma_f32_16x16x32_bf16 v[136:139], v[244:247], a[52:55], v[136:139]
    s_add_u32 m0, s74, 8192
    s_add_u32 s38, s72, 4
    s_cmp_ge_u32 s38, 8
    s_cselect_b32 s6, 7, 0
    s_sub_u32 s38, s38, s6
    s_mul_i32 s38, s38, 128
    s_add_u32 s38, s38, s73
    buffer_load_dwordx4 v28, s[56:59], s38 offen lds
    v_mfma_f32_16x16x32_bf16 v[144:147], v[240:243], a[40:43], v[144:147]
    ds_read_b64_tr_b16 v[232:233], v21 offset:0
    ds_read_b64_tr_b16 v[234:235], v21 offset:1024
    v_mfma_f32_16x16x32_bf16 v[144:147], v[244:247], a[56:59], v[144:147]
    ds_read_b64_tr_b16 v[236:237], v21 offset:8192
    ds_read_b64_tr_b16 v[238:239], v21 offset:9216
    v_mfma_f32_16x16x32_bf16 v[152:155], v[240:243], a[44:47], v[152:155]
    ds_read_b128 a[72:75], v9 offset:20480
    v_mfma_f32_16x16x32_bf16 v[152:155], v[244:247], a[60:63], v[152:155]
    ds_read_b128 a[88:91], v10 offset:20480
    v_mfma_f32_16x16x32_bf16 v[132:135], v[248:251], a[32:35], v[132:135]
    ds_read_b128 a[76:79], v9 offset:22528
    v_mfma_f32_16x16x32_bf16 v[132:135], v[252:255], a[48:51], v[132:135]
    ds_read_b128 a[92:95], v10 offset:22528
    v_mfma_f32_16x16x32_bf16 v[140:143], v[248:251], a[36:39], v[140:143]
    buffer_load_dwordx4 v29, s[56:59], s38 offen offset:1024 lds
    v_mfma_f32_16x16x32_bf16 v[140:143], v[252:255], a[52:55], v[140:143]
    v_mfma_f32_16x16x32_bf16 v[148:151], v[248:251], a[40:43], v[148:151]
    buffer_load_dwordx4 v30, s[56:59], s38 offen offset:2048 lds
    v_mfma_f32_16x16x32_bf16 v[148:151], v[252:255], a[56:59], v[148:151]
    v_mfma_f32_16x16x32_bf16 v[156:159], v[248:251], a[44:47], v[156:159]
    v_mfma_f32_16x16x32_bf16 v[156:159], v[252:255], a[60:63], v[156:159]
    s_waitcnt lgkmcnt(0)
    v_mfma_f32_16x16x32_bf16 v[32:35], v[224:227], a[64:67], v[32:35]
    ds_read_b64_tr_b16 v[240:241], v22 offset:0
    ds_read_b64_tr_b16 v[242:243], v22 offset:1024
    v_mfma_f32_16x16x32_bf16 v[32:35], v[228:231], a[80:83], v[32:35]
    buffer_load_dwordx4 v31, s[56:59], s38 offen offset:3072 lds
    v_mfma_f32_16x16x32_bf16 v[40:43], v[224:227], a[68:71], v[40:43]
    ds_read_b64_tr_b16 v[244:245], v22 offset:8192
    s_add_u32 m0, s74, 12288
    v_mfma_f32_16x16x32_bf16 v[40:43], v[228:231], a[84:87], v[40:43]
    ds_read_b64_tr_b16 v[246:247], v22 offset:9216
    s_add_u32 s38, s38, 32768
    v_mfma_f32_16x16x32_bf16 v[48:51], v[224:227], a[72:75], v[48:51]
    ds_read_b64_tr_b16 v[248:249], v23 offset:0
    v_mfma_f32_16x16x32_bf16 v[48:51], v[228:231], a[88:91], v[48:51]
    buffer_load_dwordx4 v28, s[56:59], s38 offen lds
    v_mfma_f32_16x16x32_bf16 v[56:59], v[224:227], a[76:79], v[56:59]
    ds_read_b64_tr_b16 v[250:251], v23 offset:1024
    v_mfma_f32_16x16x32_bf16 v[56:59], v[228:231], a[92:95], v[56:59]
    ds_read_b64_tr_b16 v[252:253], v23 offset:8192
    v_mfma_f32_16x16x32_bf16 v[36:39], v[232:235], a[64:67], v[36:39]
    buffer_load_dwordx4 v29, s[56:59], s38 offen offset:1024 lds
    v_mfma_f32_16x16x32_bf16 v[36:39], v[236:239], a[80:83], v[36:39]
    ds_read_b64_tr_b16 v[254:255], v23 offset:9216
    v_mfma_f32_16x16x32_bf16 v[44:47], v[232:235], a[68:71], v[44:47]
    v_mfma_f32_16x16x32_bf16 v[44:47], v[236:239], a[84:87], v[44:47]
    buffer_load_dwordx4 v30, s[56:59], s38 offen offset:2048 lds
    v_mfma_f32_16x16x32_bf16 v[52:55], v[232:235], a[72:75], v[52:55]
    v_mfma_f32_16x16x32_bf16 v[52:55], v[236:239], a[88:91], v[52:55]
    v_mfma_f32_16x16x32_bf16 v[60:63], v[232:235], a[76:79], v[60:63]
    v_mfma_f32_16x16x32_bf16 v[60:63], v[236:239], a[92:95], v[60:63]
    s_waitcnt lgkmcnt(0)
    v_mfma_f32_16x16x32_bf16 v[64:67], v[240:243], a[64:67], v[64:67]
    ds_read_b64_tr_b16 v[224:225], v24 offset:0
    ds_read_b64_tr_b16 v[226:227], v24 offset:1024
    v_mfma_f32_16x16x32_bf16 v[64:67], v[244:247], a[80:83], v[64:67]
    buffer_load_dwordx4 v31, s[56:59], s38 offen offset:3072 lds
    v_mfma_f32_16x16x32_bf16 v[72:75], v[240:243], a[68:71], v[72:75]
    s_add_u32 s37, s72, 5
    s_cmp_ge_u32 s37, 8
    s_cselect_b32 s6, 7, 0
    s_sub_u32 s37, s37, s6
    s_mul_i32 s37, s37, 524288
    s_add_u32 m0, s33, 147456
    s_add_u32 s37, s37, s42
    buffer_load_dwordx4 v16, s[52:55], s37 offen lds
    v_mfma_f32_16x16x32_bf16 v[72:75], v[244:247], a[84:87], v[72:75]
    ds_read_b64_tr_b16 v[228:229], v24 offset:8192
    ds_read_b64_tr_b16 v[230:231], v24 offset:9216
    v_mfma_f32_16x16x32_bf16 v[80:83], v[240:243], a[72:75], v[80:83]
    ds_read_b64_tr_b16 v[232:233], v25 offset:0
    v_mfma_f32_16x16x32_bf16 v[80:83], v[244:247], a[88:91], v[80:83]
    v_mfma_f32_16x16x32_bf16 v[88:91], v[240:243], a[76:79], v[88:91]
    ds_read_b64_tr_b16 v[234:235], v25 offset:1024
    v_mfma_f32_16x16x32_bf16 v[88:91], v[244:247], a[92:95], v[88:91]
    buffer_load_dwordx4 v17, s[52:55], s37 offen offset:1024 lds
    v_mfma_f32_16x16x32_bf16 v[68:71], v[248:251], a[64:67], v[68:71]
    ds_read_b64_tr_b16 v[236:237], v25 offset:8192
    v_mfma_f32_16x16x32_bf16 v[68:71], v[252:255], a[80:83], v[68:71]
    buffer_load_dwordx4 v18, s[52:55], s37 offen offset:2048 lds
    s_lshl_b32 s48, s2, 2
    v_mfma_f32_16x16x32_bf16 v[76:79], v[248:251], a[68:71], v[76:79]
    ds_read_b64_tr_b16 v[238:239], v25 offset:9216
    s_add_u32 s48, s48, s14
    s_lshl_b32 s48, s48, 12
    v_mfma_f32_16x16x32_bf16 v[76:79], v[252:255], a[84:87], v[76:79]
    v_and_b32 v11, 15, v0
    v_lshlrev_b32 v11, 7, v11
    v_mfma_f32_16x16x32_bf16 v[84:87], v[248:251], a[72:75], v[84:87]
    buffer_load_dword v3, v11, s[20:23], s48 offen offset:0
    v_mfma_f32_16x16x32_bf16 v[84:87], v[252:255], a[88:91], v[84:87]
    v_mfma_f32_16x16x32_bf16 v[92:95], v[248:251], a[76:79], v[92:95]
    v_mfma_f32_16x16x32_bf16 v[92:95], v[252:255], a[92:95], v[92:95]
    s_waitcnt vmcnt(16) lgkmcnt(0)
    v_mfma_f32_16x16x32_bf16 v[96:99], v[224:227], a[64:67], v[96:99]
    ds_read_b64_tr_b16 v[240:241], v26 offset:0
    v_readfirstlane_b32 s70, v14
    v_mfma_f32_16x16x32_bf16 v[96:99], v[228:231], a[80:83], v[96:99]
    ds_read_b64_tr_b16 v[242:243], v26 offset:1024
    ds_read_b64_tr_b16 v[244:245], v26 offset:8192
    v_mfma_f32_16x16x32_bf16 v[104:107], v[224:227], a[68:71], v[104:107]
    buffer_load_dwordx4 v19, s[52:55], s37 offen offset:3072 lds
    v_mfma_f32_16x16x32_bf16 v[104:107], v[228:231], a[84:87], v[104:107]
    ds_read_b64_tr_b16 v[246:247], v26 offset:9216
    v_readfirstlane_b32 s71, v15
    v_mfma_f32_16x16x32_bf16 v[112:115], v[224:227], a[72:75], v[112:115]
    s_add_u32 m0, s74, 16384
    s_add_u32 s38, s72, 5
    s_cmp_ge_u32 s38, 8
    s_cselect_b32 s6, 7, 0
    s_sub_u32 s38, s38, s6
    s_mul_i32 s38, s38, 128
    s_add_u32 s38, s38, s73
    buffer_load_dwordx4 v28, s[56:59], s38 offen lds
    v_mfma_f32_16x16x32_bf16 v[112:115], v[228:231], a[88:91], v[112:115]
    ds_read_b64_tr_b16 v[248:249], v27 offset:0
    ds_read_b64_tr_b16 v[250:251], v27 offset:1024
    v_mfma_f32_16x16x32_bf16 v[120:123], v[224:227], a[76:79], v[120:123]
    ds_read_b64_tr_b16 v[252:253], v27 offset:8192
    s_nop 0
    v_mfma_f32_16x16x32_bf16 v[120:123], v[228:231], a[92:95], v[120:123]
    ds_read_b64_tr_b16 v[254:255], v27 offset:9216
    ds_read_b128 a[96:99], v9 offset:0
    v_mfma_f32_16x16x32_bf16 v[100:103], v[232:235], a[64:67], v[100:103]
    ds_read_b128 a[112:115], v10 offset:0
    s_mul_i32 s70, s70, 1664525
    v_mfma_f32_16x16x32_bf16 v[100:103], v[236:239], a[80:83], v[100:103]
    ds_read_b128 a[100:103], v9 offset:2048
    ds_read_b128 a[116:119], v10 offset:2048
    v_mfma_f32_16x16x32_bf16 v[108:111], v[232:235], a[68:71], v[108:111]
    s_add_u32 s70, s70, 1013904223
    v_mfma_f32_16x16x32_bf16 v[108:111], v[236:239], a[84:87], v[108:111]
    s_mul_i32 s71, s71, 1664525
    buffer_load_dwordx4 v29, s[56:59], s38 offen offset:1024 lds
    v_mfma_f32_16x16x32_bf16 v[116:119], v[232:235], a[72:75], v[116:119]
    s_add_u32 s71, s71, 1013904223
    v_mfma_f32_16x16x32_bf16 v[116:119], v[236:239], a[88:91], v[116:119]
    v_mfma_f32_16x16x32_bf16 v[124:127], v[232:235], a[76:79], v[124:127]
    v_mfma_f32_16x16x32_bf16 v[124:127], v[236:239], a[92:95], v[124:127]
    s_waitcnt vmcnt(27) lgkmcnt(0)
    v_mfma_f32_16x16x32_bf16 v[128:131], v[240:243], a[64:67], v[128:131]
    s_barrier
    ds_read_b64_tr_b16 v[224:225], v20 offset:16384
    ds_read_b64_tr_b16 v[226:227], v20 offset:17408
    v_mfma_f32_16x16x32_bf16 v[128:131], v[244:247], a[80:83], v[128:131]
    buffer_load_dwordx4 v30, s[56:59], s38 offen offset:2048 lds
    v_mfma_f32_16x16x32_bf16 v[136:139], v[240:243], a[68:71], v[136:139]
    ds_read_b64_tr_b16 v[228:229], v20 offset:24576
    ds_read_b64_tr_b16 v[230:231], v20 offset:25600
    v_mfma_f32_16x16x32_bf16 v[136:139], v[244:247], a[84:87], v[136:139]
    buffer_load_dwordx4 v31, s[56:59], s38 offen offset:3072 lds
    v_mfma_f32_16x16x32_bf16 v[144:147], v[240:243], a[72:75], v[144:147]
    ds_read_b64_tr_b16 v[232:233], v21 offset:16384
    ds_read_b64_tr_b16 v[234:235], v21 offset:17408
    v_mfma_f32_16x16x32_bf16 v[144:147], v[244:247], a[88:91], v[144:147]
    ds_read_b64_tr_b16 v[236:237], v21 offset:24576
    s_add_u32 m0, s74, 20480
    s_add_u32 s38, s38, 32768
    v_mfma_f32_16x16x32_bf16 v[152:155], v[240:243], a[76:79], v[152:155]
    ds_read_b64_tr_b16 v[238:239], v21 offset:25600
    ds_read_b128 a[104:107], v9 offset:4096
    v_mfma_f32_16x16x32_bf16 v[152:155], v[244:247], a[92:95], v[152:155]
    buffer_load_dwordx4 v28, s[56:59], s38 offen lds
    v_mfma_f32_16x16x32_bf16 v[132:135], v[248:251], a[64:67], v[132:135]
    ds_read_b128 a[120:123], v10 offset:4096
    ds_read_b128 a[108:111], v9 offset:6144
    v_mfma_f32_16x16x32_bf16 v[132:135], v[252:255], a[80:83], v[132:135]
    ds_read_b128 a[124:127], v10 offset:6144
    s_lshl_b32 s48, s15, 2
    s_add_u32 s48, s48, s68
    v_mfma_f32_16x16x32_bf16 v[140:143], v[248:251], a[68:71], v[140:143]
    v_mov_b32 v15, s70
    v_mfma_f32_16x16x32_bf16 v[140:143], v[252:255], a[84:87], v[140:143]
    v_mfma_f32_16x16x32_bf16 v[148:151], v[248:251], a[72:75], v[148:151]
    buffer_store_dword v15, v1, s[24:27], s48 offen offset:256 sc1
    v_mfma_f32_16x16x32_bf16 v[148:151], v[252:255], a[88:91], v[148:151]
    v_mfma_f32_16x16x32_bf16 v[156:159], v[248:251], a[76:79], v[156:159]
    v_mfma_f32_16x16x32_bf16 v[156:159], v[252:255], a[92:95], v[156:159]
    s_waitcnt lgkmcnt(0)
    v_mfma_f32_16x16x32_bf16 v[32:35], v[224:227], a[96:99], v[32:35]
    ds_read_b64_tr_b16 v[240:241], v22 offset:16384
    ds_read_b64_tr_b16 v[242:243], v22 offset:17408
    v_mfma_f32_16x16x32_bf16 v[32:35], v[228:231], a[112:115], v[32:35]
    buffer_load_dwordx4 v29, s[56:59], s38 offen offset:1024 lds
    v_mfma_f32_16x16x32_bf16 v[40:43], v[224:227], a[100:103], v[40:43]
    buffer_load_dwordx4 v30, s[56:59], s38 offen offset:2048 lds
    v_mfma_f32_16x16x32_bf16 v[40:43], v[228:231], a[116:119], v[40:43]
    ds_read_b64_tr_b16 v[244:245], v22 offset:24576
    ds_read_b64_tr_b16 v[246:247], v22 offset:25600
    v_mfma_f32_16x16x32_bf16 v[48:51], v[224:227], a[104:107], v[48:51]
    buffer_load_dwordx4 v31, s[56:59], s38 offen offset:3072 lds
    v_mfma_f32_16x16x32_bf16 v[48:51], v[228:231], a[120:123], v[48:51]
    s_add_u32 s37, s72, 6
    s_cmp_ge_u32 s37, 8
    s_cselect_b32 s6, 7, 0
    s_sub_u32 s37, s37, s6
    s_mul_i32 s37, s37, 524288
    s_add_u32 m0, s33, 98304
    s_add_u32 s37, s37, s42
    buffer_load_dwordx4 v16, s[52:55], s37 offen lds
    v_mfma_f32_16x16x32_bf16 v[56:59], v[224:227], a[108:111], v[56:59]
    ds_read_b64_tr_b16 v[248:249], v23 offset:16384
    ds_read_b64_tr_b16 v[250:251], v23 offset:17408
    v_mfma_f32_16x16x32_bf16 v[56:59], v[228:231], a[124:127], v[56:59]
    ds_read_b64_tr_b16 v[252:253], v23 offset:24576
    v_mfma_f32_16x16x32_bf16 v[36:39], v[232:235], a[96:99], v[36:39]
    v_mfma_f32_16x16x32_bf16 v[36:39], v[236:239], a[112:115], v[36:39]
    ds_read_b64_tr_b16 v[254:255], v23 offset:25600
    s_lshl_b32 s48, s2, 2
    s_add_u32 s48, s48, s14
    v_mfma_f32_16x16x32_bf16 v[44:47], v[232:235], a[100:103], v[44:47]
    s_lshl_b32 s48, s48, 12
    v_and_b32 v11, 15, v0
    v_mfma_f32_16x16x32_bf16 v[44:47], v[236:239], a[116:119], v[44:47]
    v_lshlrev_b32 v11, 7, v11
    v_mfma_f32_16x16x32_bf16 v[52:55], v[232:235], a[104:107], v[52:55]
    buffer_load_dword v3, v11, s[20:23], s48 offen offset:2048
    v_mfma_f32_16x16x32_bf16 v[52:55], v[236:239], a[120:123], v[52:55]
    v_mfma_f32_16x16x32_bf16 v[60:63], v[232:235], a[108:111], v[60:63]
    v_mfma_f32_16x16x32_bf16 v[60:63], v[236:239], a[124:127], v[60:63]
    s_waitcnt lgkmcnt(0)
    v_mfma_f32_16x16x32_bf16 v[64:67], v[240:243], a[96:99], v[64:67]
    ds_read_b64_tr_b16 v[224:225], v24 offset:16384
    ds_read_b64_tr_b16 v[226:227], v24 offset:17408
    v_mfma_f32_16x16x32_bf16 v[64:67], v[244:247], a[112:115], v[64:67]
    buffer_load_dwordx4 v17, s[52:55], s37 offen offset:1024 lds
    v_mfma_f32_16x16x32_bf16 v[72:75], v[240:243], a[100:103], v[72:75]
    ds_read_b64_tr_b16 v[228:229], v24 offset:24576
    v_mfma_f32_16x16x32_bf16 v[72:75], v[244:247], a[116:119], v[72:75]
    ds_read_b64_tr_b16 v[230:231], v24 offset:25600
    v_mfma_f32_16x16x32_bf16 v[80:83], v[240:243], a[104:107], v[80:83]
    ds_read_b64_tr_b16 v[232:233], v25 offset:16384
    v_mfma_f32_16x16x32_bf16 v[80:83], v[244:247], a[120:123], v[80:83]
    buffer_load_dwordx4 v18, s[52:55], s37 offen offset:2048 lds
    v_mfma_f32_16x16x32_bf16 v[88:91], v[240:243], a[108:111], v[88:91]
    ds_read_b64_tr_b16 v[234:235], v25 offset:17408
    v_mfma_f32_16x16x32_bf16 v[88:91], v[244:247], a[124:127], v[88:91]
    ds_read_b64_tr_b16 v[236:237], v25 offset:24576
    v_mfma_f32_16x16x32_bf16 v[68:71], v[248:251], a[96:99], v[68:71]
    v_mfma_f32_16x16x32_bf16 v[68:71], v[252:255], a[112:115], v[68:71]
    ds_read_b64_tr_b16 v[238:239], v25 offset:25600
    v_mfma_f32_16x16x32_bf16 v[76:79], v[248:251], a[100:103], v[76:79]
    buffer_load_dwordx4 v19, s[52:55], s37 offen offset:3072 lds
    v_mfma_f32_16x16x32_bf16 v[76:79], v[252:255], a[116:119], v[76:79]
    v_mfma_f32_16x16x32_bf16 v[84:87], v[248:251], a[104:107], v[84:87]
    v_mfma_f32_16x16x32_bf16 v[84:87], v[252:255], a[120:123], v[84:87]
    v_mfma_f32_16x16x32_bf16 v[92:95], v[248:251], a[108:111], v[92:95]
    v_mfma_f32_16x16x32_bf16 v[92:95], v[252:255], a[124:127], v[92:95]
    s_waitcnt vmcnt(19) lgkmcnt(0)
    v_mfma_f32_16x16x32_bf16 v[96:99], v[224:227], a[96:99], v[96:99]
    ds_read_b64_tr_b16 v[240:241], v26 offset:16384
    ds_read_b64_tr_b16 v[242:243], v26 offset:17408
    v_mfma_f32_16x16x32_bf16 v[96:99], v[228:231], a[112:115], v[96:99]
    s_add_u32 m0, s74, 0
    s_add_u32 s38, s72, 6
    s_cmp_ge_u32 s38, 8
    s_cselect_b32 s6, 7, 0
    s_sub_u32 s38, s38, s6
    s_mul_i32 s38, s38, 128
    s_add_u32 s38, s38, s73
    buffer_load_dwordx4 v28, s[56:59], s38 offen lds
    v_mfma_f32_16x16x32_bf16 v[104:107], v[224:227], a[100:103], v[104:107]
    ds_read_b64_tr_b16 v[244:245], v26 offset:24576
    ds_read_b64_tr_b16 v[246:247], v26 offset:25600
    v_mfma_f32_16x16x32_bf16 v[104:107], v[228:231], a[116:119], v[104:107]
    ds_read_b64_tr_b16 v[248:249], v27 offset:16384
    ds_read_b64_tr_b16 v[250:251], v27 offset:17408
    v_mfma_f32_16x16x32_bf16 v[112:115], v[224:227], a[104:107], v[112:115]
    ds_read_b64_tr_b16 v[252:253], v27 offset:24576
    v_mfma_f32_16x16x32_bf16 v[112:115], v[228:231], a[120:123], v[112:115]
    ds_read_b64_tr_b16 v[254:255], v27 offset:25600
    v_mfma_f32_16x16x32_bf16 v[120:123], v[224:227], a[108:111], v[120:123]
    ds_read_b128 a[128:131], v9 offset:8192
    v_mfma_f32_16x16x32_bf16 v[120:123], v[228:231], a[124:127], v[120:123]
    ds_read_b128 a[144:147], v10 offset:8192
    v_mfma_f32_16x16x32_bf16 v[100:103], v[232:235], a[96:99], v[100:103]
    ds_read_b128 a[132:135], v9 offset:10240
    v_mfma_f32_16x16x32_bf16 v[100:103], v[236:239], a[112:115], v[100:103]
    buffer_load_dwordx4 v29, s[56:59], s38 offen offset:1024 lds
    v_mfma_f32_16x16x32_bf16 v[108:111], v[232:235], a[100:103], v[108:111]
    ds_read_b128 a[148:151], v10 offset:10240
    v_mfma_f32_16x16x32_bf16 v[108:111], v[236:239], a[116:119], v[108:111]
    buffer_load_dwordx4 v30, s[56:59], s38 offen offset:2048 lds
    v_mfma_f32_16x16x32_bf16 v[116:119], v[232:235], a[104:107], v[116:119]
    v_mfma_f32_16x16x32_bf16 v[116:119], v[236:239], a[120:123], v[116:119]
    v_mfma_f32_16x16x32_bf16 v[124:127], v[232:235], a[108:111], v[124:127]
    v_mfma_f32_16x16x32_bf16 v[124:127], v[236:239], a[124:127], v[124:127]
    s_waitcnt vmcnt(30) lgkmcnt(0)
    v_mfma_f32_16x16x32_bf16 v[128:131], v[240:243], a[96:99], v[128:131]
    s_barrier
    ds_read_b64_tr_b16 v[224:225], v20 offset:32768
    ds_read_b64_tr_b16 v[226:227], v20 offset:33792
    v_mfma_f32_16x16x32_bf16 v[128:131], v[244:247], a[112:115], v[128:131]
    buffer_load_dwordx4 v31, s[56:59], s38 offen offset:3072 lds
    v_mfma_f32_16x16x32_bf16 v[136:139], v[240:243], a[100:103], v[136:139]
    ds_read_b64_tr_b16 v[228:229], v20 offset:40960
    ds_read_b64_tr_b16 v[230:231], v20 offset:41984
    v_mfma_f32_16x16x32_bf16 v[136:139], v[244:247], a[116:119], v[136:139]
    ds_read_b64_tr_b16 v[232:233], v21 offset:32768
    s_add_u32 m0, s74, 4096
    v_mfma_f32_16x16x32_bf16 v[144:147], v[240:243], a[104:107], v[144:147]
    ds_read_b64_tr_b16 v[234:235], v21 offset:33792
    ds_read_b64_tr_b16 v[236:237], v21 offset:40960
    v_mfma_f32_16x16x32_bf16 v[144:147], v[244:247], a[120:123], v[144:147]
    ds_read_b64_tr_b16 v[238:239], v21 offset:41984
    s_add_u32 s38, s38, 32768
    v_mfma_f32_16x16x32_bf16 v[152:155], v[240:243], a[108:111], v[152:155]
    buffer_load_dwordx4 v28, s[56:59], s38 offen lds
    v_mfma_f32_16x16x32_bf16 v[152:155], v[244:247], a[124:127], v[152:155]
    ds_read_b128 a[136:139], v9 offset:12288
    ds_read_b128 a[152:155], v10 offset:12288
    v_mfma_f32_16x16x32_bf16 v[132:135], v[248:251], a[96:99], v[132:135]
    ds_read_b128 a[140:143], v9 offset:14336
    v_mfma_f32_16x16x32_bf16 v[132:135], v[252:255], a[112:115], v[132:135]
    ds_read_b128 a[156:159], v10 offset:14336
    v_mfma_f32_16x16x32_bf16 v[140:143], v[248:251], a[100:103], v[140:143]
    buffer_load_dwordx4 v29, s[56:59], s38 offen offset:1024 lds
    v_mfma_f32_16x16x32_bf16 v[140:143], v[252:255], a[116:119], v[140:143]
    v_mfma_f32_16x16x32_bf16 v[148:151], v[248:251], a[104:107], v[148:151]
    v_mfma_f32_16x16x32_bf16 v[148:151], v[252:255], a[120:123], v[148:151]
    v_mfma_f32_16x16x32_bf16 v[156:159], v[248:251], a[108:111], v[156:159]
    v_mfma_f32_16x16x32_bf16 v[156:159], v[252:255], a[124:127], v[156:159]
    s_waitcnt lgkmcnt(0)
    v_mfma_f32_16x16x32_bf16 v[32:35], v[224:227], a[128:131], v[32:35]
    ds_read_b64_tr_b16 v[240:241], v22 offset:32768
    ds_read_b64_tr_b16 v[242:243], v22 offset:33792
    v_mfma_f32_16x16x32_bf16 v[32:35], v[228:231], a[144:147], v[32:35]
    buffer_load_dwordx4 v30, s[56:59], s38 offen offset:2048 lds
    v_mfma_f32_16x16x32_bf16 v[40:43], v[224:227], a[132:135], v[40:43]
    ds_read_b64_tr_b16 v[244:245], v22 offset:40960
    v_mfma_f32_16x16x32_bf16 v[40:43], v[228:231], a[148:151], v[40:43]
    buffer_load_dwordx4 v31, s[56:59], s38 offen offset:3072 lds
    v_mfma_f32_16x16x32_bf16 v[48:51], v[224:227], a[136:139], v[48:51]
    ds_read_b64_tr_b16 v[246:247], v22 offset:41984
    ds_read_b64_tr_b16 v[248:249], v23 offset:32768
    v_mfma_f32_16x16x32_bf16 v[48:51], v[228:231], a[152:155], v[48:51]
    s_add_u32 s37, s72, 7
    s_cmp_ge_u32 s37, 8
    s_cselect_b32 s6, 7, 0
    s_sub_u32 s37, s37, s6
    s_mul_i32 s37, s37, 524288
    s_add_u32 m0, s33, 114688
    s_add_u32 s37, s37, s42
    buffer_load_dwordx4 v16, s[52:55], s37 offen lds
    v_mfma_f32_16x16x32_bf16 v[56:59], v[224:227], a[140:143], v[56:59]
    ds_read_b64_tr_b16 v[250:251], v23 offset:33792
    v_mfma_f32_16x16x32_bf16 v[56:59], v[228:231], a[156:159], v[56:59]
    ds_read_b64_tr_b16 v[252:253], v23 offset:40960
    v_mfma_f32_16x16x32_bf16 v[36:39], v[232:235], a[128:131], v[36:39]
    v_mfma_f32_16x16x32_bf16 v[36:39], v[236:239], a[144:147], v[36:39]
    ds_read_b64_tr_b16 v[254:255], v23 offset:41984
    v_mfma_f32_16x16x32_bf16 v[44:47], v[232:235], a[132:135], v[44:47]
    v_mfma_f32_16x16x32_bf16 v[44:47], v[236:239], a[148:151], v[44:47]
    v_mfma_f32_16x16x32_bf16 v[52:55], v[232:235], a[136:139], v[52:55]
    buffer_load_dwordx4 v17, s[52:55], s37 offen offset:1024 lds
    v_mfma_f32_16x16x32_bf16 v[52:55], v[236:239], a[152:155], v[52:55]
    v_mfma_f32_16x16x32_bf16 v[60:63], v[232:235], a[140:143], v[60:63]
    v_mfma_f32_16x16x32_bf16 v[60:63], v[236:239], a[156:159], v[60:63]
    s_waitcnt lgkmcnt(0)
    v_mfma_f32_16x16x32_bf16 v[64:67], v[240:243], a[128:131], v[64:67]
    ds_read_b64_tr_b16 v[224:225], v24 offset:32768
    ds_read_b64_tr_b16 v[226:227], v24 offset:33792
    v_mfma_f32_16x16x32_bf16 v[64:67], v[244:247], a[144:147], v[64:67]
    buffer_load_dwordx4 v18, s[52:55], s37 offen offset:2048 lds
    v_mfma_f32_16x16x32_bf16 v[72:75], v[240:243], a[132:135], v[72:75]
    ds_read_b64_tr_b16 v[228:229], v24 offset:40960
    v_mfma_f32_16x16x32_bf16 v[72:75], v[244:247], a[148:151], v[72:75]
    buffer_load_dwordx4 v19, s[52:55], s37 offen offset:3072 lds
    v_mfma_f32_16x16x32_bf16 v[80:83], v[240:243], a[136:139], v[80:83]
    ds_read_b64_tr_b16 v[230:231], v24 offset:41984
    ds_read_b64_tr_b16 v[232:233], v25 offset:32768
    v_mfma_f32_16x16x32_bf16 v[80:83], v[244:247], a[152:155], v[80:83]
    s_add_u32 m0, s74, 8192
    s_add_u32 s38, s72, 7
    s_cmp_ge_u32 s38, 8
    s_cselect_b32 s6, 7, 0
    s_sub_u32 s38, s38, s6
    s_mul_i32 s38, s38, 128
    s_add_u32 s38, s38, s73
    buffer_load_dwordx4 v28, s[56:59], s38 offen lds
    v_mfma_f32_16x16x32_bf16 v[88:91], v[240:243], a[140:143], v[88:91]
    ds_read_b64_tr_b16 v[234:235], v25 offset:33792
    v_mfma_f32_16x16x32_bf16 v[88:91], v[244:247], a[156:159], v[88:91]
    ds_read_b64_tr_b16 v[236:237], v25 offset:40960
    v_mfma_f32_16x16x32_bf16 v[68:71], v[248:251], a[128:131], v[68:71]
    v_mfma_f32_16x16x32_bf16 v[68:71], v[252:255], a[144:147], v[68:71]
    ds_read_b64_tr_b16 v[238:239], v25 offset:41984
    v_mfma_f32_16x16x32_bf16 v[76:79], v[248:251], a[132:135], v[76:79]
    v_mfma_f32_16x16x32_bf16 v[76:79], v[252:255], a[148:151], v[76:79]
    v_mfma_f32_16x16x32_bf16 v[84:87], v[248:251], a[136:139], v[84:87]
    v_mfma_f32_16x16x32_bf16 v[84:87], v[252:255], a[152:155], v[84:87]
    v_mfma_f32_16x16x32_bf16 v[92:95], v[248:251], a[140:143], v[92:95]
    v_mfma_f32_16x16x32_bf16 v[92:95], v[252:255], a[156:159], v[92:95]
    s_waitcnt vmcnt(18) lgkmcnt(0)
    v_mfma_f32_16x16x32_bf16 v[96:99], v[224:227], a[128:131], v[96:99]
    ds_read_b64_tr_b16 v[240:241], v26 offset:32768
    ds_read_b64_tr_b16 v[242:243], v26 offset:33792
    v_mfma_f32_16x16x32_bf16 v[96:99], v[228:231], a[144:147], v[96:99]
    buffer_load_dwordx4 v29, s[56:59], s38 offen offset:1024 lds
    v_mfma_f32_16x16x32_bf16 v[104:107], v[224:227], a[132:135], v[104:107]
    ds_read_b64_tr_b16 v[244:245], v26 offset:40960
    ds_read_b64_tr_b16 v[246:247], v26 offset:41984
    v_mfma_f32_16x16x32_bf16 v[104:107], v[228:231], a[148:151], v[104:107]
    ds_read_b64_tr_b16 v[248:249], v27 offset:32768
    ds_read_b64_tr_b16 v[250:251], v27 offset:33792
    v_mfma_f32_16x16x32_bf16 v[112:115], v[224:227], a[136:139], v[112:115]
    ds_read_b64_tr_b16 v[252:253], v27 offset:40960
    v_mfma_f32_16x16x32_bf16 v[112:115], v[228:231], a[152:155], v[112:115]
    buffer_load_dwordx4 v30, s[56:59], s38 offen offset:2048 lds
    v_mfma_f32_16x16x32_bf16 v[120:123], v[224:227], a[140:143], v[120:123]
    ds_read_b64_tr_b16 v[254:255], v27 offset:41984
    ds_read_b128 a[160:163], v9 offset:16384
    v_mfma_f32_16x16x32_bf16 v[120:123], v[228:231], a[156:159], v[120:123]
    ds_read_b128 a[176:179], v10 offset:16384
    v_mfma_f32_16x16x32_bf16 v[100:103], v[232:235], a[128:131], v[100:103]
    ds_read_b128 a[164:167], v9 offset:18432
    v_mfma_f32_16x16x32_bf16 v[100:103], v[236:239], a[144:147], v[100:103]
    ds_read_b128 a[180:183], v10 offset:18432
    v_mfma_f32_16x16x32_bf16 v[108:111], v[232:235], a[132:135], v[108:111]
    buffer_load_dwordx4 v31, s[56:59], s38 offen offset:3072 lds
    v_mfma_f32_16x16x32_bf16 v[108:111], v[236:239], a[148:151], v[108:111]
    v_mfma_f32_16x16x32_bf16 v[116:119], v[232:235], a[136:139], v[116:119]
    v_mfma_f32_16x16x32_bf16 v[116:119], v[236:239], a[152:155], v[116:119]
    v_mfma_f32_16x16x32_bf16 v[124:127], v[232:235], a[140:143], v[124:127]
    v_mfma_f32_16x16x32_bf16 v[124:127], v[236:239], a[156:159], v[124:127]
    s_waitcnt vmcnt(30) lgkmcnt(0)
    v_mfma_f32_16x16x32_bf16 v[128:131], v[240:243], a[128:131], v[128:131]
    s_barrier
    ds_read_b64_tr_b16 v[224:225], v20 offset:49152
    ds_read_b64_tr_b16 v[226:227], v20 offset:50176
    v_mfma_f32_16x16x32_bf16 v[128:131], v[244:247], a[144:147], v[128:131]
    ds_read_b64_tr_b16 v[228:229], v20 offset:57344
    s_add_u32 m0, s74, 12288
    s_add_u32 s38, s38, 32768
    v_mfma_f32_16x16x32_bf16 v[136:139], v[240:243], a[132:135], v[136:139]
    ds_read_b64_tr_b16 v[230:231], v20 offset:58368
    ds_read_b64_tr_b16 v[232:233], v21 offset:49152
    v_mfma_f32_16x16x32_bf16 v[136:139], v[244:247], a[148:151], v[136:139]
    buffer_load_dwordx4 v28, s[56:59], s38 offen lds
    v_mfma_f32_16x16x32_bf16 v[144:147], v[240:243], a[136:139], v[144:147]
    ds_read_b64_tr_b16 v[234:235], v21 offset:50176
    ds_read_b64_tr_b16 v[236:237], v21 offset:57344
    v_mfma_f32_16x16x32_bf16 v[144:147], v[244:247], a[152:155], v[144:147]
    ds_read_b64_tr_b16 v[238:239], v21 offset:58368
    v_mfma_f32_16x16x32_bf16 v[152:155], v[240:243], a[140:143], v[152:155]
    buffer_load_dwordx4 v29, s[56:59], s38 offen offset:1024 lds
    v_mfma_f32_16x16x32_bf16 v[152:155], v[244:247], a[156:159], v[152:155]
    ds_read_b128 a[168:171], v9 offset:20480
    ds_read_b128 a[184:187], v10 offset:20480
    v_mfma_f32_16x16x32_bf16 v[132:135], v[248:251], a[128:131], v[132:135]
    ds_read_b128 a[172:175], v9 offset:22528
    v_mfma_f32_16x16x32_bf16 v[132:135], v[252:255], a[144:147], v[132:135]
    ds_read_b128 a[188:191], v10 offset:22528
    v_mfma_f32_16x16x32_bf16 v[140:143], v[248:251], a[132:135], v[140:143]
    buffer_load_dwordx4 v30, s[56:59], s38 offen offset:2048 lds
    v_mfma_f32_16x16x32_bf16 v[140:143], v[252:255], a[148:151], v[140:143]
    v_mfma_f32_16x16x32_bf16 v[148:151], v[248:251], a[136:139], v[148:151]
    v_mfma_f32_16x16x32_bf16 v[148:151], v[252:255], a[152:155], v[148:151]
    v_mfma_f32_16x16x32_bf16 v[156:159], v[248:251], a[140:143], v[156:159]
    v_mfma_f32_16x16x32_bf16 v[156:159], v[252:255], a[156:159], v[156:159]
    s_waitcnt lgkmcnt(0)
    v_mfma_f32_16x16x32_bf16 v[32:35], v[224:227], a[160:163], v[32:35]
    ds_read_b64_tr_b16 v[240:241], v22 offset:49152
    ds_read_b64_tr_b16 v[242:243], v22 offset:50176
    v_mfma_f32_16x16x32_bf16 v[32:35], v[228:231], a[176:179], v[32:35]
    buffer_load_dwordx4 v31, s[56:59], s38 offen offset:3072 lds
    v_mfma_f32_16x16x32_bf16 v[40:43], v[224:227], a[164:167], v[40:43]
    ds_read_b64_tr_b16 v[244:245], v22 offset:57344
    v_mfma_f32_16x16x32_bf16 v[40:43], v[228:231], a[180:183], v[40:43]
    ds_read_b64_tr_b16 v[246:247], v22 offset:58368
    s_mov_b32 s37, 0
    v_mfma_f32_16x16x32_bf16 v[48:51], v[224:227], a[168:171], v[48:51]
    ds_read_b64_tr_b16 v[248:249], v23 offset:49152
    s_add_u32 m0, s33, 131072
    v_mfma_f32_16x16x32_bf16 v[48:51], v[228:231], a[184:187], v[48:51]
    s_add_u32 s37, s37, s42
    v_mfma_f32_16x16x32_bf16 v[56:59], v[224:227], a[172:175], v[56:59]
    ds_read_b64_tr_b16 v[250:251], v23 offset:50176
    v_mfma_f32_16x16x32_bf16 v[56:59], v[228:231], a[188:191], v[56:59]
    buffer_load_dwordx4 v16, s[60:63], s37 offen lds
    v_mfma_f32_16x16x32_bf16 v[36:39], v[232:235], a[160:163], v[36:39]
    ds_read_b64_tr_b16 v[252:253], v23 offset:57344
    v_mfma_f32_16x16x32_bf16 v[36:39], v[236:239], a[176:179], v[36:39]
    ds_read_b64_tr_b16 v[254:255], v23 offset:58368
    v_mfma_f32_16x16x32_bf16 v[44:47], v[232:235], a[164:167], v[44:47]
    buffer_load_dwordx4 v17, s[60:63], s37 offen offset:1024 lds
    v_mfma_f32_16x16x32_bf16 v[44:47], v[236:239], a[180:183], v[44:47]
    v_mfma_f32_16x16x32_bf16 v[52:55], v[232:235], a[168:171], v[52:55]
    v_mfma_f32_16x16x32_bf16 v[52:55], v[236:239], a[184:187], v[52:55]
    v_mfma_f32_16x16x32_bf16 v[60:63], v[232:235], a[172:175], v[60:63]
    v_mfma_f32_16x16x32_bf16 v[60:63], v[236:239], a[188:191], v[60:63]
    s_waitcnt lgkmcnt(0)
    v_mfma_f32_16x16x32_bf16 v[64:67], v[240:243], a[160:163], v[64:67]
    ds_read_b64_tr_b16 v[224:225], v24 offset:49152
    ds_read_b64_tr_b16 v[226:227], v24 offset:50176
    v_mfma_f32_16x16x32_bf16 v[64:67], v[244:247], a[176:179], v[64:67]
    buffer_load_dwordx4 v18, s[60:63], s37 offen offset:2048 lds
    v_mfma_f32_16x16x32_bf16 v[72:75], v[240:243], a[164:167], v[72:75]
    ds_read_b64_tr_b16 v[228:229], v24 offset:57344
    v_mfma_f32_16x16x32_bf16 v[72:75], v[244:247], a[180:183], v[72:75]
    ds_read_b64_tr_b16 v[230:231], v24 offset:58368
    v_mfma_f32_16x16x32_bf16 v[80:83], v[240:243], a[168:171], v[80:83]
    ds_read_b64_tr_b16 v[232:233], v25 offset:49152
    v_mfma_f32_16x16x32_bf16 v[80:83], v[244:247], a[184:187], v[80:83]
    v_mfma_f32_16x16x32_bf16 v[88:91], v[240:243], a[172:175], v[88:91]
    ds_read_b64_tr_b16 v[234:235], v25 offset:50176
    v_mfma_f32_16x16x32_bf16 v[88:91], v[244:247], a[188:191], v[88:91]
    buffer_load_dwordx4 v19, s[60:63], s37 offen offset:3072 lds
    v_mfma_f32_16x16x32_bf16 v[68:71], v[248:251], a[160:163], v[68:71]
    ds_read_b64_tr_b16 v[236:237], v25 offset:57344
    v_mfma_f32_16x16x32_bf16 v[68:71], v[252:255], a[176:179], v[68:71]
    ds_read_b64_tr_b16 v[238:239], v25 offset:58368
    v_mfma_f32_16x16x32_bf16 v[76:79], v[248:251], a[164:167], v[76:79]
    v_mfma_f32_16x16x32_bf16 v[76:79], v[252:255], a[180:183], v[76:79]
    v_mfma_f32_16x16x32_bf16 v[84:87], v[248:251], a[168:171], v[84:87]
    v_mfma_f32_16x16x32_bf16 v[84:87], v[252:255], a[184:187], v[84:87]
    v_mfma_f32_16x16x32_bf16 v[92:95], v[248:251], a[172:175], v[92:95]
    v_mfma_f32_16x16x32_bf16 v[92:95], v[252:255], a[188:191], v[92:95]
    s_waitcnt vmcnt(16) lgkmcnt(0)
    v_mfma_f32_16x16x32_bf16 v[96:99], v[224:227], a[160:163], v[96:99]
    ds_read_b64_tr_b16 v[240:241], v26 offset:49152
    ds_read_b64_tr_b16 v[242:243], v26 offset:50176
    v_mfma_f32_16x16x32_bf16 v[96:99], v[228:231], a[176:179], v[96:99]
    ds_read_b64_tr_b16 v[244:245], v26 offset:57344
    ds_read_b64_tr_b16 v[246:247], v26 offset:58368
    v_mfma_f32_16x16x32_bf16 v[104:107], v[224:227], a[164:167], v[104:107]
    ds_read_b64_tr_b16 v[248:249], v27 offset:49152
    v_mfma_f32_16x16x32_bf16 v[104:107], v[228:231], a[180:183], v[104:107]
    ds_read_b64_tr_b16 v[250:251], v27 offset:50176
    v_mfma_f32_16x16x32_bf16 v[112:115], v[224:227], a[168:171], v[112:115]
    ds_read_b64_tr_b16 v[252:253], v27 offset:57344
    v_mfma_f32_16x16x32_bf16 v[112:115], v[228:231], a[184:187], v[112:115]
    ds_read_b64_tr_b16 v[254:255], v27 offset:58368
    v_mfma_f32_16x16x32_bf16 v[120:123], v[224:227], a[172:175], v[120:123]
    ds_read_b128 a[192:195], v9 offset:0
    v_mfma_f32_16x16x32_bf16 v[120:123], v[228:231], a[188:191], v[120:123]
    ds_read_b128 a[208:211], v10 offset:0
    v_mfma_f32_16x16x32_bf16 v[100:103], v[232:235], a[160:163], v[100:103]
    ds_read_b128 a[196:199], v9 offset:2048
    v_mfma_f32_16x16x32_bf16 v[100:103], v[236:239], a[176:179], v[100:103]
    ds_read_b128 a[212:215], v10 offset:2048
    v_mfma_f32_16x16x32_bf16 v[108:111], v[232:235], a[164:167], v[108:111]
    v_mfma_f32_16x16x32_bf16 v[108:111], v[236:239], a[180:183], v[108:111]
    v_mfma_f32_16x16x32_bf16 v[116:119], v[232:235], a[168:171], v[116:119]
    v_mfma_f32_16x16x32_bf16 v[116:119], v[236:239], a[184:187], v[116:119]
    v_mfma_f32_16x16x32_bf16 v[124:127], v[232:235], a[172:175], v[124:127]
    v_mfma_f32_16x16x32_bf16 v[124:127], v[236:239], a[188:191], v[124:127]
    s_waitcnt vmcnt(24) lgkmcnt(0)
    v_mfma_f32_16x16x32_bf16 v[128:131], v[240:243], a[160:163], v[128:131]
    s_barrier
    ds_read_b64_tr_b16 v[224:225], v20 offset:0
    ds_read_b64_tr_b16 v[226:227], v20 offset:1024
    v_mfma_f32_16x16x32_bf16 v[128:131], v[244:247], a[176:179], v[128:131]
    s_add_u32 s37, s72, 1
    s_cmp_ge_u32 s37, 8
    s_cselect_b32 s6, 7, 0
    s_sub_u32 s37, s37, s6
    s_mul_i32 s37, s37, 524288
    s_add_u32 m0, s33, 147456
    s_add_u32 s37, s37, s42
    buffer_load_dwordx4 v16, s[60:63], s37 offen lds
    v_mfma_f32_16x16x32_bf16 v[136:139], v[240:243], a[164:167], v[136:139]
    ds_read_b64_tr_b16 v[228:229], v20 offset:8192
    ds_read_b64_tr_b16 v[230:231], v20 offset:9216
    v_mfma_f32_16x16x32_bf16 v[136:139], v[244:247], a[180:183], v[136:139]
    ds_read_b64_tr_b16 v[232:233], v21 offset:0
    ds_read_b64_tr_b16 v[234:235], v21 offset:1024
    v_mfma_f32_16x16x32_bf16 v[144:147], v[240:243], a[168:171], v[144:147]
    ds_read_b64_tr_b16 v[236:237], v21 offset:8192
    v_mfma_f32_16x16x32_bf16 v[144:147], v[244:247], a[184:187], v[144:147]
    ds_read_b64_tr_b16 v[238:239], v21 offset:9216
    v_mfma_f32_16x16x32_bf16 v[152:155], v[240:243], a[172:175], v[152:155]
    ds_read_b128 a[200:203], v9 offset:4096
    v_mfma_f32_16x16x32_bf16 v[152:155], v[244:247], a[188:191], v[152:155]
    ds_read_b128 a[216:219], v10 offset:4096
    v_mfma_f32_16x16x32_bf16 v[132:135], v[248:251], a[160:163], v[132:135]
    ds_read_b128 a[204:207], v9 offset:6144
    v_mfma_f32_16x16x32_bf16 v[132:135], v[252:255], a[176:179], v[132:135]
    buffer_load_dwordx4 v17, s[60:63], s37 offen offset:1024 lds
    v_mfma_f32_16x16x32_bf16 v[140:143], v[248:251], a[164:167], v[140:143]
    ds_read_b128 a[220:223], v10 offset:6144
    v_mfma_f32_16x16x32_bf16 v[140:143], v[252:255], a[180:183], v[140:143]
    buffer_load_dwordx4 v18, s[60:63], s37 offen offset:2048 lds
    v_mfma_f32_16x16x32_bf16 v[148:151], v[248:251], a[168:171], v[148:151]
    v_mfma_f32_16x16x32_bf16 v[148:151], v[252:255], a[184:187], v[148:151]
    v_mfma_f32_16x16x32_bf16 v[156:159], v[248:251], a[172:175], v[156:159]
    v_mfma_f32_16x16x32_bf16 v[156:159], v[252:255], a[188:191], v[156:159]
    s_waitcnt lgkmcnt(0)
    v_mfma_f32_16x16x32_bf16 v[32:35], v[224:227], a[192:195], v[32:35]
    ds_read_b64_tr_b16 v[240:241], v22 offset:0
    ds_read_b64_tr_b16 v[242:243], v22 offset:1024
    v_mfma_f32_16x16x32_bf16 v[32:35], v[228:231], a[208:211], v[32:35]
    buffer_load_dwordx4 v19, s[60:63], s37 offen offset:3072 lds
    v_mfma_f32_16x16x32_bf16 v[40:43], v[224:227], a[196:199], v[40:43]
    ds_read_b64_tr_b16 v[244:245], v22 offset:8192
    v_mfma_f32_16x16x32_bf16 v[40:43], v[228:231], a[212:215], v[40:43]
    ds_read_b64_tr_b16 v[246:247], v22 offset:9216
    v_mfma_f32_16x16x32_bf16 v[48:51], v[224:227], a[200:203], v[48:51]
    ds_read_b64_tr_b16 v[248:249], v23 offset:0
    v_mfma_f32_16x16x32_bf16 v[48:51], v[228:231], a[216:219], v[48:51]
    v_mfma_f32_16x16x32_bf16 v[56:59], v[224:227], a[204:207], v[56:59]
    ds_read_b64_tr_b16 v[250:251], v23 offset:1024
    v_mfma_f32_16x16x32_bf16 v[56:59], v[228:231], a[220:223], v[56:59]
    ds_read_b64_tr_b16 v[252:253], v23 offset:8192
    v_mfma_f32_16x16x32_bf16 v[36:39], v[232:235], a[192:195], v[36:39]
    v_mfma_f32_16x16x32_bf16 v[36:39], v[236:239], a[208:211], v[36:39]
    ds_read_b64_tr_b16 v[254:255], v23 offset:9216
    v_mfma_f32_16x16x32_bf16 v[44:47], v[232:235], a[196:199], v[44:47]
    v_mfma_f32_16x16x32_bf16 v[44:47], v[236:239], a[212:215], v[44:47]
    v_mfma_f32_16x16x32_bf16 v[52:55], v[232:235], a[200:203], v[52:55]
    v_mfma_f32_16x16x32_bf16 v[52:55], v[236:239], a[216:219], v[52:55]
    v_mfma_f32_16x16x32_bf16 v[60:63], v[232:235], a[204:207], v[60:63]
    v_mfma_f32_16x16x32_bf16 v[60:63], v[236:239], a[220:223], v[60:63]
    s_waitcnt lgkmcnt(0)
    v_mfma_f32_16x16x32_bf16 v[64:67], v[240:243], a[192:195], v[64:67]
    ds_read_b64_tr_b16 v[224:225], v24 offset:0
    ds_read_b64_tr_b16 v[226:227], v24 offset:1024
    v_mfma_f32_16x16x32_bf16 v[64:67], v[244:247], a[208:211], v[64:67]
    ds_read_b64_tr_b16 v[228:229], v24 offset:8192
    v_mfma_f32_16x16x32_bf16 v[72:75], v[240:243], a[196:199], v[72:75]
    v_mfma_f32_16x16x32_bf16 v[72:75], v[244:247], a[212:215], v[72:75]
    ds_read_b64_tr_b16 v[230:231], v24 offset:9216
    v_mfma_f32_16x16x32_bf16 v[80:83], v[240:243], a[200:203], v[80:83]
    ds_read_b64_tr_b16 v[232:233], v25 offset:0
    v_mfma_f32_16x16x32_bf16 v[80:83], v[244:247], a[216:219], v[80:83]
    v_mfma_f32_16x16x32_bf16 v[88:91], v[240:243], a[204:207], v[88:91]
    ds_read_b64_tr_b16 v[234:235], v25 offset:1024
    v_mfma_f32_16x16x32_bf16 v[88:91], v[244:247], a[220:223], v[88:91]
    ds_read_b64_tr_b16 v[236:237], v25 offset:8192
    v_mfma_f32_16x16x32_bf16 v[68:71], v[248:251], a[192:195], v[68:71]
    v_mfma_f32_16x16x32_bf16 v[68:71], v[252:255], a[208:211], v[68:71]
    ds_read_b64_tr_b16 v[238:239], v25 offset:9216
    v_mfma_f32_16x16x32_bf16 v[76:79], v[248:251], a[196:199], v[76:79]
    v_mfma_f32_16x16x32_bf16 v[76:79], v[252:255], a[212:215], v[76:79]
    v_mfma_f32_16x16x32_bf16 v[84:87], v[248:251], a[200:203], v[84:87]
    v_mfma_f32_16x16x32_bf16 v[84:87], v[252:255], a[216:219], v[84:87]
    v_mfma_f32_16x16x32_bf16 v[92:95], v[248:251], a[204:207], v[92:95]
    v_mfma_f32_16x16x32_bf16 v[92:95], v[252:255], a[220:223], v[92:95]
    s_waitcnt vmcnt(8) lgkmcnt(0)
    v_mfma_f32_16x16x32_bf16 v[96:99], v[224:227], a[192:195], v[96:99]
    ds_read_b64_tr_b16 v[240:241], v26 offset:0
    ds_read_b64_tr_b16 v[242:243], v26 offset:1024
    v_mfma_f32_16x16x32_bf16 v[96:99], v[228:231], a[208:211], v[96:99]
    ds_read_b64_tr_b16 v[244:245], v26 offset:8192
    ds_read_b64_tr_b16 v[246:247], v26 offset:9216
    v_mfma_f32_16x16x32_bf16 v[104:107], v[224:227], a[196:199], v[104:107]
    ds_read_b64_tr_b16 v[248:249], v27 offset:0
    v_mfma_f32_16x16x32_bf16 v[104:107], v[228:231], a[212:215], v[104:107]
    ds_read_b64_tr_b16 v[250:251], v27 offset:1024
    v_mfma_f32_16x16x32_bf16 v[112:115], v[224:227], a[200:203], v[112:115]
    ds_read_b64_tr_b16 v[252:253], v27 offset:8192
    v_mfma_f32_16x16x32_bf16 v[112:115], v[228:231], a[216:219], v[112:115]
    ds_read_b64_tr_b16 v[254:255], v27 offset:9216
    v_mfma_f32_16x16x32_bf16 v[120:123], v[224:227], a[204:207], v[120:123]
    ds_read_b128 a[224:227], v9 offset:8192
    v_mfma_f32_16x16x32_bf16 v[120:123], v[228:231], a[220:223], v[120:123]
    ds_read_b128 a[240:243], v10 offset:8192
    v_mfma_f32_16x16x32_bf16 v[100:103], v[232:235], a[192:195], v[100:103]
    ds_read_b128 a[228:231], v9 offset:10240
    v_mfma_f32_16x16x32_bf16 v[100:103], v[236:239], a[208:211], v[100:103]
    ds_read_b128 a[244:247], v10 offset:10240
    v_mfma_f32_16x16x32_bf16 v[108:111], v[232:235], a[196:199], v[108:111]
    v_mfma_f32_16x16x32_bf16 v[108:111], v[236:239], a[212:215], v[108:111]
    v_mfma_f32_16x16x32_bf16 v[116:119], v[232:235], a[200:203], v[116:119]
    v_mfma_f32_16x16x32_bf16 v[116:119], v[236:239], a[216:219], v[116:119]
    v_mfma_f32_16x16x32_bf16 v[124:127], v[232:235], a[204:207], v[124:127]
    v_mfma_f32_16x16x32_bf16 v[124:127], v[236:239], a[220:223], v[124:127]
    s_waitcnt vmcnt(16) lgkmcnt(0)
    v_mfma_f32_16x16x32_bf16 v[128:131], v[240:243], a[192:195], v[128:131]
    s_barrier
    ds_read_b64_tr_b16 v[224:225], v20 offset:16384
    ds_read_b64_tr_b16 v[226:227], v20 offset:17408
    v_mfma_f32_16x16x32_bf16 v[128:131], v[244:247], a[208:211], v[128:131]
    s_add_u32 s37, s72, 2
    s_cmp_ge_u32 s37, 8
    s_cselect_b32 s6, 7, 0
    s_sub_u32 s37, s37, s6
    s_mul_i32 s37, s37, 524288
    s_add_u32 m0, s33, 98304
    s_add_u32 s37, s37, s42
    buffer_load_dwordx4 v16, s[60:63], s37 offen lds
    v_mfma_f32_16x16x32_bf16 v[136:139], v[240:243], a[196:199], v[136:139]
    ds_read_b64_tr_b16 v[228:229], v20 offset:24576
    ds_read_b64_tr_b16 v[230:231], v20 offset:25600
    v_mfma_f32_16x16x32_bf16 v[136:139], v[244:247], a[212:215], v[136:139]
    ds_read_b64_tr_b16 v[232:233], v21 offset:16384
    ds_read_b64_tr_b16 v[234:235], v21 offset:17408
    v_mfma_f32_16x16x32_bf16 v[144:147], v[240:243], a[200:203], v[144:147]
    ds_read_b64_tr_b16 v[236:237], v21 offset:24576
    v_mfma_f32_16x16x32_bf16 v[144:147], v[244:247], a[216:219], v[144:147]
    ds_read_b64_tr_b16 v[238:239], v21 offset:25600
    v_mfma_f32_16x16x32_bf16 v[152:155], v[240:243], a[204:207], v[152:155]
    ds_read_b128 a[232:235], v9 offset:12288
    v_mfma_f32_16x16x32_bf16 v[152:155], v[244:247], a[220:223], v[152:155]
    ds_read_b128 a[248:251], v10 offset:12288
    v_mfma_f32_16x16x32_bf16 v[132:135], v[248:251], a[192:195], v[132:135]
    ds_read_b128 a[236:239], v9 offset:14336
    v_mfma_f32_16x16x32_bf16 v[132:135], v[252:255], a[208:211], v[132:135]
    buffer_load_dwordx4 v17, s[60:63], s37 offen offset:1024 lds
    v_mfma_f32_16x16x32_bf16 v[140:143], v[248:251], a[196:199], v[140:143]
    ds_read_b128 a[252:255], v10 offset:14336
    v_mfma_f32_16x16x32_bf16 v[140:143], v[252:255], a[212:215], v[140:143]
    buffer_load_dwordx4 v18, s[60:63], s37 offen offset:2048 lds
    v_mfma_f32_16x16x32_bf16 v[148:151], v[248:251], a[200:203], v[148:151]
    v_mfma_f32_16x16x32_bf16 v[148:151], v[252:255], a[216:219], v[148:151]
    v_mfma_f32_16x16x32_bf16 v[156:159], v[248:251], a[204:207], v[156:159]
    v_mfma_f32_16x16x32_bf16 v[156:159], v[252:255], a[220:223], v[156:159]
    s_waitcnt lgkmcnt(0)
    v_mfma_f32_16x16x32_bf16 v[32:35], v[224:227], a[224:227], v[32:35]
    ds_read_b64_tr_b16 v[240:241], v22 offset:16384
    ds_read_b64_tr_b16 v[242:243], v22 offset:17408
    v_mfma_f32_16x16x32_bf16 v[32:35], v[228:231], a[240:243], v[32:35]
    buffer_load_dwordx4 v19, s[60:63], s37 offen offset:3072 lds
    v_mfma_f32_16x16x32_bf16 v[40:43], v[224:227], a[228:231], v[40:43]
    ds_read_b64_tr_b16 v[244:245], v22 offset:24576
    v_mfma_f32_16x16x32_bf16 v[40:43], v[228:231], a[244:247], v[40:43]
    ds_read_b64_tr_b16 v[246:247], v22 offset:25600
    v_mfma_f32_16x16x32_bf16 v[48:51], v[224:227], a[232:235], v[48:51]
    ds_read_b64_tr_b16 v[248:249], v23 offset:16384
    v_mfma_f32_16x16x32_bf16 v[48:51], v[228:231], a[248:251], v[48:51]
    v_mfma_f32_16x16x32_bf16 v[56:59], v[224:227], a[236:239], v[56:59]
    ds_read_b64_tr_b16 v[250:251], v23 offset:17408
    v_mfma_f32_16x16x32_bf16 v[56:59], v[228:231], a[252:255], v[56:59]
    ds_read_b64_tr_b16 v[252:253], v23 offset:24576
    v_mfma_f32_16x16x32_bf16 v[36:39], v[232:235], a[224:227], v[36:39]
    v_mfma_f32_16x16x32_bf16 v[36:39], v[236:239], a[240:243], v[36:39]
    ds_read_b64_tr_b16 v[254:255], v23 offset:25600
    v_mfma_f32_16x16x32_bf16 v[44:47], v[232:235], a[228:231], v[44:47]
    v_mfma_f32_16x16x32_bf16 v[44:47], v[236:239], a[244:247], v[44:47]
    v_mfma_f32_16x16x32_bf16 v[52:55], v[232:235], a[232:235], v[52:55]
    v_mfma_f32_16x16x32_bf16 v[52:55], v[236:239], a[248:251], v[52:55]
    v_mfma_f32_16x16x32_bf16 v[60:63], v[232:235], a[236:239], v[60:63]
    v_mfma_f32_16x16x32_bf16 v[60:63], v[236:239], a[252:255], v[60:63]
    s_waitcnt lgkmcnt(0)
    v_mfma_f32_16x16x32_bf16 v[64:67], v[240:243], a[224:227], v[64:67]
    ds_read_b64_tr_b16 v[224:225], v24 offset:16384
    ds_read_b64_tr_b16 v[226:227], v24 offset:17408
    v_mfma_f32_16x16x32_bf16 v[64:67], v[244:247], a[240:243], v[64:67]
    ds_read_b64_tr_b16 v[228:229], v24 offset:24576
    v_mfma_f32_16x16x32_bf16 v[72:75], v[240:243], a[228:231], v[72:75]
    v_cvt_pk_bf16_f32 v32, v32, v33
    v_cvt_pk_bf16_f32 v33, v34, v35
    v_mfma_f32_16x16x32_bf16 v[72:75], v[244:247], a[244:247], v[72:75]
    ds_read_b64_tr_b16 v[230:231], v24 offset:25600
    v_cvt_pk_bf16_f32 v34, v36, v37
    v_mfma_f32_16x16x32_bf16 v[80:83], v[240:243], a[232:235], v[80:83]
    v_cvt_pk_bf16_f32 v35, v38, v39
    v_cvt_pk_bf16_f32 v36, v40, v41
    v_mfma_f32_16x16x32_bf16 v[80:83], v[244:247], a[248:251], v[80:83]
    ds_read_b64_tr_b16 v[232:233], v25 offset:16384
    v_cvt_pk_bf16_f32 v37, v42, v43
    v_mfma_f32_16x16x32_bf16 v[88:91], v[240:243], a[236:239], v[88:91]
    ds_read_b64_tr_b16 v[234:235], v25 offset:17408
    v_cvt_pk_bf16_f32 v38, v44, v45
    v_mfma_f32_16x16x32_bf16 v[88:91], v[244:247], a[252:255], v[88:91]
    ds_read_b64_tr_b16 v[236:237], v25 offset:24576
    v_cvt_pk_bf16_f32 v39, v46, v47
    v_mfma_f32_16x16x32_bf16 v[68:71], v[248:251], a[224:227], v[68:71]
    v_cvt_pk_bf16_f32 v40, v48, v49
    v_cvt_pk_bf16_f32 v41, v50, v51
    v_mfma_f32_16x16x32_bf16 v[68:71], v[252:255], a[240:243], v[68:71]
    ds_read_b64_tr_b16 v[238:239], v25 offset:25600
    v_cvt_pk_bf16_f32 v42, v52, v53
    v_mfma_f32_16x16x32_bf16 v[76:79], v[248:251], a[228:231], v[76:79]
    v_cvt_pk_bf16_f32 v43, v54, v55
    v_mfma_f32_16x16x32_bf16 v[76:79], v[252:255], a[244:247], v[76:79]
    v_cvt_pk_bf16_f32 v44, v56, v57
    v_cvt_pk_bf16_f32 v45, v58, v59
    v_mfma_f32_16x16x32_bf16 v[84:87], v[248:251], a[232:235], v[84:87]
    v_cvt_pk_bf16_f32 v46, v60, v61
    v_mfma_f32_16x16x32_bf16 v[84:87], v[252:255], a[248:251], v[84:87]
    v_cvt_pk_bf16_f32 v47, v62, v63
    v_mfma_f32_16x16x32_bf16 v[92:95], v[248:251], a[236:239], v[92:95]
    v_mfma_f32_16x16x32_bf16 v[92:95], v[252:255], a[252:255], v[92:95]
    s_waitcnt lgkmcnt(0)
    v_mfma_f32_16x16x32_bf16 v[96:99], v[224:227], a[224:227], v[96:99]
    ds_read_b64_tr_b16 v[240:241], v26 offset:16384
    ds_read_b64_tr_b16 v[242:243], v26 offset:17408
    v_mfma_f32_16x16x32_bf16 v[96:99], v[228:231], a[240:243], v[96:99]
    ds_read_b64_tr_b16 v[244:245], v26 offset:24576
    v_mfma_f32_16x16x32_bf16 v[104:107], v[224:227], a[228:231], v[104:107]
    v_cvt_pk_bf16_f32 v48, v64, v65
    v_cvt_pk_bf16_f32 v49, v66, v67
    v_mfma_f32_16x16x32_bf16 v[104:107], v[228:231], a[244:247], v[104:107]
    ds_read_b64_tr_b16 v[246:247], v26 offset:25600
    v_cvt_pk_bf16_f32 v50, v68, v69
    v_mfma_f32_16x16x32_bf16 v[112:115], v[224:227], a[232:235], v[112:115]
    v_cvt_pk_bf16_f32 v51, v70, v71
    v_cvt_pk_bf16_f32 v52, v72, v73
    v_mfma_f32_16x16x32_bf16 v[112:115], v[228:231], a[248:251], v[112:115]
    ds_read_b64_tr_b16 v[248:249], v27 offset:16384
    v_cvt_pk_bf16_f32 v53, v74, v75
    v_mfma_f32_16x16x32_bf16 v[120:123], v[224:227], a[236:239], v[120:123]
    ds_read_b64_tr_b16 v[250:251], v27 offset:17408
    v_cvt_pk_bf16_f32 v54, v76, v77
    v_mfma_f32_16x16x32_bf16 v[120:123], v[228:231], a[252:255], v[120:123]
    ds_read_b64_tr_b16 v[252:253], v27 offset:24576
    v_cvt_pk_bf16_f32 v55, v78, v79
    v_mfma_f32_16x16x32_bf16 v[100:103], v[232:235], a[224:227], v[100:103]
    v_cvt_pk_bf16_f32 v56, v80, v81
    v_cvt_pk_bf16_f32 v57, v82, v83
    v_mfma_f32_16x16x32_bf16 v[100:103], v[236:239], a[240:243], v[100:103]
    ds_read_b64_tr_b16 v[254:255], v27 offset:25600
    v_cvt_pk_bf16_f32 v58, v84, v85
    v_mfma_f32_16x16x32_bf16 v[108:111], v[232:235], a[228:231], v[108:111]
    v_cvt_pk_bf16_f32 v59, v86, v87
    v_mfma_f32_16x16x32_bf16 v[108:111], v[236:239], a[244:247], v[108:111]
    v_cvt_pk_bf16_f32 v60, v88, v89
    v_cvt_pk_bf16_f32 v61, v90, v91
    v_mfma_f32_16x16x32_bf16 v[116:119], v[232:235], a[232:235], v[116:119]
    v_cvt_pk_bf16_f32 v62, v92, v93
    v_mfma_f32_16x16x32_bf16 v[116:119], v[236:239], a[248:251], v[116:119]
    v_cvt_pk_bf16_f32 v63, v94, v95
    v_mfma_f32_16x16x32_bf16 v[124:127], v[232:235], a[236:239], v[124:127]
    v_mfma_f32_16x16x32_bf16 v[124:127], v[236:239], a[252:255], v[124:127]
    s_waitcnt vmcnt(8) lgkmcnt(0)
    v_mfma_f32_16x16x32_bf16 v[128:131], v[240:243], a[224:227], v[128:131]
    s_barrier
    ds_read_b64_tr_b16 v[224:225], v20 offset:32768
    ds_read_b64_tr_b16 v[226:227], v20 offset:33792
    v_mfma_f32_16x16x32_bf16 v[128:131], v[244:247], a[240:243], v[128:131]
    s_add_u32 s37, s72, 3
    s_cmp_ge_u32 s37, 8
    s_cselect_b32 s6, 7, 0
    s_sub_u32 s37, s37, s6
    s_mul_i32 s37, s37, 524288
    s_add_u32 m0, s33, 114688
    s_add_u32 s37, s37, s42
    buffer_load_dwordx4 v16, s[60:63], s37 offen lds
    v_mfma_f32_16x16x32_bf16 v[136:139], v[240:243], a[228:231], v[136:139]
    v_cvt_pk_bf16_f32 v64, v96, v97
    v_cvt_pk_bf16_f32 v65, v98, v99
    v_mfma_f32_16x16x32_bf16 v[136:139], v[244:247], a[244:247], v[136:139]
    ds_read_b64_tr_b16 v[228:229], v20 offset:40960
    v_cvt_pk_bf16_f32 v66, v100, v101
    v_mfma_f32_16x16x32_bf16 v[144:147], v[240:243], a[232:235], v[144:147]
    ds_read_b64_tr_b16 v[230:231], v20 offset:41984
    v_cvt_pk_bf16_f32 v67, v102, v103
    v_mfma_f32_16x16x32_bf16 v[144:147], v[244:247], a[248:251], v[144:147]
    ds_read_b64_tr_b16 v[232:233], v21 offset:32768
    v_cvt_pk_bf16_f32 v68, v104, v105
    v_mfma_f32_16x16x32_bf16 v[152:155], v[240:243], a[236:239], v[152:155]
    v_cvt_pk_bf16_f32 v69, v106, v107
    v_cvt_pk_bf16_f32 v70, v108, v109
    v_mfma_f32_16x16x32_bf16 v[152:155], v[244:247], a[252:255], v[152:155]
    ds_read_b64_tr_b16 v[234:235], v21 offset:33792
    v_cvt_pk_bf16_f32 v71, v110, v111
    v_mfma_f32_16x16x32_bf16 v[132:135], v[248:251], a[224:227], v[132:135]
    ds_read_b64_tr_b16 v[236:237], v21 offset:40960
    v_cvt_pk_bf16_f32 v72, v112, v113
    v_mfma_f32_16x16x32_bf16 v[132:135], v[252:255], a[240:243], v[132:135]
    ds_read_b64_tr_b16 v[238:239], v21 offset:41984
    v_cvt_pk_bf16_f32 v73, v114, v115
    v_mfma_f32_16x16x32_bf16 v[140:143], v[248:251], a[228:231], v[140:143]
    buffer_load_dwordx4 v17, s[60:63], s37 offen offset:1024 lds
    v_mfma_f32_16x16x32_bf16 v[140:143], v[252:255], a[244:247], v[140:143]
    v_cvt_pk_bf16_f32 v74, v116, v117
    v_cvt_pk_bf16_f32 v75, v118, v119
    v_mfma_f32_16x16x32_bf16 v[148:151], v[248:251], a[232:235], v[148:151]
    v_cvt_pk_bf16_f32 v76, v120, v121
    v_cvt_pk_bf16_f32 v77, v122, v123
    v_mfma_f32_16x16x32_bf16 v[148:151], v[252:255], a[248:251], v[148:151]
    buffer_load_dwordx4 v18, s[60:63], s37 offen offset:2048 lds
    v_mfma_f32_16x16x32_bf16 v[156:159], v[248:251], a[236:239], v[156:159]
    v_cvt_pk_bf16_f32 v78, v124, v125
    v_cvt_pk_bf16_f32 v79, v126, v127
    v_mfma_f32_16x16x32_bf16 v[156:159], v[252:255], a[252:255], v[156:159]
    s_waitcnt lgkmcnt(0)
    v_mfma_f32_16x16x32_bf16 v[160:163], a[0:3], v[224:227], 0
    ds_read_b64_tr_b16 v[240:241], v22 offset:32768
    ds_read_b64_tr_b16 v[242:243], v22 offset:33792
    v_mfma_f32_16x16x32_bf16 v[160:163], a[16:19], v[228:231], v[160:163]
    buffer_load_dwordx4 v19, s[60:63], s37 offen offset:3072 lds
    v_mfma_f32_16x16x32_bf16 v[164:167], a[4:7], v[224:227], 0
    v_cvt_pk_bf16_f32 v80, v128, v129
    v_cvt_pk_bf16_f32 v81, v130, v131
    v_mfma_f32_16x16x32_bf16 v[164:167], a[20:23], v[228:231], v[164:167]
    ds_read_b64_tr_b16 v[244:245], v22 offset:40960
    v_cvt_pk_bf16_f32 v82, v132, v133
    v_mfma_f32_16x16x32_bf16 v[168:171], a[8:11], v[224:227], 0
    ds_read_b64_tr_b16 v[246:247], v22 offset:41984
    v_cvt_pk_bf16_f32 v83, v134, v135
    v_mfma_f32_16x16x32_bf16 v[168:171], a[24:27], v[228:231], v[168:171]
    v_and_b32 v13, 31, v0
    v_cvt_pk_bf16_f32 v84, v136, v137
    v_mfma_f32_16x16x32_bf16 v[172:175], a[12:15], v[224:227], 0
    ds_read_b64_tr_b16 v[248:249], v23 offset:32768
    v_cvt_pk_bf16_f32 v85, v138, v139
    v_mfma_f32_16x16x32_bf16 v[172:175], a[28:31], v[228:231], v[172:175]
    ds_read_b64_tr_b16 v[250:251], v23 offset:33792
    v_cvt_pk_bf16_f32 v86, v140, v141
    v_mfma_f32_16x16x32_bf16 v[176:179], a[0:3], v[232:235], 0
    v_lshlrev_b32 v13, 2, v13
    v_cvt_pk_bf16_f32 v87, v142, v143
    v_mfma_f32_16x16x32_bf16 v[176:179], a[16:19], v[236:239], v[176:179]
    ds_read_b64_tr_b16 v[252:253], v23 offset:40960
    v_cvt_pk_bf16_f32 v88, v144, v145
    v_mfma_f32_16x16x32_bf16 v[180:183], a[4:7], v[232:235], 0
    ds_read_b64_tr_b16 v[254:255], v23 offset:41984
    v_cvt_pk_bf16_f32 v89, v146, v147
    v_mfma_f32_16x16x32_bf16 v[180:183], a[20:23], v[236:239], v[180:183]
    v_cvt_pk_bf16_f32 v90, v148, v149
    v_cvt_pk_bf16_f32 v91, v150, v151
    v_mfma_f32_16x16x32_bf16 v[184:187], a[8:11], v[232:235], 0
    buffer_load_dword v14, v13, s[24:27], s68 offen offset:256 sc1
    v_mfma_f32_16x16x32_bf16 v[184:187], a[24:27], v[236:239], v[184:187]
    v_cvt_pk_bf16_f32 v92, v152, v153
    v_cvt_pk_bf16_f32 v93, v154, v155
    v_mfma_f32_16x16x32_bf16 v[188:191], a[12:15], v[232:235], 0
    v_cvt_pk_bf16_f32 v94, v156, v157
    v_cvt_pk_bf16_f32 v95, v158, v159
    v_mfma_f32_16x16x32_bf16 v[188:191], a[28:31], v[236:239], v[188:191]
    s_waitcnt lgkmcnt(0)
    v_mfma_f32_16x16x32_bf16 v[192:195], a[0:3], v[240:243], 0
    ds_read_b64_tr_b16 v[224:225], v24 offset:32768
    ds_read_b64_tr_b16 v[226:227], v24 offset:33792
    v_mfma_f32_16x16x32_bf16 v[192:195], a[16:19], v[244:247], v[192:195]
    ds_read_b64_tr_b16 v[228:229], v24 offset:40960
    s_add_u32 s49, s75, 0
    v_mfma_f32_16x16x32_bf16 v[196:199], a[4:7], v[240:243], 0
    v_mfma_f32_16x16x32_bf16 v[196:199], a[20:23], v[244:247], v[196:199]
    ds_read_b64_tr_b16 v[230:231], v24 offset:41984
    v_mfma_f32_16x16x32_bf16 v[200:203], a[8:11], v[240:243], 0
    buffer_store_dwordx4 v[32:35], v6, s[24:27], s49 offen offset:0 sc1
    v_mfma_f32_16x16x32_bf16 v[200:203], a[24:27], v[244:247], v[200:203]
    ds_read_b64_tr_b16 v[232:233], v25 offset:32768
    v_mfma_f32_16x16x32_bf16 v[204:207], a[12:15], v[240:243], 0
    ds_read_b64_tr_b16 v[234:235], v25 offset:33792
    v_mfma_f32_16x16x32_bf16 v[204:207], a[28:31], v[244:247], v[204:207]
    ds_read_b64_tr_b16 v[236:237], v25 offset:40960
    v_mfma_f32_16x16x32_bf16 v[208:211], a[0:3], v[248:251], 0
    v_mfma_f32_16x16x32_bf16 v[208:211], a[16:19], v[252:255], v[208:211]
    ds_read_b64_tr_b16 v[238:239], v25 offset:41984
    v_mfma_f32_16x16x32_bf16 v[212:215], a[4:7], v[248:251], 0
    v_mfma_f32_16x16x32_bf16 v[212:215], a[20:23], v[252:255], v[212:215]
    v_mfma_f32_16x16x32_bf16 v[216:219], a[8:11], v[248:251], 0
    v_mfma_f32_16x16x32_bf16 v[216:219], a[24:27], v[252:255], v[216:219]
    v_mfma_f32_16x16x32_bf16 v[220:223], a[12:15], v[248:251], 0
    v_mfma_f32_16x16x32_bf16 v[220:223], a[28:31], v[252:255], v[220:223]
    s_waitcnt lgkmcnt(0)
    v_mfma_f32_16x16x32_bf16 v[96:99], a[0:3], v[224:227], 0
    ds_read_b64_tr_b16 v[240:241], v26 offset:32768
    ds_read_b64_tr_b16 v[242:243], v26 offset:33792
    v_mfma_f32_16x16x32_bf16 v[96:99], a[16:19], v[228:231], v[96:99]
    ds_read_b64_tr_b16 v[244:245], v26 offset:40960
    s_add_u32 s49, s75, 4096
    v_mfma_f32_16x16x32_bf16 v[100:103], a[4:7], v[224:227], 0
    v_mfma_f32_16x16x32_bf16 v[100:103], a[20:23], v[228:231], v[100:103]
    ds_read_b64_tr_b16 v[246:247], v26 offset:41984
    v_mfma_f32_16x16x32_bf16 v[104:107], a[8:11], v[224:227], 0
    buffer_store_dwordx4 v[36:39], v6, s[24:27], s49 offen offset:0 sc1
    v_mfma_f32_16x16x32_bf16 v[104:107], a[24:27], v[228:231], v[104:107]
    ds_read_b64_tr_b16 v[248:249], v27 offset:32768
    v_mfma_f32_16x16x32_bf16 v[108:111], a[12:15], v[224:227], 0
    ds_read_b64_tr_b16 v[250:251], v27 offset:33792
    v_mfma_f32_16x16x32_bf16 v[108:111], a[28:31], v[228:231], v[108:111]
    ds_read_b64_tr_b16 v[252:253], v27 offset:40960
    v_mfma_f32_16x16x32_bf16 v[112:115], a[0:3], v[232:235], 0
    v_mfma_f32_16x16x32_bf16 v[112:115], a[16:19], v[236:239], v[112:115]
    ds_read_b64_tr_b16 v[254:255], v27 offset:41984
    v_mfma_f32_16x16x32_bf16 v[116:119], a[4:7], v[232:235], 0
    v_mfma_f32_16x16x32_bf16 v[116:119], a[20:23], v[236:239], v[116:119]
    v_mfma_f32_16x16x32_bf16 v[120:123], a[8:11], v[232:235], 0
    v_mfma_f32_16x16x32_bf16 v[120:123], a[24:27], v[236:239], v[120:123]
    v_mfma_f32_16x16x32_bf16 v[124:127], a[12:15], v[232:235], 0
    v_mfma_f32_16x16x32_bf16 v[124:127], a[28:31], v[236:239], v[124:127]
    s_waitcnt vmcnt(2) lgkmcnt(0)
    v_cmp_ne_u32 vcc, s70, v14
    s_nop 0
    s_cbranch_vccnz KB_SPX
KB_SPXR:
    v_mfma_f32_16x16x32_bf16 v[128:131], a[0:3], v[240:243], 0
    s_barrier
    ds_read_b64_tr_b16 v[224:225], v20 offset:49152
    ds_read_b64_tr_b16 v[226:227], v20 offset:50176
    v_mfma_f32_16x16x32_bf16 v[128:131], a[16:19], v[244:247], v[128:131]
    s_add_u32 s37, s72, 4
    s_cmp_ge_u32 s37, 8
    s_cselect_b32 s6, 7, 0
    s_sub_u32 s37, s37, s6
    s_mul_i32 s37, s37, 524288
    s_add_u32 m0, s33, 131072
    s_add_u32 s37, s37, s42
    buffer_load_dwordx4 v16, s[60:63], s37 offen lds
    v_mfma_f32_16x16x32_bf16 v[132:135], a[4:7], v[240:243], 0
    ds_read_b64_tr_b16 v[228:229], v20 offset:57344
    v_mfma_f32_16x16x32_bf16 v[132:135], a[20:23], v[244:247], v[132:135]
    ds_read_b64_tr_b16 v[230:231], v20 offset:58368
    v_mfma_f32_16x16x32_bf16 v[136:139], a[8:11], v[240:243], 0
    ds_read_b64_tr_b16 v[232:233], v21 offset:49152
    v_mfma_f32_16x16x32_bf16 v[136:139], a[24:27], v[244:247], v[136:139]
    v_mfma_f32_16x16x32_bf16 v[140:143], a[12:15], v[240:243], 0
    ds_read_b64_tr_b16 v[234:235], v21 offset:50176
    v_mfma_f32_16x16x32_bf16 v[140:143], a[28:31], v[244:247], v[140:143]
    ds_read_b64_tr_b16 v[236:237], v21 offset:57344
    v_mfma_f32_16x16x32_bf16 v[144:147], a[0:3], v[248:251], 0
    buffer_load_dwordx4 v17, s[60:63], s37 offen offset:1024 lds
    v_mfma_f32_16x16x32_bf16 v[144:147], a[16:19], v[252:255], v[144:147]
    ds_read_b64_tr_b16 v[238:239], v21 offset:58368
    v_mfma_f32_16x16x32_bf16 v[148:151], a[4:7], v[248:251], 0
    v_mfma_f32_16x16x32_bf16 v[148:151], a[20:23], v[252:255], v[148:151]
    buffer_load_dwordx4 v18, s[60:63], s37 offen offset:2048 lds
    v_mfma_f32_16x16x32_bf16 v[152:155], a[8:11], v[248:251], 0
    v_mfma_f32_16x16x32_bf16 v[152:155], a[24:27], v[252:255], v[152:155]
    v_mfma_f32_16x16x32_bf16 v[156:159], a[12:15], v[248:251], 0
    v_mfma_f32_16x16x32_bf16 v[156:159], a[28:31], v[252:255], v[156:159]
    s_waitcnt lgkmcnt(0)
    v_mfma_f32_16x16x32_bf16 v[160:163], a[32:35], v[224:227], v[160:163]
    ds_read_b64_tr_b16 v[240:241], v22 offset:49152
    ds_read_b64_tr_b16 v[242:243], v22 offset:50176
    v_mfma_f32_16x16x32_bf16 v[160:163], a[48:51], v[228:231], v[160:163]
    buffer_load_dwordx4 v19, s[60:63], s37 offen offset:3072 lds
    v_mfma_f32_16x16x32_bf16 v[164:167], a[36:39], v[224:227], v[164:167]
    s_cmp_eq_u32 s15, 0
    s_cselect_b32 s48, 0, 0x40000000
    v_mov_b32 v15, s70
    v_or_b32 v13, s48, v1
    buffer_store_dword v15, v13, s[24:27], s68 offen sc1
    v_mfma_f32_16x16x32_bf16 v[164:167], a[52:55], v[228:231], v[164:167]
    ds_read_b64_tr_b16 v[244:245], v22 offset:57344
    ds_read_b64_tr_b16 v[246:247], v22 offset:58368
    v_mfma_f32_16x16x32_bf16 v[168:171], a[40:43], v[224:227], v[168:171]
    ds_read_b64_tr_b16 v[248:249], v23 offset:49152
    v_mfma_f32_16x16x32_bf16 v[168:171], a[56:59], v[228:231], v[168:171]
    v_mfma_f32_16x16x32_bf16 v[172:175], a[44:47], v[224:227], v[172:175]
    ds_read_b64_tr_b16 v[250:251], v23 offset:50176
    v_mfma_f32_16x16x32_bf16 v[172:175], a[60:63], v[228:231], v[172:175]
    ds_read_b64_tr_b16 v[252:253], v23 offset:57344
    s_mov_b32 s76, 0
    s_add_u32 s77, s76, s40
    v_mfma_f32_16x16x32_bf16 v[176:179], a[32:35], v[232:235], v[176:179]
    buffer_load_dwordx4 a[0:3], v6, s[24:27], s77 offen offset:0 sc1
    v_mfma_f32_16x16x32_bf16 v[176:179], a[48:51], v[236:239], v[176:179]
    ds_read_b64_tr_b16 v[254:255], v23 offset:58368
    v_mfma_f32_16x16x32_bf16 v[180:183], a[36:39], v[232:235], v[180:183]
    buffer_load_dwordx4 a[16:19], v6, s[24:27], s77 offen offset:1024 sc1
    v_mfma_f32_16x16x32_bf16 v[180:183], a[52:55], v[236:239], v[180:183]
    v_mfma_f32_16x16x32_bf16 v[184:187], a[40:43], v[232:235], v[184:187]
    s_add_u32 s49, s75, 8192
    buffer_store_dwordx4 v[40:43], v6, s[24:27], s49 offen offset:0 sc1
    v_mfma_f32_16x16x32_bf16 v[184:187], a[56:59], v[236:239], v[184:187]
    v_mfma_f32_16x16x32_bf16 v[188:191], a[44:47], v[232:235], v[188:191]
    v_mfma_f32_16x16x32_bf16 v[188:191], a[60:63], v[236:239], v[188:191]
    s_waitcnt lgkmcnt(0)
    v_mfma_f32_16x16x32_bf16 v[192:195], a[32:35], v[240:243], v[192:195]
    ds_read_b64_tr_b16 v[224:225], v24 offset:49152
    ds_read_b64_tr_b16 v[226:227], v24 offset:50176
    v_mfma_f32_16x16x32_bf16 v[192:195], a[48:51], v[244:247], v[192:195]
    ds_read_b64_tr_b16 v[228:229], v24 offset:57344
    s_add_u32 s77, s76, s40
    s_add_u32 s77, s77, 16384
    v_mfma_f32_16x16x32_bf16 v[196:199], a[36:39], v[240:243], v[196:199]
    v_mfma_f32_16x16x32_bf16 v[196:199], a[52:55], v[244:247], v[196:199]
    ds_read_b64_tr_b16 v[230:231], v24 offset:58368
    v_mfma_f32_16x16x32_bf16 v[200:203], a[40:43], v[240:243], v[200:203]
    buffer_load_dwordx4 a[4:7], v6, s[24:27], s77 offen offset:0 sc1
    v_mfma_f32_16x16x32_bf16 v[200:203], a[56:59], v[244:247], v[200:203]
    ds_read_b64_tr_b16 v[232:233], v25 offset:49152
    v_mfma_f32_16x16x32_bf16 v[204:207], a[44:47], v[240:243], v[204:207]
    ds_read_b64_tr_b16 v[234:235], v25 offset:50176
    v_mfma_f32_16x16x32_bf16 v[204:207], a[60:63], v[244:247], v[204:207]
    ds_read_b64_tr_b16 v[236:237], v25 offset:57344
    v_mfma_f32_16x16x32_bf16 v[208:211], a[32:35], v[248:251], v[208:211]
    buffer_load_dwordx4 a[20:23], v6, s[24:27], s77 offen offset:1024 sc1
    v_mfma_f32_16x16x32_bf16 v[208:211], a[48:51], v[252:255], v[208:211]
    ds_read_b64_tr_b16 v[238:239], v25 offset:58368
    v_mfma_f32_16x16x32_bf16 v[212:215], a[36:39], v[248:251], v[212:215]
    v_mfma_f32_16x16x32_bf16 v[212:215], a[52:55], v[252:255], v[212:215]
    v_mfma_f32_16x16x32_bf16 v[216:219], a[40:43], v[248:251], v[216:219]
    v_mfma_f32_16x16x32_bf16 v[216:219], a[56:59], v[252:255], v[216:219]
    v_mfma_f32_16x16x32_bf16 v[220:223], a[44:47], v[248:251], v[220:223]
    v_mfma_f32_16x16x32_bf16 v[220:223], a[60:63], v[252:255], v[220:223]
    s_waitcnt lgkmcnt(0)
    v_mfma_f32_16x16x32_bf16 v[96:99], a[32:35], v[224:227], v[96:99]
    ds_read_b64_tr_b16 v[240:241], v26 offset:49152
    ds_read_b64_tr_b16 v[242:243], v26 offset:50176
    v_mfma_f32_16x16x32_bf16 v[96:99], a[48:51], v[228:231], v[96:99]
    s_add_u32 s77, s76, s41
    buffer_load_dwordx4 a[8:11], v6, s[24:27], s77 offen offset:0 sc1
    v_mfma_f32_16x16x32_bf16 v[100:103], a[36:39], v[224:227], v[100:103]
    ds_read_b64_tr_b16 v[244:245], v26 offset:57344
    v_mfma_f32_16x16x32_bf16 v[100:103], a[52:55], v[228:231], v[100:103]
    ds_read_b64_tr_b16 v[246:247], v26 offset:58368
    v_mfma_f32_16x16x32_bf16 v[104:107], a[40:43], v[224:227], v[104:107]
    ds_read_b64_tr_b16 v[248:249], v27 offset:49152
    v_mfma_f32_16x16x32_bf16 v[104:107], a[56:59], v[228:231], v[104:107]
    buffer_load_dwordx4 a[24:27], v6, s[24:27], s77 offen offset:1024 sc1
    v_mfma_f32_16x16x32_bf16 v[108:111], a[44:47], v[224:227], v[108:111]
    ds_read_b64_tr_b16 v[250:251], v27 offset:50176
    v_mfma_f32_16x16x32_bf16 v[108:111], a[60:63], v[228:231], v[108:111]
    ds_read_b64_tr_b16 v[252:253], v27 offset:57344
    v_mfma_f32_16x16x32_bf16 v[112:115], a[32:35], v[232:235], v[112:115]
    v_mfma_f32_16x16x32_bf16 v[112:115], a[48:51], v[236:239], v[112:115]
    ds_read_b64_tr_b16 v[254:255], v27 offset:58368
    s_add_u32 s49, s75, 12288
    v_mfma_f32_16x16x32_bf16 v[116:119], a[36:39], v[232:235], v[116:119]
    buffer_store_dwordx4 v[44:47], v6, s[24:27], s49 offen offset:0 sc1
    v_mfma_f32_16x16x32_bf16 v[116:119], a[52:55], v[236:239], v[116:119]
    v_mfma_f32_16x16x32_bf16 v[120:123], a[40:43], v[232:235], v[120:123]
    v_mfma_f32_16x16x32_bf16 v[120:123], a[56:59], v[236:239], v[120:123]
    v_mfma_f32_16x16x32_bf16 v[124:127], a[44:47], v[232:235], v[124:127]
    v_mfma_f32_16x16x32_bf16 v[124:127], a[60:63], v[236:239], v[124:127]
    s_waitcnt vmcnt(20) lgkmcnt(0)
    v_mfma_f32_16x16x32_bf16 v[128:131], a[32:35], v[240:243], v[128:131]
    s_barrier
    ds_read_b64_tr_b16 v[224:225], v20 offset:0
    ds_read_b64_tr_b16 v[226:227], v20 offset:1024
    v_mfma_f32_16x16x32_bf16 v[128:131], a[48:51], v[244:247], v[128:131]
    s_add_u32 s37, s72, 5
    s_cmp_ge_u32 s37, 8
    s_cselect_b32 s6, 7, 0
    s_sub_u32 s37, s37, s6
    s_mul_i32 s37, s37, 524288
    s_add_u32 m0, s33, 147456
    s_add_u32 s37, s37, s42
    buffer_load_dwordx4 v16, s[60:63], s37 offen lds
    v_mfma_f32_16x16x32_bf16 v[132:135], a[36:39], v[240:243], v[132:135]
    ds_read_b64_tr_b16 v[228:229], v20 offset:8192
    v_mfma_f32_16x16x32_bf16 v[132:135], a[52:55], v[244:247], v[132:135]
    ds_read_b64_tr_b16 v[230:231], v20 offset:9216
    v_mfma_f32_16x16x32_bf16 v[136:139], a[40:43], v[240:243], v[136:139]
    ds_read_b64_tr_b16 v[232:233], v21 offset:0
    v_mfma_f32_16x16x32_bf16 v[136:139], a[56:59], v[244:247], v[136:139]
    buffer_load_dwordx4 v17, s[60:63], s37 offen offset:1024 lds
    v_mfma_f32_16x16x32_bf16 v[140:143], a[44:47], v[240:243], v[140:143]
    ds_read_b64_tr_b16 v[234:235], v21 offset:1024
    v_mfma_f32_16x16x32_bf16 v[140:143], a[60:63], v[244:247], v[140:143]
    buffer_load_dwordx4 v18, s[60:63], s37 offen offset:2048 lds
    v_mfma_f32_16x16x32_bf16 v[144:147], a[32:35], v[248:251], v[144:147]
    ds_read_b64_tr_b16 v[236:237], v21 offset:8192
    v_mfma_f32_16x16x32_bf16 v[144:147], a[48:51], v[252:255], v[144:147]
    ds_read_b64_tr_b16 v[238:239], v21 offset:9216
    s_add_u32 s77, s76, s41
    v_mfma_f32_16x16x32_bf16 v[148:151], a[36:39], v[248:251], v[148:151]
    s_add_u32 s77, s77, 16384
    buffer_load_dwordx4 a[12:15], v6, s[24:27], s77 offen offset:0 sc1
    v_mfma_f32_16x16x32_bf16 v[148:151], a[52:55], v[252:255], v[148:151]
    v_mfma_f32_16x16x32_bf16 v[152:155], a[40:43], v[248:251], v[152:155]
    buffer_load_dwordx4 a[28:31], v6, s[24:27], s77 offen offset:1024 sc1
    v_mfma_f32_16x16x32_bf16 v[152:155], a[56:59], v[252:255], v[152:155]
    v_mfma_f32_16x16x32_bf16 v[156:159], a[44:47], v[248:251], v[156:159]
    v_mfma_f32_16x16x32_bf16 v[156:159], a[60:63], v[252:255], v[156:159]
    s_waitcnt lgkmcnt(0)
    v_mfma_f32_16x16x32_bf16 v[160:163], a[64:67], v[224:227], v[160:163]
    ds_read_b64_tr_b16 v[240:241], v22 offset:0
    ds_read_b64_tr_b16 v[242:243], v22 offset:1024
    v_mfma_f32_16x16x32_bf16 v[160:163], a[80:83], v[228:231], v[160:163]
    buffer_load_dwordx4 v19, s[60:63], s37 offen offset:3072 lds
    v_mfma_f32_16x16x32_bf16 v[164:167], a[68:71], v[224:227], v[164:167]
    ds_read_b64_tr_b16 v[244:245], v22 offset:8192
    v_mfma_f32_16x16x32_bf16 v[164:167], a[84:87], v[228:231], v[164:167]
    s_add_u32 s76, s72, 1
    s_cmp_ge_u32 s76, 8
    s_cselect_b32 s6, 7, 0
    s_sub_u32 s76, s76, s6
    s_mul_i32 s76, s76, 2048
    s_add_u32 s77, s76, s40
    buffer_load_dwordx4 a[32:35], v6, s[24:27], s77 offen offset:0 sc1
    v_mfma_f32_16x16x32_bf16 v[168:171], a[72:75], v[224:227], v[168:171]
    ds_read_b64_tr_b16 v[246:247], v22 offset:9216
    ds_read_b64_tr_b16 v[248:249], v23 offset:0
    v_mfma_f32_16x16x32_bf16 v[168:171], a[88:91], v[228:231], v[168:171]
    v_mfma_f32_16x16x32_bf16 v[172:175], a[76:79], v[224:227], v[172:175]
    ds_read_b64_tr_b16 v[250:251], v23 offset:1024
    v_mfma_f32_16x16x32_bf16 v[172:175], a[92:95], v[228:231], v[172:175]
    ds_read_b64_tr_b16 v[252:253], v23 offset:8192
    v_mfma_f32_16x16x32_bf16 v[176:179], a[64:67], v[232:235], v[176:179]
    buffer_load_dwordx4 a[48:51], v6, s[24:27], s77 offen offset:1024 sc1
    v_mfma_f32_16x16x32_bf16 v[176:179], a[80:83], v[236:239], v[176:179]
    ds_read_b64_tr_b16 v[254:255], v23 offset:9216
    v_mfma_f32_16x16x32_bf16 v[180:183], a[68:71], v[232:235], v[180:183]
    v_mfma_f32_16x16x32_bf16 v[180:183], a[84:87], v[236:239], v[180:183]
    s_add_u32 s49, s75, 0
    v_mfma_f32_16x16x32_bf16 v[184:187], a[72:75], v[232:235], v[184:187]
    buffer_store_dwordx4 v[48:51], v6, s[24:27], s49 offen offset:1024 sc1
    v_mfma_f32_16x16x32_bf16 v[184:187], a[88:91], v[236:239], v[184:187]
    v_mfma_f32_16x16x32_bf16 v[188:191], a[76:79], v[232:235], v[188:191]
    v_mfma_f32_16x16x32_bf16 v[188:191], a[92:95], v[236:239], v[188:191]
    s_waitcnt lgkmcnt(0)
    v_mfma_f32_16x16x32_bf16 v[192:195], a[64:67], v[240:243], v[192:195]
    ds_read_b64_tr_b16 v[224:225], v24 offset:0
    ds_read_b64_tr_b16 v[226:227], v24 offset:1024
    v_mfma_f32_16x16x32_bf16 v[192:195], a[80:83], v[244:247], v[192:195]
    ds_read_b64_tr_b16 v[228:229], v24 offset:8192
    s_add_u32 s77, s76, s40
    s_add_u32 s77, s77, 16384
    v_mfma_f32_16x16x32_bf16 v[196:199], a[68:71], v[240:243], v[196:199]
    v_mfma_f32_16x16x32_bf16 v[196:199], a[84:87], v[244:247], v[196:199]
    ds_read_b64_tr_b16 v[230:231], v24 offset:9216
    v_mfma_f32_16x16x32_bf16 v[200:203], a[72:75], v[240:243], v[200:203]
    buffer_load_dwordx4 a[36:39], v6, s[24:27], s77 offen offset:0 sc1
    v_mfma_f32_16x16x32_bf16 v[200:203], a[88:91], v[244:247], v[200:203]
    ds_read_b64_tr_b16 v[232:233], v25 offset:0
    v_mfma_f32_16x16x32_bf16 v[204:207], a[76:79], v[240:243], v[204:207]
    ds_read_b64_tr_b16 v[234:235], v25 offset:1024
    v_mfma_f32_16x16x32_bf16 v[204:207], a[92:95], v[244:247], v[204:207]
    ds_read_b64_tr_b16 v[236:237], v25 offset:8192
    v_mfma_f32_16x16x32_bf16 v[208:211], a[64:67], v[248:251], v[208:211]
    buffer_load_dwordx4 a[52:55], v6, s[24:27], s77 offen offset:1024 sc1
    v_mfma_f32_16x16x32_bf16 v[208:211], a[80:83], v[252:255], v[208:211]
    ds_read_b64_tr_b16 v[238:239], v25 offset:9216
    v_mfma_f32_16x16x32_bf16 v[212:215], a[68:71], v[248:251], v[212:215]
    v_mfma_f32_16x16x32_bf16 v[212:215], a[84:87], v[252:255], v[212:215]
    v_mfma_f32_16x16x32_bf16 v[216:219], a[72:75], v[248:251], v[216:219]
    v_mfma_f32_16x16x32_bf16 v[216:219], a[88:91], v[252:255], v[216:219]
    v_mfma_f32_16x16x32_bf16 v[220:223], a[76:79], v[248:251], v[220:223]
    v_mfma_f32_16x16x32_bf16 v[220:223], a[92:95], v[252:255], v[220:223]
    s_waitcnt lgkmcnt(0)
    v_mfma_f32_16x16x32_bf16 v[96:99], a[64:67], v[224:227], v[96:99]
    ds_read_b64_tr_b16 v[240:241], v26 offset:0
    ds_read_b64_tr_b16 v[242:243], v26 offset:1024
    v_mfma_f32_16x16x32_bf16 v[96:99], a[80:83], v[228:231], v[96:99]
    s_add_u32 s77, s76, s41
    buffer_load_dwordx4 a[40:43], v6, s[24:27], s77 offen offset:0 sc1
    v_mfma_f32_16x16x32_bf16 v[100:103], a[68:71], v[224:227], v[100:103]
    ds_read_b64_tr_b16 v[244:245], v26 offset:8192
    v_mfma_f32_16x16x32_bf16 v[100:103], a[84:87], v[228:231], v[100:103]
    ds_read_b64_tr_b16 v[246:247], v26 offset:9216
    v_mfma_f32_16x16x32_bf16 v[104:107], a[72:75], v[224:227], v[104:107]
    ds_read_b64_tr_b16 v[248:249], v27 offset:0
    v_mfma_f32_16x16x32_bf16 v[104:107], a[88:91], v[228:231], v[104:107]
    buffer_load_dwordx4 a[56:59], v6, s[24:27], s77 offen offset:1024 sc1
    v_mfma_f32_16x16x32_bf16 v[108:111], a[76:79], v[224:227], v[108:111]
    ds_read_b64_tr_b16 v[250:251], v27 offset:1024
    v_mfma_f32_16x16x32_bf16 v[108:111], a[92:95], v[228:231], v[108:111]
    ds_read_b64_tr_b16 v[252:253], v27 offset:8192
    v_mfma_f32_16x16x32_bf16 v[112:115], a[64:67], v[232:235], v[112:115]
    v_mfma_f32_16x16x32_bf16 v[112:115], a[80:83], v[236:239], v[112:115]
    ds_read_b64_tr_b16 v[254:255], v27 offset:9216
    s_add_u32 s49, s75, 4096
    v_mfma_f32_16x16x32_bf16 v[116:119], a[68:71], v[232:235], v[116:119]
    buffer_store_dwordx4 v[52:55], v6, s[24:27], s49 offen offset:1024 sc1
    v_mfma_f32_16x16x32_bf16 v[116:119], a[84:87], v[236:239], v[116:119]
    v_mfma_f32_16x16x32_bf16 v[120:123], a[72:75], v[232:235], v[120:123]
    v_mfma_f32_16x16x32_bf16 v[120:123], a[88:91], v[236:239], v[120:123]
    v_mfma_f32_16x16x32_bf16 v[124:127], a[76:79], v[232:235], v[124:127]
    v_mfma_f32_16x16x32_bf16 v[124:127], a[92:95], v[236:239], v[124:127]
    s_waitcnt vmcnt(30) lgkmcnt(0)
    v_mfma_f32_16x16x32_bf16 v[128:131], a[64:67], v[240:243], v[128:131]
    s_barrier
    ds_read_b64_tr_b16 v[224:225], v20 offset:16384
    ds_read_b64_tr_b16 v[226:227], v20 offset:17408
    v_mfma_f32_16x16x32_bf16 v[128:131], a[80:83], v[244:247], v[128:131]
    s_add_u32 s37, s72, 6
    s_cmp_ge_u32 s37, 8
    s_cselect_b32 s6, 7, 0
    s_sub_u32 s37, s37, s6
    s_mul_i32 s37, s37, 524288
    s_add_u32 m0, s33, 98304
    s_add_u32 s37, s37, s42
    buffer_load_dwordx4 v16, s[60:63], s37 offen lds
    v_mfma_f32_16x16x32_bf16 v[132:135], a[68:71], v[240:243], v[132:135]
    ds_read_b64_tr_b16 v[228:229], v20 offset:24576
    v_mfma_f32_16x16x32_bf16 v[132:135], a[84:87], v[244:247], v[132:135]
    ds_read_b64_tr_b16 v[230:231], v20 offset:25600
    v_mfma_f32_16x16x32_bf16 v[136:139], a[72:75], v[240:243], v[136:139]
    ds_read_b64_tr_b16 v[232:233], v21 offset:16384
    v_mfma_f32_16x16x32_bf16 v[136:139], a[88:91], v[244:247], v[136:139]
    buffer_load_dwordx4 v17, s[60:63], s37 offen offset:1024 lds
    v_mfma_f32_16x16x32_bf16 v[140:143], a[76:79], v[240:243], v[140:143]
    ds_read_b64_tr_b16 v[234:235], v21 offset:17408
    v_mfma_f32_16x16x32_bf16 v[140:143], a[92:95], v[244:247], v[140:143]
    buffer_load_dwordx4 v18, s[60:63], s37 offen offset:2048 lds
    v_mfma_f32_16x16x32_bf16 v[144:147], a[64:67], v[248:251], v[144:147]
    ds_read_b64_tr_b16 v[236:237], v21 offset:24576
    v_mfma_f32_16x16x32_bf16 v[144:147], a[80:83], v[252:255], v[144:147]
    ds_read_b64_tr_b16 v[238:239], v21 offset:25600
    s_add_u32 s77, s76, s41
    v_mfma_f32_16x16x32_bf16 v[148:151], a[68:71], v[248:251], v[148:151]
    s_add_u32 s77, s77, 16384
    buffer_load_dwordx4 a[44:47], v6, s[24:27], s77 offen offset:0 sc1
    v_mfma_f32_16x16x32_bf16 v[148:151], a[84:87], v[252:255], v[148:151]
    v_mfma_f32_16x16x32_bf16 v[152:155], a[72:75], v[248:251], v[152:155]
    buffer_load_dwordx4 a[60:63], v6, s[24:27], s77 offen offset:1024 sc1
    v_mfma_f32_16x16x32_bf16 v[152:155], a[88:91], v[252:255], v[152:155]
    v_mfma_f32_16x16x32_bf16 v[156:159], a[76:79], v[248:251], v[156:159]
    v_mfma_f32_16x16x32_bf16 v[156:159], a[92:95], v[252:255], v[156:159]
    s_waitcnt lgkmcnt(0)
    v_mfma_f32_16x16x32_bf16 v[160:163], a[96:99], v[224:227], v[160:163]
    ds_read_b64_tr_b16 v[240:241], v22 offset:16384
    ds_read_b64_tr_b16 v[242:243], v22 offset:17408
    v_mfma_f32_16x16x32_bf16 v[160:163], a[112:115], v[228:231], v[160:163]
    buffer_load_dwordx4 v19, s[60:63], s37 offen offset:3072 lds
    s_getpc_b64 s[50:51]
    v_mfma_f32_16x16x32_bf16 v[164:167], a[100:103], v[224:227], v[164:167]
    ds_read_b64_tr_b16 v[244:245], v22 offset:24576
    s_lshr_b32 s43, s2, 3
    s_lshl_b32 s43, s43, 2
    s_add_u32 s43, s43, s14
    v_mfma_f32_16x16x32_bf16 v[164:167], a[116:119], v[228:231], v[164:167]
    ds_read_b64_tr_b16 v[246:247], v22 offset:25600
    s_lshl_b32 s43, s43, 7
    v_min_u32 v11, 1, v0
    v_mfma_f32_16x16x32_bf16 v[168:171], a[104:107], v[224:227], v[168:171]
    ds_read_b64_tr_b16 v[248:249], v23 offset:16384
    v_lshlrev_b32 v11, 14, v11
    v_mfma_f32_16x16x32_bf16 v[168:171], a[120:123], v[228:231], v[168:171]
    v_add_u32 v11, s43, v11
    v_mfma_f32_16x16x32_bf16 v[172:175], a[108:111], v[224:227], v[172:175]
    global_load_dword v11, v11, s[50:51]
    v_mfma_f32_16x16x32_bf16 v[172:175], a[124:127], v[228:231], v[172:175]
    ds_read_b64_tr_b16 v[250:251], v23 offset:17408
    ds_read_b64_tr_b16 v[252:253], v23 offset:24576
    v_mfma_f32_16x16x32_bf16 v[176:179], a[96:99], v[232:235], v[176:179]
    s_add_u32 s76, s72, 2
    s_cmp_ge_u32 s76, 8
    s_cselect_b32 s6, 7, 0
    s_sub_u32 s76, s76, s6
    s_mul_i32 s76, s76, 2048
    s_add_u32 s77, s76, s40
    buffer_load_dwordx4 a[64:67], v6, s[24:27], s77 offen offset:0 sc1
    v_mfma_f32_16x16x32_bf16 v[176:179], a[112:115], v[236:239], v[176:179]
    ds_read_b64_tr_b16 v[254:255], v23 offset:25600
    v_mfma_f32_16x16x32_bf16 v[180:183], a[100:103], v[232:235], v[180:183]
    v_mfma_f32_16x16x32_bf16 v[180:183], a[116:119], v[236:239], v[180:183]
    buffer_load_dwordx4 a[80:83], v6, s[24:27], s77 offen offset:1024 sc1
    v_mfma_f32_16x16x32_bf16 v[184:187], a[104:107], v[232:235], v[184:187]
    s_add_u32 s49, s75, 8192
    v_mfma_f32_16x16x32_bf16 v[184:187], a[120:123], v[236:239], v[184:187]
    buffer_store_dwordx4 v[56:59], v6, s[24:27], s49 offen offset:1024 sc1
    v_mfma_f32_16x16x32_bf16 v[188:191], a[108:111], v[232:235], v[188:191]
    v_mfma_f32_16x16x32_bf16 v[188:191], a[124:127], v[236:239], v[188:191]
    s_waitcnt lgkmcnt(0)
    v_mfma_f32_16x16x32_bf16 v[192:195], a[96:99], v[240:243], v[192:195]
    ds_read_b64_tr_b16 v[224:225], v24 offset:16384
    ds_read_b64_tr_b16 v[226:227], v24 offset:17408
    v_mfma_f32_16x16x32_bf16 v[192:195], a[112:115], v[244:247], v[192:195]
    ds_read_b64_tr_b16 v[228:229], v24 offset:24576
    s_add_u32 s77, s76, s40
    s_add_u32 s77, s77, 16384
    v_mfma_f32_16x16x32_bf16 v[196:199], a[100:103], v[240:243], v[196:199]
    v_mfma_f32_16x16x32_bf16 v[196:199], a[116:119], v[244:247], v[196:199]
    ds_read_b64_tr_b16 v[230:231], v24 offset:25600
    v_mfma_f32_16x16x32_bf16 v[200:203], a[104:107], v[240:243], v[200:203]
    buffer_load_dwordx4 a[68:71], v6, s[24:27], s77 offen offset:0 sc1
    v_mfma_f32_16x16x32_bf16 v[200:203], a[120:123], v[244:247], v[200:203]
    ds_read_b64_tr_b16 v[232:233], v25 offset:16384
    v_mfma_f32_16x16x32_bf16 v[204:207], a[108:111], v[240:243], v[204:207]
    ds_read_b64_tr_b16 v[234:235], v25 offset:17408
    v_mfma_f32_16x16x32_bf16 v[204:207], a[124:127], v[244:247], v[204:207]
    ds_read_b64_tr_b16 v[236:237], v25 offset:24576
    v_mfma_f32_16x16x32_bf16 v[208:211], a[96:99], v[248:251], v[208:211]
    buffer_load_dwordx4 a[84:87], v6, s[24:27], s77 offen offset:1024 sc1
    v_mfma_f32_16x16x32_bf16 v[208:211], a[112:115], v[252:255], v[208:211]
    ds_read_b64_tr_b16 v[238:239], v25 offset:25600
    v_mfma_f32_16x16x32_bf16 v[212:215], a[100:103], v[248:251], v[212:215]
    v_mfma_f32_16x16x32_bf16 v[212:215], a[116:119], v[252:255], v[212:215]
    v_mfma_f32_16x16x32_bf16 v[216:219], a[104:107], v[248:251], v[216:219]
    v_mfma_f32_16x16x32_bf16 v[216:219], a[120:123], v[252:255], v[216:219]
    v_mfma_f32_16x16x32_bf16 v[220:223], a[108:111], v[248:251], v[220:223]
    v_mfma_f32_16x16x32_bf16 v[220:223], a[124:127], v[252:255], v[220:223]
    s_waitcnt lgkmcnt(0)
    v_mfma_f32_16x16x32_bf16 v[96:99], a[96:99], v[224:227], v[96:99]
    ds_read_b64_tr_b16 v[240:241], v26 offset:16384
    ds_read_b64_tr_b16 v[242:243], v26 offset:17408
    v_mfma_f32_16x16x32_bf16 v[96:99], a[112:115], v[228:231], v[96:99]
    s_add_u32 s77, s76, s41
    buffer_load_dwordx4 a[72:75], v6, s[24:27], s77 offen offset:0 sc1
    v_mfma_f32_16x16x32_bf16 v[100:103], a[100:103], v[224:227], v[100:103]
    ds_read_b64_tr_b16 v[244:245], v26 offset:24576
    v_mfma_f32_16x16x32_bf16 v[100:103], a[116:119], v[228:231], v[100:103]
    ds_read_b64_tr_b16 v[246:247], v26 offset:25600
    v_mfma_f32_16x16x32_bf16 v[104:107], a[104:107], v[224:227], v[104:107]
    ds_read_b64_tr_b16 v[248:249], v27 offset:16384
    v_mfma_f32_16x16x32_bf16 v[104:107], a[120:123], v[228:231], v[104:107]
    buffer_load_dwordx4 a[88:91], v6, s[24:27], s77 offen offset:1024 sc1
    v_mfma_f32_16x16x32_bf16 v[108:111], a[108:111], v[224:227], v[108:111]
    ds_read_b64_tr_b16 v[250:251], v27 offset:17408
    v_mfma_f32_16x16x32_bf16 v[108:111], a[124:127], v[228:231], v[108:111]
    ds_read_b64_tr_b16 v[252:253], v27 offset:24576
    v_mfma_f32_16x16x32_bf16 v[112:115], a[96:99], v[232:235], v[112:115]
    v_mfma_f32_16x16x32_bf16 v[112:115], a[112:115], v[236:239], v[112:115]
    ds_read_b64_tr_b16 v[254:255], v27 offset:25600
    s_add_u32 s49, s75, 12288
    v_mfma_f32_16x16x32_bf16 v[116:119], a[100:103], v[232:235], v[116:119]
    buffer_store_dwordx4 v[60:63], v6, s[24:27], s49 offen offset:1024 sc1
    v_mfma_f32_16x16x32_bf16 v[116:119], a[116:119], v[236:239], v[116:119]
    v_mfma_f32_16x16x32_bf16 v[120:123], a[104:107], v[232:235], v[120:123]
    v_mfma_f32_16x16x32_bf16 v[120:123], a[120:123], v[236:239], v[120:123]
    v_mfma_f32_16x16x32_bf16 v[124:127], a[108:111], v[232:235], v[124:127]
    v_mfma_f32_16x16x32_bf16 v[124:127], a[124:127], v[236:239], v[124:127]
    s_waitcnt vmcnt(38) lgkmcnt(0)
    v_mfma_f32_16x16x32_bf16 v[128:131], a[96:99], v[240:243], v[128:131]
    s_barrier
    ds_read_b64_tr_b16 v[224:225], v20 offset:32768
    ds_read_b64_tr_b16 v[226:227], v20 offset:33792
    v_mfma_f32_16x16x32_bf16 v[128:131], a[112:115], v[244:247], v[128:131]
    s_add_u32 s37, s72, 7
    s_cmp_ge_u32 s37, 8
    s_cselect_b32 s6, 7, 0
    s_sub_u32 s37, s37, s6
    s_mul_i32 s37, s37, 524288
    s_add_u32 m0, s33, 114688
    s_add_u32 s37, s37, s42
    buffer_load_dwordx4 v16, s[60:63], s37 offen lds
    v_mfma_f32_16x16x32_bf16 v[132:135], a[100:103], v[240:243], v[132:135]
    ds_read_b64_tr_b16 v[228:229], v20 offset:40960
    v_mfma_f32_16x16x32_bf16 v[132:135], a[116:119], v[244:247], v[132:135]
    ds_read_b64_tr_b16 v[230:231], v20 offset:41984
    v_mfma_f32_16x16x32_bf16 v[136:139], a[104:107], v[240:243], v[136:139]
    ds_read_b64_tr_b16 v[232:233], v21 offset:32768
    v_mfma_f32_16x16x32_bf16 v[136:139], a[120:123], v[244:247], v[136:139]
    buffer_load_dwordx4 v17, s[60:63], s37 offen offset:1024 lds
    v_mfma_f32_16x16x32_bf16 v[140:143], a[108:111], v[240:243], v[140:143]
    ds_read_b64_tr_b16 v[234:235], v21 offset:33792
    v_mfma_f32_16x16x32_bf16 v[140:143], a[124:127], v[244:247], v[140:143]
    buffer_load_dwordx4 v18, s[60:63], s37 offen offset:2048 lds
    v_mfma_f32_16x16x32_bf16 v[144:147], a[96:99], v[248:251], v[144:147]
    ds_read_b64_tr_b16 v[236:237], v21 offset:40960
    v_mfma_f32_16x16x32_bf16 v[144:147], a[112:115], v[252:255], v[144:147]
    ds_read_b64_tr_b16 v[238:239], v21 offset:41984
    s_add_u32 s77, s76, s41
    v_mfma_f32_16x16x32_bf16 v[148:151], a[100:103], v[248:251], v[148:151]
    s_add_u32 s77, s77, 16384
    buffer_load_dwordx4 a[76:79], v6, s[24:27], s77 offen offset:0 sc1
    v_mfma_f32_16x16x32_bf16 v[148:151], a[116:119], v[252:255], v[148:151]
    v_mfma_f32_16x16x32_bf16 v[152:155], a[104:107], v[248:251], v[152:155]
    buffer_load_dwordx4 a[92:95], v6, s[24:27], s77 offen offset:1024 sc1
    v_mfma_f32_16x16x32_bf16 v[152:155], a[120:123], v[252:255], v[152:155]
    v_mfma_f32_16x16x32_bf16 v[156:159], a[108:111], v[248:251], v[156:159]
    v_mfma_f32_16x16x32_bf16 v[156:159], a[124:127], v[252:255], v[156:159]
    s_waitcnt lgkmcnt(0)
    v_mfma_f32_16x16x32_bf16 v[160:163], a[128:131], v[224:227], v[160:163]
    ds_read_b64_tr_b16 v[240:241], v22 offset:32768
    ds_read_b64_tr_b16 v[242:243], v22 offset:33792
    v_mfma_f32_16x16x32_bf16 v[160:163], a[144:147], v[228:231], v[160:163]
    buffer_load_dwordx4 v19, s[60:63], s37 offen offset:3072 lds
    v_mfma_f32_16x16x32_bf16 v[164:167], a[132:135], v[224:227], v[164:167]
    ds_read_b64_tr_b16 v[244:245], v22 offset:40960
    v_mfma_f32_16x16x32_bf16 v[164:167], a[148:151], v[228:231], v[164:167]
    s_add_u32 s76, s72, 3
    s_cmp_ge_u32 s76, 8
    s_cselect_b32 s6, 7, 0
    s_sub_u32 s76, s76, s6
    s_mul_i32 s76, s76, 2048
    s_add_u32 s77, s76, s40
    buffer_load_dwordx4 a[96:99], v6, s[24:27], s77 offen offset:0 sc1
    v_mfma_f32_16x16x32_bf16 v[168:171], a[136:139], v[224:227], v[168:171]
    ds_read_b64_tr_b16 v[246:247], v22 offset:41984
    ds_read_b64_tr_b16 v[248:249], v23 offset:32768
    v_mfma_f32_16x16x32_bf16 v[168:171], a[152:155], v[228:231], v[168:171]
    v_mfma_f32_16x16x32_bf16 v[172:175], a[140:143], v[224:227], v[172:175]
    ds_read_b64_tr_b16 v[250:251], v23 offset:33792
    v_mfma_f32_16x16x32_bf16 v[172:175], a[156:159], v[228:231], v[172:175]
    ds_read_b64_tr_b16 v[252:253], v23 offset:40960
    v_mfma_f32_16x16x32_bf16 v[176:179], a[128:131], v[232:235], v[176:179]
    buffer_load_dwordx4 a[112:115], v6, s[24:27], s77 offen offset:1024 sc1
    v_mfma_f32_16x16x32_bf16 v[176:179], a[144:147], v[236:239], v[176:179]
    ds_read_b64_tr_b16 v[254:255], v23 offset:41984
    v_mfma_f32_16x16x32_bf16 v[180:183], a[132:135], v[232:235], v[180:183]
    v_mfma_f32_16x16x32_bf16 v[180:183], a[148:151], v[236:239], v[180:183]
    s_add_u32 s49, s75, 0
    v_mfma_f32_16x16x32_bf16 v[184:187], a[136:139], v[232:235], v[184:187]
    buffer_store_dwordx4 v[64:67], v6, s[24:27], s49 offen offset:2048 sc1
    v_mfma_f32_16x16x32_bf16 v[184:187], a[152:155], v[236:239], v[184:187]
    v_mfma_f32_16x16x32_bf16 v[188:191], a[140:143], v[232:235], v[188:191]
    v_mfma_f32_16x16x32_bf16 v[188:191], a[156:159], v[236:239], v[188:191]
    s_waitcnt lgkmcnt(0)
    v_mfma_f32_16x16x32_bf16 v[192:195], a[128:131], v[240:243], v[192:195]
    ds_read_b64_tr_b16 v[224:225], v24 offset:32768
    ds_read_b64_tr_b16 v[226:227], v24 offset:33792
    v_mfma_f32_16x16x32_bf16 v[192:195], a[144:147], v[244:247], v[192:195]
    ds_read_b64_tr_b16 v[228:229], v24 offset:40960
    s_add_u32 s77, s76, s40
    s_add_u32 s77, s77, 16384
    v_mfma_f32_16x16x32_bf16 v[196:199], a[132:135], v[240:243], v[196:199]
    buffer_load_dwordx4 a[100:103], v6, s[24:27], s77 offen offset:0 sc1
    v_mfma_f32_16x16x32_bf16 v[196:199], a[148:151], v[244:247], v[196:199]
    ds_read_b64_tr_b16 v[230:231], v24 offset:41984
    v_mfma_f32_16x16x32_bf16 v[200:203], a[136:139], v[240:243], v[200:203]
    ds_read_b64_tr_b16 v[232:233], v25 offset:32768
    v_mfma_f32_16x16x32_bf16 v[200:203], a[152:155], v[244:247], v[200:203]
    buffer_load_dwordx4 a[116:119], v6, s[24:27], s77 offen offset:1024 sc1
    v_mfma_f32_16x16x32_bf16 v[204:207], a[140:143], v[240:243], v[204:207]
    ds_read_b64_tr_b16 v[234:235], v25 offset:33792
    v_mfma_f32_16x16x32_bf16 v[204:207], a[156:159], v[244:247], v[204:207]
    ds_read_b64_tr_b16 v[236:237], v25 offset:40960
    v_mfma_f32_16x16x32_bf16 v[208:211], a[128:131], v[248:251], v[208:211]
    v_mfma_f32_16x16x32_bf16 v[208:211], a[144:147], v[252:255], v[208:211]
    ds_read_b64_tr_b16 v[238:239], v25 offset:41984
    s_add_u32 s49, s75, 4096
    v_mfma_f32_16x16x32_bf16 v[212:215], a[132:135], v[248:251], v[212:215]
    buffer_store_dwordx4 v[68:71], v6, s[24:27], s49 offen offset:2048 sc1
    v_mfma_f32_16x16x32_bf16 v[212:215], a[148:151], v[252:255], v[212:215]
    v_mfma_f32_16x16x32_bf16 v[216:219], a[136:139], v[248:251], v[216:219]
    v_mfma_f32_16x16x32_bf16 v[216:219], a[152:155], v[252:255], v[216:219]
    v_mfma_f32_16x16x32_bf16 v[220:223], a[140:143], v[248:251], v[220:223]
    v_mfma_f32_16x16x32_bf16 v[220:223], a[156:159], v[252:255], v[220:223]
    s_waitcnt lgkmcnt(0)
    v_mfma_f32_16x16x32_bf16 v[96:99], a[128:131], v[224:227], v[96:99]
    ds_read_b64_tr_b16 v[240:241], v26 offset:32768
    ds_read_b64_tr_b16 v[242:243], v26 offset:33792
    v_mfma_f32_16x16x32_bf16 v[96:99], a[144:147], v[228:231], v[96:99]
    ds_read_b64_tr_b16 v[244:245], v26 offset:40960
    s_add_u32 s77, s76, s41
    v_mfma_f32_16x16x32_bf16 v[100:103], a[132:135], v[224:227], v[100:103]
    buffer_load_dwordx4 a[104:107], v6, s[24:27], s77 offen offset:0 sc1
    v_mfma_f32_16x16x32_bf16 v[100:103], a[148:151], v[228:231], v[100:103]
    ds_read_b64_tr_b16 v[246:247], v26 offset:41984
    v_mfma_f32_16x16x32_bf16 v[104:107], a[136:139], v[224:227], v[104:107]
    ds_read_b64_tr_b16 v[248:249], v27 offset:32768
    v_mfma_f32_16x16x32_bf16 v[104:107], a[152:155], v[228:231], v[104:107]
    v_mfma_f32_16x16x32_bf16 v[108:111], a[140:143], v[224:227], v[108:111]
    ds_read_b64_tr_b16 v[250:251], v27 offset:33792
    v_mfma_f32_16x16x32_bf16 v[108:111], a[156:159], v[228:231], v[108:111]
    ds_read_b64_tr_b16 v[252:253], v27 offset:40960
    v_mfma_f32_16x16x32_bf16 v[112:115], a[128:131], v[232:235], v[112:115]
    buffer_load_dwordx4 a[120:123], v6, s[24:27], s77 offen offset:1024 sc1
    v_mfma_f32_16x16x32_bf16 v[112:115], a[144:147], v[236:239], v[112:115]
    ds_read_b64_tr_b16 v[254:255], v27 offset:41984
    v_mfma_f32_16x16x32_bf16 v[116:119], a[132:135], v[232:235], v[116:119]
    v_mfma_f32_16x16x32_bf16 v[116:119], a[148:151], v[236:239], v[116:119]
    v_mfma_f32_16x16x32_bf16 v[120:123], a[136:139], v[232:235], v[120:123]
    v_mfma_f32_16x16x32_bf16 v[120:123], a[152:155], v[236:239], v[120:123]
    v_mfma_f32_16x16x32_bf16 v[124:127], a[140:143], v[232:235], v[124:127]
    v_mfma_f32_16x16x32_bf16 v[124:127], a[156:159], v[236:239], v[124:127]
    s_waitcnt vmcnt(37) lgkmcnt(0)
    v_mfma_f32_16x16x32_bf16 v[128:131], a[128:131], v[240:243], v[128:131]
    s_barrier
    ds_read_b64_tr_b16 v[224:225], v20 offset:49152
    ds_read_b64_tr_b16 v[226:227], v20 offset:50176
    v_mfma_f32_16x16x32_bf16 v[128:131], a[144:147], v[244:247], v[128:131]
    s_mov_b32 s37, 0
    s_add_u32 m0, s33, 131072
    s_add_u32 s37, s37, s42
    v_mfma_f32_16x16x32_bf16 v[132:135], a[132:135], v[240:243], v[132:135]
    buffer_load_dwordx4 v16, s[20:23], s37 offen lds
    v_mfma_f32_16x16x32_bf16 v[132:135], a[148:151], v[244:247], v[132:135]
    ds_read_b64_tr_b16 v[228:229], v20 offset:57344
    ds_read_b64_tr_b16 v[230:231], v20 offset:58368
    v_mfma_f32_16x16x32_bf16 v[136:139], a[136:139], v[240:243], v[136:139]
    buffer_load_dwordx4 v17, s[20:23], s37 offen offset:1024 lds
    v_mfma_f32_16x16x32_bf16 v[136:139], a[152:155], v[244:247], v[136:139]
    ds_read_b64_tr_b16 v[232:233], v21 offset:49152
    v_mfma_f32_16x16x32_bf16 v[140:143], a[140:143], v[240:243], v[140:143]
    buffer_load_dwordx4 v18, s[20:23], s37 offen offset:2048 lds
    v_mfma_f32_16x16x32_bf16 v[140:143], a[156:159], v[244:247], v[140:143]
    ds_read_b64_tr_b16 v[234:235], v21 offset:50176
    s_add_u32 s77, s76, s41
    s_add_u32 s77, s77, 16384
    v_mfma_f32_16x16x32_bf16 v[144:147], a[128:131], v[248:251], v[144:147]
    ds_read_b64_tr_b16 v[236:237], v21 offset:57344
    v_mfma_f32_16x16x32_bf16 v[144:147], a[144:147], v[252:255], v[144:147]
    buffer_load_dwordx4 a[108:111], v6, s[24:27], s77 offen offset:0 sc1
    v_mfma_f32_16x16x32_bf16 v[148:151], a[132:135], v[248:251], v[148:151]
    ds_read_b64_tr_b16 v[238:239], v21 offset:58368
    v_mfma_f32_16x16x32_bf16 v[148:151], a[148:151], v[252:255], v[148:151]
    buffer_load_dwordx4 a[124:127], v6, s[24:27], s77 offen offset:1024 sc1
    v_mfma_f32_16x16x32_bf16 v[152:155], a[136:139], v[248:251], v[152:155]
    s_add_u32 s49, s75, 8192
    buffer_store_dwordx4 v[72:75], v6, s[24:27], s49 offen offset:2048 sc1
    v_mfma_f32_16x16x32_bf16 v[152:155], a[152:155], v[252:255], v[152:155]
    v_mfma_f32_16x16x32_bf16 v[156:159], a[140:143], v[248:251], v[156:159]
    v_mfma_f32_16x16x32_bf16 v[156:159], a[156:159], v[252:255], v[156:159]
    s_waitcnt lgkmcnt(0)
    v_mfma_f32_16x16x32_bf16 v[160:163], a[160:163], v[224:227], v[160:163]
    ds_read_b64_tr_b16 v[240:241], v22 offset:49152
    ds_read_b64_tr_b16 v[242:243], v22 offset:50176
    v_mfma_f32_16x16x32_bf16 v[160:163], a[176:179], v[228:231], v[160:163]
    buffer_load_dwordx4 v19, s[20:23], s37 offen offset:3072 lds
    v_mfma_f32_16x16x32_bf16 v[164:167], a[164:167], v[224:227], v[164:167]
    ds_read_b64_tr_b16 v[244:245], v22 offset:57344
    v_mfma_f32_16x16x32_bf16 v[164:167], a[180:183], v[228:231], v[164:167]
    s_add_u32 s76, s72, 4
    s_cmp_ge_u32 s76, 8
    s_cselect_b32 s6, 7, 0
    s_sub_u32 s76, s76, s6
    s_mul_i32 s76, s76, 2048
    s_add_u32 s77, s76, s40
    buffer_load_dwordx4 a[128:131], v6, s[24:27], s77 offen offset:0 sc1
    v_mfma_f32_16x16x32_bf16 v[168:171], a[168:171], v[224:227], v[168:171]
    ds_read_b64_tr_b16 v[246:247], v22 offset:58368
    ds_read_b64_tr_b16 v[248:249], v23 offset:49152
    v_mfma_f32_16x16x32_bf16 v[168:171], a[184:187], v[228:231], v[168:171]
    v_mfma_f32_16x16x32_bf16 v[172:175], a[172:175], v[224:227], v[172:175]
    ds_read_b64_tr_b16 v[250:251], v23 offset:50176
    v_mfma_f32_16x16x32_bf16 v[172:175], a[188:191], v[228:231], v[172:175]
    ds_read_b64_tr_b16 v[252:253], v23 offset:57344
    v_mfma_f32_16x16x32_bf16 v[176:179], a[160:163], v[232:235], v[176:179]
    v_mfma_f32_16x16x32_bf16 v[176:179], a[176:179], v[236:239], v[176:179]
    ds_read_b64_tr_b16 v[254:255], v23 offset:58368
    v_mfma_f32_16x16x32_bf16 v[180:183], a[164:167], v[232:235], v[180:183]
    v_mfma_f32_16x16x32_bf16 v[180:183], a[180:183], v[236:239], v[180:183]
    buffer_load_dwordx4 a[144:147], v6, s[24:27], s77 offen offset:1024 sc1
    v_mfma_f32_16x16x32_bf16 v[184:187], a[168:171], v[232:235], v[184:187]
    v_mfma_f32_16x16x32_bf16 v[184:187], a[184:187], v[236:239], v[184:187]
    v_mfma_f32_16x16x32_bf16 v[188:191], a[172:175], v[232:235], v[188:191]
    v_mfma_f32_16x16x32_bf16 v[188:191], a[188:191], v[236:239], v[188:191]
    s_waitcnt lgkmcnt(0)
    v_mfma_f32_16x16x32_bf16 v[192:195], a[160:163], v[240:243], v[192:195]
    ds_read_b64_tr_b16 v[224:225], v24 offset:49152
    ds_read_b64_tr_b16 v[226:227], v24 offset:50176
    v_mfma_f32_16x16x32_bf16 v[192:195], a[176:179], v[244:247], v[192:195]
    ds_read_b64_tr_b16 v[228:229], v24 offset:57344
    s_add_u32 s77, s76, s40
    s_add_u32 s77, s77, 16384
    v_mfma_f32_16x16x32_bf16 v[196:199], a[164:167], v[240:243], v[196:199]
    buffer_load_dwordx4 a[132:135], v6, s[24:27], s77 offen offset:0 sc1
    v_mfma_f32_16x16x32_bf16 v[196:199], a[180:183], v[244:247], v[196:199]
    ds_read_b64_tr_b16 v[230:231], v24 offset:58368
    v_mfma_f32_16x16x32_bf16 v[200:203], a[168:171], v[240:243], v[200:203]
    ds_read_b64_tr_b16 v[232:233], v25 offset:49152
    v_mfma_f32_16x16x32_bf16 v[200:203], a[184:187], v[244:247], v[200:203]
    buffer_load_dwordx4 a[148:151], v6, s[24:27], s77 offen offset:1024 sc1
    v_mfma_f32_16x16x32_bf16 v[204:207], a[172:175], v[240:243], v[204:207]
    ds_read_b64_tr_b16 v[234:235], v25 offset:50176
    v_mfma_f32_16x16x32_bf16 v[204:207], a[188:191], v[244:247], v[204:207]
    ds_read_b64_tr_b16 v[236:237], v25 offset:57344
    v_mfma_f32_16x16x32_bf16 v[208:211], a[160:163], v[248:251], v[208:211]
    v_mfma_f32_16x16x32_bf16 v[208:211], a[176:179], v[252:255], v[208:211]
    ds_read_b64_tr_b16 v[238:239], v25 offset:58368
    s_add_u32 s49, s75, 12288
    v_mfma_f32_16x16x32_bf16 v[212:215], a[164:167], v[248:251], v[212:215]
    buffer_store_dwordx4 v[76:79], v6, s[24:27], s49 offen offset:2048 sc1
    v_mfma_f32_16x16x32_bf16 v[212:215], a[180:183], v[252:255], v[212:215]
    v_mfma_f32_16x16x32_bf16 v[216:219], a[168:171], v[248:251], v[216:219]
    v_mfma_f32_16x16x32_bf16 v[216:219], a[184:187], v[252:255], v[216:219]
    v_mfma_f32_16x16x32_bf16 v[220:223], a[172:175], v[248:251], v[220:223]
    v_mfma_f32_16x16x32_bf16 v[220:223], a[188:191], v[252:255], v[220:223]
    s_waitcnt lgkmcnt(0)
    v_mfma_f32_16x16x32_bf16 v[96:99], a[160:163], v[224:227], v[96:99]
    ds_read_b64_tr_b16 v[240:241], v26 offset:49152
    ds_read_b64_tr_b16 v[242:243], v26 offset:50176
    v_mfma_f32_16x16x32_bf16 v[96:99], a[176:179], v[228:231], v[96:99]
    ds_read_b64_tr_b16 v[244:245], v26 offset:57344
    s_add_u32 s77, s76, s41
    v_mfma_f32_16x16x32_bf16 v[100:103], a[164:167], v[224:227], v[100:103]
    buffer_load_dwordx4 a[136:139], v6, s[24:27], s77 offen offset:0 sc1
    v_mfma_f32_16x16x32_bf16 v[100:103], a[180:183], v[228:231], v[100:103]
    ds_read_b64_tr_b16 v[246:247], v26 offset:58368
    v_mfma_f32_16x16x32_bf16 v[104:107], a[168:171], v[224:227], v[104:107]
    ds_read_b64_tr_b16 v[248:249], v27 offset:49152
    v_mfma_f32_16x16x32_bf16 v[104:107], a[184:187], v[228:231], v[104:107]
    v_mfma_f32_16x16x32_bf16 v[108:111], a[172:175], v[224:227], v[108:111]
    ds_read_b64_tr_b16 v[250:251], v27 offset:50176
    v_mfma_f32_16x16x32_bf16 v[108:111], a[188:191], v[228:231], v[108:111]
    ds_read_b64_tr_b16 v[252:253], v27 offset:57344
    v_mfma_f32_16x16x32_bf16 v[112:115], a[160:163], v[232:235], v[112:115]
    buffer_load_dwordx4 a[152:155], v6, s[24:27], s77 offen offset:1024 sc1
    v_mfma_f32_16x16x32_bf16 v[112:115], a[176:179], v[236:239], v[112:115]
    ds_read_b64_tr_b16 v[254:255], v27 offset:58368
    v_mfma_f32_16x16x32_bf16 v[116:119], a[164:167], v[232:235], v[116:119]
    v_mfma_f32_16x16x32_bf16 v[116:119], a[180:183], v[236:239], v[116:119]
    v_mfma_f32_16x16x32_bf16 v[120:123], a[168:171], v[232:235], v[120:123]
    v_mfma_f32_16x16x32_bf16 v[120:123], a[184:187], v[236:239], v[120:123]
    v_mfma_f32_16x16x32_bf16 v[124:127], a[172:175], v[232:235], v[124:127]
    v_mfma_f32_16x16x32_bf16 v[124:127], a[188:191], v[236:239], v[124:127]
    s_waitcnt vmcnt(37) lgkmcnt(0)
    v_mfma_f32_16x16x32_bf16 v[128:131], a[160:163], v[240:243], v[128:131]
    s_barrier
    ds_read_b64_tr_b16 v[224:225], v20 offset:0
    ds_read_b64_tr_b16 v[226:227], v20 offset:1024
    v_mfma_f32_16x16x32_bf16 v[128:131], a[176:179], v[244:247], v[128:131]
    s_add_u32 s37, s72, 1
    s_cmp_ge_u32 s37, 8
    s_cselect_b32 s6, 7, 0
    s_sub_u32 s37, s37, s6
    s_mul_i32 s37, s37, 524288
    s_add_u32 m0, s33, 147456
    s_add_u32 s37, s37, s42
    buffer_load_dwordx4 v16, s[20:23], s37 offen lds
    v_mfma_f32_16x16x32_bf16 v[132:135], a[164:167], v[240:243], v[132:135]
    ds_read_b64_tr_b16 v[228:229], v20 offset:8192
    v_mfma_f32_16x16x32_bf16 v[132:135], a[180:183], v[244:247], v[132:135]
    ds_read_b64_tr_b16 v[230:231], v20 offset:9216
    v_mfma_f32_16x16x32_bf16 v[136:139], a[168:171], v[240:243], v[136:139]
    ds_read_b64_tr_b16 v[232:233], v21 offset:0
    v_mfma_f32_16x16x32_bf16 v[136:139], a[184:187], v[244:247], v[136:139]
    buffer_load_dwordx4 v17, s[20:23], s37 offen offset:1024 lds
    v_mfma_f32_16x16x32_bf16 v[140:143], a[172:175], v[240:243], v[140:143]
    ds_read_b64_tr_b16 v[234:235], v21 offset:1024
    v_mfma_f32_16x16x32_bf16 v[140:143], a[188:191], v[244:247], v[140:143]
    buffer_load_dwordx4 v18, s[20:23], s37 offen offset:2048 lds
    v_mfma_f32_16x16x32_bf16 v[144:147], a[160:163], v[248:251], v[144:147]
    ds_read_b64_tr_b16 v[236:237], v21 offset:8192
    s_add_u32 s77, s76, s41
    s_add_u32 s77, s77, 16384
    v_mfma_f32_16x16x32_bf16 v[144:147], a[176:179], v[252:255], v[144:147]
    ds_read_b64_tr_b16 v[238:239], v21 offset:9216
    v_mfma_f32_16x16x32_bf16 v[148:151], a[164:167], v[248:251], v[148:151]
    buffer_load_dwordx4 a[140:143], v6, s[24:27], s77 offen offset:0 sc1
    v_mfma_f32_16x16x32_bf16 v[148:151], a[180:183], v[252:255], v[148:151]
    buffer_load_dwordx4 a[156:159], v6, s[24:27], s77 offen offset:1024 sc1
    v_mfma_f32_16x16x32_bf16 v[152:155], a[168:171], v[248:251], v[152:155]
    s_add_u32 s49, s75, 0
    buffer_store_dwordx4 v[80:83], v6, s[24:27], s49 offen offset:3072 sc1
    v_mfma_f32_16x16x32_bf16 v[152:155], a[184:187], v[252:255], v[152:155]
    v_mfma_f32_16x16x32_bf16 v[156:159], a[172:175], v[248:251], v[156:159]
    v_mfma_f32_16x16x32_bf16 v[156:159], a[188:191], v[252:255], v[156:159]
    s_waitcnt lgkmcnt(0)
    v_mfma_f32_16x16x32_bf16 v[160:163], a[192:195], v[224:227], v[160:163]
    ds_read_b64_tr_b16 v[240:241], v22 offset:0
    ds_read_b64_tr_b16 v[242:243], v22 offset:1024
    v_mfma_f32_16x16x32_bf16 v[160:163], a[208:211], v[228:231], v[160:163]
    buffer_load_dwordx4 v19, s[20:23], s37 offen offset:3072 lds
    v_mfma_f32_16x16x32_bf16 v[164:167], a[196:199], v[224:227], v[164:167]
    ds_read_b64_tr_b16 v[244:245], v22 offset:8192
    v_mfma_f32_16x16x32_bf16 v[164:167], a[212:215], v[228:231], v[164:167]
    s_add_u32 s76, s72, 5
    s_cmp_ge_u32 s76, 8
    s_cselect_b32 s6, 7, 0
    s_sub_u32 s76, s76, s6
    s_mul_i32 s76, s76, 2048
    s_add_u32 s77, s76, s40
    buffer_load_dwordx4 a[160:163], v6, s[24:27], s77 offen offset:0 sc1
    v_mfma_f32_16x16x32_bf16 v[168:171], a[200:203], v[224:227], v[168:171]
    ds_read_b64_tr_b16 v[246:247], v22 offset:9216
    ds_read_b64_tr_b16 v[248:249], v23 offset:0
    v_mfma_f32_16x16x32_bf16 v[168:171], a[216:219], v[228:231], v[168:171]
    v_mfma_f32_16x16x32_bf16 v[172:175], a[204:207], v[224:227], v[172:175]
    ds_read_b64_tr_b16 v[250:251], v23 offset:1024
    v_mfma_f32_16x16x32_bf16 v[172:175], a[220:223], v[228:231], v[172:175]
    ds_read_b64_tr_b16 v[252:253], v23 offset:8192
    v_mfma_f32_16x16x32_bf16 v[176:179], a[192:195], v[232:235], v[176:179]
    v_mfma_f32_16x16x32_bf16 v[176:179], a[208:211], v[236:239], v[176:179]
    ds_read_b64_tr_b16 v[254:255], v23 offset:9216
    v_mfma_f32_16x16x32_bf16 v[180:183], a[196:199], v[232:235], v[180:183]
    v_mfma_f32_16x16x32_bf16 v[180:183], a[212:215], v[236:239], v[180:183]
    buffer_load_dwordx4 a[176:179], v6, s[24:27], s77 offen offset:1024 sc1
    v_mfma_f32_16x16x32_bf16 v[184:187], a[200:203], v[232:235], v[184:187]
    v_mfma_f32_16x16x32_bf16 v[184:187], a[216:219], v[236:239], v[184:187]
    v_mfma_f32_16x16x32_bf16 v[188:191], a[204:207], v[232:235], v[188:191]
    v_mfma_f32_16x16x32_bf16 v[188:191], a[220:223], v[236:239], v[188:191]
    s_waitcnt lgkmcnt(0)
    v_mfma_f32_16x16x32_bf16 v[192:195], a[192:195], v[240:243], v[192:195]
    ds_read_b64_tr_b16 v[224:225], v24 offset:0
    ds_read_b64_tr_b16 v[226:227], v24 offset:1024
    v_mfma_f32_16x16x32_bf16 v[192:195], a[208:211], v[244:247], v[192:195]
    ds_read_b64_tr_b16 v[228:229], v24 offset:8192
    s_add_u32 s77, s76, s40
    s_add_u32 s77, s77, 16384
    v_mfma_f32_16x16x32_bf16 v[196:199], a[196:199], v[240:243], v[196:199]
    buffer_load_dwordx4 a[164:167], v6, s[24:27], s77 offen offset:0 sc1
    v_mfma_f32_16x16x32_bf16 v[196:199], a[212:215], v[244:247], v[196:199]
    ds_read_b64_tr_b16 v[230:231], v24 offset:9216
    v_mfma_f32_16x16x32_bf16 v[200:203], a[200:203], v[240:243], v[200:203]
    ds_read_b64_tr_b16 v[232:233], v25 offset:0
    v_mfma_f32_16x16x32_bf16 v[200:203], a[216:219], v[244:247], v[200:203]
    buffer_load_dwordx4 a[180:183], v6, s[24:27], s77 offen offset:1024 sc1
    v_mfma_f32_16x16x32_bf16 v[204:207], a[204:207], v[240:243], v[204:207]
    ds_read_b64_tr_b16 v[234:235], v25 offset:1024
    v_mfma_f32_16x16x32_bf16 v[204:207], a[220:223], v[244:247], v[204:207]
    ds_read_b64_tr_b16 v[236:237], v25 offset:8192
    v_mfma_f32_16x16x32_bf16 v[208:211], a[192:195], v[248:251], v[208:211]
    v_mfma_f32_16x16x32_bf16 v[208:211], a[208:211], v[252:255], v[208:211]
    ds_read_b64_tr_b16 v[238:239], v25 offset:9216
    s_add_u32 s49, s75, 4096
    v_mfma_f32_16x16x32_bf16 v[212:215], a[196:199], v[248:251], v[212:215]
    buffer_store_dwordx4 v[84:87], v6, s[24:27], s49 offen offset:3072 sc1
    v_mfma_f32_16x16x32_bf16 v[212:215], a[212:215], v[252:255], v[212:215]
    v_mfma_f32_16x16x32_bf16 v[216:219], a[200:203], v[248:251], v[216:219]
    v_mfma_f32_16x16x32_bf16 v[216:219], a[216:219], v[252:255], v[216:219]
    v_mfma_f32_16x16x32_bf16 v[220:223], a[204:207], v[248:251], v[220:223]
    v_mfma_f32_16x16x32_bf16 v[220:223], a[220:223], v[252:255], v[220:223]
    s_waitcnt lgkmcnt(0)
    v_mfma_f32_16x16x32_bf16 v[96:99], a[192:195], v[224:227], v[96:99]
    ds_read_b64_tr_b16 v[240:241], v26 offset:0
    ds_read_b64_tr_b16 v[242:243], v26 offset:1024
    v_mfma_f32_16x16x32_bf16 v[96:99], a[208:211], v[228:231], v[96:99]
    ds_read_b64_tr_b16 v[244:245], v26 offset:8192
    s_add_u32 s77, s76, s41
    v_mfma_f32_16x16x32_bf16 v[100:103], a[196:199], v[224:227], v[100:103]
    buffer_load_dwordx4 a[168:171], v6, s[24:27], s77 offen offset:0 sc1
    v_mfma_f32_16x16x32_bf16 v[100:103], a[212:215], v[228:231], v[100:103]
    ds_read_b64_tr_b16 v[246:247], v26 offset:9216
    v_mfma_f32_16x16x32_bf16 v[104:107], a[200:203], v[224:227], v[104:107]
    ds_read_b64_tr_b16 v[248:249], v27 offset:0
    v_mfma_f32_16x16x32_bf16 v[104:107], a[216:219], v[228:231], v[104:107]
    v_mfma_f32_16x16x32_bf16 v[108:111], a[204:207], v[224:227], v[108:111]
    ds_read_b64_tr_b16 v[250:251], v27 offset:1024
    v_mfma_f32_16x16x32_bf16 v[108:111], a[220:223], v[228:231], v[108:111]
    ds_read_b64_tr_b16 v[252:253], v27 offset:8192
    v_mfma_f32_16x16x32_bf16 v[112:115], a[192:195], v[232:235], v[112:115]
    buffer_load_dwordx4 a[184:187], v6, s[24:27], s77 offen offset:1024 sc1
    v_mfma_f32_16x16x32_bf16 v[112:115], a[208:211], v[236:239], v[112:115]
    ds_read_b64_tr_b16 v[254:255], v27 offset:9216
    v_mfma_f32_16x16x32_bf16 v[116:119], a[196:199], v[232:235], v[116:119]
    v_mfma_f32_16x16x32_bf16 v[116:119], a[212:215], v[236:239], v[116:119]
    v_mfma_f32_16x16x32_bf16 v[120:123], a[200:203], v[232:235], v[120:123]
    v_mfma_f32_16x16x32_bf16 v[120:123], a[216:219], v[236:239], v[120:123]
    v_mfma_f32_16x16x32_bf16 v[124:127], a[204:207], v[232:235], v[124:127]
    v_mfma_f32_16x16x32_bf16 v[124:127], a[220:223], v[236:239], v[124:127]
    s_waitcnt vmcnt(36) lgkmcnt(0)
    v_mfma_f32_16x16x32_bf16 v[128:131], a[192:195], v[240:243], v[128:131]
    s_barrier
    ds_read_b64_tr_b16 v[224:225], v20 offset:16384
    ds_read_b64_tr_b16 v[226:227], v20 offset:17408
    v_mfma_f32_16x16x32_bf16 v[128:131], a[208:211], v[244:247], v[128:131]
    s_add_u32 s37, s72, 2
    s_cmp_ge_u32 s37, 8
    s_cselect_b32 s6, 7, 0
    s_sub_u32 s37, s37, s6
    s_mul_i32 s37, s37, 524288
    s_add_u32 m0, s33, 98304
    s_add_u32 s37, s37, s42
    buffer_load_dwordx4 v16, s[20:23], s37 offen lds
    v_mfma_f32_16x16x32_bf16 v[132:135], a[196:199], v[240:243], v[132:135]
    ds_read_b64_tr_b16 v[228:229], v20 offset:24576
    v_mfma_f32_16x16x32_bf16 v[132:135], a[212:215], v[244:247], v[132:135]
    ds_read_b64_tr_b16 v[230:231], v20 offset:25600
    v_mfma_f32_16x16x32_bf16 v[136:139], a[200:203], v[240:243], v[136:139]
    ds_read_b64_tr_b16 v[232:233], v21 offset:16384
    v_mfma_f32_16x16x32_bf16 v[136:139], a[216:219], v[244:247], v[136:139]
    buffer_load_dwordx4 v17, s[20:23], s37 offen offset:1024 lds
    v_mfma_f32_16x16x32_bf16 v[140:143], a[204:207], v[240:243], v[140:143]
    ds_read_b64_tr_b16 v[234:235], v21 offset:17408
    v_mfma_f32_16x16x32_bf16 v[140:143], a[220:223], v[244:247], v[140:143]
    buffer_load_dwordx4 v18, s[20:23], s37 offen offset:2048 lds
    v_mfma_f32_16x16x32_bf16 v[144:147], a[192:195], v[248:251], v[144:147]
    ds_read_b64_tr_b16 v[236:237], v21 offset:24576
    s_add_u32 s77, s76, s41
    s_add_u32 s77, s77, 16384
    v_mfma_f32_16x16x32_bf16 v[144:147], a[208:211], v[252:255], v[144:147]
    ds_read_b64_tr_b16 v[238:239], v21 offset:25600
    v_mfma_f32_16x16x32_bf16 v[148:151], a[196:199], v[248:251], v[148:151]
    buffer_load_dwordx4 a[172:175], v6, s[24:27], s77 offen offset:0 sc1
    v_mfma_f32_16x16x32_bf16 v[148:151], a[212:215], v[252:255], v[148:151]
    buffer_load_dwordx4 a[188:191], v6, s[24:27], s77 offen offset:1024 sc1
    v_mfma_f32_16x16x32_bf16 v[152:155], a[200:203], v[248:251], v[152:155]
    s_add_u32 s49, s75, 8192
    buffer_store_dwordx4 v[88:91], v6, s[24:27], s49 offen offset:3072 sc1
    v_mfma_f32_16x16x32_bf16 v[152:155], a[216:219], v[252:255], v[152:155]
    v_mfma_f32_16x16x32_bf16 v[156:159], a[204:207], v[248:251], v[156:159]
    v_mfma_f32_16x16x32_bf16 v[156:159], a[220:223], v[252:255], v[156:159]
    s_waitcnt lgkmcnt(0)
    v_mfma_f32_16x16x32_bf16 v[160:163], a[224:227], v[224:227], v[160:163]
    ds_read_b64_tr_b16 v[240:241], v22 offset:16384
    ds_read_b64_tr_b16 v[242:243], v22 offset:17408
    v_mfma_f32_16x16x32_bf16 v[160:163], a[240:243], v[228:231], v[160:163]
    buffer_load_dwordx4 v19, s[20:23], s37 offen offset:3072 lds
    v_mfma_f32_16x16x32_bf16 v[164:167], a[228:231], v[224:227], v[164:167]
    ds_read_b64_tr_b16 v[244:245], v22 offset:24576
    v_mfma_f32_16x16x32_bf16 v[164:167], a[244:247], v[228:231], v[164:167]
    s_add_u32 s76, s72, 6
    s_cmp_ge_u32 s76, 8
    s_cselect_b32 s6, 7, 0
    s_sub_u32 s76, s76, s6
    s_mul_i32 s76, s76, 2048
    s_add_u32 s77, s76, s40
    buffer_load_dwordx4 a[192:195], v6, s[24:27], s77 offen offset:0 sc1
    v_mfma_f32_16x16x32_bf16 v[168:171], a[232:235], v[224:227], v[168:171]
    ds_read_b64_tr_b16 v[246:247], v22 offset:25600
    ds_read_b64_tr_b16 v[248:249], v23 offset:16384
    v_mfma_f32_16x16x32_bf16 v[168:171], a[248:251], v[228:231], v[168:171]
    v_mfma_f32_16x16x32_bf16 v[172:175], a[236:239], v[224:227], v[172:175]
    ds_read_b64_tr_b16 v[250:251], v23 offset:17408
    v_mfma_f32_16x16x32_bf16 v[172:175], a[252:255], v[228:231], v[172:175]
    ds_read_b64_tr_b16 v[252:253], v23 offset:24576
    v_mfma_f32_16x16x32_bf16 v[176:179], a[224:227], v[232:235], v[176:179]
    v_mfma_f32_16x16x32_bf16 v[176:179], a[240:243], v[236:239], v[176:179]
    ds_read_b64_tr_b16 v[254:255], v23 offset:25600
    v_mfma_f32_16x16x32_bf16 v[180:183], a[228:231], v[232:235], v[180:183]
    v_mfma_f32_16x16x32_bf16 v[180:183], a[244:247], v[236:239], v[180:183]
    buffer_load_dwordx4 a[208:211], v6, s[24:27], s77 offen offset:1024 sc1
    v_mfma_f32_16x16x32_bf16 v[184:187], a[232:235], v[232:235], v[184:187]
    v_mfma_f32_16x16x32_bf16 v[184:187], a[248:251], v[236:239], v[184:187]
    v_mfma_f32_16x16x32_bf16 v[188:191], a[236:239], v[232:235], v[188:191]
    v_mfma_f32_16x16x32_bf16 v[188:191], a[252:255], v[236:239], v[188:191]
    s_waitcnt lgkmcnt(0)
    v_mfma_f32_16x16x32_bf16 v[192:195], a[224:227], v[240:243], v[192:195]
    ds_read_b64_tr_b16 v[224:225], v24 offset:16384
    ds_read_b64_tr_b16 v[226:227], v24 offset:17408
    v_mfma_f32_16x16x32_bf16 v[192:195], a[240:243], v[244:247], v[192:195]
    ds_read_b64_tr_b16 v[228:229], v24 offset:24576
    s_add_u32 s77, s76, s40
    s_add_u32 s77, s77, 16384
    v_mfma_f32_16x16x32_bf16 v[196:199], a[228:231], v[240:243], v[196:199]
    v_cvt_pk_bf16_f32 v160, v160, v161
    v_cvt_pk_bf16_f32 v161, v162, v163
    v_mfma_f32_16x16x32_bf16 v[196:199], a[244:247], v[244:247], v[196:199]
    buffer_load_dwordx4 a[196:199], v6, s[24:27], s77 offen offset:0 sc1
    v_mfma_f32_16x16x32_bf16 v[200:203], a[232:235], v[240:243], v[200:203]
    ds_read_b64_tr_b16 v[230:231], v24 offset:25600
    v_cvt_pk_bf16_f32 v162, v164, v165
    v_mfma_f32_16x16x32_bf16 v[200:203], a[248:251], v[244:247], v[200:203]
    v_cvt_pk_bf16_f32 v163, v166, v167
    v_cvt_pk_bf16_f32 v164, v168, v169
    v_mfma_f32_16x16x32_bf16 v[204:207], a[236:239], v[240:243], v[204:207]
    ds_read_b64_tr_b16 v[232:233], v25 offset:16384
    v_cvt_pk_bf16_f32 v165, v170, v171
    v_mfma_f32_16x16x32_bf16 v[204:207], a[252:255], v[244:247], v[204:207]
    buffer_load_dwordx4 a[212:215], v6, s[24:27], s77 offen offset:1024 sc1
    v_mfma_f32_16x16x32_bf16 v[208:211], a[224:227], v[248:251], v[208:211]
    ds_read_b64_tr_b16 v[234:235], v25 offset:17408
    v_cvt_pk_bf16_f32 v166, v172, v173
    v_mfma_f32_16x16x32_bf16 v[208:211], a[240:243], v[252:255], v[208:211]
    ds_read_b64_tr_b16 v[236:237], v25 offset:24576
    v_cvt_pk_bf16_f32 v167, v174, v175
    v_mfma_f32_16x16x32_bf16 v[212:215], a[228:231], v[248:251], v[212:215]
    s_add_u32 s49, s75, 12288
    v_cvt_pk_bf16_f32 v168, v176, v177
    v_cvt_pk_bf16_f32 v169, v178, v179
    v_mfma_f32_16x16x32_bf16 v[212:215], a[244:247], v[252:255], v[212:215]
    ds_read_b64_tr_b16 v[238:239], v25 offset:25600
    v_cvt_pk_bf16_f32 v170, v180, v181
    v_mfma_f32_16x16x32_bf16 v[216:219], a[232:235], v[248:251], v[216:219]
    v_cvt_pk_bf16_f32 v171, v182, v183
    v_cvt_pk_bf16_f32 v172, v184, v185
    v_mfma_f32_16x16x32_bf16 v[216:219], a[248:251], v[252:255], v[216:219]
    buffer_store_dwordx4 v[92:95], v6, s[24:27], s49 offen offset:3072 sc1
    v_mfma_f32_16x16x32_bf16 v[220:223], a[236:239], v[248:251], v[220:223]
    v_cvt_pk_bf16_f32 v173, v186, v187
    v_cvt_pk_bf16_f32 v174, v188, v189
    v_mfma_f32_16x16x32_bf16 v[220:223], a[252:255], v[252:255], v[220:223]
    v_cvt_pk_bf16_f32 v175, v190, v191
    s_waitcnt lgkmcnt(0)
    v_mfma_f32_16x16x32_bf16 v[96:99], a[224:227], v[224:227], v[96:99]
    ds_read_b64_tr_b16 v[240:241], v26 offset:16384
    ds_read_b64_tr_b16 v[242:243], v26 offset:17408
    v_mfma_f32_16x16x32_bf16 v[96:99], a[240:243], v[228:231], v[96:99]
    ds_read_b64_tr_b16 v[244:245], v26 offset:24576
    s_add_u32 s77, s76, s41
    v_mfma_f32_16x16x32_bf16 v[100:103], a[228:231], v[224:227], v[100:103]
    v_cvt_pk_bf16_f32 v176, v192, v193
    v_cvt_pk_bf16_f32 v177, v194, v195
    v_mfma_f32_16x16x32_bf16 v[100:103], a[244:247], v[228:231], v[100:103]
    buffer_load_dwordx4 a[200:203], v6, s[24:27], s77 offen offset:0 sc1
    v_mfma_f32_16x16x32_bf16 v[104:107], a[232:235], v[224:227], v[104:107]
    ds_read_b64_tr_b16 v[246:247], v26 offset:25600
    v_cvt_pk_bf16_f32 v178, v196, v197
    v_mfma_f32_16x16x32_bf16 v[104:107], a[248:251], v[228:231], v[104:107]
    v_cvt_pk_bf16_f32 v179, v198, v199
    v_cvt_pk_bf16_f32 v180, v200, v201
    v_mfma_f32_16x16x32_bf16 v[108:111], a[236:239], v[224:227], v[108:111]
    ds_read_b64_tr_b16 v[248:249], v27 offset:16384
    v_cvt_pk_bf16_f32 v181, v202, v203
    v_mfma_f32_16x16x32_bf16 v[108:111], a[252:255], v[228:231], v[108:111]
    ds_read_b64_tr_b16 v[250:251], v27 offset:17408
    v_cvt_pk_bf16_f32 v182, v204, v205
    v_mfma_f32_16x16x32_bf16 v[112:115], a[224:227], v[232:235], v[112:115]
    ds_read_b64_tr_b16 v[252:253], v27 offset:24576
    v_cvt_pk_bf16_f32 v183, v206, v207
    v_mfma_f32_16x16x32_bf16 v[112:115], a[240:243], v[236:239], v[112:115]
    v_cvt_pk_bf16_f32 v184, v208, v209
    v_cvt_pk_bf16_f32 v185, v210, v211
    v_mfma_f32_16x16x32_bf16 v[116:119], a[228:231], v[232:235], v[116:119]
    buffer_load_dwordx4 a[216:219], v6, s[24:27], s77 offen offset:1024 sc1
    v_mfma_f32_16x16x32_bf16 v[116:119], a[244:247], v[236:239], v[116:119]
    ds_read_b64_tr_b16 v[254:255], v27 offset:25600
    v_cvt_pk_bf16_f32 v186, v212, v213
    v_mfma_f32_16x16x32_bf16 v[120:123], a[232:235], v[232:235], v[120:123]
    v_cvt_pk_bf16_f32 v187, v214, v215
    v_cvt_pk_bf16_f32 v188, v216, v217
    v_mfma_f32_16x16x32_bf16 v[120:123], a[248:251], v[236:239], v[120:123]
    v_cvt_pk_bf16_f32 v189, v218, v219
    v_cvt_pk_bf16_f32 v190, v220, v221
    v_mfma_f32_16x16x32_bf16 v[124:127], a[236:239], v[232:235], v[124:127]
    v_cvt_pk_bf16_f32 v191, v222, v223
    v_mfma_f32_16x16x32_bf16 v[124:127], a[252:255], v[236:239], v[124:127]
    s_waitcnt vmcnt(35) lgkmcnt(0)
    v_mfma_f32_16x16x32_bf16 v[128:131], a[224:227], v[240:243], v[128:131]
    s_barrier
    ds_read_b64_tr_b16 v[224:225], v20 offset:32768
    ds_read_b64_tr_b16 v[226:227], v20 offset:33792
    v_mfma_f32_16x16x32_bf16 v[128:131], a[240:243], v[244:247], v[128:131]
    s_add_u32 s37, s72, 3
    s_cmp_ge_u32 s37, 8
    s_cselect_b32 s6, 7, 0
    s_sub_u32 s37, s37, s6
    s_mul_i32 s37, s37, 524288
    s_add_u32 m0, s33, 114688
    s_add_u32 s37, s37, s42
    buffer_load_dwordx4 v16, s[20:23], s37 offen lds
    v_mfma_f32_16x16x32_bf16 v[132:135], a[228:231], v[240:243], v[132:135]
    v_cvt_pk_bf16_f32 v192, v96, v97
    v_cvt_pk_bf16_f32 v193, v98, v99
    v_mfma_f32_16x16x32_bf16 v[132:135], a[244:247], v[244:247], v[132:135]
    ds_read_b64_tr_b16 v[228:229], v20 offset:40960
    v_cvt_pk_bf16_f32 v194, v100, v101
    v_mfma_f32_16x16x32_bf16 v[136:139], a[232:235], v[240:243], v[136:139]
    ds_read_b64_tr_b16 v[230:231], v20 offset:41984
    v_cvt_pk_bf16_f32 v195, v102, v103
    v_mfma_f32_16x16x32_bf16 v[136:139], a[248:251], v[244:247], v[136:139]
    ds_read_b64_tr_b16 v[232:233], v21 offset:32768
    v_cvt_pk_bf16_f32 v196, v104, v105
    v_mfma_f32_16x16x32_bf16 v[140:143], a[236:239], v[240:243], v[140:143]
    v_cvt_pk_bf16_f32 v197, v106, v107
    v_cvt_pk_bf16_f32 v198, v108, v109
    v_mfma_f32_16x16x32_bf16 v[140:143], a[252:255], v[244:247], v[140:143]
    buffer_load_dwordx4 v17, s[20:23], s37 offen offset:1024 lds
    v_mfma_f32_16x16x32_bf16 v[144:147], a[224:227], v[248:251], v[144:147]
    ds_read_b64_tr_b16 v[234:235], v21 offset:33792
    v_cvt_pk_bf16_f32 v199, v110, v111
    v_mfma_f32_16x16x32_bf16 v[144:147], a[240:243], v[252:255], v[144:147]
    ds_read_b64_tr_b16 v[236:237], v21 offset:40960
    v_cvt_pk_bf16_f32 v200, v112, v113
    v_mfma_f32_16x16x32_bf16 v[148:151], a[228:231], v[248:251], v[148:151]
    buffer_load_dwordx4 v18, s[20:23], s37 offen offset:2048 lds
    s_add_u32 s77, s76, s41
    v_mfma_f32_16x16x32_bf16 v[148:151], a[244:247], v[252:255], v[148:151]
    ds_read_b64_tr_b16 v[238:239], v21 offset:41984
    v_cvt_pk_bf16_f32 v201, v114, v115
    v_mfma_f32_16x16x32_bf16 v[152:155], a[232:235], v[248:251], v[152:155]
    s_add_u32 s77, s77, 16384
    v_cvt_pk_bf16_f32 v202, v116, v117
    v_cvt_pk_bf16_f32 v203, v118, v119
    v_mfma_f32_16x16x32_bf16 v[152:155], a[248:251], v[252:255], v[152:155]
    buffer_load_dwordx4 a[204:207], v6, s[24:27], s77 offen offset:0 sc1
    v_mfma_f32_16x16x32_bf16 v[156:159], a[236:239], v[248:251], v[156:159]
    v_cvt_pk_bf16_f32 v204, v120, v121
    v_cvt_pk_bf16_f32 v205, v122, v123
    v_mfma_f32_16x16x32_bf16 v[156:159], a[252:255], v[252:255], v[156:159]
    buffer_load_dwordx4 a[220:223], v6, s[24:27], s77 offen offset:1024 sc1
    v_cvt_pk_bf16_f32 v206, v124, v125
    v_cvt_pk_bf16_f32 v207, v126, v127
    s_waitcnt vmcnt(63) lgkmcnt(0)
    v_mfma_f32_16x16x32_bf16 v[32:35], v[224:227], a[0:3], 0
    ds_read_b64_tr_b16 v[240:241], v22 offset:32768
    ds_read_b64_tr_b16 v[242:243], v22 offset:33792
    v_mfma_f32_16x16x32_bf16 v[32:35], v[228:231], a[16:19], v[32:35]
    buffer_load_dwordx4 v19, s[20:23], s37 offen offset:3072 lds
    v_mfma_f32_16x16x32_bf16 v[40:43], v[224:227], a[4:7], 0
    v_cvt_pk_bf16_f32 v208, v128, v129
    v_cvt_pk_bf16_f32 v209, v130, v131
    v_mfma_f32_16x16x32_bf16 v[40:43], v[228:231], a[20:23], v[40:43]
    ds_read_b64_tr_b16 v[244:245], v22 offset:40960
    v_cvt_pk_bf16_f32 v210, v132, v133
    v_mfma_f32_16x16x32_bf16 v[48:51], v[224:227], a[8:11], 0
    s_add_u32 s76, s72, 7
    s_cmp_ge_u32 s76, 8
    s_cselect_b32 s6, 7, 0
    s_sub_u32 s76, s76, s6
    s_mul_i32 s76, s76, 2048
    s_add_u32 s77, s76, s40
    buffer_load_dwordx4 a[224:227], v6, s[24:27], s77 offen offset:0 sc1
    v_mfma_f32_16x16x32_bf16 v[48:51], v[228:231], a[24:27], v[48:51]
    ds_read_b64_tr_b16 v[246:247], v22 offset:41984
    v_cvt_pk_bf16_f32 v211, v134, v135
    v_mfma_f32_16x16x32_bf16 v[56:59], v[224:227], a[12:15], 0
    ds_read_b64_tr_b16 v[248:249], v23 offset:32768
    v_cvt_pk_bf16_f32 v212, v136, v137
    v_mfma_f32_16x16x32_bf16 v[56:59], v[228:231], a[28:31], v[56:59]
    v_cvt_pk_bf16_f32 v213, v138, v139
    v_cvt_pk_bf16_f32 v214, v140, v141
    v_mfma_f32_16x16x32_bf16 v[36:39], v[232:235], a[0:3], 0
    ds_read_b64_tr_b16 v[250:251], v23 offset:33792
    v_cvt_pk_bf16_f32 v215, v142, v143
    v_mfma_f32_16x16x32_bf16 v[36:39], v[236:239], a[16:19], v[36:39]
    ds_read_b64_tr_b16 v[252:253], v23 offset:40960
    v_cvt_pk_bf16_f32 v216, v144, v145
    v_mfma_f32_16x16x32_bf16 v[44:47], v[232:235], a[4:7], 0
    ds_read_b64_tr_b16 v[254:255], v23 offset:41984
    v_cvt_pk_bf16_f32 v217, v146, v147
    v_mfma_f32_16x16x32_bf16 v[44:47], v[236:239], a[20:23], v[44:47]
    v_cvt_pk_bf16_f32 v218, v148, v149
    v_cvt_pk_bf16_f32 v219, v150, v151
    v_mfma_f32_16x16x32_bf16 v[52:55], v[232:235], a[8:11], 0
    v_cvt_pk_bf16_f32 v220, v152, v153
    v_cvt_pk_bf16_f32 v221, v154, v155
    v_mfma_f32_16x16x32_bf16 v[52:55], v[236:239], a[24:27], v[52:55]
    buffer_load_dwordx4 a[240:243], v6, s[24:27], s77 offen offset:1024 sc1
    v_mfma_f32_16x16x32_bf16 v[60:63], v[232:235], a[12:15], 0
    v_cvt_pk_bf16_f32 v222, v156, v157
    v_cvt_pk_bf16_f32 v223, v158, v159
    v_mfma_f32_16x16x32_bf16 v[60:63], v[236:239], a[28:31], v[60:63]
    s_waitcnt lgkmcnt(0)
    v_mfma_f32_16x16x32_bf16 v[64:67], v[240:243], a[0:3], 0
    ds_read_b64_tr_b16 v[224:225], v24 offset:32768
    ds_read_b64_tr_b16 v[226:227], v24 offset:33792
    v_mfma_f32_16x16x32_bf16 v[64:67], v[244:247], a[16:19], v[64:67]
    ds_read_b64_tr_b16 v[228:229], v24 offset:40960
    s_add_u32 s77, s76, s40
    s_add_u32 s77, s77, 16384
    v_mfma_f32_16x16x32_bf16 v[72:75], v[240:243], a[4:7], 0
    buffer_load_dwordx4 a[228:231], v6, s[24:27], s77 offen offset:0 sc1
    v_mfma_f32_16x16x32_bf16 v[72:75], v[244:247], a[20:23], v[72:75]
    ds_read_b64_tr_b16 v[230:231], v24 offset:41984
    v_mfma_f32_16x16x32_bf16 v[80:83], v[240:243], a[8:11], 0
    ds_read_b64_tr_b16 v[232:233], v25 offset:32768
    v_mfma_f32_16x16x32_bf16 v[80:83], v[244:247], a[24:27], v[80:83]
    buffer_load_dwordx4 a[244:247], v6, s[24:27], s77 offen offset:1024 sc1
    v_mfma_f32_16x16x32_bf16 v[88:91], v[240:243], a[12:15], 0
    ds_read_b64_tr_b16 v[234:235], v25 offset:33792
    v_mfma_f32_16x16x32_bf16 v[88:91], v[244:247], a[28:31], v[88:91]
    ds_read_b64_tr_b16 v[236:237], v25 offset:40960
    v_mfma_f32_16x16x32_bf16 v[68:71], v[248:251], a[0:3], 0
    v_mfma_f32_16x16x32_bf16 v[68:71], v[252:255], a[16:19], v[68:71]
    ds_read_b64_tr_b16 v[238:239], v25 offset:41984
    s_add_u32 s49, s75, 16777216
    v_mfma_f32_16x16x32_bf16 v[76:79], v[248:251], a[4:7], 0
    buffer_store_dwordx4 v[160:163], v6, s[24:27], s49 offen offset:0 sc1
    v_mfma_f32_16x16x32_bf16 v[76:79], v[252:255], a[20:23], v[76:79]
    v_mfma_f32_16x16x32_bf16 v[84:87], v[248:251], a[8:11], 0
    v_mfma_f32_16x16x32_bf16 v[84:87], v[252:255], a[24:27], v[84:87]
    v_mfma_f32_16x16x32_bf16 v[92:95], v[248:251], a[12:15], 0
    v_mfma_f32_16x16x32_bf16 v[92:95], v[252:255], a[28:31], v[92:95]
    s_waitcnt lgkmcnt(0)
    v_mfma_f32_16x16x32_bf16 v[96:99], v[224:227], a[0:3], 0
    ds_read_b64_tr_b16 v[240:241], v26 offset:32768
    ds_read_b64_tr_b16 v[242:243], v26 offset:33792
    v_mfma_f32_16x16x32_bf16 v[96:99], v[228:231], a[16:19], v[96:99]
    s_add_u32 s77, s76, s41
    buffer_load_dwordx4 a[232:235], v6, s[24:27], s77 offen offset:0 sc1
    v_mfma_f32_16x16x32_bf16 v[104:107], v[224:227], a[4:7], 0
    ds_read_b64_tr_b16 v[244:245], v26 offset:40960
    v_mfma_f32_16x16x32_bf16 v[104:107], v[228:231], a[20:23], v[104:107]
    ds_read_b64_tr_b16 v[246:247], v26 offset:41984
    v_mfma_f32_16x16x32_bf16 v[112:115], v[224:227], a[8:11], 0
    ds_read_b64_tr_b16 v[248:249], v27 offset:32768
    v_mfma_f32_16x16x32_bf16 v[112:115], v[228:231], a[24:27], v[112:115]
    buffer_load_dwordx4 a[248:251], v6, s[24:27], s77 offen offset:1024 sc1
    v_mfma_f32_16x16x32_bf16 v[120:123], v[224:227], a[12:15], 0
    ds_read_b64_tr_b16 v[250:251], v27 offset:33792
    v_mfma_f32_16x16x32_bf16 v[120:123], v[228:231], a[28:31], v[120:123]
    ds_read_b64_tr_b16 v[252:253], v27 offset:40960
    v_mfma_f32_16x16x32_bf16 v[100:103], v[232:235], a[0:3], 0
    v_mfma_f32_16x16x32_bf16 v[100:103], v[236:239], a[16:19], v[100:103]
    ds_read_b64_tr_b16 v[254:255], v27 offset:41984
    s_add_u32 s49, s75, 16785408
    v_mfma_f32_16x16x32_bf16 v[108:111], v[232:235], a[4:7], 0
    buffer_store_dwordx4 v[164:167], v6, s[24:27], s49 offen offset:0 sc1
    v_mfma_f32_16x16x32_bf16 v[108:111], v[236:239], a[20:23], v[108:111]
    v_mfma_f32_16x16x32_bf16 v[116:119], v[232:235], a[8:11], 0
    v_mfma_f32_16x16x32_bf16 v[116:119], v[236:239], a[24:27], v[116:119]
    v_mfma_f32_16x16x32_bf16 v[124:127], v[232:235], a[12:15], 0
    v_mfma_f32_16x16x32_bf16 v[124:127], v[236:239], a[28:31], v[124:127]
    s_waitcnt vmcnt(16) lgkmcnt(0)
    v_mfma_f32_16x16x32_bf16 v[128:131], v[240:243], a[0:3], 0
    s_barrier
    ds_read_b64_tr_b16 v[224:225], v20 offset:49152
    ds_read_b64_tr_b16 v[226:227], v20 offset:50176
    v_mfma_f32_16x16x32_bf16 v[128:131], v[244:247], a[16:19], v[128:131]
    s_add_u32 s37, s72, 4
    s_cmp_ge_u32 s37, 8
    s_cselect_b32 s6, 7, 0
    s_sub_u32 s37, s37, s6
    s_mul_i32 s37, s37, 524288
    s_add_u32 m0, s33, 131072
    s_add_u32 s37, s37, s42
    buffer_load_dwordx4 v16, s[20:23], s37 offen lds
    v_mfma_f32_16x16x32_bf16 v[136:139], v[240:243], a[4:7], 0
    ds_read_b64_tr_b16 v[228:229], v20 offset:57344
    v_mfma_f32_16x16x32_bf16 v[136:139], v[244:247], a[20:23], v[136:139]
    ds_read_b64_tr_b16 v[230:231], v20 offset:58368
    v_mfma_f32_16x16x32_bf16 v[144:147], v[240:243], a[8:11], 0
    buffer_load_dwordx4 v17, s[20:23], s37 offen offset:1024 lds
    v_mfma_f32_16x16x32_bf16 v[144:147], v[244:247], a[24:27], v[144:147]
    ds_read_b64_tr_b16 v[232:233], v21 offset:49152
    v_mfma_f32_16x16x32_bf16 v[152:155], v[240:243], a[12:15], 0
    buffer_load_dwordx4 v18, s[20:23], s37 offen offset:2048 lds
    s_add_u32 s77, s76, s41
    v_mfma_f32_16x16x32_bf16 v[152:155], v[244:247], a[28:31], v[152:155]
    ds_read_b64_tr_b16 v[234:235], v21 offset:50176
    s_add_u32 s77, s77, 16384
    v_mfma_f32_16x16x32_bf16 v[132:135], v[248:251], a[0:3], 0
    buffer_load_dwordx4 a[236:239], v6, s[24:27], s77 offen offset:0 sc1
    v_mfma_f32_16x16x32_bf16 v[132:135], v[252:255], a[16:19], v[132:135]
    ds_read_b64_tr_b16 v[236:237], v21 offset:57344
    ds_read_b64_tr_b16 v[238:239], v21 offset:58368
    v_mfma_f32_16x16x32_bf16 v[140:143], v[248:251], a[4:7], 0
    buffer_load_dwordx4 a[252:255], v6, s[24:27], s77 offen offset:1024 sc1
    s_add_u32 s49, s75, 16777216
    v_mfma_f32_16x16x32_bf16 v[140:143], v[252:255], a[20:23], v[140:143]
    buffer_store_dwordx4 v[168:171], v6, s[24:27], s49 offen offset:1024 sc1
    s_lshl_b32 s48, s16, 2
    v_mfma_f32_16x16x32_bf16 v[148:151], v[248:251], a[8:11], 0
    s_add_u32 s48, s48, s69
    v_mov_b32 v15, s71
    v_mfma_f32_16x16x32_bf16 v[148:151], v[252:255], a[24:27], v[148:151]
    buffer_store_dword v15, v1, s[24:27], s48 offen offset:256 sc1
    v_mfma_f32_16x16x32_bf16 v[156:159], v[248:251], a[12:15], 0
    v_mfma_f32_16x16x32_bf16 v[156:159], v[252:255], a[28:31], v[156:159]
    s_waitcnt vmcnt(63) lgkmcnt(0)
    v_mfma_f32_16x16x32_bf16 v[32:35], v[224:227], a[32:35], v[32:35]
    ds_read_b64_tr_b16 v[240:241], v22 offset:49152
    ds_read_b64_tr_b16 v[242:243], v22 offset:50176
    v_mfma_f32_16x16x32_bf16 v[32:35], v[228:231], a[48:51], v[32:35]
    buffer_load_dwordx4 v19, s[20:23], s37 offen offset:3072 lds
    v_mfma_f32_16x16x32_bf16 v[40:43], v[224:227], a[36:39], v[40:43]
    ds_read_b64_tr_b16 v[244:245], v22 offset:57344
    v_mfma_f32_16x16x32_bf16 v[40:43], v[228:231], a[52:55], v[40:43]
    ds_read_b64_tr_b16 v[246:247], v22 offset:58368
    v_mfma_f32_16x16x32_bf16 v[48:51], v[224:227], a[40:43], v[48:51]
    ds_read_b64_tr_b16 v[248:249], v23 offset:49152
    v_mfma_f32_16x16x32_bf16 v[48:51], v[228:231], a[56:59], v[48:51]
    s_add_u32 s49, s75, 16785408
    v_mfma_f32_16x16x32_bf16 v[56:59], v[224:227], a[44:47], v[56:59]
    ds_read_b64_tr_b16 v[250:251], v23 offset:50176
    v_mfma_f32_16x16x32_bf16 v[56:59], v[228:231], a[60:63], v[56:59]
    ds_read_b64_tr_b16 v[252:253], v23 offset:57344
    v_mfma_f32_16x16x32_bf16 v[36:39], v[232:235], a[32:35], v[36:39]
    buffer_store_dwordx4 v[172:175], v6, s[24:27], s49 offen offset:1024 sc1
    v_mfma_f32_16x16x32_bf16 v[36:39], v[236:239], a[48:51], v[36:39]
    ds_read_b64_tr_b16 v[254:255], v23 offset:58368
    v_mfma_f32_16x16x32_bf16 v[44:47], v[232:235], a[36:39], v[44:47]
    v_mfma_f32_16x16x32_bf16 v[44:47], v[236:239], a[52:55], v[44:47]
    v_mfma_f32_16x16x32_bf16 v[52:55], v[232:235], a[40:43], v[52:55]
    v_mfma_f32_16x16x32_bf16 v[52:55], v[236:239], a[56:59], v[52:55]
    v_mfma_f32_16x16x32_bf16 v[60:63], v[232:235], a[44:47], v[60:63]
    v_mfma_f32_16x16x32_bf16 v[60:63], v[236:239], a[60:63], v[60:63]
    s_waitcnt lgkmcnt(0)
    v_mfma_f32_16x16x32_bf16 v[64:67], v[240:243], a[32:35], v[64:67]
    ds_read_b64_tr_b16 v[224:225], v24 offset:49152
    ds_read_b64_tr_b16 v[226:227], v24 offset:50176
    v_mfma_f32_16x16x32_bf16 v[64:67], v[244:247], a[48:51], v[64:67]
    ds_read_b64_tr_b16 v[228:229], v24 offset:57344
    s_add_u32 s49, s75, 16777216
    v_mfma_f32_16x16x32_bf16 v[72:75], v[240:243], a[36:39], v[72:75]
    v_mfma_f32_16x16x32_bf16 v[72:75], v[244:247], a[52:55], v[72:75]
    ds_read_b64_tr_b16 v[230:231], v24 offset:58368
    v_mfma_f32_16x16x32_bf16 v[80:83], v[240:243], a[40:43], v[80:83]
    buffer_store_dwordx4 v[176:179], v6, s[24:27], s49 offen offset:2048 sc1
    v_mfma_f32_16x16x32_bf16 v[80:83], v[244:247], a[56:59], v[80:83]
    ds_read_b64_tr_b16 v[232:233], v25 offset:49152
    v_mfma_f32_16x16x32_bf16 v[88:91], v[240:243], a[44:47], v[88:91]
    ds_read_b64_tr_b16 v[234:235], v25 offset:50176
    v_mfma_f32_16x16x32_bf16 v[88:91], v[244:247], a[60:63], v[88:91]
    ds_read_b64_tr_b16 v[236:237], v25 offset:57344
    v_mfma_f32_16x16x32_bf16 v[68:71], v[248:251], a[32:35], v[68:71]
    v_mfma_f32_16x16x32_bf16 v[68:71], v[252:255], a[48:51], v[68:71]
    ds_read_b64_tr_b16 v[238:239], v25 offset:58368
    v_mfma_f32_16x16x32_bf16 v[76:79], v[248:251], a[36:39], v[76:79]
    v_mfma_f32_16x16x32_bf16 v[76:79], v[252:255], a[52:55], v[76:79]
    v_mfma_f32_16x16x32_bf16 v[84:87], v[248:251], a[40:43], v[84:87]
    v_mfma_f32_16x16x32_bf16 v[84:87], v[252:255], a[56:59], v[84:87]
    v_mfma_f32_16x16x32_bf16 v[92:95], v[248:251], a[44:47], v[92:95]
    v_mfma_f32_16x16x32_bf16 v[92:95], v[252:255], a[60:63], v[92:95]
    s_waitcnt lgkmcnt(0)
    v_mfma_f32_16x16x32_bf16 v[96:99], v[224:227], a[32:35], v[96:99]
    ds_read_b64_tr_b16 v[240:241], v26 offset:49152
    ds_read_b64_tr_b16 v[242:243], v26 offset:50176
    v_mfma_f32_16x16x32_bf16 v[96:99], v[228:231], a[48:51], v[96:99]
    ds_read_b64_tr_b16 v[244:245], v26 offset:57344
    s_add_u32 s49, s75, 16785408
    v_mfma_f32_16x16x32_bf16 v[104:107], v[224:227], a[36:39], v[104:107]
    v_mfma_f32_16x16x32_bf16 v[104:107], v[228:231], a[52:55], v[104:107]
    ds_read_b64_tr_b16 v[246:247], v26 offset:58368
    v_mfma_f32_16x16x32_bf16 v[112:115], v[224:227], a[40:43], v[112:115]
    buffer_store_dwordx4 v[180:183], v6, s[24:27], s49 offen offset:2048 sc1
    v_mfma_f32_16x16x32_bf16 v[112:115], v[228:231], a[56:59], v[112:115]
    ds_read_b64_tr_b16 v[248:249], v27 offset:49152
    v_mfma_f32_16x16x32_bf16 v[120:123], v[224:227], a[44:47], v[120:123]
    ds_read_b64_tr_b16 v[250:251], v27 offset:50176
    v_mfma_f32_16x16x32_bf16 v[120:123], v[228:231], a[60:63], v[120:123]
    ds_read_b64_tr_b16 v[252:253], v27 offset:57344
    v_mfma_f32_16x16x32_bf16 v[100:103], v[232:235], a[32:35], v[100:103]
    v_mfma_f32_16x16x32_bf16 v[100:103], v[236:239], a[48:51], v[100:103]
    ds_read_b64_tr_b16 v[254:255], v27 offset:58368
    v_mfma_f32_16x16x32_bf16 v[108:111], v[232:235], a[36:39], v[108:111]
    v_mfma_f32_16x16x32_bf16 v[108:111], v[236:239], a[52:55], v[108:111]
    v_mfma_f32_16x16x32_bf16 v[116:119], v[232:235], a[40:43], v[116:119]
    v_mfma_f32_16x16x32_bf16 v[116:119], v[236:239], a[56:59], v[116:119]
    v_mfma_f32_16x16x32_bf16 v[124:127], v[232:235], a[44:47], v[124:127]
    v_mfma_f32_16x16x32_bf16 v[124:127], v[236:239], a[60:63], v[124:127]
    s_waitcnt vmcnt(32) lgkmcnt(0)
    v_mfma_f32_16x16x32_bf16 v[128:131], v[240:243], a[32:35], v[128:131]
    s_barrier
    ds_read_b64_tr_b16 v[224:225], v20 offset:0
    ds_read_b64_tr_b16 v[226:227], v20 offset:1024
    v_mfma_f32_16x16x32_bf16 v[128:131], v[244:247], a[48:51], v[128:131]
    s_add_u32 s37, s72, 5
    s_cmp_ge_u32 s37, 8
    s_cselect_b32 s6, 7, 0
    s_sub_u32 s37, s37, s6
    s_mul_i32 s37, s37, 524288
    s_add_u32 m0, s33, 147456
    s_add_u32 s37, s37, s42
    buffer_load_dwordx4 v16, s[20:23], s37 offen lds
    v_mfma_f32_16x16x32_bf16 v[136:139], v[240:243], a[36:39], v[136:139]
    ds_read_b64_tr_b16 v[228:229], v20 offset:8192
    v_mfma_f32_16x16x32_bf16 v[136:139], v[244:247], a[52:55], v[136:139]
    ds_read_b64_tr_b16 v[230:231], v20 offset:9216
    v_mfma_f32_16x16x32_bf16 v[144:147], v[240:243], a[40:43], v[144:147]
    ds_read_b64_tr_b16 v[232:233], v21 offset:0
    v_mfma_f32_16x16x32_bf16 v[144:147], v[244:247], a[56:59], v[144:147]
    v_mfma_f32_16x16x32_bf16 v[152:155], v[240:243], a[44:47], v[152:155]
    ds_read_b64_tr_b16 v[234:235], v21 offset:1024
    v_mfma_f32_16x16x32_bf16 v[152:155], v[244:247], a[60:63], v[152:155]
    buffer_load_dwordx4 v17, s[20:23], s37 offen offset:1024 lds
    v_mfma_f32_16x16x32_bf16 v[132:135], v[248:251], a[32:35], v[132:135]
    ds_read_b64_tr_b16 v[236:237], v21 offset:8192
    v_mfma_f32_16x16x32_bf16 v[132:135], v[252:255], a[48:51], v[132:135]
    ds_read_b64_tr_b16 v[238:239], v21 offset:9216
    v_mfma_f32_16x16x32_bf16 v[140:143], v[248:251], a[36:39], v[140:143]
    buffer_load_dwordx4 v18, s[20:23], s37 offen offset:2048 lds
    v_mfma_f32_16x16x32_bf16 v[140:143], v[252:255], a[52:55], v[140:143]
    s_add_u32 s49, s75, 16777216
    v_mfma_f32_16x16x32_bf16 v[148:151], v[248:251], a[40:43], v[148:151]
    buffer_store_dwordx4 v[184:187], v6, s[24:27], s49 offen offset:3072 sc1
    v_mfma_f32_16x16x32_bf16 v[148:151], v[252:255], a[56:59], v[148:151]
    v_mfma_f32_16x16x32_bf16 v[156:159], v[248:251], a[44:47], v[156:159]
    v_mfma_f32_16x16x32_bf16 v[156:159], v[252:255], a[60:63], v[156:159]
    s_waitcnt vmcnt(63) lgkmcnt(0)
    v_mfma_f32_16x16x32_bf16 v[32:35], v[224:227], a[64:67], v[32:35]
    ds_read_b64_tr_b16 v[240:241], v22 offset:0
    ds_read_b64_tr_b16 v[242:243], v22 offset:1024
    v_mfma_f32_16x16x32_bf16 v[32:35], v[228:231], a[80:83], v[32:35]
    buffer_load_dwordx4 v19, s[20:23], s37 offen offset:3072 lds
    v_mfma_f32_16x16x32_bf16 v[40:43], v[224:227], a[68:71], v[40:43]
    ds_read_b64_tr_b16 v[244:245], v22 offset:8192
    v_mfma_f32_16x16x32_bf16 v[40:43], v[228:231], a[84:87], v[40:43]
    ds_read_b64_tr_b16 v[246:247], v22 offset:9216
    v_mfma_f32_16x16x32_bf16 v[48:51], v[224:227], a[72:75], v[48:51]
    ds_read_b64_tr_b16 v[248:249], v23 offset:0
    v_mfma_f32_16x16x32_bf16 v[48:51], v[228:231], a[88:91], v[48:51]
    s_add_u32 s49, s75, 16785408
    v_mfma_f32_16x16x32_bf16 v[56:59], v[224:227], a[76:79], v[56:59]
    ds_read_b64_tr_b16 v[250:251], v23 offset:1024
    v_mfma_f32_16x16x32_bf16 v[56:59], v[228:231], a[92:95], v[56:59]
    ds_read_b64_tr_b16 v[252:253], v23 offset:8192
    v_mfma_f32_16x16x32_bf16 v[36:39], v[232:235], a[64:67], v[36:39]
    buffer_store_dwordx4 v[188:191], v6, s[24:27], s49 offen offset:3072 sc1
    v_mfma_f32_16x16x32_bf16 v[36:39], v[236:239], a[80:83], v[36:39]
    ds_read_b64_tr_b16 v[254:255], v23 offset:9216
    v_mfma_f32_16x16x32_bf16 v[44:47], v[232:235], a[68:71], v[44:47]
    v_mfma_f32_16x16x32_bf16 v[44:47], v[236:239], a[84:87], v[44:47]
    v_mfma_f32_16x16x32_bf16 v[52:55], v[232:235], a[72:75], v[52:55]
    v_mfma_f32_16x16x32_bf16 v[52:55], v[236:239], a[88:91], v[52:55]
    v_mfma_f32_16x16x32_bf16 v[60:63], v[232:235], a[76:79], v[60:63]
    v_mfma_f32_16x16x32_bf16 v[60:63], v[236:239], a[92:95], v[60:63]
    s_waitcnt lgkmcnt(0)
    v_mfma_f32_16x16x32_bf16 v[64:67], v[240:243], a[64:67], v[64:67]
    ds_read_b64_tr_b16 v[224:225], v24 offset:0
    ds_read_b64_tr_b16 v[226:227], v24 offset:1024
    v_mfma_f32_16x16x32_bf16 v[64:67], v[244:247], a[80:83], v[64:67]
    ds_read_b64_tr_b16 v[228:229], v24 offset:8192
    s_add_u32 s49, s75, 16781312
    v_mfma_f32_16x16x32_bf16 v[72:75], v[240:243], a[68:71], v[72:75]
    v_mfma_f32_16x16x32_bf16 v[72:75], v[244:247], a[84:87], v[72:75]
    ds_read_b64_tr_b16 v[230:231], v24 offset:9216
    v_mfma_f32_16x16x32_bf16 v[80:83], v[240:243], a[72:75], v[80:83]
    buffer_store_dwordx4 v[192:195], v6, s[24:27], s49 offen offset:0 sc1
    v_mfma_f32_16x16x32_bf16 v[80:83], v[244:247], a[88:91], v[80:83]
    ds_read_b64_tr_b16 v[232:233], v25 offset:0
    v_mfma_f32_16x16x32_bf16 v[88:91], v[240:243], a[76:79], v[88:91]
    ds_read_b64_tr_b16 v[234:235], v25 offset:1024
    v_mfma_f32_16x16x32_bf16 v[88:91], v[244:247], a[92:95], v[88:91]
    ds_read_b64_tr_b16 v[236:237], v25 offset:8192
    v_mfma_f32_16x16x32_bf16 v[68:71], v[248:251], a[64:67], v[68:71]
    v_mfma_f32_16x16x32_bf16 v[68:71], v[252:255], a[80:83], v[68:71]
    ds_read_b64_tr_b16 v[238:239], v25 offset:9216
    v_mfma_f32_16x16x32_bf16 v[76:79], v[248:251], a[68:71], v[76:79]
    v_mfma_f32_16x16x32_bf16 v[76:79], v[252:255], a[84:87], v[76:79]
    v_mfma_f32_16x16x32_bf16 v[84:87], v[248:251], a[72:75], v[84:87]
    v_mfma_f32_16x16x32_bf16 v[84:87], v[252:255], a[88:91], v[84:87]
    v_mfma_f32_16x16x32_bf16 v[92:95], v[248:251], a[76:79], v[92:95]
    v_mfma_f32_16x16x32_bf16 v[92:95], v[252:255], a[92:95], v[92:95]
    s_waitcnt lgkmcnt(0)
    v_mfma_f32_16x16x32_bf16 v[96:99], v[224:227], a[64:67], v[96:99]
    ds_read_b64_tr_b16 v[240:241], v26 offset:0
    ds_read_b64_tr_b16 v[242:243], v26 offset:1024
    v_mfma_f32_16x16x32_bf16 v[96:99], v[228:231], a[80:83], v[96:99]
    s_add_u32 s49, s75, 16789504
    buffer_store_dwordx4 v[196:199], v6, s[24:27], s49 offen offset:0 sc1
    v_mfma_f32_16x16x32_bf16 v[104:107], v[224:227], a[68:71], v[104:107]
    ds_read_b64_tr_b16 v[244:245], v26 offset:8192
    v_mfma_f32_16x16x32_bf16 v[104:107], v[228:231], a[84:87], v[104:107]
    ds_read_b64_tr_b16 v[246:247], v26 offset:9216
    v_mfma_f32_16x16x32_bf16 v[112:115], v[224:227], a[72:75], v[112:115]
    ds_read_b64_tr_b16 v[248:249], v27 offset:0
    v_and_b32 v13, 7, v0
    v_mfma_f32_16x16x32_bf16 v[112:115], v[228:231], a[88:91], v[112:115]
    v_mfma_f32_16x16x32_bf16 v[120:123], v[224:227], a[76:79], v[120:123]
    ds_read_b64_tr_b16 v[250:251], v27 offset:1024
    v_mfma_f32_16x16x32_bf16 v[120:123], v[228:231], a[92:95], v[120:123]
    ds_read_b64_tr_b16 v[252:253], v27 offset:8192
    v_lshlrev_b32 v13, 2, v13
    v_mfma_f32_16x16x32_bf16 v[100:103], v[232:235], a[64:67], v[100:103]
    v_mfma_f32_16x16x32_bf16 v[100:103], v[236:239], a[80:83], v[100:103]
    ds_read_b64_tr_b16 v[254:255], v27 offset:9216
    v_mfma_f32_16x16x32_bf16 v[108:111], v[232:235], a[68:71], v[108:111]
    buffer_load_dword v14, v13, s[24:27], s69 offen offset:256 sc1
    v_mfma_f32_16x16x32_bf16 v[108:111], v[236:239], a[84:87], v[108:111]
    v_mfma_f32_16x16x32_bf16 v[116:119], v[232:235], a[72:75], v[116:119]
    v_mfma_f32_16x16x32_bf16 v[116:119], v[236:239], a[88:91], v[116:119]
    v_mfma_f32_16x16x32_bf16 v[124:127], v[232:235], a[76:79], v[124:127]
    v_mfma_f32_16x16x32_bf16 v[124:127], v[236:239], a[92:95], v[124:127]
    s_waitcnt vmcnt(28) lgkmcnt(0)
    v_mfma_f32_16x16x32_bf16 v[128:131], v[240:243], a[64:67], v[128:131]
    s_barrier
    ds_read_b64_tr_b16 v[224:225], v20 offset:16384
    ds_read_b64_tr_b16 v[226:227], v20 offset:17408
    v_mfma_f32_16x16x32_bf16 v[128:131], v[244:247], a[80:83], v[128:131]
    s_add_u32 s37, s72, 6
    s_cmp_ge_u32 s37, 8
    s_cselect_b32 s6, 7, 0
    s_sub_u32 s37, s37, s6
    s_mul_i32 s37, s37, 524288
    s_add_u32 m0, s33, 98304
    s_add_u32 s37, s37, s42
    buffer_load_dwordx4 v16, s[20:23], s37 offen lds
    v_mfma_f32_16x16x32_bf16 v[136:139], v[240:243], a[68:71], v[136:139]
    ds_read_b64_tr_b16 v[228:229], v20 offset:24576
    v_mfma_f32_16x16x32_bf16 v[136:139], v[244:247], a[84:87], v[136:139]
    ds_read_b64_tr_b16 v[230:231], v20 offset:25600
    v_mfma_f32_16x16x32_bf16 v[144:147], v[240:243], a[72:75], v[144:147]
    ds_read_b64_tr_b16 v[232:233], v21 offset:16384
    v_mfma_f32_16x16x32_bf16 v[144:147], v[244:247], a[88:91], v[144:147]
    v_mfma_f32_16x16x32_bf16 v[152:155], v[240:243], a[76:79], v[152:155]
    ds_read_b64_tr_b16 v[234:235], v21 offset:17408
    v_mfma_f32_16x16x32_bf16 v[152:155], v[244:247], a[92:95], v[152:155]
    buffer_load_dwordx4 v17, s[20:23], s37 offen offset:1024 lds
    v_mfma_f32_16x16x32_bf16 v[132:135], v[248:251], a[64:67], v[132:135]
    ds_read_b64_tr_b16 v[236:237], v21 offset:24576
    v_mfma_f32_16x16x32_bf16 v[132:135], v[252:255], a[80:83], v[132:135]
    ds_read_b64_tr_b16 v[238:239], v21 offset:25600
    v_mfma_f32_16x16x32_bf16 v[140:143], v[248:251], a[68:71], v[140:143]
    buffer_load_dwordx4 v18, s[20:23], s37 offen offset:2048 lds
    v_mfma_f32_16x16x32_bf16 v[140:143], v[252:255], a[84:87], v[140:143]
    s_add_u32 s49, s75, 16781312
    v_mfma_f32_16x16x32_bf16 v[148:151], v[248:251], a[72:75], v[148:151]
    buffer_store_dwordx4 v[200:203], v6, s[24:27], s49 offen offset:1024 sc1
    v_mfma_f32_16x16x32_bf16 v[148:151], v[252:255], a[88:91], v[148:151]
    v_mfma_f32_16x16x32_bf16 v[156:159], v[248:251], a[76:79], v[156:159]
    v_mfma_f32_16x16x32_bf16 v[156:159], v[252:255], a[92:95], v[156:159]
    s_waitcnt vmcnt(63) lgkmcnt(0)
    v_mfma_f32_16x16x32_bf16 v[32:35], v[224:227], a[96:99], v[32:35]
    ds_read_b64_tr_b16 v[240:241], v22 offset:16384
    ds_read_b64_tr_b16 v[242:243], v22 offset:17408
    v_mfma_f32_16x16x32_bf16 v[32:35], v[228:231], a[112:115], v[32:35]
    buffer_load_dwordx4 v19, s[20:23], s37 offen offset:3072 lds
    v_mfma_f32_16x16x32_bf16 v[40:43], v[224:227], a[100:103], v[40:43]
    ds_read_b64_tr_b16 v[244:245], v22 offset:24576
    v_mfma_f32_16x16x32_bf16 v[40:43], v[228:231], a[116:119], v[40:43]
    ds_read_b64_tr_b16 v[246:247], v22 offset:25600
    v_mfma_f32_16x16x32_bf16 v[48:51], v[224:227], a[104:107], v[48:51]
    ds_read_b64_tr_b16 v[248:249], v23 offset:16384
    v_mfma_f32_16x16x32_bf16 v[48:51], v[228:231], a[120:123], v[48:51]
    s_add_u32 s49, s75, 16789504
    v_mfma_f32_16x16x32_bf16 v[56:59], v[224:227], a[108:111], v[56:59]
    ds_read_b64_tr_b16 v[250:251], v23 offset:17408
    v_mfma_f32_16x16x32_bf16 v[56:59], v[228:231], a[124:127], v[56:59]
    ds_read_b64_tr_b16 v[252:253], v23 offset:24576
    v_mfma_f32_16x16x32_bf16 v[36:39], v[232:235], a[96:99], v[36:39]
    buffer_store_dwordx4 v[204:207], v6, s[24:27], s49 offen offset:1024 sc1
    v_mfma_f32_16x16x32_bf16 v[36:39], v[236:239], a[112:115], v[36:39]
    ds_read_b64_tr_b16 v[254:255], v23 offset:25600
    v_mfma_f32_16x16x32_bf16 v[44:47], v[232:235], a[100:103], v[44:47]
    v_mfma_f32_16x16x32_bf16 v[44:47], v[236:239], a[116:119], v[44:47]
    v_mfma_f32_16x16x32_bf16 v[52:55], v[232:235], a[104:107], v[52:55]
    v_mfma_f32_16x16x32_bf16 v[52:55], v[236:239], a[120:123], v[52:55]
    v_mfma_f32_16x16x32_bf16 v[60:63], v[232:235], a[108:111], v[60:63]
    v_mfma_f32_16x16x32_bf16 v[60:63], v[236:239], a[124:127], v[60:63]
    s_waitcnt lgkmcnt(0)
    v_mfma_f32_16x16x32_bf16 v[64:67], v[240:243], a[96:99], v[64:67]
    ds_read_b64_tr_b16 v[224:225], v24 offset:16384
    ds_read_b64_tr_b16 v[226:227], v24 offset:17408
    v_mfma_f32_16x16x32_bf16 v[64:67], v[244:247], a[112:115], v[64:67]
    ds_read_b64_tr_b16 v[228:229], v24 offset:24576
    s_add_u32 s49, s75, 16781312
    v_mfma_f32_16x16x32_bf16 v[72:75], v[240:243], a[100:103], v[72:75]
    v_mfma_f32_16x16x32_bf16 v[72:75], v[244:247], a[116:119], v[72:75]
    ds_read_b64_tr_b16 v[230:231], v24 offset:25600
    v_mfma_f32_16x16x32_bf16 v[80:83], v[240:243], a[104:107], v[80:83]
    buffer_store_dwordx4 v[208:211], v6, s[24:27], s49 offen offset:2048 sc1
    v_mfma_f32_16x16x32_bf16 v[80:83], v[244:247], a[120:123], v[80:83]
    ds_read_b64_tr_b16 v[232:233], v25 offset:16384
    v_mfma_f32_16x16x32_bf16 v[88:91], v[240:243], a[108:111], v[88:91]
    ds_read_b64_tr_b16 v[234:235], v25 offset:17408
    v_mfma_f32_16x16x32_bf16 v[88:91], v[244:247], a[124:127], v[88:91]
    ds_read_b64_tr_b16 v[236:237], v25 offset:24576
    v_mfma_f32_16x16x32_bf16 v[68:71], v[248:251], a[96:99], v[68:71]
    v_mfma_f32_16x16x32_bf16 v[68:71], v[252:255], a[112:115], v[68:71]
    ds_read_b64_tr_b16 v[238:239], v25 offset:25600
    v_mfma_f32_16x16x32_bf16 v[76:79], v[248:251], a[100:103], v[76:79]
    v_mfma_f32_16x16x32_bf16 v[76:79], v[252:255], a[116:119], v[76:79]
    v_mfma_f32_16x16x32_bf16 v[84:87], v[248:251], a[104:107], v[84:87]
    v_mfma_f32_16x16x32_bf16 v[84:87], v[252:255], a[120:123], v[84:87]
    v_mfma_f32_16x16x32_bf16 v[92:95], v[248:251], a[108:111], v[92:95]
    v_mfma_f32_16x16x32_bf16 v[92:95], v[252:255], a[124:127], v[92:95]
    s_waitcnt lgkmcnt(0)
    v_mfma_f32_16x16x32_bf16 v[96:99], v[224:227], a[96:99], v[96:99]
    ds_read_b64_tr_b16 v[240:241], v26 offset:16384
    ds_read_b64_tr_b16 v[242:243], v26 offset:17408
    v_mfma_f32_16x16x32_bf16 v[96:99], v[228:231], a[112:115], v[96:99]
    ds_read_b64_tr_b16 v[244:245], v26 offset:24576
    s_add_u32 s49, s75, 16789504
    v_mfma_f32_16x16x32_bf16 v[104:107], v[224:227], a[100:103], v[104:107]
    v_mfma_f32_16x16x32_bf16 v[104:107], v[228:231], a[116:119], v[104:107]
    ds_read_b64_tr_b16 v[246:247], v26 offset:25600
    v_mfma_f32_16x16x32_bf16 v[112:115], v[224:227], a[104:107], v[112:115]
    buffer_store_dwordx4 v[212:215], v6, s[24:27], s49 offen offset:2048 sc1
    v_mfma_f32_16x16x32_bf16 v[112:115], v[228:231], a[120:123], v[112:115]
    ds_read_b64_tr_b16 v[248:249], v27 offset:16384
    v_mfma_f32_16x16x32_bf16 v[120:123], v[224:227], a[108:111], v[120:123]
    ds_read_b64_tr_b16 v[250:251], v27 offset:17408
    v_mfma_f32_16x16x32_bf16 v[120:123], v[228:231], a[124:127], v[120:123]
    ds_read_b64_tr_b16 v[252:253], v27 offset:24576
    v_mfma_f32_16x16x32_bf16 v[100:103], v[232:235], a[96:99], v[100:103]
    v_mfma_f32_16x16x32_bf16 v[100:103], v[236:239], a[112:115], v[100:103]
    ds_read_b64_tr_b16 v[254:255], v27 offset:25600
    v_mfma_f32_16x16x32_bf16 v[108:111], v[232:235], a[100:103], v[108:111]
    v_mfma_f32_16x16x32_bf16 v[108:111], v[236:239], a[116:119], v[108:111]
    v_mfma_f32_16x16x32_bf16 v[116:119], v[232:235], a[104:107], v[116:119]
    v_mfma_f32_16x16x32_bf16 v[116:119], v[236:239], a[120:123], v[116:119]
    v_mfma_f32_16x16x32_bf16 v[124:127], v[232:235], a[108:111], v[124:127]
    v_mfma_f32_16x16x32_bf16 v[124:127], v[236:239], a[124:127], v[124:127]
    s_waitcnt vmcnt(8) lgkmcnt(0)
    v_cmp_ne_u32 vcc, s71, v14
    s_nop 0
    s_cbranch_vccnz KB_SPK
KB_SPKR:
    v_mfma_f32_16x16x32_bf16 v[128:131], v[240:243], a[96:99], v[128:131]
    s_barrier
    ds_read_b64_tr_b16 v[224:225], v20 offset:32768
    ds_read_b64_tr_b16 v[226:227], v20 offset:33792
    v_mfma_f32_16x16x32_bf16 v[128:131], v[244:247], a[112:115], v[128:131]
    s_add_u32 s37, s72, 7
    s_cmp_ge_u32 s37, 8
    s_cselect_b32 s6, 7, 0
    s_sub_u32 s37, s37, s6
    s_mul_i32 s37, s37, 524288
    s_add_u32 m0, s33, 114688
    s_add_u32 s37, s37, s42
    buffer_load_dwordx4 v16, s[20:23], s37 offen lds
    v_mfma_f32_16x16x32_bf16 v[136:139], v[240:243], a[100:103], v[136:139]
    ds_read_b64_tr_b16 v[228:229], v20 offset:40960
    v_mfma_f32_16x16x32_bf16 v[136:139], v[244:247], a[116:119], v[136:139]
    ds_read_b64_tr_b16 v[230:231], v20 offset:41984
    v_mfma_f32_16x16x32_bf16 v[144:147], v[240:243], a[104:107], v[144:147]
    ds_read_b64_tr_b16 v[232:233], v21 offset:32768
    v_mfma_f32_16x16x32_bf16 v[144:147], v[244:247], a[120:123], v[144:147]
    v_mfma_f32_16x16x32_bf16 v[152:155], v[240:243], a[108:111], v[152:155]
    ds_read_b64_tr_b16 v[234:235], v21 offset:33792
    v_mfma_f32_16x16x32_bf16 v[152:155], v[244:247], a[124:127], v[152:155]
    buffer_load_dwordx4 v17, s[20:23], s37 offen offset:1024 lds
    v_mfma_f32_16x16x32_bf16 v[132:135], v[248:251], a[96:99], v[132:135]
    ds_read_b64_tr_b16 v[236:237], v21 offset:40960
    v_mfma_f32_16x16x32_bf16 v[132:135], v[252:255], a[112:115], v[132:135]
    ds_read_b64_tr_b16 v[238:239], v21 offset:41984
    v_mfma_f32_16x16x32_bf16 v[140:143], v[248:251], a[100:103], v[140:143]
    buffer_load_dwordx4 v18, s[20:23], s37 offen offset:2048 lds
    v_mfma_f32_16x16x32_bf16 v[140:143], v[252:255], a[116:119], v[140:143]
    s_add_u32 s49, s75, 16781312
    v_mfma_f32_16x16x32_bf16 v[148:151], v[248:251], a[104:107], v[148:151]
    buffer_store_dwordx4 v[216:219], v6, s[24:27], s49 offen offset:3072 sc1
    v_mfma_f32_16x16x32_bf16 v[148:151], v[252:255], a[120:123], v[148:151]
    v_mfma_f32_16x16x32_bf16 v[156:159], v[248:251], a[108:111], v[156:159]
    v_mfma_f32_16x16x32_bf16 v[156:159], v[252:255], a[124:127], v[156:159]
    s_waitcnt vmcnt(63) lgkmcnt(0)
    v_mfma_f32_16x16x32_bf16 v[32:35], v[224:227], a[128:131], v[32:35]
    ds_read_b64_tr_b16 v[240:241], v22 offset:32768
    ds_read_b64_tr_b16 v[242:243], v22 offset:33792
    v_mfma_f32_16x16x32_bf16 v[32:35], v[228:231], a[144:147], v[32:35]
    buffer_load_dwordx4 v19, s[20:23], s37 offen offset:3072 lds
    s_add_u32 s49, s75, 16789504
    v_mfma_f32_16x16x32_bf16 v[40:43], v[224:227], a[132:135], v[40:43]
    ds_read_b64_tr_b16 v[244:245], v22 offset:40960
    v_mfma_f32_16x16x32_bf16 v[40:43], v[228:231], a[148:151], v[40:43]
    buffer_store_dwordx4 v[220:223], v6, s[24:27], s49 offen offset:3072 sc1
    v_mfma_f32_16x16x32_bf16 v[48:51], v[224:227], a[136:139], v[48:51]
    ds_read_b64_tr_b16 v[246:247], v22 offset:41984
    ds_read_b64_tr_b16 v[248:249], v23 offset:32768
    v_mfma_f32_16x16x32_bf16 v[48:51], v[228:231], a[152:155], v[48:51]
    s_add_u32 m0, s33, 0
    s_add_u32 s38, s31, 0
    buffer_load_dwordx4 v5, s[24:27], s38 offen offset:0 sc1 lds
    v_mfma_f32_16x16x32_bf16 v[56:59], v[224:227], a[140:143], v[56:59]
    ds_read_b64_tr_b16 v[250:251], v23 offset:33792
    v_mfma_f32_16x16x32_bf16 v[56:59], v[228:231], a[156:159], v[56:59]
    ds_read_b64_tr_b16 v[252:253], v23 offset:40960
    v_mfma_f32_16x16x32_bf16 v[36:39], v[232:235], a[128:131], v[36:39]
    buffer_load_dwordx4 v5, s[24:27], s38 offen offset:1024 sc1 lds
    v_mfma_f32_16x16x32_bf16 v[36:39], v[236:239], a[144:147], v[36:39]
    ds_read_b64_tr_b16 v[254:255], v23 offset:41984
    v_mfma_f32_16x16x32_bf16 v[44:47], v[232:235], a[132:135], v[44:47]
    buffer_load_dwordx4 v5, s[24:27], s38 offen offset:2048 sc1 lds
    v_mfma_f32_16x16x32_bf16 v[44:47], v[236:239], a[148:151], v[44:47]
    v_mfma_f32_16x16x32_bf16 v[52:55], v[232:235], a[136:139], v[52:55]
    buffer_load_dwordx4 v5, s[24:27], s38 offen offset:3072 sc1 lds
    v_mfma_f32_16x16x32_bf16 v[52:55], v[236:239], a[152:155], v[52:55]
    v_mfma_f32_16x16x32_bf16 v[60:63], v[232:235], a[140:143], v[60:63]
    v_mfma_f32_16x16x32_bf16 v[60:63], v[236:239], a[156:159], v[60:63]
    s_waitcnt lgkmcnt(0)
    v_mfma_f32_16x16x32_bf16 v[64:67], v[240:243], a[128:131], v[64:67]
    ds_read_b64_tr_b16 v[224:225], v24 offset:32768
    ds_read_b64_tr_b16 v[226:227], v24 offset:33792
    v_mfma_f32_16x16x32_bf16 v[64:67], v[244:247], a[144:147], v[64:67]
    ds_read_b64_tr_b16 v[228:229], v24 offset:40960
    s_getpc_b64 s[50:51]
    s_lshr_b32 s77, s2, 3
    s_lshl_b32 s77, s77, 2
    v_mfma_f32_16x16x32_bf16 v[72:75], v[240:243], a[132:135], v[72:75]
    s_add_u32 s77, s77, s14
    v_mfma_f32_16x16x32_bf16 v[72:75], v[244:247], a[148:151], v[72:75]
    ds_read_b64_tr_b16 v[230:231], v24 offset:41984
    s_lshl_b32 s77, s77, 7
    v_mfma_f32_16x16x32_bf16 v[80:83], v[240:243], a[136:139], v[80:83]
    ds_read_b64_tr_b16 v[232:233], v25 offset:32768
    v_min_u32 v163, 1, v0
    v_mfma_f32_16x16x32_bf16 v[80:83], v[244:247], a[152:155], v[80:83]
    v_mfma_f32_16x16x32_bf16 v[88:91], v[240:243], a[140:143], v[88:91]
    ds_read_b64_tr_b16 v[234:235], v25 offset:33792
    v_mfma_f32_16x16x32_bf16 v[88:91], v[244:247], a[156:159], v[88:91]
    ds_read_b64_tr_b16 v[236:237], v25 offset:40960
    v_lshlrev_b32 v163, 14, v163
    v_mfma_f32_16x16x32_bf16 v[68:71], v[248:251], a[128:131], v[68:71]
    v_mfma_f32_16x16x32_bf16 v[68:71], v[252:255], a[144:147], v[68:71]
    ds_read_b64_tr_b16 v[238:239], v25 offset:41984
    v_add_u32 v163, s77, v163
    v_mfma_f32_16x16x32_bf16 v[76:79], v[248:251], a[132:135], v[76:79]
    v_mfma_f32_16x16x32_bf16 v[76:79], v[252:255], a[148:151], v[76:79]
    global_load_dword v163, v163, s[50:51]
    v_mfma_f32_16x16x32_bf16 v[84:87], v[248:251], a[136:139], v[84:87]
    v_mfma_f32_16x16x32_bf16 v[84:87], v[252:255], a[152:155], v[84:87]
    v_mfma_f32_16x16x32_bf16 v[92:95], v[248:251], a[140:143], v[92:95]
    v_mfma_f32_16x16x32_bf16 v[92:95], v[252:255], a[156:159], v[92:95]
    s_waitcnt lgkmcnt(0)
    v_mfma_f32_16x16x32_bf16 v[96:99], v[224:227], a[128:131], v[96:99]
    ds_read_b64_tr_b16 v[240:241], v26 offset:32768
    ds_read_b64_tr_b16 v[242:243], v26 offset:33792
    v_mfma_f32_16x16x32_bf16 v[96:99], v[228:231], a[144:147], v[96:99]
    ds_read_b64_tr_b16 v[244:245], v26 offset:40960
    s_add_u32 m0, s33, 32768
    s_add_u32 s38, s31, 16384
    v_mfma_f32_16x16x32_bf16 v[104:107], v[224:227], a[132:135], v[104:107]
    buffer_load_dwordx4 v5, s[24:27], s38 offen offset:0 sc1 lds
    v_mfma_f32_16x16x32_bf16 v[104:107], v[228:231], a[148:151], v[104:107]
    ds_read_b64_tr_b16 v[246:247], v26 offset:41984
    v_mfma_f32_16x16x32_bf16 v[112:115], v[224:227], a[136:139], v[112:115]
    ds_read_b64_tr_b16 v[248:249], v27 offset:32768
    v_mfma_f32_16x16x32_bf16 v[112:115], v[228:231], a[152:155], v[112:115]
    buffer_load_dwordx4 v5, s[24:27], s38 offen offset:1024 sc1 lds
    v_mfma_f32_16x16x32_bf16 v[120:123], v[224:227], a[140:143], v[120:123]
    ds_read_b64_tr_b16 v[250:251], v27 offset:33792
    v_mfma_f32_16x16x32_bf16 v[120:123], v[228:231], a[156:159], v[120:123]
    ds_read_b64_tr_b16 v[252:253], v27 offset:40960
    v_mfma_f32_16x16x32_bf16 v[100:103], v[232:235], a[128:131], v[100:103]
    buffer_load_dwordx4 v5, s[24:27], s38 offen offset:2048 sc1 lds
    v_mfma_f32_16x16x32_bf16 v[100:103], v[236:239], a[144:147], v[100:103]
    ds_read_b64_tr_b16 v[254:255], v27 offset:41984
    v_mfma_f32_16x16x32_bf16 v[108:111], v[232:235], a[132:135], v[108:111]
    v_mfma_f32_16x16x32_bf16 v[108:111], v[236:239], a[148:151], v[108:111]
    buffer_load_dwordx4 v5, s[24:27], s38 offen offset:3072 sc1 lds
    v_mfma_f32_16x16x32_bf16 v[116:119], v[232:235], a[136:139], v[116:119]
    v_mfma_f32_16x16x32_bf16 v[116:119], v[236:239], a[152:155], v[116:119]
    v_mfma_f32_16x16x32_bf16 v[124:127], v[232:235], a[140:143], v[124:127]
    v_mfma_f32_16x16x32_bf16 v[124:127], v[236:239], a[156:159], v[124:127]
    s_waitcnt vmcnt(27) lgkmcnt(0)
    v_mfma_f32_16x16x32_bf16 v[128:131], v[240:243], a[128:131], v[128:131]
    s_barrier
    ds_read_b64_tr_b16 v[224:225], v20 offset:49152
    ds_read_b64_tr_b16 v[226:227], v20 offset:50176
    v_mfma_f32_16x16x32_bf16 v[128:131], v[244:247], a[144:147], v[128:131]
    v_mfma_f32_16x16x32_bf16 v[136:139], v[240:243], a[132:135], v[136:139]
    ds_read_b64_tr_b16 v[228:229], v20 offset:57344
    v_mfma_f32_16x16x32_bf16 v[136:139], v[244:247], a[148:151], v[136:139]
    ds_read_b64_tr_b16 v[230:231], v20 offset:58368
    v_mfma_f32_16x16x32_bf16 v[144:147], v[240:243], a[136:139], v[144:147]
    ds_read_b64_tr_b16 v[232:233], v21 offset:49152
    v_mfma_f32_16x16x32_bf16 v[144:147], v[244:247], a[152:155], v[144:147]
    v_mfma_f32_16x16x32_bf16 v[152:155], v[240:243], a[140:143], v[152:155]
    ds_read_b64_tr_b16 v[234:235], v21 offset:50176
    v_mfma_f32_16x16x32_bf16 v[152:155], v[244:247], a[156:159], v[152:155]
    ds_read_b64_tr_b16 v[236:237], v21 offset:57344
    v_mfma_f32_16x16x32_bf16 v[132:135], v[248:251], a[128:131], v[132:135]
    v_mfma_f32_16x16x32_bf16 v[132:135], v[252:255], a[144:147], v[132:135]
    ds_read_b64_tr_b16 v[238:239], v21 offset:58368
    v_mfma_f32_16x16x32_bf16 v[140:143], v[248:251], a[132:135], v[140:143]
    v_mfma_f32_16x16x32_bf16 v[140:143], v[252:255], a[148:151], v[140:143]
    v_mfma_f32_16x16x32_bf16 v[148:151], v[248:251], a[136:139], v[148:151]
    v_mfma_f32_16x16x32_bf16 v[148:151], v[252:255], a[152:155], v[148:151]
    v_mfma_f32_16x16x32_bf16 v[156:159], v[248:251], a[140:143], v[156:159]
    v_mfma_f32_16x16x32_bf16 v[156:159], v[252:255], a[156:159], v[156:159]
    s_waitcnt vmcnt(63) lgkmcnt(0)
    v_mfma_f32_16x16x32_bf16 v[32:35], v[224:227], a[160:163], v[32:35]
    ds_read_b64_tr_b16 v[240:241], v22 offset:49152
    ds_read_b64_tr_b16 v[242:243], v22 offset:50176
    v_mfma_f32_16x16x32_bf16 v[32:35], v[228:231], a[176:179], v[32:35]
    ds_read_b64_tr_b16 v[244:245], v22 offset:57344
    s_add_u32 m0, s33, 65536
    s_sub_u32 s38, s28, 16384
    v_mfma_f32_16x16x32_bf16 v[40:43], v[224:227], a[164:167], v[40:43]
    buffer_load_dwordx4 v5, s[24:27], s38 offen offset:0 sc1 lds
    v_mfma_f32_16x16x32_bf16 v[40:43], v[228:231], a[180:183], v[40:43]
    ds_read_b64_tr_b16 v[246:247], v22 offset:58368
    v_mfma_f32_16x16x32_bf16 v[48:51], v[224:227], a[168:171], v[48:51]
    ds_read_b64_tr_b16 v[248:249], v23 offset:49152
    v_mfma_f32_16x16x32_bf16 v[48:51], v[228:231], a[184:187], v[48:51]
    buffer_load_dwordx4 v5, s[24:27], s38 offen offset:1024 sc1 lds
    v_mfma_f32_16x16x32_bf16 v[56:59], v[224:227], a[172:175], v[56:59]
    ds_read_b64_tr_b16 v[250:251], v23 offset:50176
    v_mfma_f32_16x16x32_bf16 v[56:59], v[228:231], a[188:191], v[56:59]
    ds_read_b64_tr_b16 v[252:253], v23 offset:57344
    v_mfma_f32_16x16x32_bf16 v[36:39], v[232:235], a[160:163], v[36:39]
    buffer_load_dwordx4 v5, s[24:27], s38 offen offset:2048 sc1 lds
    v_mfma_f32_16x16x32_bf16 v[36:39], v[236:239], a[176:179], v[36:39]
    ds_read_b64_tr_b16 v[254:255], v23 offset:58368
    v_mfma_f32_16x16x32_bf16 v[44:47], v[232:235], a[164:167], v[44:47]
    v_mfma_f32_16x16x32_bf16 v[44:47], v[236:239], a[180:183], v[44:47]
    buffer_load_dwordx4 v5, s[24:27], s38 offen offset:3072 sc1 lds
    v_mfma_f32_16x16x32_bf16 v[52:55], v[232:235], a[168:171], v[52:55]
    v_mfma_f32_16x16x32_bf16 v[52:55], v[236:239], a[184:187], v[52:55]
    v_mfma_f32_16x16x32_bf16 v[60:63], v[232:235], a[172:175], v[60:63]
    v_mfma_f32_16x16x32_bf16 v[60:63], v[236:239], a[188:191], v[60:63]
    s_waitcnt lgkmcnt(0)
    v_mfma_f32_16x16x32_bf16 v[64:67], v[240:243], a[160:163], v[64:67]
    ds_read_b64_tr_b16 v[224:225], v24 offset:49152
    ds_read_b64_tr_b16 v[226:227], v24 offset:50176
    v_mfma_f32_16x16x32_bf16 v[64:67], v[244:247], a[176:179], v[64:67]
    ds_read_b64_tr_b16 v[228:229], v24 offset:57344
    v_mfma_f32_16x16x32_bf16 v[72:75], v[240:243], a[164:167], v[72:75]
    v_mfma_f32_16x16x32_bf16 v[72:75], v[244:247], a[180:183], v[72:75]
    ds_read_b64_tr_b16 v[230:231], v24 offset:58368
    v_mfma_f32_16x16x32_bf16 v[80:83], v[240:243], a[168:171], v[80:83]
    ds_read_b64_tr_b16 v[232:233], v25 offset:49152
    v_mfma_f32_16x16x32_bf16 v[80:83], v[244:247], a[184:187], v[80:83]
    v_mfma_f32_16x16x32_bf16 v[88:91], v[240:243], a[172:175], v[88:91]
    ds_read_b64_tr_b16 v[234:235], v25 offset:50176
    v_mfma_f32_16x16x32_bf16 v[88:91], v[244:247], a[188:191], v[88:91]
    ds_read_b64_tr_b16 v[236:237], v25 offset:57344
    v_mfma_f32_16x16x32_bf16 v[68:71], v[248:251], a[160:163], v[68:71]
    v_mfma_f32_16x16x32_bf16 v[68:71], v[252:255], a[176:179], v[68:71]
    ds_read_b64_tr_b16 v[238:239], v25 offset:58368
    v_mfma_f32_16x16x32_bf16 v[76:79], v[248:251], a[164:167], v[76:79]
    v_mfma_f32_16x16x32_bf16 v[76:79], v[252:255], a[180:183], v[76:79]
    v_mfma_f32_16x16x32_bf16 v[84:87], v[248:251], a[168:171], v[84:87]
    v_mfma_f32_16x16x32_bf16 v[84:87], v[252:255], a[184:187], v[84:87]
    v_mfma_f32_16x16x32_bf16 v[92:95], v[248:251], a[172:175], v[92:95]
    v_mfma_f32_16x16x32_bf16 v[92:95], v[252:255], a[188:191], v[92:95]
    s_waitcnt lgkmcnt(0)
    v_mfma_f32_16x16x32_bf16 v[96:99], v[224:227], a[160:163], v[96:99]
    ds_read_b64_tr_b16 v[240:241], v26 offset:49152
    ds_read_b64_tr_b16 v[242:243], v26 offset:50176
    v_mfma_f32_16x16x32_bf16 v[96:99], v[228:231], a[176:179], v[96:99]
    s_cmp_eq_u32 s16, 0
    s_cselect_b32 s48, 0, 0x40000000
    v_mov_b32 v15, s71
    v_or_b32 v13, s48, v1
    buffer_store_dword v15, v13, s[24:27], s69 offen sc1
    v_mfma_f32_16x16x32_bf16 v[104:107], v[224:227], a[164:167], v[104:107]
    ds_read_b64_tr_b16 v[244:245], v26 offset:57344
    v_mfma_f32_16x16x32_bf16 v[104:107], v[228:231], a[180:183], v[104:107]
    ds_read_b64_tr_b16 v[246:247], v26 offset:58368
    v_mfma_f32_16x16x32_bf16 v[112:115], v[224:227], a[168:171], v[112:115]
    ds_read_b64_tr_b16 v[248:249], v27 offset:49152
    v_mfma_f32_16x16x32_bf16 v[112:115], v[228:231], a[184:187], v[112:115]
    v_mfma_f32_16x16x32_bf16 v[120:123], v[224:227], a[172:175], v[120:123]
    ds_read_b64_tr_b16 v[250:251], v27 offset:50176
    v_mfma_f32_16x16x32_bf16 v[120:123], v[228:231], a[188:191], v[120:123]
    ds_read_b64_tr_b16 v[252:253], v27 offset:57344
    v_mfma_f32_16x16x32_bf16 v[100:103], v[232:235], a[160:163], v[100:103]
    v_mfma_f32_16x16x32_bf16 v[100:103], v[236:239], a[176:179], v[100:103]
    ds_read_b64_tr_b16 v[254:255], v27 offset:58368
    v_mfma_f32_16x16x32_bf16 v[108:111], v[232:235], a[164:167], v[108:111]
    v_mfma_f32_16x16x32_bf16 v[108:111], v[236:239], a[180:183], v[108:111]
    v_mfma_f32_16x16x32_bf16 v[116:119], v[232:235], a[168:171], v[116:119]
    v_mfma_f32_16x16x32_bf16 v[116:119], v[236:239], a[184:187], v[116:119]
    v_mfma_f32_16x16x32_bf16 v[124:127], v[232:235], a[172:175], v[124:127]
    v_mfma_f32_16x16x32_bf16 v[124:127], v[236:239], a[188:191], v[124:127]
    s_waitcnt vmcnt(14) lgkmcnt(0)
    v_mfma_f32_16x16x32_bf16 v[128:131], v[240:243], a[160:163], v[128:131]
    s_barrier
    ds_read_b64_tr_b16 v[224:225], v20 offset:0
    ds_read_b64_tr_b16 v[226:227], v20 offset:1024
    v_mfma_f32_16x16x32_bf16 v[128:131], v[244:247], a[176:179], v[128:131]
    s_xor_b32 s43, s69, 0
    s_lshl_b32 s48, s16, 2
    v_mfma_f32_16x16x32_bf16 v[136:139], v[240:243], a[164:167], v[136:139]
    ds_read_b64_tr_b16 v[228:229], v20 offset:8192
    v_mfma_f32_16x16x32_bf16 v[136:139], v[244:247], a[180:183], v[136:139]
    ds_read_b64_tr_b16 v[230:231], v20 offset:9216
    s_add_u32 s48, s48, s43
    v_mfma_f32_16x16x32_bf16 v[144:147], v[240:243], a[168:171], v[144:147]
    ds_read_b64_tr_b16 v[232:233], v21 offset:0
    v_mfma_f32_16x16x32_bf16 v[144:147], v[244:247], a[184:187], v[144:147]
    v_mov_b32 v15, s71
    v_mfma_f32_16x16x32_bf16 v[152:155], v[240:243], a[172:175], v[152:155]
    ds_read_b64_tr_b16 v[234:235], v21 offset:1024
    v_mfma_f32_16x16x32_bf16 v[152:155], v[244:247], a[188:191], v[152:155]
    ds_read_b64_tr_b16 v[236:237], v21 offset:8192
    v_mfma_f32_16x16x32_bf16 v[132:135], v[248:251], a[160:163], v[132:135]
    buffer_store_dword v15, v1, s[24:27], s48 offen offset:512 sc1
    v_mfma_f32_16x16x32_bf16 v[132:135], v[252:255], a[176:179], v[132:135]
    ds_read_b64_tr_b16 v[238:239], v21 offset:9216
    v_mfma_f32_16x16x32_bf16 v[140:143], v[248:251], a[164:167], v[140:143]
    v_mfma_f32_16x16x32_bf16 v[140:143], v[252:255], a[180:183], v[140:143]
    v_mfma_f32_16x16x32_bf16 v[148:151], v[248:251], a[168:171], v[148:151]
    v_mfma_f32_16x16x32_bf16 v[148:151], v[252:255], a[184:187], v[148:151]
    v_mfma_f32_16x16x32_bf16 v[156:159], v[248:251], a[172:175], v[156:159]
    v_mfma_f32_16x16x32_bf16 v[156:159], v[252:255], a[188:191], v[156:159]
    s_waitcnt vmcnt(58) lgkmcnt(0)
    v_mfma_f32_16x16x32_bf16 v[32:35], v[224:227], a[192:195], v[32:35]
    ds_read_b64_tr_b16 v[240:241], v22 offset:0
    v_and_b32 v161, 15, v0
    v_mfma_f32_16x16x32_bf16 v[32:35], v[228:231], a[208:211], v[32:35]
    ds_read_b64_tr_b16 v[242:243], v22 offset:1024
    v_lshrrev_b32 v160, 4, v0
    v_mfma_f32_16x16x32_bf16 v[40:43], v[224:227], a[196:199], v[40:43]
    ds_read_b64_tr_b16 v[244:245], v22 offset:8192
    v_lshlrev_b32 v160, 2, v160
    v_mfma_f32_16x16x32_bf16 v[40:43], v[228:231], a[212:215], v[40:43]
    ds_read_b64_tr_b16 v[246:247], v22 offset:9216
    v_sub_u32 v161, v161, v160
    v_mfma_f32_16x16x32_bf16 v[48:51], v[224:227], a[200:203], v[48:51]
    ds_read_b64_tr_b16 v[248:249], v23 offset:0
    s_sub_i32 s37, s17, s18
    s_lshl_b32 s37, s37, 5
    v_mfma_f32_16x16x32_bf16 v[48:51], v[228:231], a[216:219], v[48:51]
    v_add_u32 v9, s37, v161
    v_mfma_f32_16x16x32_bf16 v[56:59], v[224:227], a[204:207], v[56:59]
    ds_read_b64_tr_b16 v[250:251], v23 offset:1024
    s_add_u32 s37, s17, s18
    v_mfma_f32_16x16x32_bf16 v[56:59], v[228:231], a[220:223], v[56:59]
    ds_read_b64_tr_b16 v[252:253], v23 offset:8192
    s_sub_i32 s37, 1, s37
    v_mfma_f32_16x16x32_bf16 v[36:39], v[232:235], a[192:195], v[36:39]
    s_lshl_b32 s37, s37, 5
    v_add_u32 v10, s37, v161
    v_mfma_f32_16x16x32_bf16 v[36:39], v[236:239], a[208:211], v[36:39]
    ds_read_b64_tr_b16 v[254:255], v23 offset:9216
    v_mfma_f32_16x16x32_bf16 v[44:47], v[232:235], a[196:199], v[44:47]
    v_mov_b32 v11, 0xff800000
    v_mfma_f32_16x16x32_bf16 v[44:47], v[236:239], a[212:215], v[44:47]
    s_and_b32 s15, s2, 7
    v_mfma_f32_16x16x32_bf16 v[52:55], v[232:235], a[200:203], v[52:55]
    s_lshl_b32 s15, s15, 2
    v_mfma_f32_16x16x32_bf16 v[52:55], v[236:239], a[216:219], v[52:55]
    s_bfe_u32 s37, s2, 0x20003
    s_add_u32 s15, s15, s37
    v_mfma_f32_16x16x32_bf16 v[60:63], v[232:235], a[204:207], v[60:63]
    v_mfma_f32_16x16x32_bf16 v[60:63], v[236:239], a[220:223], v[60:63]
    s_waitcnt lgkmcnt(0)
    v_mfma_f32_16x16x32_bf16 v[64:67], v[240:243], a[192:195], v[64:67]
    ds_read_b64_tr_b16 v[224:225], v24 offset:0
    v_lshrrev_b32 v162, 3, v0
    v_mfma_f32_16x16x32_bf16 v[64:67], v[244:247], a[208:211], v[64:67]
    ds_read_b64_tr_b16 v[226:227], v24 offset:1024
    v_lshrrev_b32 v160, 4, v0
    v_mfma_f32_16x16x32_bf16 v[72:75], v[240:243], a[196:199], v[72:75]
    ds_read_b64_tr_b16 v[228:229], v24 offset:8192
    v_lshlrev_b32 v160, 1, v160
    v_mfma_f32_16x16x32_bf16 v[72:75], v[244:247], a[212:215], v[72:75]
    ds_read_b64_tr_b16 v[230:231], v24 offset:9216
    v_and_b32 v161, 7, v0
    v_mfma_f32_16x16x32_bf16 v[80:83], v[240:243], a[200:203], v[80:83]
    ds_read_b64_tr_b16 v[232:233], v25 offset:0
    v_xor_b32 v160, v160, v161
    v_mfma_f32_16x16x32_bf16 v[80:83], v[244:247], a[216:219], v[80:83]
    v_lshlrev_b32 v160, 4, v160
    v_lshl_add_u32 v16, v162, 10, v160
    v_mfma_f32_16x16x32_bf16 v[88:91], v[240:243], a[204:207], v[88:91]
    ds_read_b64_tr_b16 v[234:235], v25 offset:1024
    v_mfma_f32_16x16x32_bf16 v[88:91], v[244:247], a[220:223], v[88:91]
    ds_read_b64_tr_b16 v[236:237], v25 offset:8192
    v_add_u32 v17, 7168, v16
    v_mfma_f32_16x16x32_bf16 v[68:71], v[248:251], a[192:195], v[68:71]
    v_add_u32 v18, 14336, v16
    v_mfma_f32_16x16x32_bf16 v[68:71], v[252:255], a[208:211], v[68:71]
    ds_read_b64_tr_b16 v[238:239], v25 offset:9216
    v_add_u32 v19, 21504, v16
    v_mfma_f32_16x16x32_bf16 v[76:79], v[248:251], a[196:199], v[76:79]
    s_mov_b32 s20, s4
    v_mfma_f32_16x16x32_bf16 v[76:79], v[252:255], a[212:215], v[76:79]
    s_mov_b32 s21, s5
    v_mfma_f32_16x16x32_bf16 v[84:87], v[248:251], a[200:203], v[84:87]
    s_mov_b32 s22, 0x400000
    s_lshl_b32 s58, s14, 15
    v_mfma_f32_16x16x32_bf16 v[84:87], v[252:255], a[216:219], v[84:87]
    s_and_b32 s59, s15, 7
    s_add_u32 s37, s15, s16
    v_mfma_f32_16x16x32_bf16 v[92:95], v[248:251], a[204:207], v[92:95]
    v_mfma_f32_16x16x32_bf16 v[92:95], v[252:255], a[220:223], v[92:95]
    s_waitcnt lgkmcnt(0)
    v_mfma_f32_16x16x32_bf16 v[96:99], v[224:227], a[192:195], v[96:99]
    ds_read_b64_tr_b16 v[240:241], v26 offset:0
    s_and_b32 s38, s16, 3
    s_lshl_b32 s37, s14, 2
    v_mfma_f32_16x16x32_bf16 v[96:99], v[228:231], a[208:211], v[96:99]
    ds_read_b64_tr_b16 v[242:243], v26 offset:1024
    s_add_u32 s38, s38, s37
    s_lshl_b32 s60, s38, 15
    v_mfma_f32_16x16x32_bf16 v[104:107], v[224:227], a[196:199], v[104:107]
    ds_read_b64_tr_b16 v[244:245], v26 offset:8192
    s_lshl_b32 s64, s38, 10
    v_mfma_f32_16x16x32_bf16 v[104:107], v[228:231], a[212:215], v[104:107]
    ds_read_b64_tr_b16 v[246:247], v26 offset:9216
    s_lshl_b32 s61, s38, 15
    v_mfma_f32_16x16x32_bf16 v[112:115], v[224:227], a[200:203], v[112:115]
    ds_read_b64_tr_b16 v[248:249], v27 offset:0
    s_lshl_b32 s65, s38, 10
    v_mfma_f32_16x16x32_bf16 v[112:115], v[228:231], a[216:219], v[112:115]
    s_lshl_b32 s62, s38, 15
    v_mfma_f32_16x16x32_bf16 v[120:123], v[224:227], a[204:207], v[120:123]
    ds_read_b64_tr_b16 v[250:251], v27 offset:1024
    s_lshl_b32 s66, s38, 10
    v_mfma_f32_16x16x32_bf16 v[120:123], v[228:231], a[220:223], v[120:123]
    ds_read_b64_tr_b16 v[252:253], v27 offset:8192
    s_lshl_b32 s63, s38, 15
    v_mfma_f32_16x16x32_bf16 v[100:103], v[232:235], a[192:195], v[100:103]
    s_lshl_b32 s67, s38, 10
    v_mfma_f32_16x16x32_bf16 v[100:103], v[236:239], a[208:211], v[100:103]
    ds_read_b64_tr_b16 v[254:255], v27 offset:9216
    s_lshl_b32 s37, s14, 20
    v_mfma_f32_16x16x32_bf16 v[108:111], v[232:235], a[196:199], v[108:111]
    s_lshl_b32 s38, s59, 7
    v_mfma_f32_16x16x32_bf16 v[108:111], v[236:239], a[212:215], v[108:111]
    s_add_u32 s37, s37, s38
    v_mfma_f32_16x16x32_bf16 v[116:119], v[232:235], a[200:203], v[116:119]
    s_add_u32 s60, s60, s37
    v_mfma_f32_16x16x32_bf16 v[116:119], v[236:239], a[216:219], v[116:119]
    s_add_u32 s61, s61, s37
    v_mfma_f32_16x16x32_bf16 v[124:127], v[232:235], a[204:207], v[124:127]
    v_mfma_f32_16x16x32_bf16 v[124:127], v[236:239], a[220:223], v[124:127]
    s_waitcnt vmcnt(16) lgkmcnt(0)
    v_mfma_f32_16x16x32_bf16 v[128:131], v[240:243], a[192:195], v[128:131]
    s_barrier
    ds_read_b64_tr_b16 v[224:225], v20 offset:16384
    s_add_u32 s62, s62, s37
    s_add_u32 s63, s63, s37
    v_mfma_f32_16x16x32_bf16 v[128:131], v[244:247], a[208:211], v[128:131]
    ds_read_b64_tr_b16 v[226:227], v20 offset:17408
    s_lshr_b32 s37, s15, 3
    s_lshl_b32 s73, s16, 2
    v_mfma_f32_16x16x32_bf16 v[136:139], v[240:243], a[196:199], v[136:139]
    ds_read_b64_tr_b16 v[228:229], v20 offset:24576
    s_sub_u32 s74, 60, s73
    v_mfma_f32_16x16x32_bf16 v[136:139], v[244:247], a[212:215], v[136:139]
    ds_read_b64_tr_b16 v[230:231], v20 offset:25600
    s_add_u32 s73, s73, s37
    v_mfma_f32_16x16x32_bf16 v[144:147], v[240:243], a[200:203], v[144:147]
    ds_read_b64_tr_b16 v[232:233], v21 offset:16384
    s_add_u32 s74, s74, s37
    v_mfma_f32_16x16x32_bf16 v[144:147], v[244:247], a[216:219], v[144:147]
    s_lshl_b32 s38, s73, 18
    v_mfma_f32_16x16x32_bf16 v[152:155], v[240:243], a[204:207], v[152:155]
    ds_read_b64_tr_b16 v[234:235], v21 offset:17408
    s_add_u32 s38, s38, s58
    v_mfma_f32_16x16x32_bf16 v[152:155], v[244:247], a[220:223], v[152:155]
    ds_read_b64_tr_b16 v[236:237], v21 offset:24576
    s_add_u32 s38, s38, 50331648
    v_mfma_f32_16x16x32_bf16 v[132:135], v[248:251], a[192:195], v[132:135]
    s_add_u32 s64, s64, s38
    v_mfma_f32_16x16x32_bf16 v[132:135], v[252:255], a[208:211], v[132:135]
    ds_read_b64_tr_b16 v[238:239], v21 offset:25600
    s_add_u32 s65, s65, s38
    v_mfma_f32_16x16x32_bf16 v[140:143], v[248:251], a[196:199], v[140:143]
    s_add_u32 s66, s66, s38
    v_mfma_f32_16x16x32_bf16 v[140:143], v[252:255], a[212:215], v[140:143]
    s_add_u32 s67, s67, s38
    v_mfma_f32_16x16x32_bf16 v[148:151], v[248:251], a[200:203], v[148:151]
    s_lshl_b32 s78, s2, 2
    v_mfma_f32_16x16x32_bf16 v[148:151], v[252:255], a[216:219], v[148:151]
    s_add_u32 s78, s78, s14
    v_mfma_f32_16x16x32_bf16 v[156:159], v[248:251], a[204:207], v[156:159]
    v_mfma_f32_16x16x32_bf16 v[156:159], v[252:255], a[220:223], v[156:159]
    s_waitcnt vmcnt(44) lgkmcnt(0)
    v_mfma_f32_16x16x32_bf16 v[32:35], v[224:227], a[224:227], v[32:35]
    ds_read_b64_tr_b16 v[240:241], v22 offset:16384
    s_lshl_b32 s79, s78, 12
    v_mfma_f32_16x16x32_bf16 v[32:35], v[228:231], a[240:243], v[32:35]
    ds_read_b64_tr_b16 v[242:243], v22 offset:17408
    s_add_u32 s4, s4, s79
    s_addc_u32 s5, s5, 0
    v_mfma_f32_16x16x32_bf16 v[40:43], v[224:227], a[228:231], v[40:43]
    ds_read_b64_tr_b16 v[244:245], v22 offset:24576
    s_cmp_ge_u32 s78, 896
    s_cselect_b32 s79, 896, 0
    s_sub_u32 s78, s78, s79
    v_mfma_f32_16x16x32_bf16 v[40:43], v[228:231], a[244:247], v[40:43]
    ds_read_b64_tr_b16 v[246:247], v22 offset:25600
    s_lshl_b32 s79, s78, 11
    v_mfma_f32_16x16x32_bf16 v[48:51], v[224:227], a[232:235], v[48:51]
    ds_read_b64_tr_b16 v[248:249], v23 offset:16384
    s_add_u32 s8, s8, s79
    s_addc_u32 s9, s9, 0
    v_mfma_f32_16x16x32_bf16 v[48:51], v[228:231], a[248:251], v[48:51]
    s_add_u32 s10, s10, s79
    s_addc_u32 s11, s11, 0
    v_mfma_f32_16x16x32_bf16 v[56:59], v[224:227], a[236:239], v[56:59]
    ds_read_b64_tr_b16 v[250:251], v23 offset:17408
    s_add_u32 s12, s12, s79
    s_addc_u32 s13, s13, 0
    v_mfma_f32_16x16x32_bf16 v[56:59], v[228:231], a[252:255], v[56:59]
    ds_read_b64_tr_b16 v[252:253], v23 offset:24576
    v_mfma_f32_16x16x32_bf16 v[36:39], v[232:235], a[224:227], v[36:39]
    v_and_b32 v188, 15, v0
    v_mfma_f32_16x16x32_bf16 v[36:39], v[236:239], a[240:243], v[36:39]
    ds_read_b64_tr_b16 v[254:255], v23 offset:25600
    v_lshlrev_b32 v188, 7, v188
    v_mfma_f32_16x16x32_bf16 v[44:47], v[232:235], a[228:231], v[44:47]
    v_mfma_f32_16x16x32_bf16 v[44:47], v[236:239], a[244:247], v[44:47]
    s_add_u32 s6, s4, 2048
    s_addc_u32 s7, s5, 0
    v_mfma_f32_16x16x32_bf16 v[52:55], v[232:235], a[232:235], v[52:55]
    s_lshl_b32 s76, s15, 2
    v_mfma_f32_16x16x32_bf16 v[52:55], v[236:239], a[248:251], v[52:55]
    s_add_u32 s76, s76, s68
    v_mfma_f32_16x16x32_bf16 v[60:63], v[232:235], a[236:239], v[60:63]
    v_mfma_f32_16x16x32_bf16 v[60:63], v[236:239], a[252:255], v[60:63]
    s_waitcnt lgkmcnt(0)
    v_mfma_f32_16x16x32_bf16 v[64:67], v[240:243], a[224:227], v[64:67]
    ds_read_b64_tr_b16 v[224:225], v24 offset:16384
    ds_read_b64_tr_b16 v[226:227], v24 offset:17408
    v_mfma_f32_16x16x32_bf16 v[64:67], v[244:247], a[240:243], v[64:67]
    ds_read_b64_tr_b16 v[228:229], v24 offset:24576
    v_mfma_f32_16x16x32_bf16 v[72:75], v[240:243], a[228:231], v[72:75]
    v_cvt_pk_bf16_f32 v32, v32, v33
    v_cvt_pk_bf16_f32 v33, v34, v35
    v_mfma_f32_16x16x32_bf16 v[72:75], v[244:247], a[244:247], v[72:75]
    v_cvt_pk_bf16_f32 v34, v36, v37
    v_cvt_pk_bf16_f32 v35, v38, v39
    v_mfma_f32_16x16x32_bf16 v[80:83], v[240:243], a[232:235], v[80:83]
    ds_read_b64_tr_b16 v[230:231], v24 offset:25600
    ds_read_b64_tr_b16 v[232:233], v25 offset:16384
    v_mfma_f32_16x16x32_bf16 v[80:83], v[244:247], a[248:251], v[80:83]
    ds_write_b128 v7, v[32:35] offset:0
    v_mfma_f32_16x16x32_bf16 v[88:91], v[240:243], a[236:239], v[88:91]
    v_cvt_pk_bf16_f32 v40, v40, v41
    v_cvt_pk_bf16_f32 v41, v42, v43
    v_mfma_f32_16x16x32_bf16 v[88:91], v[244:247], a[252:255], v[88:91]
    ds_read_b64_tr_b16 v[234:235], v25 offset:17408
    v_cvt_pk_bf16_f32 v42, v44, v45
    v_mfma_f32_16x16x32_bf16 v[68:71], v[248:251], a[224:227], v[68:71]
    ds_read_b64_tr_b16 v[236:237], v25 offset:24576
    v_cvt_pk_bf16_f32 v43, v46, v47
    v_mfma_f32_16x16x32_bf16 v[68:71], v[252:255], a[240:243], v[68:71]
    ds_write_b128 v7, v[40:43] offset:4096
    v_mfma_f32_16x16x32_bf16 v[76:79], v[248:251], a[228:231], v[76:79]
    ds_read_b64_tr_b16 v[238:239], v25 offset:25600
    v_cvt_pk_bf16_f32 v192, v48, v49
    v_mfma_f32_16x16x32_bf16 v[76:79], v[252:255], a[244:247], v[76:79]
    v_cvt_pk_bf16_f32 v193, v50, v51
    v_cvt_pk_bf16_f32 v194, v52, v53
    v_mfma_f32_16x16x32_bf16 v[84:87], v[248:251], a[232:235], v[84:87]
    v_cvt_pk_bf16_f32 v195, v54, v55
    v_cvt_pk_bf16_f32 v208, v56, v57
    v_mfma_f32_16x16x32_bf16 v[84:87], v[252:255], a[248:251], v[84:87]
    v_cvt_pk_bf16_f32 v209, v58, v59
    v_cvt_pk_bf16_f32 v210, v60, v61
    v_mfma_f32_16x16x32_bf16 v[92:95], v[248:251], a[236:239], v[92:95]
    v_cvt_pk_bf16_f32 v211, v62, v63
    v_mfma_f32_16x16x32_bf16 v[92:95], v[252:255], a[252:255], v[92:95]
    s_waitcnt lgkmcnt(0)
    v_mfma_f32_16x16x32_bf16 v[96:99], v[224:227], a[224:227], v[96:99]
    ds_read_b64_tr_b16 v[240:241], v26 offset:16384
    ds_read_b64_tr_b16 v[242:243], v26 offset:17408
    v_mfma_f32_16x16x32_bf16 v[96:99], v[228:231], a[240:243], v[96:99]
    ds_read_b64_tr_b16 v[244:245], v26 offset:24576
    v_and_b32 v13, 7, v0
    v_mfma_f32_16x16x32_bf16 v[104:107], v[224:227], a[228:231], v[104:107]
    v_cvt_pk_bf16_f32 v64, v64, v65
    v_cvt_pk_bf16_f32 v65, v66, v67
    v_mfma_f32_16x16x32_bf16 v[104:107], v[228:231], a[244:247], v[104:107]
    v_cvt_pk_bf16_f32 v66, v68, v69
    v_cvt_pk_bf16_f32 v67, v70, v71
    v_mfma_f32_16x16x32_bf16 v[112:115], v[224:227], a[232:235], v[112:115]
    ds_read_b64_tr_b16 v[246:247], v26 offset:25600
    v_lshlrev_b32 v13, 2, v13
    v_mfma_f32_16x16x32_bf16 v[112:115], v[228:231], a[248:251], v[112:115]
    ds_write_b128 v7, v[64:67] offset:1024
    v_mfma_f32_16x16x32_bf16 v[120:123], v[224:227], a[236:239], v[120:123]
    ds_read_b64_tr_b16 v[248:249], v27 offset:16384
    v_cvt_pk_bf16_f32 v72, v72, v73
    v_mfma_f32_16x16x32_bf16 v[120:123], v[228:231], a[252:255], v[120:123]
    ds_read_b64_tr_b16 v[250:251], v27 offset:17408
    v_cvt_pk_bf16_f32 v73, v74, v75
    v_mfma_f32_16x16x32_bf16 v[100:103], v[232:235], a[224:227], v[100:103]
    v_cvt_pk_bf16_f32 v74, v76, v77
    v_cvt_pk_bf16_f32 v75, v78, v79
    v_mfma_f32_16x16x32_bf16 v[100:103], v[236:239], a[240:243], v[100:103]
    ds_read_b64_tr_b16 v[252:253], v27 offset:24576
    ds_read_b64_tr_b16 v[254:255], v27 offset:25600
    v_mfma_f32_16x16x32_bf16 v[108:111], v[232:235], a[228:231], v[108:111]
    ds_write_b128 v7, v[72:75] offset:5120
    v_mfma_f32_16x16x32_bf16 v[108:111], v[236:239], a[244:247], v[108:111]
    buffer_load_dword v14, v13, s[24:27], s69 offen offset:512 sc1
    v_mfma_f32_16x16x32_bf16 v[116:119], v[232:235], a[232:235], v[116:119]
    v_cvt_pk_bf16_f32 v196, v80, v81
    v_cvt_pk_bf16_f32 v197, v82, v83
    v_mfma_f32_16x16x32_bf16 v[116:119], v[236:239], a[248:251], v[116:119]
    v_cvt_pk_bf16_f32 v198, v84, v85
    v_cvt_pk_bf16_f32 v199, v86, v87
    v_mfma_f32_16x16x32_bf16 v[124:127], v[232:235], a[236:239], v[124:127]
    v_cvt_pk_bf16_f32 v212, v88, v89
    v_cvt_pk_bf16_f32 v213, v90, v91
    v_mfma_f32_16x16x32_bf16 v[124:127], v[236:239], a[252:255], v[124:127]
    v_cvt_pk_bf16_f32 v214, v92, v93
    v_cvt_pk_bf16_f32 v215, v94, v95
    s_waitcnt lgkmcnt(0)
    v_mfma_f32_16x16x32_bf16 v[128:131], v[240:243], a[224:227], v[128:131]
    v_mfma_f32_16x16x32_bf16 v[128:131], v[244:247], a[240:243], v[128:131]
    v_mfma_f32_16x16x32_bf16 v[136:139], v[240:243], a[228:231], v[136:139]
    v_cvt_pk_bf16_f32 v96, v96, v97
    v_cvt_pk_bf16_f32 v97, v98, v99
    v_mfma_f32_16x16x32_bf16 v[136:139], v[244:247], a[244:247], v[136:139]
    v_cvt_pk_bf16_f32 v98, v100, v101
    v_cvt_pk_bf16_f32 v99, v102, v103
    v_mfma_f32_16x16x32_bf16 v[144:147], v[240:243], a[232:235], v[144:147]
    ds_write_b128 v7, v[96:99] offset:2048
    v_mfma_f32_16x16x32_bf16 v[144:147], v[244:247], a[248:251], v[144:147]
    v_cvt_pk_bf16_f32 v104, v104, v105
    v_cvt_pk_bf16_f32 v105, v106, v107
    v_mfma_f32_16x16x32_bf16 v[152:155], v[240:243], a[236:239], v[152:155]
    v_cvt_pk_bf16_f32 v106, v108, v109
    v_cvt_pk_bf16_f32 v107, v110, v111
    v_mfma_f32_16x16x32_bf16 v[152:155], v[244:247], a[252:255], v[152:155]
    ds_write_b128 v7, v[104:107] offset:6144
    v_mfma_f32_16x16x32_bf16 v[132:135], v[248:251], a[224:227], v[132:135]
    v_mfma_f32_16x16x32_bf16 v[132:135], v[252:255], a[240:243], v[132:135]
    v_cvt_pk_bf16_f32 v200, v112, v113
    v_mfma_f32_16x16x32_bf16 v[140:143], v[248:251], a[228:231], v[140:143]
    v_cvt_pk_bf16_f32 v201, v114, v115
    v_cvt_pk_bf16_f32 v202, v116, v117
    v_mfma_f32_16x16x32_bf16 v[140:143], v[252:255], a[244:247], v[140:143]
    v_cvt_pk_bf16_f32 v203, v118, v119
    v_cvt_pk_bf16_f32 v216, v120, v121
    v_mfma_f32_16x16x32_bf16 v[148:151], v[248:251], a[232:235], v[148:151]
    v_cvt_pk_bf16_f32 v217, v122, v123
    v_mfma_f32_16x16x32_bf16 v[148:151], v[252:255], a[248:251], v[148:151]
    v_cvt_pk_bf16_f32 v218, v124, v125
    v_cvt_pk_bf16_f32 v219, v126, v127
    v_mfma_f32_16x16x32_bf16 v[156:159], v[248:251], a[236:239], v[156:159]
    v_mfma_f32_16x16x32_bf16 v[156:159], v[252:255], a[252:255], v[156:159]
    v_cvt_pk_bf16_f32 v128, v128, v129
    v_cvt_pk_bf16_f32 v129, v130, v131
    v_cvt_pk_bf16_f32 v130, v132, v133
    v_cvt_pk_bf16_f32 v131, v134, v135
    ds_write_b128 v7, v[128:131] offset:3072
    v_cvt_pk_bf16_f32 v136, v136, v137
    v_cvt_pk_bf16_f32 v137, v138, v139
    v_cvt_pk_bf16_f32 v138, v140, v141
    v_cvt_pk_bf16_f32 v139, v142, v143
    ds_write_b128 v7, v[136:139] offset:7168
    v_cvt_pk_bf16_f32 v204, v144, v145
    v_cvt_pk_bf16_f32 v205, v146, v147
    v_cvt_pk_bf16_f32 v206, v148, v149
    v_cvt_pk_bf16_f32 v207, v150, v151
    v_cvt_pk_bf16_f32 v220, v152, v153
    v_cvt_pk_bf16_f32 v221, v154, v155
    v_cvt_pk_bf16_f32 v222, v156, v157
    v_cvt_pk_bf16_f32 v223, v158, v159
    s_waitcnt vmcnt(0)
    v_cmp_ne_u32 vcc, s71, v14
    s_nop 0
    s_cbranch_vccnz KB_SPV
KB_SPVR:
    s_add_u32 m0, s33, 49152
    s_add_u32 s38, s31, 16777216
    buffer_load_dwordx4 v4, s[24:27], s38 offen offset:0 sc1 lds
    buffer_load_dwordx4 v4, s[24:27], s38 offen offset:1024 sc1 lds
    buffer_load_dwordx4 v4, s[24:27], s38 offen offset:2048 sc1 lds
    buffer_load_dwordx4 v4, s[24:27], s38 offen offset:3072 sc1 lds
    s_add_u32 m0, s33, 81920
    s_add_u32 s38, s31, 16793600
    buffer_load_dwordx4 v4, s[24:27], s38 offen offset:0 sc1 lds
    buffer_load_dwordx4 v4, s[24:27], s38 offen offset:1024 sc1 lds
    buffer_load_dwordx4 v4, s[24:27], s38 offen offset:2048 sc1 lds
    buffer_load_dwordx4 v4, s[24:27], s38 offen offset:3072 sc1 lds
    s_add_u32 m0, s32, s33
    s_add_u32 s32, s32, 32768
    s_and_b32 s32, s32, 0x1ffff
    v_add_u32 v3, s32, v2
    s_waitcnt vmcnt(8) lgkmcnt(0)
    s_barrier
    ds_read_b128 a[128:131], v12 offset:0
    ds_read_b128 a[132:135], v12 offset:1024
    ds_read_b128 a[136:139], v12 offset:2048
    ds_read_b128 a[140:143], v12 offset:3072
    ds_read_b128 a[144:147], v12 offset:4096
    ds_read_b128 a[148:151], v12 offset:5120
    ds_read_b128 a[152:155], v12 offset:6144
    ds_read_b128 a[156:159], v12 offset:7168
    ds_read_b128 a[192:195], v3 offset:0
    ds_read_b128 a[196:199], v3 offset:1024
    ds_read_b128 a[200:203], v3 offset:2048
    ds_read_b128 a[204:207], v3 offset:3072
    ds_read_b128 a[208:211], v3 offset:4096
    ds_read_b128 a[212:215], v3 offset:5120
    ds_read_b128 a[216:219], v3 offset:6144
    ds_read_b128 a[220:223], v3 offset:7168
    ds_read_b128 a[160:163], v12 offset:8192
    ds_read_b128 a[164:167], v12 offset:9216
    ds_read_b128 a[168:171], v12 offset:10240
    ds_read_b128 a[172:175], v12 offset:11264
    ds_read_b128 a[176:179], v12 offset:12288
    ds_read_b128 a[180:183], v12 offset:13312
    ds_read_b128 a[184:187], v12 offset:14336
    ds_read_b128 a[188:191], v12 offset:15360
    v_mov_b32 v244, 0x3f803f80
    v_mov_b32 v245, 0x3f803f80
    v_mov_b32 v246, 0x3f803f80
    v_mov_b32 v247, 0x3f803f80
    v_mov_b32 v248, 0xc1a00000
    v_mov_b32 v249, 0xc1a00000
    v_mov_b32 v250, 0xc1a00000
    v_mov_b32 v251, 0xc1a00000
    v_mov_b32 v253, 0x40000000
    v_mov_b32 v254, s70
    v_mov_b32 v128, v248
    v_mov_b32 v129, v248
    v_mov_b32 v130, v248
    v_mov_b32 v131, v248
    v_mov_b32 v132, v248
    v_mov_b32 v133, v248
    v_mov_b32 v134, v248
    v_mov_b32 v135, v248
    v_mov_b32 v136, v248
    v_mov_b32 v137, v248
    v_mov_b32 v138, v248
    v_mov_b32 v139, v248
    v_mov_b32 v140, v248
    v_mov_b32 v141, v248
    v_mov_b32 v142, v248
    v_mov_b32 v143, v248
    s_waitcnt lgkmcnt(8)
    v_mfma_f32_16x16x32_bf16 v[32:35], a[192:195], a[128:131], v[248:251]
    buffer_load_dwordx4 v5, s[24:27], s28 offen offset:0 sc1 lds
    v_mfma_f32_16x16x32_bf16 v[32:35], a[196:199], a[132:135], v[32:35]
    buffer_load_dwordx4 v5, s[24:27], s28 offen offset:1024 sc1 lds
    v_mfma_f32_16x16x32_bf16 v[32:35], a[200:203], a[136:139], v[32:35]
    buffer_load_dwordx4 v5, s[24:27], s28 offen offset:2048 sc1 lds
    v_mfma_f32_16x16x32_bf16 v[32:35], a[204:207], a[140:143], v[32:35]
    buffer_load_dwordx4 v5, s[24:27], s28 offen offset:3072 sc1 lds
    s_add_u32 m0, m0, 16384
    v_mfma_f32_16x16x32_bf16 v[36:39], a[208:211], a[128:131], v[248:251]
    s_add_u32 s38, s28, 16777216
    buffer_load_dwordx4 v4, s[24:27], s29 offen offset:0 sc1 lds
    v_mfma_f32_16x16x32_bf16 v[36:39], a[212:215], a[132:135], v[36:39]
    v_mfma_f32_16x16x32_bf16 v[36:39], a[216:219], a[136:139], v[36:39]
    buffer_load_dwordx4 v4, s[24:27], s29 offen offset:1024 sc1 lds
    v_mfma_f32_16x16x32_bf16 v[36:39], a[220:223], a[140:143], v[36:39]
    s_add_u32 s28, s28, 16384
    buffer_load_dwordx4 v4, s[24:27], s29 offen offset:2048 sc1 lds
    v_mfma_f32_16x16x32_bf16 v[40:43], a[192:195], a[144:147], v[248:251]
    v_mfma_f32_16x16x32_bf16 v[40:43], a[196:199], a[148:151], v[40:43]
    s_cmp_eq_u32 s28, s30
    s_cselect_b32 s28, s31, s28
    s_cselect_b32 s30, s19, s30
    v_mfma_f32_16x16x32_bf16 v[40:43], a[200:203], a[152:155], v[40:43]
    buffer_load_dwordx4 v4, s[24:27], s29 offen offset:3072 sc1 lds
    v_mfma_f32_16x16x32_bf16 v[40:43], a[204:207], a[156:159], v[40:43]
    s_mov_b32 s29, s38
    v_mfma_f32_16x16x32_bf16 v[44:47], a[208:211], a[144:147], v[248:251]
    s_add_u32 m0, s32, s33
    s_add_u32 s32, s32, 32768
    v_mfma_f32_16x16x32_bf16 v[44:47], a[212:215], a[148:151], v[44:47]
    s_and_b32 s32, s32, 0x1ffff
    v_add_u32 v3, s32, v2
    v_mfma_f32_16x16x32_bf16 v[44:47], a[216:219], a[152:155], v[44:47]
    v_mfma_f32_16x16x32_bf16 v[44:47], a[220:223], a[156:159], v[44:47]
    s_waitcnt lgkmcnt(0)
    v_mfma_f32_16x16x32_bf16 v[48:51], a[192:195], a[160:163], v[248:251]
    v_mfma_f32_16x16x32_bf16 v[48:51], a[196:199], a[164:167], v[48:51]
    v_mfma_f32_16x16x32_bf16 v[48:51], a[200:203], a[168:171], v[48:51]
    s_cmp_lg_u32 s16, 0
    s_cbranch_scc1 KB_NM
    v_cmp_le_i32 s[50:51], 0, v9
    v_cmp_le_i32 s[52:53], 1, v9
    v_cmp_le_i32 s[54:55], 2, v9
    v_cmp_le_i32 s[56:57], 3, v9
    v_cndmask_b32 v32, v11, v32, s[50:51]
    v_cndmask_b32 v33, v11, v33, s[52:53]
    v_cndmask_b32 v34, v11, v34, s[54:55]
    v_cndmask_b32 v35, v11, v35, s[56:57]
    v_cmp_le_i32 s[50:51], 16, v9
    v_cmp_le_i32 s[52:53], 17, v9
    v_cmp_le_i32 s[54:55], 18, v9
    v_cmp_le_i32 s[56:57], 19, v9
    v_cndmask_b32 v36, v11, v36, s[50:51]
    v_cndmask_b32 v37, v11, v37, s[52:53]
    v_cndmask_b32 v38, v11, v38, s[54:55]
    v_cndmask_b32 v39, v11, v39, s[56:57]
    v_cmp_le_i32 s[50:51], -16, v9
    v_cmp_le_i32 s[52:53], -15, v9
    v_cmp_le_i32 s[54:55], -14, v9
    v_cmp_le_i32 s[56:57], -13, v9
    v_cndmask_b32 v40, v11, v40, s[50:51]
    v_cndmask_b32 v41, v11, v41, s[52:53]
    v_cndmask_b32 v42, v11, v42, s[54:55]
    v_cndmask_b32 v43, v11, v43, s[56:57]
    v_cmp_le_i32 s[50:51], 0, v9
    v_cmp_le_i32 s[52:53], 1, v9
    v_cmp_le_i32 s[54:55], 2, v9
    v_cmp_le_i32 s[56:57], 3, v9
    v_cndmask_b32 v44, v11, v44, s[50:51]
    v_cndmask_b32 v45, v11, v45, s[52:53]
    v_cndmask_b32 v46, v11, v46, s[54:55]
    v_cndmask_b32 v47, v11, v47, s[56:57]
KB_NM:
    v_mfma_f32_16x16x32_bf16 v[48:51], a[204:207], a[172:175], v[48:51]
    v_mfma_f32_16x16x32_bf16 v[52:55], a[208:211], a[160:163], v[248:251]
    v_mfma_f32_16x16x32_bf16 v[52:55], a[212:215], a[164:167], v[52:55]
    v_mfma_f32_16x16x32_bf16 v[52:55], a[216:219], a[168:171], v[52:55]
    v_mfma_f32_16x16x32_bf16 v[52:55], a[220:223], a[172:175], v[52:55]
    v_mfma_f32_16x16x32_bf16 v[56:59], a[192:195], a[176:179], v[248:251]
    v_exp_f32 v160, v32
    v_mfma_f32_16x16x32_bf16 v[56:59], a[196:199], a[180:183], v[56:59]
    v_exp_f32 v161, v33
    v_mfma_f32_16x16x32_bf16 v[56:59], a[200:203], a[184:187], v[56:59]
    v_exp_f32 v162, v34
    v_mfma_f32_16x16x32_bf16 v[56:59], a[204:207], a[188:191], v[56:59]
    v_cvt_pk_bf16_f32 v96, v160, v161
    v_mfma_f32_16x16x32_bf16 v[60:63], a[208:211], a[176:179], v[248:251]
    v_exp_f32 v163, v35
    v_mfma_f32_16x16x32_bf16 v[60:63], a[212:215], a[180:183], v[60:63]
    v_exp_f32 v164, v36
    v_mfma_f32_16x16x32_bf16 v[60:63], a[216:219], a[184:187], v[60:63]
    v_cvt_pk_bf16_f32 v97, v162, v163
    v_mfma_f32_16x16x32_bf16 v[60:63], a[220:223], a[188:191], v[60:63]
    v_exp_f32 v165, v37
    v_exp_f32 v166, v38
    v_cvt_pk_bf16_f32 v98, v164, v165
    v_exp_f32 v167, v39
    v_or3_b32 v174, v96, v97, v98
    v_exp_f32 v160, v40
    v_cvt_pk_bf16_f32 v99, v166, v167
    v_exp_f32 v161, v41
    v_exp_f32 v162, v42
    s_waitcnt lgkmcnt(0)
    s_barrier
    ds_read_b128 a[192:195], v3 offset:0
    ds_read_b128 a[196:199], v3 offset:1024
    ds_read_b128 a[200:203], v3 offset:2048
    ds_read_b128 a[204:207], v3 offset:3072
    ds_read_b128 a[208:211], v3 offset:4096
    ds_read_b128 a[212:215], v3 offset:5120
    ds_read_b128 a[216:219], v3 offset:6144
    ds_read_b128 a[220:223], v3 offset:7168
    v_cvt_pk_bf16_f32 v100, v160, v161
    v_exp_f32 v163, v43
    v_or3_b32 v174, v174, v99, v100
    v_exp_f32 v164, v44
    v_cvt_pk_bf16_f32 v101, v162, v163
    v_exp_f32 v165, v45
    v_exp_f32 v166, v46
    v_cvt_pk_bf16_f32 v102, v164, v165
    v_exp_f32 v167, v47
    v_or3_b32 v174, v174, v101, v102
    v_cvt_pk_bf16_f32 v103, v166, v167
    v_or_b32 v174, v174, v103
    v_and_b32 v174, s39, v174
    v_cmp_ne_u32 vcc, 0, v174
    v_or3_b32 v172, v96, v97, v98
    v_or3_b32 v173, v100, v101, v102
    v_or_b32 v172, v172, v99
    v_or_b32 v173, v173, v103
    v_and_b32 v172, s3, v172
    v_and_b32 v173, s3, v173
    v_min_u32 v172, v172, v173
    v_cmp_eq_u32 s[50:51], 0, v172
    s_nop 0
    s_or_b64 vcc, vcc, s[50:51]
    s_cbranch_vccnz KB_SL1
KB_SL1R:
    s_waitcnt lgkmcnt(0)
    v_mfma_f32_16x16x32_bf16 v[64:67], a[192:195], a[128:131], v[128:131]
    v_exp_f32 v160, v48
    v_mfma_f32_16x16x32_bf16 v[64:67], a[196:199], a[132:135], v[64:67]
    buffer_load_dwordx4 v5, s[24:27], s28 offen offset:0 sc1 lds
    v_mfma_f32_16x16x32_bf16 v[64:67], a[200:203], a[136:139], v[64:67]
    ds_write_b128 v7, v[192:195] offset:0
    v_mfma_f32_16x16x32_bf16 v[64:67], a[204:207], a[140:143], v[64:67]
    v_exp_f32 v161, v49
    v_mfma_f32_16x16x32_bf16 v[68:71], a[208:211], a[128:131], v[128:131]
    ds_write_b128 v7, v[196:199] offset:1024
    v_mfma_f32_16x16x32_bf16 v[68:71], a[212:215], a[132:135], v[68:71]
    v_exp_f32 v162, v50
    v_mfma_f32_16x16x32_bf16 v[68:71], a[216:219], a[136:139], v[68:71]
    buffer_load_dwordx4 v5, s[24:27], s28 offen offset:1024 sc1 lds
    ds_write_b128 v7, v[200:203] offset:2048
    v_mfma_f32_16x16x32_bf16 v[68:71], a[220:223], a[140:143], v[68:71]
    v_cvt_pk_bf16_f32 v104, v160, v161
    v_exp_f32 v163, v51
    v_mfma_f32_16x16x32_bf16 v[72:75], a[192:195], a[144:147], v[132:135]
    ds_write_b128 v7, v[204:207] offset:3072
    v_mfma_f32_16x16x32_bf16 v[72:75], a[196:199], a[148:151], v[72:75]
    v_exp_f32 v164, v52
    v_mfma_f32_16x16x32_bf16 v[72:75], a[200:203], a[152:155], v[72:75]
    buffer_load_dwordx4 v5, s[24:27], s28 offen offset:2048 sc1 lds
    ds_write_b128 v7, v[208:211] offset:4096
    v_cvt_pk_bf16_f32 v105, v162, v163
    v_mfma_f32_16x16x32_bf16 v[72:75], a[204:207], a[156:159], v[72:75]
    v_exp_f32 v165, v53
    v_mfma_f32_16x16x32_bf16 v[76:79], a[208:211], a[144:147], v[132:135]
    ds_write_b128 v7, v[212:215] offset:5120
    v_exp_f32 v166, v54
    v_mfma_f32_16x16x32_bf16 v[76:79], a[212:215], a[148:151], v[76:79]
    v_cvt_pk_bf16_f32 v106, v164, v165
    v_mfma_f32_16x16x32_bf16 v[76:79], a[216:219], a[152:155], v[76:79]
    buffer_load_dwordx4 v5, s[24:27], s28 offen offset:3072 sc1 lds
    ds_write_b128 v7, v[216:219] offset:6144
    v_exp_f32 v167, v55
    v_mfma_f32_16x16x32_bf16 v[76:79], a[220:223], a[156:159], v[76:79]
    ds_write_b128 v7, v[220:223] offset:7168
    v_or3_b32 v174, v104, v105, v106
    v_exp_f32 v160, v56
    v_cvt_pk_bf16_f32 v107, v166, v167
    s_waitcnt vmcnt(16)
    v_mfma_f32_16x16x32_bf16 v[80:83], a[192:195], a[160:163], v[136:139]
    s_barrier
    v_exp_f32 v161, v57
    v_mfma_f32_16x16x32_bf16 v[80:83], a[196:199], a[164:167], v[80:83]
    ds_read_b128 a[224:227], v3 offset:16384
    s_add_u32 m0, m0, 16384
    s_add_u32 s38, s28, 16777216
    v_mfma_f32_16x16x32_bf16 v[80:83], a[200:203], a[168:171], v[80:83]
    v_exp_f32 v162, v58
    v_mfma_f32_16x16x32_bf16 v[80:83], a[204:207], a[172:175], v[80:83]
    buffer_load_dwordx4 v4, s[24:27], s29 offen offset:0 sc1 lds
    v_mfma_f32_16x16x32_bf16 v[84:87], a[208:211], a[160:163], v[136:139]
    ds_read_b128 a[228:231], v3 offset:17408
    v_cvt_pk_bf16_f32 v108, v160, v161
    v_mfma_f32_16x16x32_bf16 v[84:87], a[212:215], a[164:167], v[84:87]
    ds_read_b128 a[232:235], v3 offset:18432
    v_exp_f32 v163, v59
    v_mfma_f32_16x16x32_bf16 v[84:87], a[216:219], a[168:171], v[84:87]
    buffer_load_dwordx4 v4, s[24:27], s29 offen offset:1024 sc1 lds
    v_or3_b32 v174, v174, v107, v108
    v_exp_f32 v164, v60
    v_mfma_f32_16x16x32_bf16 v[84:87], a[220:223], a[172:175], v[84:87]
    ds_read_b128 a[236:239], v3 offset:19456
    v_cvt_pk_bf16_f32 v109, v162, v163
    v_mfma_f32_16x16x32_bf16 v[88:91], a[192:195], a[176:179], v[140:143]
    ds_read_b128 a[240:243], v3 offset:20480
    s_add_u32 s28, s28, 16384
    buffer_load_dwordx4 v4, s[24:27], s29 offen offset:2048 sc1 lds
    v_exp_f32 v165, v61
    v_exp_f32 v166, v62
    v_mfma_f32_16x16x32_bf16 v[88:91], a[196:199], a[180:183], v[88:91]
    ds_read_b128 a[244:247], v3 offset:21504
    ds_read_b128 a[248:251], v3 offset:22528
    ds_read_b128 a[252:255], v3 offset:23552
    v_cvt_pk_bf16_f32 v110, v164, v165
    v_mfma_f32_16x16x32_bf16 v[88:91], a[200:203], a[184:187], v[88:91]
    s_cmp_eq_u32 s28, s30
    s_cselect_b32 s28, s31, s28
    s_cselect_b32 s30, s19, s30
    v_exp_f32 v167, v63
    v_mfma_f32_16x16x32_bf16 v[88:91], a[204:207], a[188:191], v[88:91]
    buffer_load_dwordx4 v4, s[24:27], s29 offen offset:3072 sc1 lds
    s_mov_b32 s29, s38
    v_or3_b32 v174, v174, v109, v110
    v_cvt_pk_bf16_f32 v111, v166, v167
    v_mfma_f32_16x16x32_bf16 v[92:95], a[208:211], a[176:179], v[140:143]
    s_add_u32 m0, s32, s33
    v_or_b32 v174, v174, v111
    v_and_b32 v174, s39, v174
    v_mfma_f32_16x16x32_bf16 v[92:95], a[212:215], a[180:183], v[92:95]
    v_cmp_ne_u32 vcc, 0, v174
    v_or3_b32 v172, v104, v105, v106
    v_or3_b32 v173, v108, v109, v110
    v_or_b32 v172, v172, v107
    v_or_b32 v173, v173, v111
    v_and_b32 v172, s3, v172
    v_and_b32 v173, s3, v173
    v_min_u32 v172, v172, v173
    v_cmp_eq_u32 s[50:51], 0, v172
    s_nop 0
    s_or_b64 vcc, vcc, s[50:51]
    v_mfma_f32_16x16x32_bf16 v[92:95], a[216:219], a[184:187], v[92:95]
    s_add_u32 s32, s32, 32768
    s_and_b32 s32, s32, 0x1ffff
    v_add_u32 v3, s32, v2
    v_mfma_f32_16x16x32_bf16 v[92:95], a[220:223], a[188:191], v[92:95]
    s_cbranch_vccnz KB_SL2
KB_SL2R:
    s_cmp_eq_u32 s16, 0
    s_cbranch_scc1 KB_SMALL
KB_BLK:
    s_waitcnt vmcnt(16) lgkmcnt(0)
    v_mfma_f32_16x16x32_bf16 a[0:3], a[224:227], v[96:99], 0
    s_barrier
    v_exp_f32 v160, v64
    v_mfma_f32_16x16x32_bf16 a[16:19], a[224:227], v[100:103], 0
    v_exp_f32 v161, v65
    v_mfma_f32_16x16x32_bf16 a[4:7], a[228:231], v[96:99], 0
    ds_read_b128 a[192:195], v3 offset:0
    v_mfma_f32_16x16x32_bf16 a[20:23], a[228:231], v[100:103], 0
    buffer_load_dwordx4 v5, s[24:27], s28 offen offset:0 sc1 lds
    v_mfma_f32_16x16x32_bf16 a[8:11], a[232:235], v[96:99], 0
    v_exp_f32 v162, v66
    v_mfma_f32_16x16x32_bf16 a[24:27], a[232:235], v[100:103], 0
    ds_read_b128 a[196:199], v3 offset:1024
    v_cvt_pk_bf16_f32 v112, v160, v161
    v_mfma_f32_16x16x32_bf16 a[12:15], a[236:239], v[96:99], 0
    v_exp_f32 v163, v67
    v_mfma_f32_16x16x32_bf16 a[28:31], a[236:239], v[100:103], 0
    v_exp_f32 v164, v68
    v_mfma_f32_16x16x32_bf16 a[32:35], a[240:243], v[96:99], 0
    ds_read_b128 a[200:203], v3 offset:2048
    v_cvt_pk_bf16_f32 v113, v162, v163
    v_mfma_f32_16x16x32_bf16 a[48:51], a[240:243], v[100:103], 0
    v_exp_f32 v165, v69
    v_mfma_f32_16x16x32_bf16 a[36:39], a[244:247], v[96:99], 0
    buffer_load_dwordx4 v5, s[24:27], s28 offen offset:1024 sc1 lds
    v_mfma_f32_16x16x32_bf16 a[52:55], a[244:247], v[100:103], 0
    v_exp_f32 v166, v70
    v_mfma_f32_16x16x32_bf16 a[40:43], a[248:251], v[96:99], 0
    ds_read_b128 a[204:207], v3 offset:3072
    v_cvt_pk_bf16_f32 v114, v164, v165
    v_mfma_f32_16x16x32_bf16 a[56:59], a[248:251], v[100:103], 0
    v_exp_f32 v167, v71
    v_mfma_f32_16x16x32_bf16 a[44:47], a[252:255], v[96:99], 0
    ds_read_b128 a[208:211], v3 offset:4096
    v_or3_b32 v174, v112, v113, v114
    v_mfma_f32_16x16x32_bf16 a[60:63], a[252:255], v[100:103], 0
    v_exp_f32 v160, v72
    v_mfma_f32_16x16x32_bf16 v[20:23], v[244:247], v[96:99], 0
    ds_read_b128 a[212:215], v3 offset:5120
    v_cvt_pk_bf16_f32 v115, v166, v167
    v_mfma_f32_16x16x32_bf16 v[24:27], v[244:247], v[100:103], 0
    v_exp_f32 v161, v73
    v_mfma_f32_16x16x32_bf16 a[64:67], a[224:227], v[104:107], 0
    buffer_load_dwordx4 v5, s[24:27], s28 offen offset:2048 sc1 lds
    v_mfma_f32_16x16x32_bf16 a[80:83], a[224:227], v[108:111], 0
    v_exp_f32 v162, v74
    v_mfma_f32_16x16x32_bf16 a[68:71], a[228:231], v[104:107], 0
    ds_read_b128 a[216:219], v3 offset:6144
    v_cvt_pk_bf16_f32 v116, v160, v161
    v_mfma_f32_16x16x32_bf16 a[84:87], a[228:231], v[108:111], 0
    v_exp_f32 v163, v75
    v_mfma_f32_16x16x32_bf16 a[72:75], a[232:235], v[104:107], 0
    v_or3_b32 v174, v174, v115, v116
    v_mfma_f32_16x16x32_bf16 a[88:91], a[232:235], v[108:111], 0
    v_exp_f32 v164, v76
    v_mfma_f32_16x16x32_bf16 a[76:79], a[236:239], v[104:107], 0
    ds_read_b128 a[220:223], v3 offset:7168
    v_cvt_pk_bf16_f32 v117, v162, v163
    v_mfma_f32_16x16x32_bf16 a[92:95], a[236:239], v[108:111], 0
    v_exp_f32 v165, v77
    v_mfma_f32_16x16x32_bf16 a[96:99], a[240:243], v[104:107], 0
    buffer_load_dwordx4 v5, s[24:27], s28 offen offset:3072 sc1 lds
    v_mfma_f32_16x16x32_bf16 a[112:115], a[240:243], v[108:111], 0
    v_exp_f32 v166, v78
    v_mfma_f32_16x16x32_bf16 a[100:103], a[244:247], v[104:107], 0
    v_cvt_pk_bf16_f32 v118, v164, v165
    v_mfma_f32_16x16x32_bf16 a[116:119], a[244:247], v[108:111], 0
    v_exp_f32 v167, v79
    v_mfma_f32_16x16x32_bf16 a[104:107], a[248:251], v[104:107], 0
    v_or3_b32 v174, v174, v117, v118
    v_cvt_pk_bf16_f32 v119, v166, v167
    v_mfma_f32_16x16x32_bf16 a[120:123], a[248:251], v[108:111], 0
    v_or_b32 v174, v174, v119
    v_and_b32 v174, s39, v174
    v_mfma_f32_16x16x32_bf16 a[108:111], a[252:255], v[104:107], 0
    v_cmp_ne_u32 vcc, 0, v174
    v_mfma_f32_16x16x32_bf16 a[124:127], a[252:255], v[108:111], 0
    v_mfma_f32_16x16x32_bf16 v[28:31], v[244:247], v[104:107], 0
    v_mfma_f32_16x16x32_bf16 v[168:171], v[244:247], v[108:111], 0
    s_cbranch_vccnz KB_SL3
KB_SL3R:
    s_waitcnt lgkmcnt(0)
    v_mfma_f32_16x16x32_bf16 v[32:35], a[192:195], a[128:131], v[128:131]
    ds_read_b128 a[224:227], v3 offset:16384
    v_mfma_f32_16x16x32_bf16 v[32:35], a[196:199], a[132:135], v[32:35]
    s_add_u32 m0, m0, 16384
    v_exp_f32 v160, v80
    v_mfma_f32_16x16x32_bf16 v[32:35], a[200:203], a[136:139], v[32:35]
    s_add_u32 s38, s28, 16777216
    v_exp_f32 v161, v81
    v_mfma_f32_16x16x32_bf16 v[32:35], a[204:207], a[140:143], v[32:35]
    v_exp_f32 v162, v82
    v_mfma_f32_16x16x32_bf16 v[36:39], a[208:211], a[128:131], v[128:131]
    ds_read_b128 a[228:231], v3 offset:17408
    v_cvt_pk_bf16_f32 v120, v160, v161
    v_mfma_f32_16x16x32_bf16 v[36:39], a[212:215], a[132:135], v[36:39]
    buffer_load_dwordx4 v4, s[24:27], s29 offen offset:0 sc1 lds
    v_mfma_f32_16x16x32_bf16 v[36:39], a[216:219], a[136:139], v[36:39]
    v_exp_f32 v163, v83
    v_mfma_f32_16x16x32_bf16 v[36:39], a[220:223], a[140:143], v[36:39]
    ds_read_b128 a[232:235], v3 offset:18432
    ds_read_b128 a[236:239], v3 offset:19456
    v_mfma_f32_16x16x32_bf16 v[40:43], a[192:195], a[144:147], v[132:135]
    v_exp_f32 v164, v84
    v_mfma_f32_16x16x32_bf16 v[40:43], a[196:199], a[148:151], v[40:43]
    v_cvt_pk_bf16_f32 v121, v162, v163
    v_mfma_f32_16x16x32_bf16 v[40:43], a[200:203], a[152:155], v[40:43]
    buffer_load_dwordx4 v4, s[24:27], s29 offen offset:1024 sc1 lds
    s_add_u32 s28, s28, 16384
    v_mfma_f32_16x16x32_bf16 v[40:43], a[204:207], a[156:159], v[40:43]
    v_exp_f32 v165, v85
    v_mfma_f32_16x16x32_bf16 v[44:47], a[208:211], a[144:147], v[132:135]
    v_exp_f32 v166, v86
    v_mfma_f32_16x16x32_bf16 v[44:47], a[212:215], a[148:151], v[44:47]
    ds_read_b128 a[240:243], v3 offset:20480
    v_cvt_pk_bf16_f32 v122, v164, v165
    v_mfma_f32_16x16x32_bf16 v[44:47], a[216:219], a[152:155], v[44:47]
    v_exp_f32 v167, v87
    v_mfma_f32_16x16x32_bf16 v[44:47], a[220:223], a[156:159], v[44:47]
    buffer_load_dwordx4 v4, s[24:27], s29 offen offset:2048 sc1 lds
    v_or3_b32 v174, v120, v121, v122
    v_mfma_f32_16x16x32_bf16 v[48:51], a[192:195], a[160:163], v[136:139]
    v_exp_f32 v160, v88
    v_mfma_f32_16x16x32_bf16 v[48:51], a[196:199], a[164:167], v[48:51]
    ds_read_b128 a[244:247], v3 offset:21504
    v_cvt_pk_bf16_f32 v123, v166, v167
    v_mfma_f32_16x16x32_bf16 v[48:51], a[200:203], a[168:171], v[48:51]
    v_exp_f32 v161, v89
    v_mfma_f32_16x16x32_bf16 v[48:51], a[204:207], a[172:175], v[48:51]
    s_cmp_eq_u32 s28, s30
    s_cselect_b32 s28, s31, s28
    s_cselect_b32 s30, s19, s30
    v_exp_f32 v162, v90
    v_mfma_f32_16x16x32_bf16 v[52:55], a[208:211], a[160:163], v[136:139]
    ds_read_b128 a[248:251], v3 offset:22528
    v_cvt_pk_bf16_f32 v124, v160, v161
    v_mfma_f32_16x16x32_bf16 v[52:55], a[212:215], a[164:167], v[52:55]
    v_exp_f32 v163, v91
    v_mfma_f32_16x16x32_bf16 v[52:55], a[216:219], a[168:171], v[52:55]
    ds_read_b128 a[252:255], v3 offset:23552
    v_or3_b32 v174, v174, v123, v124
    v_mfma_f32_16x16x32_bf16 v[52:55], a[220:223], a[172:175], v[52:55]
    buffer_load_dwordx4 v4, s[24:27], s29 offen offset:3072 sc1 lds
    v_exp_f32 v164, v92
    v_mfma_f32_16x16x32_bf16 v[56:59], a[192:195], a[176:179], v[140:143]
    s_mov_b32 s29, s38
    v_cvt_pk_bf16_f32 v125, v162, v163
    v_mfma_f32_16x16x32_bf16 v[56:59], a[196:199], a[180:183], v[56:59]
    v_exp_f32 v165, v93
    v_mfma_f32_16x16x32_bf16 v[56:59], a[200:203], a[184:187], v[56:59]
    s_add_u32 m0, s32, s33
    v_exp_f32 v166, v94
    v_mfma_f32_16x16x32_bf16 v[56:59], a[204:207], a[188:191], v[56:59]
    s_add_u32 s32, s32, 32768
    s_and_b32 s32, s32, 0x1ffff
    v_cvt_pk_bf16_f32 v126, v164, v165
    v_mfma_f32_16x16x32_bf16 v[60:63], a[208:211], a[176:179], v[140:143]
    v_exp_f32 v167, v95
    v_mfma_f32_16x16x32_bf16 v[60:63], a[212:215], a[180:183], v[60:63]
    v_or3_b32 v174, v174, v125, v126
    v_cvt_pk_bf16_f32 v127, v166, v167
    v_mfma_f32_16x16x32_bf16 v[60:63], a[216:219], a[184:187], v[60:63]
    v_or_b32 v174, v174, v127
    v_and_b32 v174, s39, v174
    v_cmp_ne_u32 vcc, 0, v174
    v_mfma_f32_16x16x32_bf16 v[60:63], a[220:223], a[188:191], v[60:63]
    v_add_u32 v3, s32, v2
    s_cbranch_vccnz KB_SL4
KB_SL4R:
    s_sub_u32 s34, s35, 1
    s_sub_u32 s34, s34, s36
    s_cmp_eq_u32 s34, 0
    s_cbranch_scc1 KB_TAIL
KB_LOOP:
    s_waitcnt vmcnt(16) lgkmcnt(0)
    v_mfma_f32_16x16x32_bf16 a[0:3], a[224:227], v[112:115], a[0:3]
    s_barrier
    v_exp_f32 v160, v32
    v_mfma_f32_16x16x32_bf16 a[16:19], a[224:227], v[116:119], a[16:19]
    v_exp_f32 v161, v33
    v_mfma_f32_16x16x32_bf16 a[4:7], a[228:231], v[112:115], a[4:7]
    ds_read_b128 a[192:195], v3 offset:0
    v_mfma_f32_16x16x32_bf16 a[20:23], a[228:231], v[116:119], a[20:23]
    buffer_load_dwordx4 v5, s[24:27], s28 offen offset:0 sc1 lds
    v_mfma_f32_16x16x32_bf16 a[8:11], a[232:235], v[112:115], a[8:11]
    v_exp_f32 v162, v34
    v_mfma_f32_16x16x32_bf16 a[24:27], a[232:235], v[116:119], a[24:27]
    ds_read_b128 a[196:199], v3 offset:1024
    v_cvt_pk_bf16_f32 v96, v160, v161
    v_mfma_f32_16x16x32_bf16 a[12:15], a[236:239], v[112:115], a[12:15]
    v_exp_f32 v163, v35
    v_mfma_f32_16x16x32_bf16 a[28:31], a[236:239], v[116:119], a[28:31]
    v_exp_f32 v164, v36
    v_mfma_f32_16x16x32_bf16 a[32:35], a[240:243], v[112:115], a[32:35]
    ds_read_b128 a[200:203], v3 offset:2048
    v_cvt_pk_bf16_f32 v97, v162, v163
    v_mfma_f32_16x16x32_bf16 a[48:51], a[240:243], v[116:119], a[48:51]
    v_exp_f32 v165, v37
    v_mfma_f32_16x16x32_bf16 a[36:39], a[244:247], v[112:115], a[36:39]
    buffer_load_dwordx4 v5, s[24:27], s28 offen offset:1024 sc1 lds
    v_mfma_f32_16x16x32_bf16 a[52:55], a[244:247], v[116:119], a[52:55]
    v_exp_f32 v166, v38
    v_mfma_f32_16x16x32_bf16 a[40:43], a[248:251], v[112:115], a[40:43]
    ds_read_b128 a[204:207], v3 offset:3072
    v_cvt_pk_bf16_f32 v98, v164, v165
    v_mfma_f32_16x16x32_bf16 a[56:59], a[248:251], v[116:119], a[56:59]
    v_exp_f32 v167, v39
    v_mfma_f32_16x16x32_bf16 a[44:47], a[252:255], v[112:115], a[44:47]
    ds_read_b128 a[208:211], v3 offset:4096
    v_or3_b32 v174, v96, v97, v98
    v_mfma_f32_16x16x32_bf16 a[60:63], a[252:255], v[116:119], a[60:63]
    v_exp_f32 v160, v40
    v_mfma_f32_16x16x32_bf16 v[20:23], v[244:247], v[112:115], v[20:23]
    ds_read_b128 a[212:215], v3 offset:5120
    v_cvt_pk_bf16_f32 v99, v166, v167
    v_mfma_f32_16x16x32_bf16 v[24:27], v[244:247], v[116:119], v[24:27]
    v_exp_f32 v161, v41
    v_mfma_f32_16x16x32_bf16 a[64:67], a[224:227], v[120:123], a[64:67]
    buffer_load_dwordx4 v5, s[24:27], s28 offen offset:2048 sc1 lds
    v_mfma_f32_16x16x32_bf16 a[80:83], a[224:227], v[124:127], a[80:83]
    v_exp_f32 v162, v42
    v_mfma_f32_16x16x32_bf16 a[68:71], a[228:231], v[120:123], a[68:71]
    global_load_dword v189, v188, s[4:5]
    v_mfma_f32_16x16x32_bf16 a[84:87], a[228:231], v[124:127], a[84:87]
    ds_read_b128 a[216:219], v3 offset:6144
    v_cvt_pk_bf16_f32 v100, v160, v161
    v_mfma_f32_16x16x32_bf16 a[72:75], a[232:235], v[120:123], a[72:75]
    v_exp_f32 v163, v43
    v_mfma_f32_16x16x32_bf16 a[88:91], a[232:235], v[124:127], a[88:91]
    ds_read_b128 a[220:223], v3 offset:7168
    v_or3_b32 v174, v174, v99, v100
    v_mfma_f32_16x16x32_bf16 a[76:79], a[236:239], v[120:123], a[76:79]
    v_exp_f32 v164, v44
    v_mfma_f32_16x16x32_bf16 a[92:95], a[236:239], v[124:127], a[92:95]
    s_mov_b64 s[4:5], s[6:7]
    v_cvt_pk_bf16_f32 v101, v162, v163
    v_mfma_f32_16x16x32_bf16 a[96:99], a[240:243], v[120:123], a[96:99]
    v_exp_f32 v165, v45
    v_mfma_f32_16x16x32_bf16 a[112:115], a[240:243], v[124:127], a[112:115]
    buffer_load_dwordx4 v5, s[24:27], s28 offen offset:3072 sc1 lds
    s_mov_b64 s[6:7], s[8:9]
    v_mfma_f32_16x16x32_bf16 a[100:103], a[244:247], v[120:123], a[100:103]
    v_exp_f32 v166, v46
    v_mfma_f32_16x16x32_bf16 a[116:119], a[244:247], v[124:127], a[116:119]
    s_mov_b64 s[8:9], s[10:11]
    v_cvt_pk_bf16_f32 v102, v164, v165
    v_mfma_f32_16x16x32_bf16 a[104:107], a[248:251], v[120:123], a[104:107]
    v_exp_f32 v167, v47
    v_mfma_f32_16x16x32_bf16 a[120:123], a[248:251], v[124:127], a[120:123]
    v_or3_b32 v174, v174, v101, v102
    v_cvt_pk_bf16_f32 v103, v166, v167
    v_mfma_f32_16x16x32_bf16 a[108:111], a[252:255], v[120:123], a[108:111]
    s_mov_b64 s[10:11], s[12:13]
    v_or_b32 v174, v174, v103
    v_and_b32 v174, s39, v174
    v_mfma_f32_16x16x32_bf16 a[124:127], a[252:255], v[124:127], a[124:127]
    v_cmp_ne_u32 vcc, 0, v174
    v_mfma_f32_16x16x32_bf16 v[28:31], v[244:247], v[120:123], v[28:31]
    v_mfma_f32_16x16x32_bf16 v[168:171], v[244:247], v[124:127], v[168:171]
    s_cbranch_vccnz KB_SL5
KB_SL5R:
    s_waitcnt lgkmcnt(0)
    v_mfma_f32_16x16x32_bf16 v[64:67], a[192:195], a[128:131], v[128:131]
    ds_read_b128 a[224:227], v3 offset:16384
    v_mfma_f32_16x16x32_bf16 v[64:67], a[196:199], a[132:135], v[64:67]
    s_add_u32 m0, m0, 16384
    v_exp_f32 v160, v48
    v_mfma_f32_16x16x32_bf16 v[64:67], a[200:203], a[136:139], v[64:67]
    s_add_u32 s38, s28, 16777216
    v_exp_f32 v161, v49
    v_mfma_f32_16x16x32_bf16 v[64:67], a[204:207], a[140:143], v[64:67]
    v_exp_f32 v162, v50
    v_mfma_f32_16x16x32_bf16 v[68:71], a[208:211], a[128:131], v[128:131]
    ds_read_b128 a[228:231], v3 offset:17408
    v_cvt_pk_bf16_f32 v104, v160, v161
    v_mfma_f32_16x16x32_bf16 v[68:71], a[212:215], a[132:135], v[68:71]
    buffer_load_dwordx4 v4, s[24:27], s29 offen offset:0 sc1 lds
    v_mfma_f32_16x16x32_bf16 v[68:71], a[216:219], a[136:139], v[68:71]
    v_exp_f32 v163, v51
    v_mfma_f32_16x16x32_bf16 v[68:71], a[220:223], a[140:143], v[68:71]
    ds_read_b128 a[232:235], v3 offset:18432
    ds_read_b128 a[236:239], v3 offset:19456
    v_mfma_f32_16x16x32_bf16 v[72:75], a[192:195], a[144:147], v[132:135]
    v_exp_f32 v164, v52
    v_mfma_f32_16x16x32_bf16 v[72:75], a[196:199], a[148:151], v[72:75]
    v_cvt_pk_bf16_f32 v105, v162, v163
    v_mfma_f32_16x16x32_bf16 v[72:75], a[200:203], a[152:155], v[72:75]
    buffer_load_dwordx4 v4, s[24:27], s29 offen offset:1024 sc1 lds
    s_add_u32 s28, s28, 16384
    v_mfma_f32_16x16x32_bf16 v[72:75], a[204:207], a[156:159], v[72:75]
    v_exp_f32 v165, v53
    v_mfma_f32_16x16x32_bf16 v[76:79], a[208:211], a[144:147], v[132:135]
    v_exp_f32 v166, v54
    v_mfma_f32_16x16x32_bf16 v[76:79], a[212:215], a[148:151], v[76:79]
    ds_read_b128 a[240:243], v3 offset:20480
    v_cvt_pk_bf16_f32 v106, v164, v165
    v_mfma_f32_16x16x32_bf16 v[76:79], a[216:219], a[152:155], v[76:79]
    v_exp_f32 v167, v55
    v_mfma_f32_16x16x32_bf16 v[76:79], a[220:223], a[156:159], v[76:79]
    buffer_load_dwordx4 v4, s[24:27], s29 offen offset:2048 sc1 lds
    v_or3_b32 v174, v104, v105, v106
    v_mfma_f32_16x16x32_bf16 v[80:83], a[192:195], a[160:163], v[136:139]
    v_exp_f32 v160, v56
    v_mfma_f32_16x16x32_bf16 v[80:83], a[196:199], a[164:167], v[80:83]
    ds_read_b128 a[244:247], v3 offset:21504
    v_cvt_pk_bf16_f32 v107, v166, v167
    v_mfma_f32_16x16x32_bf16 v[80:83], a[200:203], a[168:171], v[80:83]
    v_exp_f32 v161, v57
    v_mfma_f32_16x16x32_bf16 v[80:83], a[204:207], a[172:175], v[80:83]
    s_cmp_eq_u32 s28, s30
    s_cselect_b32 s28, s31, s28
    s_cselect_b32 s30, s19, s30
    v_exp_f32 v162, v58
    v_mfma_f32_16x16x32_bf16 v[84:87], a[208:211], a[160:163], v[136:139]
    ds_read_b128 a[248:251], v3 offset:22528
    v_cvt_pk_bf16_f32 v108, v160, v161
    v_mfma_f32_16x16x32_bf16 v[84:87], a[212:215], a[164:167], v[84:87]
    v_exp_f32 v163, v59
    v_mfma_f32_16x16x32_bf16 v[84:87], a[216:219], a[168:171], v[84:87]
    ds_read_b128 a[252:255], v3 offset:23552
    v_or3_b32 v174, v174, v107, v108
    v_mfma_f32_16x16x32_bf16 v[84:87], a[220:223], a[172:175], v[84:87]
    buffer_load_dwordx4 v4, s[24:27], s29 offen offset:3072 sc1 lds
    v_exp_f32 v164, v60
    v_mfma_f32_16x16x32_bf16 v[88:91], a[192:195], a[176:179], v[140:143]
    s_mov_b32 s29, s38
    v_cvt_pk_bf16_f32 v109, v162, v163
    v_mfma_f32_16x16x32_bf16 v[88:91], a[196:199], a[180:183], v[88:91]
    v_exp_f32 v165, v61
    v_mfma_f32_16x16x32_bf16 v[88:91], a[200:203], a[184:187], v[88:91]
    s_add_u32 m0, s32, s33
    v_exp_f32 v166, v62
    v_mfma_f32_16x16x32_bf16 v[88:91], a[204:207], a[188:191], v[88:91]
    s_add_u32 s32, s32, 32768
    s_and_b32 s32, s32, 0x1ffff
    v_cvt_pk_bf16_f32 v110, v164, v165
    v_mfma_f32_16x16x32_bf16 v[92:95], a[208:211], a[176:179], v[140:143]
    v_exp_f32 v167, v63
    v_mfma_f32_16x16x32_bf16 v[92:95], a[212:215], a[180:183], v[92:95]
    v_or3_b32 v174, v174, v109, v110
    v_cvt_pk_bf16_f32 v111, v166, v167
    v_mfma_f32_16x16x32_bf16 v[92:95], a[216:219], a[184:187], v[92:95]
    v_or_b32 v174, v174, v111
    v_and_b32 v174, s39, v174
    v_cmp_ne_u32 vcc, 0, v174
    v_mfma_f32_16x16x32_bf16 v[92:95], a[220:223], a[188:191], v[92:95]
    v_add_u32 v3, s32, v2
    s_cbranch_vccnz KB_SL6
KB_SL6R:
    s_waitcnt vmcnt(16) lgkmcnt(0)
    v_mfma_f32_16x16x32_bf16 a[0:3], a[224:227], v[96:99], a[0:3]
    s_barrier
    v_exp_f32 v160, v64
    v_mfma_f32_16x16x32_bf16 a[16:19], a[224:227], v[100:103], a[16:19]
    v_exp_f32 v161, v65
    v_mfma_f32_16x16x32_bf16 a[4:7], a[228:231], v[96:99], a[4:7]
    ds_read_b128 a[192:195], v3 offset:0
    v_mfma_f32_16x16x32_bf16 a[20:23], a[228:231], v[100:103], a[20:23]
    buffer_load_dwordx4 v5, s[24:27], s28 offen offset:0 sc1 lds
    v_mfma_f32_16x16x32_bf16 a[8:11], a[232:235], v[96:99], a[8:11]
    v_exp_f32 v162, v66
    v_mfma_f32_16x16x32_bf16 a[24:27], a[232:235], v[100:103], a[24:27]
    ds_read_b128 a[196:199], v3 offset:1024
    v_cvt_pk_bf16_f32 v112, v160, v161
    v_mfma_f32_16x16x32_bf16 a[12:15], a[236:239], v[96:99], a[12:15]
    v_exp_f32 v163, v67
    v_mfma_f32_16x16x32_bf16 a[28:31], a[236:239], v[100:103], a[28:31]
    v_exp_f32 v164, v68
    v_mfma_f32_16x16x32_bf16 a[32:35], a[240:243], v[96:99], a[32:35]
    ds_read_b128 a[200:203], v3 offset:2048
    v_cvt_pk_bf16_f32 v113, v162, v163
    v_mfma_f32_16x16x32_bf16 a[48:51], a[240:243], v[100:103], a[48:51]
    v_exp_f32 v165, v69
    v_mfma_f32_16x16x32_bf16 a[36:39], a[244:247], v[96:99], a[36:39]
    buffer_load_dwordx4 v5, s[24:27], s28 offen offset:1024 sc1 lds
    v_mfma_f32_16x16x32_bf16 a[52:55], a[244:247], v[100:103], a[52:55]
    v_exp_f32 v166, v70
    v_mfma_f32_16x16x32_bf16 a[40:43], a[248:251], v[96:99], a[40:43]
    ds_read_b128 a[204:207], v3 offset:3072
    v_cvt_pk_bf16_f32 v114, v164, v165
    v_mfma_f32_16x16x32_bf16 a[56:59], a[248:251], v[100:103], a[56:59]
    v_exp_f32 v167, v71
    v_mfma_f32_16x16x32_bf16 a[44:47], a[252:255], v[96:99], a[44:47]
    ds_read_b128 a[208:211], v3 offset:4096
    v_or3_b32 v174, v112, v113, v114
    v_mfma_f32_16x16x32_bf16 a[60:63], a[252:255], v[100:103], a[60:63]
    v_exp_f32 v160, v72
    v_mfma_f32_16x16x32_bf16 v[20:23], v[244:247], v[96:99], v[20:23]
    ds_read_b128 a[212:215], v3 offset:5120
    v_cvt_pk_bf16_f32 v115, v166, v167
    v_mfma_f32_16x16x32_bf16 v[24:27], v[244:247], v[100:103], v[24:27]
    v_exp_f32 v161, v73
    v_mfma_f32_16x16x32_bf16 a[64:67], a[224:227], v[104:107], a[64:67]
    buffer_load_dwordx4 v5, s[24:27], s28 offen offset:2048 sc1 lds
    v_mfma_f32_16x16x32_bf16 a[80:83], a[224:227], v[108:111], a[80:83]
    v_exp_f32 v162, v74
    v_mfma_f32_16x16x32_bf16 a[68:71], a[228:231], v[104:107], a[68:71]
    ds_read_b128 a[216:219], v3 offset:6144
    s_sub_u32 s34, s34, 1
    v_cvt_pk_bf16_f32 v116, v160, v161
    v_mfma_f32_16x16x32_bf16 a[84:87], a[228:231], v[108:111], a[84:87]
    v_exp_f32 v163, v75
    v_mfma_f32_16x16x32_bf16 a[72:75], a[232:235], v[104:107], a[72:75]
    buffer_store_dword v254, v253, s[24:27], s76 offen offset:512 sc1
    v_mfma_f32_16x16x32_bf16 a[88:91], a[232:235], v[108:111], a[88:91]
    ds_read_b128 a[220:223], v3 offset:7168
    v_or3_b32 v174, v174, v115, v116
    v_mfma_f32_16x16x32_bf16 a[76:79], a[236:239], v[104:107], a[76:79]
    v_exp_f32 v164, v76
    v_mfma_f32_16x16x32_bf16 a[92:95], a[236:239], v[108:111], a[92:95]
    v_cvt_pk_bf16_f32 v117, v162, v163
    v_mfma_f32_16x16x32_bf16 a[96:99], a[240:243], v[104:107], a[96:99]
    v_exp_f32 v165, v77
    v_mfma_f32_16x16x32_bf16 a[112:115], a[240:243], v[108:111], a[112:115]
    buffer_load_dwordx4 v5, s[24:27], s28 offen offset:3072 sc1 lds
    v_mfma_f32_16x16x32_bf16 a[100:103], a[244:247], v[104:107], a[100:103]
    v_exp_f32 v166, v78
    v_mfma_f32_16x16x32_bf16 a[116:119], a[244:247], v[108:111], a[116:119]
    v_cvt_pk_bf16_f32 v118, v164, v165
    v_mov_b32 v253, 0x40000000
    v_mfma_f32_16x16x32_bf16 a[104:107], a[248:251], v[104:107], a[104:107]
    v_exp_f32 v167, v79
    v_mfma_f32_16x16x32_bf16 a[120:123], a[248:251], v[108:111], a[120:123]
    v_or3_b32 v174, v174, v117, v118
    v_cvt_pk_bf16_f32 v119, v166, v167
    v_mfma_f32_16x16x32_bf16 a[108:111], a[252:255], v[104:107], a[108:111]
    v_or_b32 v174, v174, v119
    v_and_b32 v174, s39, v174
    v_mfma_f32_16x16x32_bf16 a[124:127], a[252:255], v[108:111], a[124:127]
    v_cmp_ne_u32 vcc, 0, v174
    v_mfma_f32_16x16x32_bf16 v[28:31], v[244:247], v[104:107], v[28:31]
    v_mfma_f32_16x16x32_bf16 v[168:171], v[244:247], v[108:111], v[168:171]
    s_cbranch_vccnz KB_SL7
KB_SL7R:
    s_waitcnt lgkmcnt(0)
    v_mfma_f32_16x16x32_bf16 v[32:35], a[192:195], a[128:131], v[128:131]
    ds_read_b128 a[224:227], v3 offset:16384
    v_mfma_f32_16x16x32_bf16 v[32:35], a[196:199], a[132:135], v[32:35]
    s_add_u32 m0, m0, 16384
    v_exp_f32 v160, v80
    v_mfma_f32_16x16x32_bf16 v[32:35], a[200:203], a[136:139], v[32:35]
    s_add_u32 s38, s28, 16777216
    v_exp_f32 v161, v81
    v_mfma_f32_16x16x32_bf16 v[32:35], a[204:207], a[140:143], v[32:35]
    v_exp_f32 v162, v82
    v_mfma_f32_16x16x32_bf16 v[36:39], a[208:211], a[128:131], v[128:131]
    ds_read_b128 a[228:231], v3 offset:17408
    v_cvt_pk_bf16_f32 v120, v160, v161
    v_mfma_f32_16x16x32_bf16 v[36:39], a[212:215], a[132:135], v[36:39]
    buffer_load_dwordx4 v4, s[24:27], s29 offen offset:0 sc1 lds
    v_mfma_f32_16x16x32_bf16 v[36:39], a[216:219], a[136:139], v[36:39]
    v_exp_f32 v163, v83
    v_mfma_f32_16x16x32_bf16 v[36:39], a[220:223], a[140:143], v[36:39]
    ds_read_b128 a[232:235], v3 offset:18432
    ds_read_b128 a[236:239], v3 offset:19456
    v_mfma_f32_16x16x32_bf16 v[40:43], a[192:195], a[144:147], v[132:135]
    v_exp_f32 v164, v84
    v_mfma_f32_16x16x32_bf16 v[40:43], a[196:199], a[148:151], v[40:43]
    v_cvt_pk_bf16_f32 v121, v162, v163
    v_mfma_f32_16x16x32_bf16 v[40:43], a[200:203], a[152:155], v[40:43]
    buffer_load_dwordx4 v4, s[24:27], s29 offen offset:1024 sc1 lds
    s_add_u32 s28, s28, 16384
    v_mfma_f32_16x16x32_bf16 v[40:43], a[204:207], a[156:159], v[40:43]
    v_exp_f32 v165, v85
    v_mfma_f32_16x16x32_bf16 v[44:47], a[208:211], a[144:147], v[132:135]
    v_exp_f32 v166, v86
    v_mfma_f32_16x16x32_bf16 v[44:47], a[212:215], a[148:151], v[44:47]
    ds_read_b128 a[240:243], v3 offset:20480
    v_cvt_pk_bf16_f32 v122, v164, v165
    v_mfma_f32_16x16x32_bf16 v[44:47], a[216:219], a[152:155], v[44:47]
    v_exp_f32 v167, v87
    v_mfma_f32_16x16x32_bf16 v[44:47], a[220:223], a[156:159], v[44:47]
    buffer_load_dwordx4 v4, s[24:27], s29 offen offset:2048 sc1 lds
    v_or3_b32 v174, v120, v121, v122
    v_mfma_f32_16x16x32_bf16 v[48:51], a[192:195], a[160:163], v[136:139]
    v_exp_f32 v160, v88
    v_mfma_f32_16x16x32_bf16 v[48:51], a[196:199], a[164:167], v[48:51]
    ds_read_b128 a[244:247], v3 offset:21504
    v_cvt_pk_bf16_f32 v123, v166, v167
    v_mfma_f32_16x16x32_bf16 v[48:51], a[200:203], a[168:171], v[48:51]
    v_exp_f32 v161, v89
    v_mfma_f32_16x16x32_bf16 v[48:51], a[204:207], a[172:175], v[48:51]
    s_cmp_eq_u32 s28, s30
    s_cselect_b32 s28, s31, s28
    s_cselect_b32 s30, s19, s30
    v_exp_f32 v162, v90
    v_mfma_f32_16x16x32_bf16 v[52:55], a[208:211], a[160:163], v[136:139]
    ds_read_b128 a[248:251], v3 offset:22528
    v_cvt_pk_bf16_f32 v124, v160, v161
    v_mfma_f32_16x16x32_bf16 v[52:55], a[212:215], a[164:167], v[52:55]
    v_exp_f32 v163, v91
    v_mfma_f32_16x16x32_bf16 v[52:55], a[216:219], a[168:171], v[52:55]
    ds_read_b128 a[252:255], v3 offset:23552
    v_or3_b32 v174, v174, v123, v124
    v_mfma_f32_16x16x32_bf16 v[52:55], a[220:223], a[172:175], v[52:55]
    buffer_load_dwordx4 v4, s[24:27], s29 offen offset:3072 sc1 lds
    v_exp_f32 v164, v92
    v_mfma_f32_16x16x32_bf16 v[56:59], a[192:195], a[176:179], v[140:143]
    s_mov_b32 s29, s38
    v_cvt_pk_bf16_f32 v125, v162, v163
    v_mfma_f32_16x16x32_bf16 v[56:59], a[196:199], a[180:183], v[56:59]
    v_exp_f32 v165, v93
    v_mfma_f32_16x16x32_bf16 v[56:59], a[200:203], a[184:187], v[56:59]
    s_add_u32 m0, s32, s33
    v_exp_f32 v166, v94
    v_mfma_f32_16x16x32_bf16 v[56:59], a[204:207], a[188:191], v[56:59]
    s_add_u32 s32, s32, 32768
    s_and_b32 s32, s32, 0x1ffff
    v_cvt_pk_bf16_f32 v126, v164, v165
    v_mfma_f32_16x16x32_bf16 v[60:63], a[208:211], a[176:179], v[140:143]
    v_exp_f32 v167, v95
    v_mfma_f32_16x16x32_bf16 v[60:63], a[212:215], a[180:183], v[60:63]
    v_or3_b32 v174, v174, v125, v126
    v_cvt_pk_bf16_f32 v127, v166, v167
    v_mfma_f32_16x16x32_bf16 v[60:63], a[216:219], a[184:187], v[60:63]
    v_or_b32 v174, v174, v127
    v_and_b32 v174, s39, v174
    v_cmp_ne_u32 vcc, 0, v174
    v_mfma_f32_16x16x32_bf16 v[60:63], a[220:223], a[188:191], v[60:63]
    v_add_u32 v3, s32, v2
    s_cbranch_vccnz KB_SL8
KB_SL8R:
    s_cmp_lg_u32 s34, 0
    s_cbranch_scc1 KB_LOOP
KB_TAIL:
    s_cmp_lg_u32 s36, 0
    s_cbranch_scc1 KB_FIN
    s_waitcnt vmcnt(16) lgkmcnt(0)
    v_mfma_f32_16x16x32_bf16 a[0:3], a[224:227], v[112:115], a[0:3]
    s_barrier
    v_cmp_le_i32 s[50:51], 0, v9
    v_cmp_le_i32 s[52:53], 1, v9
    v_mfma_f32_16x16x32_bf16 a[16:19], a[224:227], v[116:119], a[16:19]
    v_cmp_le_i32 s[54:55], 2, v9
    v_cmp_le_i32 s[56:57], 3, v9
    v_mfma_f32_16x16x32_bf16 a[4:7], a[228:231], v[112:115], a[4:7]
    ds_read_b128 a[192:195], v3 offset:0
    v_cndmask_b32 v32, v11, v32, s[50:51]
    v_mfma_f32_16x16x32_bf16 a[20:23], a[228:231], v[116:119], a[20:23]
    buffer_load_dwordx4 v5, s[24:27], s28 offen offset:0 sc1 lds
    v_mfma_f32_16x16x32_bf16 a[8:11], a[232:235], v[112:115], a[8:11]
    v_exp_f32 v160, v32
    v_mfma_f32_16x16x32_bf16 a[24:27], a[232:235], v[116:119], a[24:27]
    v_cmp_le_i32 s[50:51], 16, v9
    v_cndmask_b32 v33, v11, v33, s[52:53]
    v_mfma_f32_16x16x32_bf16 a[12:15], a[236:239], v[112:115], a[12:15]
    v_exp_f32 v161, v33
    v_mfma_f32_16x16x32_bf16 a[28:31], a[236:239], v[116:119], a[28:31]
    ds_read_b128 a[196:199], v3 offset:1024
    v_cmp_le_i32 s[52:53], 17, v9
    v_mfma_f32_16x16x32_bf16 a[32:35], a[240:243], v[112:115], a[32:35]
    v_cndmask_b32 v34, v11, v34, s[54:55]
    v_exp_f32 v162, v34
    v_mfma_f32_16x16x32_bf16 a[48:51], a[240:243], v[116:119], a[48:51]
    v_cvt_pk_bf16_f32 v96, v160, v161
    v_cmp_le_i32 s[54:55], 18, v9
    v_mfma_f32_16x16x32_bf16 a[36:39], a[244:247], v[112:115], a[36:39]
    ds_read_b128 a[200:203], v3 offset:2048
    v_cndmask_b32 v35, v11, v35, s[56:57]
    v_mfma_f32_16x16x32_bf16 a[52:55], a[244:247], v[116:119], a[52:55]
    v_exp_f32 v163, v35
    v_cmp_le_i32 s[56:57], 19, v9
    v_mfma_f32_16x16x32_bf16 a[40:43], a[248:251], v[112:115], a[40:43]
    buffer_load_dwordx4 v5, s[24:27], s28 offen offset:1024 sc1 lds
    v_cndmask_b32 v36, v11, v36, s[50:51]
    v_exp_f32 v164, v36
    v_mfma_f32_16x16x32_bf16 a[56:59], a[248:251], v[116:119], a[56:59]
    v_cvt_pk_bf16_f32 v97, v162, v163
    v_cmp_le_i32 s[50:51], -16, v9
    v_mfma_f32_16x16x32_bf16 a[44:47], a[252:255], v[112:115], a[44:47]
    ds_read_b128 a[204:207], v3 offset:3072
    v_cndmask_b32 v37, v11, v37, s[52:53]
    v_mfma_f32_16x16x32_bf16 a[60:63], a[252:255], v[116:119], a[60:63]
    v_exp_f32 v165, v37
    v_mfma_f32_16x16x32_bf16 v[20:23], v[244:247], v[112:115], v[20:23]
    v_cmp_le_i32 s[52:53], -15, v9
    v_cndmask_b32 v38, v11, v38, s[54:55]
    v_exp_f32 v166, v38
    v_mfma_f32_16x16x32_bf16 v[24:27], v[244:247], v[116:119], v[24:27]
    ds_read_b128 a[208:211], v3 offset:4096
    v_cvt_pk_bf16_f32 v98, v164, v165
    v_mfma_f32_16x16x32_bf16 a[64:67], a[224:227], v[120:123], a[64:67]
    v_cmp_le_i32 s[54:55], -14, v9
    v_cndmask_b32 v39, v11, v39, s[56:57]
    v_mfma_f32_16x16x32_bf16 a[80:83], a[224:227], v[124:127], a[80:83]
    v_exp_f32 v167, v39
    v_mfma_f32_16x16x32_bf16 a[68:71], a[228:231], v[120:123], a[68:71]
    buffer_load_dwordx4 v5, s[24:27], s28 offen offset:2048 sc1 lds
    v_or3_b32 v174, v96, v97, v98
    v_cmp_le_i32 s[56:57], -13, v9
    v_cndmask_b32 v40, v11, v40, s[50:51]
    v_mfma_f32_16x16x32_bf16 a[84:87], a[228:231], v[124:127], a[84:87]
    ds_read_b128 a[212:215], v3 offset:5120
    v_exp_f32 v160, v40
    v_mfma_f32_16x16x32_bf16 a[72:75], a[232:235], v[120:123], a[72:75]
    v_cvt_pk_bf16_f32 v99, v166, v167
    v_cmp_le_i32 s[50:51], 0, v9
    v_mfma_f32_16x16x32_bf16 a[88:91], a[232:235], v[124:127], a[88:91]
    v_cndmask_b32 v41, v11, v41, s[52:53]
    v_exp_f32 v161, v41
    v_mfma_f32_16x16x32_bf16 a[76:79], a[236:239], v[120:123], a[76:79]
    ds_read_b128 a[216:219], v3 offset:6144
    v_cmp_le_i32 s[52:53], 1, v9
    v_cndmask_b32 v42, v11, v42, s[54:55]
    v_mfma_f32_16x16x32_bf16 a[92:95], a[236:239], v[124:127], a[92:95]
    v_exp_f32 v162, v42
    v_mfma_f32_16x16x32_bf16 a[96:99], a[240:243], v[120:123], a[96:99]
    v_cvt_pk_bf16_f32 v100, v160, v161
    v_cmp_le_i32 s[54:55], 2, v9
    v_mfma_f32_16x16x32_bf16 a[112:115], a[240:243], v[124:127], a[112:115]
    ds_read_b128 a[220:223], v3 offset:7168
    v_cndmask_b32 v43, v11, v43, s[56:57]
    v_exp_f32 v163, v43
    v_mfma_f32_16x16x32_bf16 a[100:103], a[244:247], v[120:123], a[100:103]
    buffer_load_dwordx4 v5, s[24:27], s28 offen offset:3072 sc1 lds
    v_or3_b32 v174, v174, v99, v100
    v_mfma_f32_16x16x32_bf16 a[116:119], a[244:247], v[124:127], a[116:119]
    v_cmp_le_i32 s[56:57], 3, v9
    v_cndmask_b32 v44, v11, v44, s[50:51]
    v_exp_f32 v164, v44
    v_mfma_f32_16x16x32_bf16 a[104:107], a[248:251], v[120:123], a[104:107]
    v_cvt_pk_bf16_f32 v101, v162, v163
    v_cndmask_b32 v45, v11, v45, s[52:53]
    v_mfma_f32_16x16x32_bf16 a[120:123], a[248:251], v[124:127], a[120:123]
    v_exp_f32 v165, v45
    v_mfma_f32_16x16x32_bf16 a[108:111], a[252:255], v[120:123], a[108:111]
    v_cndmask_b32 v46, v11, v46, s[54:55]
    v_mfma_f32_16x16x32_bf16 a[124:127], a[252:255], v[124:127], a[124:127]
    v_exp_f32 v166, v46
    v_cvt_pk_bf16_f32 v102, v164, v165
    v_mfma_f32_16x16x32_bf16 v[28:31], v[244:247], v[120:123], v[28:31]
    v_cndmask_b32 v47, v11, v47, s[56:57]
    v_exp_f32 v167, v47
    v_or3_b32 v174, v174, v101, v102
    v_cvt_pk_bf16_f32 v103, v166, v167
    v_or_b32 v174, v174, v103
    v_and_b32 v174, s39, v174
    v_cmp_ne_u32 vcc, 0, v174
    v_mfma_f32_16x16x32_bf16 v[168:171], v[244:247], v[124:127], v[168:171]
    s_cbranch_vccnz KB_SL9
KB_SL9R:
    s_waitcnt lgkmcnt(0)
    v_mfma_f32_16x16x32_bf16 v[80:83], a[192:195], a[160:163], v[136:139]
    ds_read_b128 a[224:227], v3 offset:16384
    ds_read_b128 a[228:231], v3 offset:17408
    v_mfma_f32_16x16x32_bf16 v[80:83], a[196:199], a[164:167], v[80:83]
    s_add_u32 m0, m0, 16384
    v_exp_f32 v160, v48
    v_mfma_f32_16x16x32_bf16 v[80:83], a[200:203], a[168:171], v[80:83]
    s_add_u32 s38, s28, 16777216
    v_exp_f32 v161, v49
    v_mfma_f32_16x16x32_bf16 v[80:83], a[204:207], a[172:175], v[80:83]
    v_exp_f32 v162, v50
    v_mfma_f32_16x16x32_bf16 v[84:87], a[208:211], a[160:163], v[136:139]
    ds_read_b128 a[232:235], v3 offset:18432
    buffer_load_dwordx4 v4, s[24:27], s29 offen offset:0 sc1 lds
    v_cvt_pk_bf16_f32 v104, v160, v161
    v_mfma_f32_16x16x32_bf16 v[84:87], a[212:215], a[164:167], v[84:87]
    ds_read_b128 a[236:239], v3 offset:19456
    v_exp_f32 v163, v51
    v_exp_f32 v164, v52
    v_mfma_f32_16x16x32_bf16 v[84:87], a[216:219], a[168:171], v[84:87]
    ds_read_b128 a[240:243], v3 offset:20480
    buffer_load_dwordx4 v4, s[24:27], s29 offen offset:1024 sc1 lds
    v_cvt_pk_bf16_f32 v105, v162, v163
    v_exp_f32 v165, v53
    v_mfma_f32_16x16x32_bf16 v[84:87], a[220:223], a[172:175], v[84:87]
    ds_read_b128 a[244:247], v3 offset:21504
    ds_read_b128 a[248:251], v3 offset:22528
    ds_read_b128 a[252:255], v3 offset:23552
    s_add_u32 s28, s28, 16384
    v_exp_f32 v166, v54
    v_mfma_f32_16x16x32_bf16 v[88:91], a[192:195], a[176:179], v[140:143]
    buffer_load_dwordx4 v4, s[24:27], s29 offen offset:2048 sc1 lds
    v_cvt_pk_bf16_f32 v106, v164, v165
    v_exp_f32 v167, v55
    v_mfma_f32_16x16x32_bf16 v[88:91], a[196:199], a[180:183], v[88:91]
    s_cmp_eq_u32 s28, s30
    s_cselect_b32 s28, s31, s28
    s_cselect_b32 s30, s19, s30
    buffer_load_dwordx4 v4, s[24:27], s29 offen offset:3072 sc1 lds
    s_mov_b32 s29, s38
    v_or3_b32 v174, v104, v105, v106
    v_exp_f32 v160, v56
    v_mfma_f32_16x16x32_bf16 v[88:91], a[200:203], a[184:187], v[88:91]
    v_cvt_pk_bf16_f32 v107, v166, v167
    v_exp_f32 v161, v57
    v_mfma_f32_16x16x32_bf16 v[88:91], a[204:207], a[188:191], v[88:91]
    v_exp_f32 v162, v58
    v_cvt_pk_bf16_f32 v108, v160, v161
    v_mfma_f32_16x16x32_bf16 v[92:95], a[208:211], a[176:179], v[140:143]
    s_add_u32 m0, s32, s33
    v_exp_f32 v163, v59
    v_or3_b32 v174, v174, v107, v108
    v_mfma_f32_16x16x32_bf16 v[92:95], a[212:215], a[180:183], v[92:95]
    v_exp_f32 v164, v60
    v_cvt_pk_bf16_f32 v109, v162, v163
    v_mfma_f32_16x16x32_bf16 v[92:95], a[216:219], a[184:187], v[92:95]
    s_add_u32 s32, s32, 32768
    v_exp_f32 v165, v61
    v_exp_f32 v166, v62
    v_cvt_pk_bf16_f32 v110, v164, v165
    v_exp_f32 v167, v63
    v_or3_b32 v174, v174, v109, v110
    v_cvt_pk_bf16_f32 v111, v166, v167
    v_or_b32 v174, v174, v111
    v_and_b32 v174, s39, v174
    v_cmp_ne_u32 vcc, 0, v174
    v_mfma_f32_16x16x32_bf16 v[92:95], a[220:223], a[188:191], v[92:95]
    s_and_b32 s32, s32, 0x1ffff
    v_add_u32 v3, s32, v2
    s_cbranch_vccnz KB_SL10
KB_SL10R:
    s_waitcnt vmcnt(16) lgkmcnt(0)
    v_mfma_f32_16x16x32_bf16 a[0:3], a[224:227], v[96:99], a[0:3]
    s_barrier
    v_cmp_le_i32 s[50:51], 0, v10
    v_cmp_le_i32 s[52:53], 1, v10
    v_mfma_f32_16x16x32_bf16 a[16:19], a[224:227], v[100:103], a[16:19]
    ds_read_b128 a[128:131], v12 offset:0
    v_cmp_le_i32 s[54:55], 2, v10
    v_mfma_f32_16x16x32_bf16 a[4:7], a[228:231], v[96:99], a[4:7]
    ds_read_b128 a[132:135], v12 offset:1024
    v_cmp_le_i32 s[56:57], 3, v10
    v_mfma_f32_16x16x32_bf16 a[20:23], a[228:231], v[100:103], a[20:23]
    ds_read_b128 a[136:139], v12 offset:2048
    v_cndmask_b32 v80, v11, v80, s[50:51]
    v_mfma_f32_16x16x32_bf16 a[8:11], a[232:235], v[96:99], a[8:11]
    buffer_load_dwordx4 v5, s[24:27], s28 offen offset:0 sc1 lds
    v_mfma_f32_16x16x32_bf16 a[24:27], a[232:235], v[100:103], a[24:27]
    v_exp_f32 v160, v80
    v_mfma_f32_16x16x32_bf16 a[12:15], a[236:239], v[96:99], a[12:15]
    ds_read_b128 a[140:143], v12 offset:3072
    v_cmp_le_i32 s[50:51], 16, v10
    v_cndmask_b32 v81, v11, v81, s[52:53]
    v_mfma_f32_16x16x32_bf16 a[28:31], a[236:239], v[100:103], a[28:31]
    v_exp_f32 v161, v81
    v_cmp_le_i32 s[52:53], 17, v10
    v_mfma_f32_16x16x32_bf16 a[32:35], a[240:243], v[96:99], a[32:35]
    ds_read_b128 a[144:147], v12 offset:4096
    v_cndmask_b32 v82, v11, v82, s[54:55]
    v_exp_f32 v162, v82
    v_mfma_f32_16x16x32_bf16 a[48:51], a[240:243], v[100:103], a[48:51]
    ds_read_b128 a[148:151], v12 offset:5120
    v_cvt_pk_bf16_f32 v120, v160, v161
    v_mfma_f32_16x16x32_bf16 a[36:39], a[244:247], v[96:99], a[36:39]
    ds_read_b128 a[152:155], v12 offset:6144
    v_cmp_le_i32 s[54:55], 18, v10
    v_cndmask_b32 v83, v11, v83, s[56:57]
    v_mfma_f32_16x16x32_bf16 a[52:55], a[244:247], v[100:103], a[52:55]
    ds_read_b128 a[156:159], v12 offset:7168
    v_exp_f32 v163, v83
    v_cmp_le_i32 s[56:57], 19, v10
    v_mfma_f32_16x16x32_bf16 a[40:43], a[248:251], v[96:99], a[40:43]
    ds_read_b128 a[192:195], v3 offset:0
    buffer_load_dwordx4 v5, s[24:27], s28 offen offset:1024 sc1 lds
    v_cndmask_b32 v84, v11, v84, s[50:51]
    v_exp_f32 v164, v84
    v_mfma_f32_16x16x32_bf16 a[56:59], a[248:251], v[100:103], a[56:59]
    ds_read_b128 a[196:199], v3 offset:1024
    v_cvt_pk_bf16_f32 v121, v162, v163
    v_mfma_f32_16x16x32_bf16 a[44:47], a[252:255], v[96:99], a[44:47]
    ds_read_b128 a[200:203], v3 offset:2048
    v_cmp_le_i32 s[50:51], -16, v10
    v_cndmask_b32 v85, v11, v85, s[52:53]
    v_mfma_f32_16x16x32_bf16 a[60:63], a[252:255], v[100:103], a[60:63]
    v_exp_f32 v165, v85
    v_mfma_f32_16x16x32_bf16 v[20:23], v[244:247], v[96:99], v[20:23]
    ds_read_b128 a[204:207], v3 offset:3072
    v_cmp_le_i32 s[52:53], -15, v10
    v_cndmask_b32 v86, v11, v86, s[54:55]
    v_exp_f32 v166, v86
    v_mfma_f32_16x16x32_bf16 v[24:27], v[244:247], v[100:103], v[24:27]
    ds_read_b128 a[208:211], v3 offset:4096
    v_cvt_pk_bf16_f32 v122, v164, v165
    v_mfma_f32_16x16x32_bf16 a[64:67], a[224:227], v[104:107], a[64:67]
    ds_read_b128 a[212:215], v3 offset:5120
    v_cmp_le_i32 s[54:55], -14, v10
    v_cndmask_b32 v87, v11, v87, s[56:57]
    v_mfma_f32_16x16x32_bf16 a[80:83], a[224:227], v[108:111], a[80:83]
    ds_read_b128 a[216:219], v3 offset:6144
    v_exp_f32 v167, v87
    v_mfma_f32_16x16x32_bf16 a[68:71], a[228:231], v[104:107], a[68:71]
    ds_read_b128 a[220:223], v3 offset:7168
    buffer_load_dwordx4 v5, s[24:27], s28 offen offset:2048 sc1 lds
    v_or3_b32 v174, v120, v121, v122
    v_cmp_le_i32 s[56:57], -13, v10
    v_cndmask_b32 v88, v11, v88, s[50:51]
    v_mfma_f32_16x16x32_bf16 a[84:87], a[228:231], v[108:111], a[84:87]
    ds_read_b128 a[160:163], v12 offset:8192
    v_exp_f32 v160, v88
    v_mfma_f32_16x16x32_bf16 a[72:75], a[232:235], v[104:107], a[72:75]
    ds_read_b128 a[164:167], v12 offset:9216
    v_cvt_pk_bf16_f32 v123, v166, v167
    v_cmp_le_i32 s[50:51], 0, v10
    v_mfma_f32_16x16x32_bf16 a[88:91], a[232:235], v[108:111], a[88:91]
    v_cndmask_b32 v89, v11, v89, s[52:53]
    v_exp_f32 v161, v89
    v_mfma_f32_16x16x32_bf16 a[76:79], a[236:239], v[104:107], a[76:79]
    ds_read_b128 a[168:171], v12 offset:10240
    v_cmp_le_i32 s[52:53], 1, v10
    v_cndmask_b32 v90, v11, v90, s[54:55]
    v_mfma_f32_16x16x32_bf16 a[92:95], a[236:239], v[108:111], a[92:95]
    ds_read_b128 a[172:175], v12 offset:11264
    v_exp_f32 v162, v90
    v_mfma_f32_16x16x32_bf16 a[96:99], a[240:243], v[104:107], a[96:99]
    ds_read_b128 a[176:179], v12 offset:12288
    v_cvt_pk_bf16_f32 v124, v160, v161
    v_cmp_le_i32 s[54:55], 2, v10
    v_mfma_f32_16x16x32_bf16 a[112:115], a[240:243], v[108:111], a[112:115]
    ds_read_b128 a[180:183], v12 offset:13312
    ds_read_b128 a[184:187], v12 offset:14336
    ds_read_b128 a[188:191], v12 offset:15360
    v_cndmask_b32 v91, v11, v91, s[56:57]
    v_exp_f32 v163, v91
    v_mfma_f32_16x16x32_bf16 a[100:103], a[244:247], v[104:107], a[100:103]
    buffer_load_dwordx4 v5, s[24:27], s28 offen offset:3072 sc1 lds
    v_or3_b32 v174, v174, v123, v124
    v_mfma_f32_16x16x32_bf16 a[116:119], a[244:247], v[108:111], a[116:119]
    v_cmp_le_i32 s[56:57], 3, v10
    v_cndmask_b32 v92, v11, v92, s[50:51]
    v_exp_f32 v164, v92
    v_mfma_f32_16x16x32_bf16 a[104:107], a[248:251], v[104:107], a[104:107]
    v_cvt_pk_bf16_f32 v125, v162, v163
    v_cndmask_b32 v93, v11, v93, s[52:53]
    v_mfma_f32_16x16x32_bf16 a[120:123], a[248:251], v[108:111], a[120:123]
    v_exp_f32 v165, v93
    v_mfma_f32_16x16x32_bf16 a[108:111], a[252:255], v[104:107], a[108:111]
    v_cndmask_b32 v94, v11, v94, s[54:55]
    v_mfma_f32_16x16x32_bf16 a[124:127], a[252:255], v[108:111], a[124:127]
    v_exp_f32 v166, v94
    v_cvt_pk_bf16_f32 v126, v164, v165
    v_mfma_f32_16x16x32_bf16 v[28:31], v[244:247], v[104:107], v[28:31]
    v_cndmask_b32 v95, v11, v95, s[56:57]
    v_exp_f32 v167, v95
    v_or3_b32 v174, v174, v125, v126
    v_cvt_pk_bf16_f32 v127, v166, v167
    v_or_b32 v174, v174, v127
    v_and_b32 v174, s39, v174
    v_cmp_ne_u32 vcc, 0, v174
    v_mfma_f32_16x16x32_bf16 v[168:171], v[244:247], v[108:111], v[168:171]
    s_cbranch_vccnz KB_SL11
KB_SL11R:
KB_TR2:
    v_mfma_f32_16x16x32_bf16 v[28:31], v[244:247], v[120:123], v[28:31]
    v_mfma_f32_16x16x32_bf16 v[168:171], v[244:247], v[124:127], v[168:171]
    s_waitcnt lgkmcnt(0)
    v_mfma_f32_16x16x32_bf16 v[32:35], a[192:195], a[128:131], v[248:251]
    s_barrier
    v_mov_b32 v144, v128
    v_mov_b32 v146, v132
    v_mov_b32 v148, v136
    v_mov_b32 v150, v140
    v_mfma_f32_16x16x32_bf16 v[32:35], a[196:199], a[132:135], v[32:35]
    v_mov_b32 v145, v20
    v_mov_b32 v147, v24
    v_mov_b32 v149, v28
    v_mfma_f32_16x16x32_bf16 v[32:35], a[200:203], a[136:139], v[32:35]
    v_mov_b32 v151, v168
    ds_write_b128 v8, v[144:147] offset:0
    v_mfma_f32_16x16x32_bf16 v[32:35], a[204:207], a[140:143], v[32:35]
    ds_write_b128 v8, v[148:151] offset:1024
    v_mfma_f32_16x16x32_bf16 v[36:39], a[208:211], a[128:131], v[248:251]
    v_mfma_f32_16x16x32_bf16 v[36:39], a[212:215], a[132:135], v[36:39]
    v_mov_b32 v128, v248
    v_mov_b32 v129, v248
    v_mfma_f32_16x16x32_bf16 v[36:39], a[216:219], a[136:139], v[36:39]
    v_mov_b32 v130, v248
    v_mov_b32 v131, v248
    v_mfma_f32_16x16x32_bf16 v[36:39], a[220:223], a[140:143], v[36:39]
    v_mov_b32 v132, v248
    v_mov_b32 v133, v248
    v_mfma_f32_16x16x32_bf16 v[40:43], a[192:195], a[144:147], v[248:251]
    v_mov_b32 v134, v248
    v_mov_b32 v135, v248
    v_mfma_f32_16x16x32_bf16 v[40:43], a[196:199], a[148:151], v[40:43]
    v_mov_b32 v136, v248
    v_mov_b32 v137, v248
    v_mfma_f32_16x16x32_bf16 v[40:43], a[200:203], a[152:155], v[40:43]
    v_mov_b32 v138, v248
    v_mov_b32 v139, v248
    v_mfma_f32_16x16x32_bf16 v[40:43], a[204:207], a[156:159], v[40:43]
    v_mov_b32 v140, v248
    v_mov_b32 v141, v248
    v_mfma_f32_16x16x32_bf16 v[44:47], a[208:211], a[144:147], v[248:251]
    v_mov_b32 v142, v248
    v_mov_b32 v143, v248
    v_mfma_f32_16x16x32_bf16 v[44:47], a[212:215], a[148:151], v[44:47]
    s_waitcnt lgkmcnt(0)
    s_barrier
    ds_read_b128 v[152:155], v7 offset:0
    ds_read_b128 v[156:159], v7 offset:1024
    v_mfma_f32_16x16x32_bf16 v[44:47], a[216:219], a[152:155], v[44:47]
    v_mfma_f32_16x16x32_bf16 v[44:47], a[220:223], a[156:159], v[44:47]
    v_mfma_f32_16x16x32_bf16 v[48:51], a[192:195], a[160:163], v[248:251]
    s_add_u32 m0, m0, 16384
    s_add_u32 s38, s28, 16777216
    buffer_load_dwordx4 v4, s[24:27], s29 offen offset:0 sc1 lds
    v_mfma_f32_16x16x32_bf16 v[48:51], a[196:199], a[164:167], v[48:51]
    v_exp_f32 v160, v32
    v_exp_f32 v161, v33
    v_mfma_f32_16x16x32_bf16 v[48:51], a[200:203], a[168:171], v[48:51]
    buffer_load_dwordx4 v4, s[24:27], s29 offen offset:1024 sc1 lds
    s_add_u32 s28, s28, 16384
    v_exp_f32 v162, v34
    v_mfma_f32_16x16x32_bf16 v[48:51], a[204:207], a[172:175], v[48:51]
    v_cvt_pk_bf16_f32 v96, v160, v161
    v_exp_f32 v163, v35
    v_mfma_f32_16x16x32_bf16 v[52:55], a[208:211], a[160:163], v[248:251]
    buffer_load_dwordx4 v4, s[24:27], s29 offen offset:2048 sc1 lds
    v_exp_f32 v164, v36
    v_mfma_f32_16x16x32_bf16 v[52:55], a[212:215], a[164:167], v[52:55]
    s_waitcnt lgkmcnt(0)
    ds_write_b128 v7, a[32:35] offset:0
    v_mfma_f32_16x16x32_bf16 v[52:55], a[216:219], a[168:171], v[52:55]
    ds_write_b128 v7, a[36:39] offset:1024
    v_mfma_f32_16x16x32_bf16 v[52:55], a[220:223], a[172:175], v[52:55]
    ds_write_b128 v7, a[40:43] offset:2048
    s_cmp_eq_u32 s28, s30
    s_cselect_b32 s28, s31, s28
    s_cselect_b32 s30, s19, s30
    v_mfma_f32_16x16x32_bf16 v[56:59], a[192:195], a[176:179], v[248:251]
    buffer_load_dwordx4 v4, s[24:27], s29 offen offset:3072 sc1 lds
    s_mov_b32 s29, s38
    v_min_f32 v240, v144, v152
    v_min_f32 v241, v146, v154
    v_mfma_f32_16x16x32_bf16 v[56:59], a[196:199], a[180:183], v[56:59]
    ds_write_b128 v7, a[44:47] offset:3072
    v_min_f32 v242, v148, v156
    v_mfma_f32_16x16x32_bf16 v[56:59], a[200:203], a[184:187], v[56:59]
    s_add_u32 m0, s32, s33
    s_add_u32 s32, s32, 32768
    s_and_b32 s32, s32, 0x1ffff
    v_min_f32 v243, v150, v158
    v_sub_f32 v180, v240, v144
    v_sub_f32 v182, v241, v146
    v_mfma_f32_16x16x32_bf16 v[56:59], a[204:207], a[188:191], v[56:59]
    ds_write_b128 v7, a[48:51] offset:4096
    v_sub_f32 v184, v242, v148
    v_mfma_f32_16x16x32_bf16 v[60:63], a[208:211], a[176:179], v[248:251]
    ds_write_b128 v7, a[52:55] offset:5120
    v_sub_f32 v186, v243, v150
    v_sub_f32 v181, v240, v152
    v_sub_f32 v183, v241, v154
    v_sub_f32 v185, v242, v156
    v_sub_f32 v187, v243, v158
    v_exp_f32 v180, v180
    v_mfma_f32_16x16x32_bf16 v[60:63], a[212:215], a[180:183], v[60:63]
    ds_write_b128 v7, a[56:59] offset:6144
    v_exp_f32 v182, v182
    v_exp_f32 v184, v184
    v_exp_f32 v186, v186
    v_mfma_f32_16x16x32_bf16 v[60:63], a[216:219], a[184:187], v[60:63]
    ds_write_b128 v7, a[60:63] offset:7168
    v_exp_f32 v181, v181
    v_exp_f32 v183, v183
    v_exp_f32 v185, v185
    v_exp_f32 v187, v187
    v_mfma_f32_16x16x32_bf16 v[60:63], a[220:223], a[188:191], v[60:63]
    ds_read_b128 a[224:227], v3 offset:16384
    ds_read_b128 a[228:231], v3 offset:17408
    ds_read_b128 a[232:235], v3 offset:18432
    ds_read_b128 a[236:239], v3 offset:19456
    ds_read_b128 a[240:243], v3 offset:20480
    ds_read_b128 a[244:247], v3 offset:21504
    ds_read_b128 a[248:251], v3 offset:22528
    ds_read_b128 a[252:255], v3 offset:23552
    v_add_u32 v3, s32, v2
    v_mul_f32 v240, v180, v145
    v_mul_f32 v241, v182, v147
    v_mul_f32 v242, v184, v149
    v_mul_f32 v243, v186, v151
    v_fma_f32 v240, v181, v153, v240
    v_fma_f32 v241, v183, v155, v241
    v_fma_f32 v242, v185, v157, v242
    v_fma_f32 v243, v187, v159, v243
    v_rcp_f32 v240, v240
    v_rcp_f32 v241, v241
    v_rcp_f32 v242, v242
    v_rcp_f32 v243, v243
    v_mul_f32 v180, v180, v240
    v_mul_f32 v182, v182, v241
    v_mul_f32 v184, v184, v242
    v_mul_f32 v186, v186, v243
    v_mul_f32 v181, v181, v240
    v_mul_f32 v183, v183, v241
    v_mul_f32 v185, v185, v242
    v_mul_f32 v187, v187, v243
    s_waitcnt vmcnt(16) lgkmcnt(0)
    v_mfma_f32_16x16x32_bf16 a[96:99], a[240:243], v[120:123], a[96:99]
    s_barrier
    ds_read_b128 a[192:195], v3 offset:0
    v_cvt_pk_bf16_f32 v97, v162, v163
    v_exp_f32 v165, v37
    v_mfma_f32_16x16x32_bf16 a[112:115], a[240:243], v[124:127], a[112:115]
    ds_read_b128 a[196:199], v3 offset:1024
    v_exp_f32 v166, v38
    v_cvt_pk_bf16_f32 v98, v164, v165
    v_mfma_f32_16x16x32_bf16 a[100:103], a[244:247], v[120:123], a[100:103]
    ds_read_b128 a[200:203], v3 offset:2048
    ds_read_b128 a[204:207], v3 offset:3072
    buffer_load_dwordx4 v5, s[24:27], s28 offen offset:0 sc1 lds
    v_mfma_f32_16x16x32_bf16 a[116:119], a[244:247], v[124:127], a[116:119]
    ds_read_b128 a[208:211], v3 offset:4096
    v_exp_f32 v167, v39
    v_or3_b32 v174, v96, v97, v98
    v_mfma_f32_16x16x32_bf16 a[104:107], a[248:251], v[120:123], a[104:107]
    ds_read_b128 a[212:215], v3 offset:5120
    v_exp_f32 v160, v40
    v_cvt_pk_bf16_f32 v99, v166, v167
    v_mfma_f32_16x16x32_bf16 a[120:123], a[248:251], v[124:127], a[120:123]
    v_exp_f32 v161, v41
    v_exp_f32 v162, v42
    v_mfma_f32_16x16x32_bf16 a[108:111], a[252:255], v[120:123], a[108:111]
    ds_read_b128 a[216:219], v3 offset:6144
    ds_read_b128 a[220:223], v3 offset:7168
    ds_read_b128 v[192:195], v8 offset:0
    v_cvt_pk_bf16_f32 v100, v160, v161
    v_mfma_f32_16x16x32_bf16 a[124:127], a[252:255], v[124:127], a[124:127]
    buffer_load_dwordx4 v5, s[24:27], s28 offen offset:1024 sc1 lds
    v_exp_f32 v163, v43
    v_mfma_f32_16x16x32_bf16 a[64:67], a[224:227], v[120:123], a[64:67]
    ds_read_b128 v[196:199], v8 offset:1024
    v_or3_b32 v174, v174, v99, v100
    v_exp_f32 v164, v44
    v_mfma_f32_16x16x32_bf16 a[80:83], a[224:227], v[124:127], a[80:83]
    ds_read_b128 v[200:203], v8 offset:2048
    v_cvt_pk_bf16_f32 v101, v162, v163
    v_exp_f32 v165, v45
    v_mfma_f32_16x16x32_bf16 a[68:71], a[228:231], v[120:123], a[68:71]
    ds_read_b128 v[204:207], v8 offset:3072
    ds_read_b128 v[208:211], v8 offset:4096
    v_exp_f32 v166, v46
    v_mfma_f32_16x16x32_bf16 a[84:87], a[228:231], v[124:127], a[84:87]
    ds_read_b128 v[212:215], v8 offset:5120
    ds_read_b128 v[216:219], v8 offset:6144
    ds_read_b128 v[220:223], v8 offset:7168
    buffer_load_dwordx4 v5, s[24:27], s28 offen offset:2048 sc1 lds
    v_mfma_f32_16x16x32_bf16 a[72:75], a[232:235], v[120:123], a[72:75]
    v_cvt_pk_bf16_f32 v102, v164, v165
    v_exp_f32 v167, v47
    v_or3_b32 v174, v174, v101, v102
    v_mfma_f32_16x16x32_bf16 a[88:91], a[232:235], v[124:127], a[88:91]
    v_cvt_pk_bf16_f32 v103, v166, v167
    v_or_b32 v174, v174, v103
    v_and_b32 v174, s39, v174
    v_mfma_f32_16x16x32_bf16 a[76:79], a[236:239], v[120:123], a[76:79]
    v_cmp_ne_u32 vcc, 0, v174
    v_or3_b32 v172, v96, v97, v98
    v_or3_b32 v173, v100, v101, v102
    v_or_b32 v172, v172, v99
    v_or_b32 v173, v173, v103
    v_and_b32 v172, s3, v172
    v_and_b32 v173, s3, v173
    v_min_u32 v172, v172, v173
    v_cmp_eq_u32 s[50:51], 0, v172
    s_nop 0
    s_or_b64 vcc, vcc, s[50:51]
    v_mfma_f32_16x16x32_bf16 a[92:95], a[236:239], v[124:127], a[92:95]
    buffer_load_dwordx4 v5, s[24:27], s28 offen offset:3072 sc1 lds
    s_cbranch_vccnz KB_SL12
KB_SL12R:
    s_waitcnt lgkmcnt(0)
    v_mfma_f32_16x16x32_bf16 v[64:67], a[192:195], a[128:131], v[128:131]
    ds_write_b128 v8, a[96:99] offset:0
    v_accvgpr_read_b32 v224, a0
    v_accvgpr_read_b32 v225, a1
    v_accvgpr_read_b32 v226, a2
    v_mfma_f32_16x16x32_bf16 v[64:67], a[196:199], a[132:135], v[64:67]
    v_accvgpr_read_b32 v227, a3
    v_accvgpr_read_b32 v228, a4
    v_accvgpr_read_b32 v229, a5
    v_accvgpr_read_b32 v230, a6
    v_accvgpr_read_b32 v231, a7
    v_mul_f32 v224, v224, v180
    v_mfma_f32_16x16x32_bf16 v[64:67], a[200:203], a[136:139], v[64:67]
    ds_write_b128 v8, a[100:103] offset:1024
    v_mul_f32 v225, v225, v180
    v_mul_f32 v226, v226, v180
    v_mul_f32 v227, v227, v180
    v_mfma_f32_16x16x32_bf16 v[64:67], a[204:207], a[140:143], v[64:67]
    v_mul_f32 v228, v228, v180
    v_mul_f32 v229, v229, v180
    v_mul_f32 v230, v230, v180
    v_mul_f32 v231, v231, v180
    v_fma_f32 v192, v192, v181, v224
    v_fma_f32 v193, v193, v181, v225
    v_mfma_f32_16x16x32_bf16 v[68:71], a[208:211], a[128:131], v[128:131]
    ds_write_b128 v8, a[104:107] offset:2048
    v_fma_f32 v194, v194, v181, v226
    v_fma_f32 v195, v195, v181, v227
    v_fma_f32 v196, v196, v181, v228
    v_mfma_f32_16x16x32_bf16 v[68:71], a[212:215], a[132:135], v[68:71]
    v_fma_f32 v197, v197, v181, v229
    v_fma_f32 v198, v198, v181, v230
    v_fma_f32 v199, v199, v181, v231
    v_cvt_pk_bf16_f32 v192, v192, v193
    v_cvt_pk_bf16_f32 v193, v194, v195
    v_cvt_pk_bf16_f32 v194, v196, v197
    v_mfma_f32_16x16x32_bf16 v[68:71], a[216:219], a[136:139], v[68:71]
    ds_write_b128 v8, a[108:111] offset:3072
    v_cvt_pk_bf16_f32 v195, v198, v199
    buffer_store_dwordx4 v[192:195], v6, s[24:27], s44 offen offset:0 sc1
    v_mfma_f32_16x16x32_bf16 v[68:71], a[220:223], a[140:143], v[68:71]
    v_accvgpr_read_b32 v232, a8
    v_accvgpr_read_b32 v233, a9
    v_accvgpr_read_b32 v234, a10
    v_accvgpr_read_b32 v235, a11
    v_accvgpr_read_b32 v236, a12
    v_accvgpr_read_b32 v237, a13
    v_mfma_f32_16x16x32_bf16 v[72:75], a[192:195], a[144:147], v[132:135]
    v_accvgpr_read_b32 v238, a14
    v_accvgpr_read_b32 v239, a15
    v_mul_f32 v232, v232, v180
    v_mul_f32 v233, v233, v180
    v_mul_f32 v234, v234, v180
    v_mul_f32 v235, v235, v180
    v_mfma_f32_16x16x32_bf16 v[72:75], a[196:199], a[148:151], v[72:75]
    ds_write_b128 v8, a[112:115] offset:4096
    v_mul_f32 v236, v236, v180
    v_mul_f32 v237, v237, v180
    v_mul_f32 v238, v238, v180
    v_mfma_f32_16x16x32_bf16 v[72:75], a[200:203], a[152:155], v[72:75]
    v_mul_f32 v239, v239, v180
    v_fma_f32 v200, v200, v181, v232
    v_fma_f32 v201, v201, v181, v233
    v_fma_f32 v202, v202, v181, v234
    v_fma_f32 v203, v203, v181, v235
    v_fma_f32 v204, v204, v181, v236
    v_mfma_f32_16x16x32_bf16 v[72:75], a[204:207], a[156:159], v[72:75]
    ds_write_b128 v8, a[116:119] offset:5120
    v_fma_f32 v205, v205, v181, v237
    v_fma_f32 v206, v206, v181, v238
    v_fma_f32 v207, v207, v181, v239
    v_mfma_f32_16x16x32_bf16 v[76:79], a[208:211], a[144:147], v[132:135]
    v_cvt_pk_bf16_f32 v200, v200, v201
    v_cvt_pk_bf16_f32 v201, v202, v203
    v_cvt_pk_bf16_f32 v202, v204, v205
    v_cvt_pk_bf16_f32 v203, v206, v207
    buffer_store_dwordx4 v[200:203], v6, s[24:27], s44 offen offset:1024 sc1
    v_mfma_f32_16x16x32_bf16 v[76:79], a[212:215], a[148:151], v[76:79]
    ds_write_b128 v8, a[120:123] offset:6144
    v_accvgpr_read_b32 v224, a16
    v_accvgpr_read_b32 v225, a17
    v_accvgpr_read_b32 v226, a18
    v_mfma_f32_16x16x32_bf16 v[76:79], a[216:219], a[152:155], v[76:79]
    v_accvgpr_read_b32 v227, a19
    v_accvgpr_read_b32 v228, a20
    v_accvgpr_read_b32 v229, a21
    v_accvgpr_read_b32 v230, a22
    v_accvgpr_read_b32 v231, a23
    v_mul_f32 v224, v224, v182
    v_mfma_f32_16x16x32_bf16 v[76:79], a[220:223], a[156:159], v[76:79]
    ds_write_b128 v8, a[124:127] offset:7168
    v_mul_f32 v225, v225, v182
    v_mul_f32 v226, v226, v182
    v_mul_f32 v227, v227, v182
    v_mul_f32 v228, v228, v182
    v_mul_f32 v229, v229, v182
    v_mul_f32 v230, v230, v182
    v_mul_f32 v231, v231, v182
    v_fma_f32 v208, v208, v183, v224
    v_fma_f32 v209, v209, v183, v225
    v_mfma_f32_16x16x32_bf16 v[80:83], a[192:195], a[160:163], v[136:139]
    s_add_u32 m0, m0, 16384
    v_fma_f32 v210, v210, v183, v226
    v_fma_f32 v211, v211, v183, v227
    v_fma_f32 v212, v212, v183, v228
    v_fma_f32 v213, v213, v183, v229
    v_fma_f32 v214, v214, v183, v230
    v_fma_f32 v215, v215, v183, v231
    v_mfma_f32_16x16x32_bf16 v[80:83], a[196:199], a[164:167], v[80:83]
    s_add_u32 s38, s28, 16777216
    v_cvt_pk_bf16_f32 v208, v208, v209
    v_cvt_pk_bf16_f32 v209, v210, v211
    v_cvt_pk_bf16_f32 v210, v212, v213
    v_cvt_pk_bf16_f32 v211, v214, v215
    s_add_u32 s44, s44, 131072
    buffer_store_dwordx4 v[208:211], v6, s[24:27], s44 offen offset:0 sc1
    v_mfma_f32_16x16x32_bf16 v[80:83], a[200:203], a[168:171], v[80:83]
    buffer_load_dwordx4 v4, s[24:27], s29 offen offset:0 sc1 lds
    v_accvgpr_read_b32 v232, a24
    v_accvgpr_read_b32 v233, a25
    v_accvgpr_read_b32 v234, a26
    v_accvgpr_read_b32 v235, a27
    v_mfma_f32_16x16x32_bf16 v[80:83], a[204:207], a[172:175], v[80:83]
    v_accvgpr_read_b32 v236, a28
    v_accvgpr_read_b32 v237, a29
    v_accvgpr_read_b32 v238, a30
    v_accvgpr_read_b32 v239, a31
    v_mul_f32 v232, v232, v182
    v_mul_f32 v233, v233, v182
    v_mfma_f32_16x16x32_bf16 v[84:87], a[208:211], a[160:163], v[136:139]
    v_mul_f32 v234, v234, v182
    v_mul_f32 v235, v235, v182
    v_mul_f32 v236, v236, v182
    v_mul_f32 v237, v237, v182
    v_mul_f32 v238, v238, v182
    v_mul_f32 v239, v239, v182
    v_mfma_f32_16x16x32_bf16 v[84:87], a[212:215], a[164:167], v[84:87]
    buffer_load_dwordx4 v4, s[24:27], s29 offen offset:1024 sc1 lds
    s_add_u32 s28, s28, 16384
    v_fma_f32 v216, v216, v183, v232
    v_fma_f32 v217, v217, v183, v233
    v_fma_f32 v218, v218, v183, v234
    v_fma_f32 v219, v219, v183, v235
    v_mfma_f32_16x16x32_bf16 v[84:87], a[216:219], a[168:171], v[84:87]
    v_fma_f32 v220, v220, v183, v236
    v_fma_f32 v221, v221, v183, v237
    v_fma_f32 v222, v222, v183, v238
    v_fma_f32 v223, v223, v183, v239
    v_cvt_pk_bf16_f32 v216, v216, v217
    v_cvt_pk_bf16_f32 v217, v218, v219
    v_mfma_f32_16x16x32_bf16 v[84:87], a[220:223], a[172:175], v[84:87]
    v_cvt_pk_bf16_f32 v218, v220, v221
    v_cvt_pk_bf16_f32 v219, v222, v223
    buffer_store_dwordx4 v[216:219], v6, s[24:27], s44 offen offset:1024 sc1
    s_waitcnt lgkmcnt(0)
    s_barrier
    ds_read_b128 v[192:195], v7 offset:0
    v_mfma_f32_16x16x32_bf16 v[88:91], a[192:195], a[176:179], v[140:143]
    ds_read_b128 v[196:199], v7 offset:1024
    ds_read_b128 v[200:203], v7 offset:2048
    ds_read_b128 v[204:207], v7 offset:3072
    ds_read_b128 v[208:211], v7 offset:4096
    ds_read_b128 v[212:215], v7 offset:5120
    ds_read_b128 v[216:219], v7 offset:6144
    v_mfma_f32_16x16x32_bf16 v[88:91], a[196:199], a[180:183], v[88:91]
    ds_read_b128 v[220:223], v7 offset:7168
    ds_read_b128 a[224:227], v3 offset:16384
    ds_read_b128 a[228:231], v3 offset:17408
    ds_read_b128 a[232:235], v3 offset:18432
    ds_read_b128 a[236:239], v3 offset:19456
    ds_read_b128 a[240:243], v3 offset:20480
    v_mfma_f32_16x16x32_bf16 v[88:91], a[200:203], a[184:187], v[88:91]
    ds_read_b128 a[244:247], v3 offset:21504
    ds_read_b128 a[248:251], v3 offset:22528
    ds_read_b128 a[252:255], v3 offset:23552
    buffer_load_dwordx4 v4, s[24:27], s29 offen offset:2048 sc1 lds
    s_cmp_eq_u32 s28, s30
    s_cselect_b32 s28, s31, s28
    s_cselect_b32 s30, s19, s30
    v_mfma_f32_16x16x32_bf16 v[88:91], a[204:207], a[188:191], v[88:91]
    v_exp_f32 v160, v48
    v_exp_f32 v161, v49
    v_exp_f32 v162, v50
    v_mfma_f32_16x16x32_bf16 v[92:95], a[208:211], a[176:179], v[140:143]
    v_cvt_pk_bf16_f32 v104, v160, v161
    v_exp_f32 v163, v51
    v_exp_f32 v164, v52
    v_cvt_pk_bf16_f32 v105, v162, v163
    v_exp_f32 v165, v53
    v_mfma_f32_16x16x32_bf16 v[92:95], a[212:215], a[180:183], v[92:95]
    v_exp_f32 v166, v54
    v_cvt_pk_bf16_f32 v106, v164, v165
    v_exp_f32 v167, v55
    v_or3_b32 v174, v104, v105, v106
    v_mfma_f32_16x16x32_bf16 v[92:95], a[216:219], a[184:187], v[92:95]
    v_exp_f32 v160, v56
    v_cvt_pk_bf16_f32 v107, v166, v167
    v_exp_f32 v161, v57
    v_exp_f32 v162, v58
    v_cvt_pk_bf16_f32 v108, v160, v161
    v_mfma_f32_16x16x32_bf16 v[92:95], a[220:223], a[188:191], v[92:95]
    buffer_load_dwordx4 v4, s[24:27], s29 offen offset:3072 sc1 lds
    s_mov_b32 s29, s38
    v_exp_f32 v163, v59
    v_or3_b32 v174, v174, v107, v108
    v_exp_f32 v164, v60
    v_cvt_pk_bf16_f32 v109, v162, v163
    v_exp_f32 v165, v61
    v_exp_f32 v166, v62
    v_cvt_pk_bf16_f32 v110, v164, v165
    v_exp_f32 v167, v63
    v_or3_b32 v174, v174, v109, v110
    v_cvt_pk_bf16_f32 v111, v166, v167
    v_or_b32 v174, v174, v111
    v_and_b32 v174, s39, v174
    v_cmp_ne_u32 vcc, 0, v174
    v_or3_b32 v172, v104, v105, v106
    v_or3_b32 v173, v108, v109, v110
    v_or_b32 v172, v172, v107
    v_or_b32 v173, v173, v111
    v_and_b32 v172, s3, v172
    v_and_b32 v173, s3, v173
    v_min_u32 v172, v172, v173
    v_cmp_eq_u32 s[50:51], 0, v172
    s_nop 0
    s_or_b64 vcc, vcc, s[50:51]
    s_cbranch_vccnz KB_SL13
KB_SL13R:
    s_add_u32 m0, s32, s33
    s_add_u32 s32, s32, 32768
    s_and_b32 s32, s32, 0x1ffff
    v_add_u32 v3, s32, v2
    s_waitcnt lgkmcnt(8)
    v_accvgpr_read_b32 v224, a64
    v_accvgpr_read_b32 v225, a65
    v_accvgpr_read_b32 v226, a66
    v_accvgpr_read_b32 v227, a67
    v_accvgpr_read_b32 v228, a68
    v_accvgpr_read_b32 v229, a69
    v_accvgpr_read_b32 v230, a70
    v_accvgpr_read_b32 v231, a71
    v_pk_mul_f32 v[224:225], v[224:225], v[184:185] op_sel_hi:[1,0]
    v_pk_mul_f32 v[226:227], v[226:227], v[184:185] op_sel_hi:[1,0]
    v_pk_mul_f32 v[228:229], v[228:229], v[184:185] op_sel_hi:[1,0]
    v_pk_mul_f32 v[230:231], v[230:231], v[184:185] op_sel_hi:[1,0]
    v_pk_fma_f32 v[192:193], v[192:193], v[184:185], v[224:225] op_sel:[0,1,0] op_sel_hi:[1,1,1]
    v_pk_fma_f32 v[194:195], v[194:195], v[184:185], v[226:227] op_sel:[0,1,0] op_sel_hi:[1,1,1]
    v_pk_fma_f32 v[196:197], v[196:197], v[184:185], v[228:229] op_sel:[0,1,0] op_sel_hi:[1,1,1]
    v_pk_fma_f32 v[198:199], v[198:199], v[184:185], v[230:231] op_sel:[0,1,0] op_sel_hi:[1,1,1]
    v_cvt_pk_bf16_f32 v192, v192, v193
    v_cvt_pk_bf16_f32 v193, v194, v195
    v_cvt_pk_bf16_f32 v194, v196, v197
    v_cvt_pk_bf16_f32 v195, v198, v199
    buffer_store_dwordx4 v[192:195], v6, s[24:27], s45 offen offset:0 sc1
    v_accvgpr_read_b32 v232, a72
    v_accvgpr_read_b32 v233, a73
    v_accvgpr_read_b32 v234, a74
    v_accvgpr_read_b32 v235, a75
    v_accvgpr_read_b32 v236, a76
    v_accvgpr_read_b32 v237, a77
    v_accvgpr_read_b32 v238, a78
    v_accvgpr_read_b32 v239, a79
    v_pk_mul_f32 v[232:233], v[232:233], v[184:185] op_sel_hi:[1,0]
    v_pk_mul_f32 v[234:235], v[234:235], v[184:185] op_sel_hi:[1,0]
    v_pk_mul_f32 v[236:237], v[236:237], v[184:185] op_sel_hi:[1,0]
    v_pk_mul_f32 v[238:239], v[238:239], v[184:185] op_sel_hi:[1,0]
    v_pk_fma_f32 v[200:201], v[200:201], v[184:185], v[232:233] op_sel:[0,1,0] op_sel_hi:[1,1,1]
    v_pk_fma_f32 v[202:203], v[202:203], v[184:185], v[234:235] op_sel:[0,1,0] op_sel_hi:[1,1,1]
    v_pk_fma_f32 v[204:205], v[204:205], v[184:185], v[236:237] op_sel:[0,1,0] op_sel_hi:[1,1,1]
    v_pk_fma_f32 v[206:207], v[206:207], v[184:185], v[238:239] op_sel:[0,1,0] op_sel_hi:[1,1,1]
    v_cvt_pk_bf16_f32 v200, v200, v201
    v_cvt_pk_bf16_f32 v201, v202, v203
    v_cvt_pk_bf16_f32 v202, v204, v205
    v_cvt_pk_bf16_f32 v203, v206, v207
    buffer_store_dwordx4 v[200:203], v6, s[24:27], s45 offen offset:1024 sc1
    v_accvgpr_read_b32 v224, a80
    v_accvgpr_read_b32 v225, a81
    v_accvgpr_read_b32 v226, a82
    v_accvgpr_read_b32 v227, a83
    v_accvgpr_read_b32 v228, a84
    v_accvgpr_read_b32 v229, a85
    v_accvgpr_read_b32 v230, a86
    v_accvgpr_read_b32 v231, a87
    v_pk_mul_f32 v[224:225], v[224:225], v[186:187] op_sel_hi:[1,0]
    v_pk_mul_f32 v[226:227], v[226:227], v[186:187] op_sel_hi:[1,0]
    v_pk_mul_f32 v[228:229], v[228:229], v[186:187] op_sel_hi:[1,0]
    v_pk_mul_f32 v[230:231], v[230:231], v[186:187] op_sel_hi:[1,0]
    v_pk_fma_f32 v[208:209], v[208:209], v[186:187], v[224:225] op_sel:[0,1,0] op_sel_hi:[1,1,1]
    v_pk_fma_f32 v[210:211], v[210:211], v[186:187], v[226:227] op_sel:[0,1,0] op_sel_hi:[1,1,1]
    v_pk_fma_f32 v[212:213], v[212:213], v[186:187], v[228:229] op_sel:[0,1,0] op_sel_hi:[1,1,1]
    v_pk_fma_f32 v[214:215], v[214:215], v[186:187], v[230:231] op_sel:[0,1,0] op_sel_hi:[1,1,1]
    v_cvt_pk_bf16_f32 v208, v208, v209
    v_cvt_pk_bf16_f32 v209, v210, v211
    v_cvt_pk_bf16_f32 v210, v212, v213
    v_cvt_pk_bf16_f32 v211, v214, v215
    s_add_u32 s45, s45, 131072
    buffer_store_dwordx4 v[208:211], v6, s[24:27], s45 offen offset:0 sc1
    v_accvgpr_read_b32 v232, a88
    v_accvgpr_read_b32 v233, a89
    v_accvgpr_read_b32 v234, a90
    v_accvgpr_read_b32 v235, a91
    v_accvgpr_read_b32 v236, a92
    v_accvgpr_read_b32 v237, a93
    v_accvgpr_read_b32 v238, a94
    v_accvgpr_read_b32 v239, a95
    v_pk_mul_f32 v[232:233], v[232:233], v[186:187] op_sel_hi:[1,0]
    v_pk_mul_f32 v[234:235], v[234:235], v[186:187] op_sel_hi:[1,0]
    v_pk_mul_f32 v[236:237], v[236:237], v[186:187] op_sel_hi:[1,0]
    v_pk_mul_f32 v[238:239], v[238:239], v[186:187] op_sel_hi:[1,0]
    v_pk_fma_f32 v[216:217], v[216:217], v[186:187], v[232:233] op_sel:[0,1,0] op_sel_hi:[1,1,1]
    v_pk_fma_f32 v[218:219], v[218:219], v[186:187], v[234:235] op_sel:[0,1,0] op_sel_hi:[1,1,1]
    v_pk_fma_f32 v[220:221], v[220:221], v[186:187], v[236:237] op_sel:[0,1,0] op_sel_hi:[1,1,1]
    v_pk_fma_f32 v[222:223], v[222:223], v[186:187], v[238:239] op_sel:[0,1,0] op_sel_hi:[1,1,1]
    v_cvt_pk_bf16_f32 v216, v216, v217
    v_cvt_pk_bf16_f32 v217, v218, v219
    v_cvt_pk_bf16_f32 v218, v220, v221
    v_cvt_pk_bf16_f32 v219, v222, v223
    buffer_store_dwordx4 v[216:219], v6, s[24:27], s45 offen offset:1024 sc1
    s_mov_b32 s36, 1
    s_sub_u32 s35, 15, s16
    s_mov_b32 s44, s46
    s_mov_b32 s45, s47
    v_mov_b32 v253, v1
    s_branch KB_BLK
KB_SMALL:
    s_waitcnt vmcnt(16) lgkmcnt(0)
    v_mfma_f32_16x16x32_bf16 a[0:3], a[224:227], v[96:99], 0
    s_barrier
    v_cmp_le_i32 s[50:51], 0, v10
    v_cmp_le_i32 s[52:53], 1, v10
    v_mfma_f32_16x16x32_bf16 a[16:19], a[224:227], v[100:103], 0
    ds_read_b128 a[128:131], v12 offset:0
    v_cmp_le_i32 s[54:55], 2, v10
    v_mfma_f32_16x16x32_bf16 a[4:7], a[228:231], v[96:99], 0
    ds_read_b128 a[132:135], v12 offset:1024
    v_cmp_le_i32 s[56:57], 3, v10
    v_mfma_f32_16x16x32_bf16 a[20:23], a[228:231], v[100:103], 0
    ds_read_b128 a[136:139], v12 offset:2048
    v_cndmask_b32 v80, v11, v80, s[50:51]
    v_mfma_f32_16x16x32_bf16 a[8:11], a[232:235], v[96:99], 0
    buffer_load_dwordx4 v5, s[24:27], s28 offen offset:0 sc1 lds
    v_mfma_f32_16x16x32_bf16 a[24:27], a[232:235], v[100:103], 0
    v_exp_f32 v160, v80
    v_mfma_f32_16x16x32_bf16 a[12:15], a[236:239], v[96:99], 0
    ds_read_b128 a[140:143], v12 offset:3072
    v_cmp_le_i32 s[50:51], 16, v10
    v_cndmask_b32 v81, v11, v81, s[52:53]
    v_mfma_f32_16x16x32_bf16 a[28:31], a[236:239], v[100:103], 0
    v_exp_f32 v161, v81
    v_cmp_le_i32 s[52:53], 17, v10
    v_mfma_f32_16x16x32_bf16 a[32:35], a[240:243], v[96:99], 0
    ds_read_b128 a[144:147], v12 offset:4096
    v_cndmask_b32 v82, v11, v82, s[54:55]
    v_exp_f32 v162, v82
    v_mfma_f32_16x16x32_bf16 a[48:51], a[240:243], v[100:103], 0
    ds_read_b128 a[148:151], v12 offset:5120
    v_cvt_pk_bf16_f32 v120, v160, v161
    v_mfma_f32_16x16x32_bf16 a[36:39], a[244:247], v[96:99], 0
    ds_read_b128 a[152:155], v12 offset:6144
    v_cmp_le_i32 s[54:55], 18, v10
    v_cndmask_b32 v83, v11, v83, s[56:57]
    v_mfma_f32_16x16x32_bf16 a[52:55], a[244:247], v[100:103], 0
    ds_read_b128 a[156:159], v12 offset:7168
    v_exp_f32 v163, v83
    v_cmp_le_i32 s[56:57], 19, v10
    v_mfma_f32_16x16x32_bf16 a[40:43], a[248:251], v[96:99], 0
    ds_read_b128 a[192:195], v3 offset:0
    buffer_load_dwordx4 v5, s[24:27], s28 offen offset:1024 sc1 lds
    v_cndmask_b32 v84, v11, v84, s[50:51]
    v_exp_f32 v164, v84
    v_mfma_f32_16x16x32_bf16 a[56:59], a[248:251], v[100:103], 0
    ds_read_b128 a[196:199], v3 offset:1024
    v_cvt_pk_bf16_f32 v121, v162, v163
    v_mfma_f32_16x16x32_bf16 a[44:47], a[252:255], v[96:99], 0
    ds_read_b128 a[200:203], v3 offset:2048
    v_cmp_le_i32 s[50:51], -16, v10
    v_cndmask_b32 v85, v11, v85, s[52:53]
    v_mfma_f32_16x16x32_bf16 a[60:63], a[252:255], v[100:103], 0
    v_exp_f32 v165, v85
    v_mfma_f32_16x16x32_bf16 v[20:23], v[244:247], v[96:99], 0
    ds_read_b128 a[204:207], v3 offset:3072
    v_cmp_le_i32 s[52:53], -15, v10
    v_cndmask_b32 v86, v11, v86, s[54:55]
    v_exp_f32 v166, v86
    v_mfma_f32_16x16x32_bf16 v[24:27], v[244:247], v[100:103], 0
    ds_read_b128 a[208:211], v3 offset:4096
    v_cvt_pk_bf16_f32 v122, v164, v165
    v_mfma_f32_16x16x32_bf16 a[64:67], a[224:227], v[104:107], 0
    ds_read_b128 a[212:215], v3 offset:5120
    v_cmp_le_i32 s[54:55], -14, v10
    v_cndmask_b32 v87, v11, v87, s[56:57]
    v_mfma_f32_16x16x32_bf16 a[80:83], a[224:227], v[108:111], 0
    ds_read_b128 a[216:219], v3 offset:6144
    v_exp_f32 v167, v87
    v_mfma_f32_16x16x32_bf16 a[68:71], a[228:231], v[104:107], 0
    ds_read_b128 a[220:223], v3 offset:7168
    buffer_load_dwordx4 v5, s[24:27], s28 offen offset:2048 sc1 lds
    v_or3_b32 v174, v120, v121, v122
    v_cmp_le_i32 s[56:57], -13, v10
    v_cndmask_b32 v88, v11, v88, s[50:51]
    v_mfma_f32_16x16x32_bf16 a[84:87], a[228:231], v[108:111], 0
    ds_read_b128 a[160:163], v12 offset:8192
    v_exp_f32 v160, v88
    v_mfma_f32_16x16x32_bf16 a[72:75], a[232:235], v[104:107], 0
    ds_read_b128 a[164:167], v12 offset:9216
    v_cvt_pk_bf16_f32 v123, v166, v167
    v_cmp_le_i32 s[50:51], 0, v10
    v_mfma_f32_16x16x32_bf16 a[88:91], a[232:235], v[108:111], 0
    v_cndmask_b32 v89, v11, v89, s[52:53]
    v_exp_f32 v161, v89
    v_mfma_f32_16x16x32_bf16 a[76:79], a[236:239], v[104:107], 0
    ds_read_b128 a[168:171], v12 offset:10240
    v_cmp_le_i32 s[52:53], 1, v10
    v_cndmask_b32 v90, v11, v90, s[54:55]
    v_mfma_f32_16x16x32_bf16 a[92:95], a[236:239], v[108:111], 0
    ds_read_b128 a[172:175], v12 offset:11264
    v_exp_f32 v162, v90
    v_mfma_f32_16x16x32_bf16 a[96:99], a[240:243], v[104:107], 0
    ds_read_b128 a[176:179], v12 offset:12288
    v_cvt_pk_bf16_f32 v124, v160, v161
    v_cmp_le_i32 s[54:55], 2, v10
    v_mfma_f32_16x16x32_bf16 a[112:115], a[240:243], v[108:111], 0
    ds_read_b128 a[180:183], v12 offset:13312
    ds_read_b128 a[184:187], v12 offset:14336
    ds_read_b128 a[188:191], v12 offset:15360
    v_cndmask_b32 v91, v11, v91, s[56:57]
    v_exp_f32 v163, v91
    v_mfma_f32_16x16x32_bf16 a[100:103], a[244:247], v[104:107], 0
    buffer_load_dwordx4 v5, s[24:27], s28 offen offset:3072 sc1 lds
    v_or3_b32 v174, v174, v123, v124
    v_mfma_f32_16x16x32_bf16 a[116:119], a[244:247], v[108:111], 0
    v_cmp_le_i32 s[56:57], 3, v10
    v_cndmask_b32 v92, v11, v92, s[50:51]
    v_exp_f32 v164, v92
    v_mfma_f32_16x16x32_bf16 a[104:107], a[248:251], v[104:107], 0
    v_cvt_pk_bf16_f32 v125, v162, v163
    v_cndmask_b32 v93, v11, v93, s[52:53]
    v_mfma_f32_16x16x32_bf16 a[120:123], a[248:251], v[108:111], 0
    v_exp_f32 v165, v93
    v_mfma_f32_16x16x32_bf16 a[108:111], a[252:255], v[104:107], 0
    v_cndmask_b32 v94, v11, v94, s[54:55]
    v_mfma_f32_16x16x32_bf16 a[124:127], a[252:255], v[108:111], 0
    v_exp_f32 v166, v94
    v_cvt_pk_bf16_f32 v126, v164, v165
    v_mfma_f32_16x16x32_bf16 v[28:31], v[244:247], v[104:107], 0
    v_cndmask_b32 v95, v11, v95, s[56:57]
    v_exp_f32 v167, v95
    v_or3_b32 v174, v174, v125, v126
    v_cvt_pk_bf16_f32 v127, v166, v167
    v_or_b32 v174, v174, v127
    v_and_b32 v174, s39, v174
    v_cmp_ne_u32 vcc, 0, v174
    v_mfma_f32_16x16x32_bf16 v[168:171], v[244:247], v[108:111], 0
    s_cbranch_vccnz KB_SL14
KB_SL14R:
    s_branch KB_TR2
KB_FIN:
    s_getpc_b64 s[78:79]
    s_lshr_b32 s43, s2, 3
    s_lshl_b32 s43, s43, 2
    s_add_u32 s43, s43, s14
    s_lshl_b32 s43, s43, 7
    v_min_u32 v190, 1, v0
    v_lshlrev_b32 v190, 14, v190
    v_add_u32 v190, s43, v190
    global_load_dword v190, v190, s[78:79]
    s_waitcnt vmcnt(16) lgkmcnt(0)
    v_mfma_f32_16x16x32_bf16 a[0:3], a[224:227], v[112:115], a[0:3]
    s_barrier
    v_exp_f32 v160, v32
    v_mfma_f32_16x16x32_bf16 a[16:19], a[224:227], v[116:119], a[16:19]
    v_exp_f32 v161, v33
    v_mfma_f32_16x16x32_bf16 a[4:7], a[228:231], v[112:115], a[4:7]
    ds_read_b128 a[192:195], v3 offset:0
    s_mov_b32 s37, m0
    v_mfma_f32_16x16x32_bf16 a[20:23], a[228:231], v[116:119], a[20:23]
    v_exp_f32 v162, v34
    v_mfma_f32_16x16x32_bf16 a[8:11], a[232:235], v[112:115], a[8:11]
    v_cvt_pk_bf16_f32 v96, v160, v161
    v_and_b32 v13, 31, v0
    v_mfma_f32_16x16x32_bf16 a[24:27], a[232:235], v[116:119], a[24:27]
    ds_read_b128 a[196:199], v3 offset:1024
    v_lshlrev_b32 v13, 2, v13
    v_mfma_f32_16x16x32_bf16 a[12:15], a[236:239], v[112:115], a[12:15]
    v_exp_f32 v163, v35
    v_mfma_f32_16x16x32_bf16 a[28:31], a[236:239], v[116:119], a[28:31]
    v_exp_f32 v164, v36
    v_mfma_f32_16x16x32_bf16 a[32:35], a[240:243], v[112:115], a[32:35]
    ds_read_b128 a[200:203], v3 offset:2048
    v_cvt_pk_bf16_f32 v97, v162, v163
    v_mfma_f32_16x16x32_bf16 a[48:51], a[240:243], v[116:119], a[48:51]
    buffer_load_dword v14, v13, s[24:27], s68 offen offset:512 sc1
    v_mfma_f32_16x16x32_bf16 a[36:39], a[244:247], v[112:115], a[36:39]
    v_exp_f32 v165, v37
    v_mfma_f32_16x16x32_bf16 a[52:55], a[244:247], v[116:119], a[52:55]
    s_lshl_b32 s48, s14, 13
    v_exp_f32 v166, v38
    v_mfma_f32_16x16x32_bf16 a[40:43], a[248:251], v[112:115], a[40:43]
    ds_read_b128 a[204:207], v3 offset:3072
    v_cvt_pk_bf16_f32 v98, v164, v165
    v_mfma_f32_16x16x32_bf16 a[56:59], a[248:251], v[116:119], a[56:59]
    s_add_u32 m0, s48, 135168
    v_exp_f32 v167, v39
    v_mfma_f32_16x16x32_bf16 a[44:47], a[252:255], v[112:115], a[44:47]
    ds_read_b128 a[208:211], v3 offset:4096
    v_or3_b32 v174, v96, v97, v98
    v_mfma_f32_16x16x32_bf16 a[60:63], a[252:255], v[116:119], a[60:63]
    s_xor_b32 s49, s60, 98304
    v_exp_f32 v160, v40
    v_mfma_f32_16x16x32_bf16 v[20:23], v[244:247], v[112:115], v[20:23]
    buffer_load_dwordx4 v16, s[20:23], s49 offen lds
    v_mfma_f32_16x16x32_bf16 v[24:27], v[244:247], v[116:119], v[24:27]
    ds_read_b128 a[212:215], v3 offset:5120
    v_cvt_pk_bf16_f32 v99, v166, v167
    v_mfma_f32_16x16x32_bf16 a[64:67], a[224:227], v[120:123], a[64:67]
    v_exp_f32 v161, v41
    v_mfma_f32_16x16x32_bf16 a[80:83], a[224:227], v[124:127], a[80:83]
    v_exp_f32 v162, v42
    v_mfma_f32_16x16x32_bf16 a[68:71], a[228:231], v[120:123], a[68:71]
    ds_read_b128 a[216:219], v3 offset:6144
    v_cvt_pk_bf16_f32 v100, v160, v161
    v_mfma_f32_16x16x32_bf16 a[84:87], a[228:231], v[124:127], a[84:87]
    buffer_load_dwordx4 v17, s[20:23], s49 offen offset:1024 lds
    v_mfma_f32_16x16x32_bf16 a[72:75], a[232:235], v[120:123], a[72:75]
    v_exp_f32 v163, v43
    v_mfma_f32_16x16x32_bf16 a[88:91], a[232:235], v[124:127], a[88:91]
    ds_read_b128 a[220:223], v3 offset:7168
    v_or3_b32 v174, v174, v99, v100
    v_mfma_f32_16x16x32_bf16 a[76:79], a[236:239], v[120:123], a[76:79]
    v_exp_f32 v164, v44
    v_mfma_f32_16x16x32_bf16 a[92:95], a[236:239], v[124:127], a[92:95]
    buffer_load_dwordx4 v18, s[20:23], s49 offen offset:2048 lds
    v_mfma_f32_16x16x32_bf16 a[96:99], a[240:243], v[120:123], a[96:99]
    v_cvt_pk_bf16_f32 v101, v162, v163
    v_mfma_f32_16x16x32_bf16 a[112:115], a[240:243], v[124:127], a[112:115]
    v_exp_f32 v165, v45
    v_mfma_f32_16x16x32_bf16 a[100:103], a[244:247], v[120:123], a[100:103]
    v_exp_f32 v166, v46
    v_mfma_f32_16x16x32_bf16 a[116:119], a[244:247], v[124:127], a[116:119]
    buffer_load_dwordx4 v19, s[20:23], s49 offen offset:3072 lds
    v_mfma_f32_16x16x32_bf16 a[104:107], a[248:251], v[120:123], a[104:107]
    v_cvt_pk_bf16_f32 v102, v164, v165
    v_mfma_f32_16x16x32_bf16 a[120:123], a[248:251], v[124:127], a[120:123]
    s_mov_b32 m0, s37
    v_exp_f32 v167, v47
    v_mfma_f32_16x16x32_bf16 a[108:111], a[252:255], v[120:123], a[108:111]
    v_or3_b32 v174, v174, v101, v102
    v_cvt_pk_bf16_f32 v103, v166, v167
    v_mfma_f32_16x16x32_bf16 a[124:127], a[252:255], v[124:127], a[124:127]
    v_or_b32 v174, v174, v103
    v_and_b32 v174, s39, v174
    v_mfma_f32_16x16x32_bf16 v[28:31], v[244:247], v[120:123], v[28:31]
    v_cmp_ne_u32 vcc, 0, v174
    v_mfma_f32_16x16x32_bf16 v[168:171], v[244:247], v[124:127], v[168:171]
    s_cbranch_vccnz KB_SL15
KB_SL15R:
    s_waitcnt lgkmcnt(0)
    v_mfma_f32_16x16x32_bf16 v[64:67], a[192:195], a[128:131], v[128:131]
    ds_read_b128 a[224:227], v3 offset:16384
    v_mfma_f32_16x16x32_bf16 v[64:67], a[196:199], a[132:135], v[64:67]
    s_add_u32 m0, m0, 16384
    v_exp_f32 v160, v48
    v_mfma_f32_16x16x32_bf16 v[64:67], a[200:203], a[136:139], v[64:67]
    s_add_u32 s38, s28, 16777216
    v_exp_f32 v161, v49
    v_mfma_f32_16x16x32_bf16 v[64:67], a[204:207], a[140:143], v[64:67]
    v_exp_f32 v162, v50
    v_mfma_f32_16x16x32_bf16 v[68:71], a[208:211], a[128:131], v[128:131]
    ds_read_b128 a[228:231], v3 offset:17408
    v_cvt_pk_bf16_f32 v104, v160, v161
    v_mfma_f32_16x16x32_bf16 v[68:71], a[212:215], a[132:135], v[68:71]
    buffer_load_dwordx4 v4, s[24:27], s29 offen offset:0 sc1 lds
    v_mfma_f32_16x16x32_bf16 v[68:71], a[216:219], a[136:139], v[68:71]
    v_exp_f32 v163, v51
    v_mfma_f32_16x16x32_bf16 v[68:71], a[220:223], a[140:143], v[68:71]
    ds_read_b128 a[232:235], v3 offset:18432
    ds_read_b128 a[236:239], v3 offset:19456
    v_mfma_f32_16x16x32_bf16 v[72:75], a[192:195], a[144:147], v[132:135]
    v_exp_f32 v164, v52
    v_mfma_f32_16x16x32_bf16 v[72:75], a[196:199], a[148:151], v[72:75]
    v_cvt_pk_bf16_f32 v105, v162, v163
    v_mfma_f32_16x16x32_bf16 v[72:75], a[200:203], a[152:155], v[72:75]
    buffer_load_dwordx4 v4, s[24:27], s29 offen offset:1024 sc1 lds
    s_add_u32 s28, s28, 16384
    v_mfma_f32_16x16x32_bf16 v[72:75], a[204:207], a[156:159], v[72:75]
    v_exp_f32 v165, v53
    v_mfma_f32_16x16x32_bf16 v[76:79], a[208:211], a[144:147], v[132:135]
    v_exp_f32 v166, v54
    v_mfma_f32_16x16x32_bf16 v[76:79], a[212:215], a[148:151], v[76:79]
    ds_read_b128 a[240:243], v3 offset:20480
    v_cvt_pk_bf16_f32 v106, v164, v165
    v_mfma_f32_16x16x32_bf16 v[76:79], a[216:219], a[152:155], v[76:79]
    v_exp_f32 v167, v55
    v_mfma_f32_16x16x32_bf16 v[76:79], a[220:223], a[156:159], v[76:79]
    buffer_load_dwordx4 v4, s[24:27], s29 offen offset:2048 sc1 lds
    v_or3_b32 v174, v104, v105, v106
    v_mfma_f32_16x16x32_bf16 v[80:83], a[192:195], a[160:163], v[136:139]
    v_exp_f32 v160, v56
    v_mfma_f32_16x16x32_bf16 v[80:83], a[196:199], a[164:167], v[80:83]
    ds_read_b128 a[244:247], v3 offset:21504
    v_cvt_pk_bf16_f32 v107, v166, v167
    v_mfma_f32_16x16x32_bf16 v[80:83], a[200:203], a[168:171], v[80:83]
    v_exp_f32 v161, v57
    v_mfma_f32_16x16x32_bf16 v[80:83], a[204:207], a[172:175], v[80:83]
    s_cmp_eq_u32 s28, s30
    s_cselect_b32 s28, s31, s28
    s_cselect_b32 s30, s19, s30
    v_exp_f32 v162, v58
    v_mfma_f32_16x16x32_bf16 v[84:87], a[208:211], a[160:163], v[136:139]
    ds_read_b128 a[248:251], v3 offset:22528
    v_cvt_pk_bf16_f32 v108, v160, v161
    v_mfma_f32_16x16x32_bf16 v[84:87], a[212:215], a[164:167], v[84:87]
    v_exp_f32 v163, v59
    v_mfma_f32_16x16x32_bf16 v[84:87], a[216:219], a[168:171], v[84:87]
    ds_read_b128 a[252:255], v3 offset:23552
    v_or3_b32 v174, v174, v107, v108
    v_mfma_f32_16x16x32_bf16 v[84:87], a[220:223], a[172:175], v[84:87]
    buffer_load_dwordx4 v4, s[24:27], s29 offen offset:3072 sc1 lds
    v_exp_f32 v164, v60
    v_mfma_f32_16x16x32_bf16 v[88:91], a[192:195], a[176:179], v[140:143]
    s_mov_b32 s29, s38
    v_cvt_pk_bf16_f32 v109, v162, v163
    v_mfma_f32_16x16x32_bf16 v[88:91], a[196:199], a[180:183], v[88:91]
    v_exp_f32 v165, v61
    v_mfma_f32_16x16x32_bf16 v[88:91], a[200:203], a[184:187], v[88:91]
    s_add_u32 m0, s32, s33
    v_exp_f32 v166, v62
    v_mfma_f32_16x16x32_bf16 v[88:91], a[204:207], a[188:191], v[88:91]
    s_add_u32 s32, s32, 32768
    s_and_b32 s32, s32, 0x1ffff
    v_cvt_pk_bf16_f32 v110, v164, v165
    v_mfma_f32_16x16x32_bf16 v[92:95], a[208:211], a[176:179], v[140:143]
    v_exp_f32 v167, v63
    v_mfma_f32_16x16x32_bf16 v[92:95], a[212:215], a[180:183], v[92:95]
    v_or3_b32 v174, v174, v109, v110
    v_cvt_pk_bf16_f32 v111, v166, v167
    v_mfma_f32_16x16x32_bf16 v[92:95], a[216:219], a[184:187], v[92:95]
    v_or_b32 v174, v174, v111
    v_and_b32 v174, s39, v174
    v_cmp_ne_u32 vcc, 0, v174
    v_mfma_f32_16x16x32_bf16 v[92:95], a[220:223], a[188:191], v[92:95]
    v_add_u32 v3, s32, v2
    s_cbranch_vccnz KB_SL16
KB_SL16R:
    s_waitcnt vmcnt(8)
    v_cmp_ne_u32 vcc, s70, v14
    s_nop 0
    s_cbranch_vccnz T_SPA
T_SPAR:
    s_waitcnt vmcnt(16) lgkmcnt(0)
    v_mfma_f32_16x16x32_bf16 a[0:3], a[224:227], v[96:99], a[0:3]
    s_barrier
    v_exp_f32 v160, v64
    v_mfma_f32_16x16x32_bf16 a[16:19], a[224:227], v[100:103], a[16:19]
    v_exp_f32 v161, v65
    v_mfma_f32_16x16x32_bf16 a[4:7], a[228:231], v[96:99], a[4:7]
    ds_read_b128 a[192:195], v3 offset:0
    s_xor_b32 s37, s64, 8192
    v_mfma_f32_16x16x32_bf16 a[20:23], a[228:231], v[100:103], a[20:23]
    v_exp_f32 v162, v66
    v_mfma_f32_16x16x32_bf16 a[8:11], a[232:235], v[96:99], a[8:11]
    buffer_load_dwordx4 v[192:195], v6, s[24:27], s37 offen sc1
    v_mfma_f32_16x16x32_bf16 a[24:27], a[232:235], v[100:103], a[24:27]
    ds_read_b128 a[196:199], v3 offset:1024
    v_cvt_pk_bf16_f32 v112, v160, v161
    v_mfma_f32_16x16x32_bf16 a[12:15], a[236:239], v[96:99], a[12:15]
    v_exp_f32 v163, v67
    v_mfma_f32_16x16x32_bf16 a[28:31], a[236:239], v[100:103], a[28:31]
    v_exp_f32 v164, v68
    v_mfma_f32_16x16x32_bf16 a[32:35], a[240:243], v[96:99], a[32:35]
    ds_read_b128 a[200:203], v3 offset:2048
    v_cvt_pk_bf16_f32 v113, v162, v163
    v_mfma_f32_16x16x32_bf16 a[48:51], a[240:243], v[100:103], a[48:51]
    s_xor_b32 s37, s64, 139264
    v_exp_f32 v165, v69
    v_mfma_f32_16x16x32_bf16 a[36:39], a[244:247], v[96:99], a[36:39]
    v_exp_f32 v166, v70
    v_mfma_f32_16x16x32_bf16 a[52:55], a[244:247], v[100:103], a[52:55]
    ds_read_b128 a[204:207], v3 offset:3072
    v_cvt_pk_bf16_f32 v114, v164, v165
    v_mfma_f32_16x16x32_bf16 a[40:43], a[248:251], v[96:99], a[40:43]
    buffer_load_dwordx4 v[196:199], v6, s[24:27], s37 offen sc1
    v_mfma_f32_16x16x32_bf16 a[56:59], a[248:251], v[100:103], a[56:59]
    v_exp_f32 v167, v71
    v_mfma_f32_16x16x32_bf16 a[44:47], a[252:255], v[96:99], a[44:47]
    ds_read_b128 a[208:211], v3 offset:4096
    v_or3_b32 v174, v112, v113, v114
    v_mfma_f32_16x16x32_bf16 a[60:63], a[252:255], v[100:103], a[60:63]
    v_exp_f32 v160, v72
    v_mfma_f32_16x16x32_bf16 v[20:23], v[244:247], v[96:99], v[20:23]
    ds_read_b128 a[212:215], v3 offset:5120
    s_xor_b32 s37, s64, 9216
    v_cvt_pk_bf16_f32 v115, v166, v167
    v_mfma_f32_16x16x32_bf16 v[24:27], v[244:247], v[100:103], v[24:27]
    v_exp_f32 v161, v73
    v_mfma_f32_16x16x32_bf16 a[64:67], a[224:227], v[104:107], a[64:67]
    v_exp_f32 v162, v74
    v_mfma_f32_16x16x32_bf16 a[80:83], a[224:227], v[108:111], a[80:83]
    buffer_load_dwordx4 v[200:203], v6, s[24:27], s37 offen sc1
    v_mfma_f32_16x16x32_bf16 a[68:71], a[228:231], v[104:107], a[68:71]
    ds_read_b128 a[216:219], v3 offset:6144
    v_cvt_pk_bf16_f32 v116, v160, v161
    v_mfma_f32_16x16x32_bf16 a[84:87], a[228:231], v[108:111], a[84:87]
    v_exp_f32 v163, v75
    v_mfma_f32_16x16x32_bf16 a[72:75], a[232:235], v[104:107], a[72:75]
    v_or3_b32 v174, v174, v115, v116
    v_mfma_f32_16x16x32_bf16 a[88:91], a[232:235], v[108:111], a[88:91]
    v_exp_f32 v164, v76
    v_mfma_f32_16x16x32_bf16 a[76:79], a[236:239], v[104:107], a[76:79]
    ds_read_b128 a[220:223], v3 offset:7168
    v_cvt_pk_bf16_f32 v117, v162, v163
    v_mfma_f32_16x16x32_bf16 a[92:95], a[236:239], v[108:111], a[92:95]
    s_xor_b32 s37, s64, 140288
    v_exp_f32 v165, v77
    v_mfma_f32_16x16x32_bf16 a[96:99], a[240:243], v[104:107], a[96:99]
    v_exp_f32 v166, v78
    v_mfma_f32_16x16x32_bf16 a[112:115], a[240:243], v[108:111], a[112:115]
    buffer_load_dwordx4 v[204:207], v6, s[24:27], s37 offen sc1
    v_mfma_f32_16x16x32_bf16 a[100:103], a[244:247], v[104:107], a[100:103]
    v_cvt_pk_bf16_f32 v118, v164, v165
    v_mfma_f32_16x16x32_bf16 a[116:119], a[244:247], v[108:111], a[116:119]
    v_exp_f32 v167, v79
    v_mfma_f32_16x16x32_bf16 a[104:107], a[248:251], v[104:107], a[104:107]
    v_or3_b32 v174, v174, v117, v118
    v_cvt_pk_bf16_f32 v119, v166, v167
    v_mfma_f32_16x16x32_bf16 a[120:123], a[248:251], v[108:111], a[120:123]
    v_or_b32 v174, v174, v119
    v_and_b32 v174, s39, v174
    v_mfma_f32_16x16x32_bf16 a[108:111], a[252:255], v[104:107], a[108:111]
    v_cmp_ne_u32 vcc, 0, v174
    v_mfma_f32_16x16x32_bf16 a[124:127], a[252:255], v[108:111], a[124:127]
    v_mfma_f32_16x16x32_bf16 v[28:31], v[244:247], v[104:107], v[28:31]
    v_mfma_f32_16x16x32_bf16 v[168:171], v[244:247], v[108:111], v[168:171]
    s_cbranch_vccnz KB_SL17
KB_SL17R:
    s_waitcnt lgkmcnt(0)
    v_mfma_f32_16x16x32_bf16 v[32:35], a[192:195], a[128:131], v[128:131]
    ds_read_b128 a[224:227], v3 offset:16384
    v_mfma_f32_16x16x32_bf16 v[32:35], a[196:199], a[132:135], v[32:35]
    s_xor_b32 s37, s64, 10240
    v_exp_f32 v160, v80
    v_mfma_f32_16x16x32_bf16 v[32:35], a[200:203], a[136:139], v[32:35]
    v_exp_f32 v161, v81
    v_mfma_f32_16x16x32_bf16 v[32:35], a[204:207], a[140:143], v[32:35]
    buffer_load_dwordx4 v[208:211], v6, s[24:27], s37 offen sc1
    v_mfma_f32_16x16x32_bf16 v[36:39], a[208:211], a[128:131], v[128:131]
    v_exp_f32 v162, v82
    v_mfma_f32_16x16x32_bf16 v[36:39], a[212:215], a[132:135], v[36:39]
    ds_read_b128 a[228:231], v3 offset:17408
    v_cvt_pk_bf16_f32 v120, v160, v161
    v_mfma_f32_16x16x32_bf16 v[36:39], a[216:219], a[136:139], v[36:39]
    s_xor_b32 s37, s64, 141312
    v_exp_f32 v163, v83
    v_mfma_f32_16x16x32_bf16 v[36:39], a[220:223], a[140:143], v[36:39]
    ds_read_b128 a[232:235], v3 offset:18432
    ds_read_b128 a[236:239], v3 offset:19456
    v_mfma_f32_16x16x32_bf16 v[40:43], a[192:195], a[144:147], v[132:135]
    v_exp_f32 v164, v84
    v_mfma_f32_16x16x32_bf16 v[40:43], a[196:199], a[148:151], v[40:43]
    v_cvt_pk_bf16_f32 v121, v162, v163
    v_mfma_f32_16x16x32_bf16 v[40:43], a[200:203], a[152:155], v[40:43]
    v_exp_f32 v165, v85
    v_mfma_f32_16x16x32_bf16 v[40:43], a[204:207], a[156:159], v[40:43]
    buffer_load_dwordx4 v[212:215], v6, s[24:27], s37 offen sc1
    v_mfma_f32_16x16x32_bf16 v[44:47], a[208:211], a[144:147], v[132:135]
    s_xor_b32 s37, s64, 11264
    v_exp_f32 v166, v86
    v_mfma_f32_16x16x32_bf16 v[44:47], a[212:215], a[148:151], v[44:47]
    ds_read_b128 a[240:243], v3 offset:20480
    v_cvt_pk_bf16_f32 v122, v164, v165
    v_mfma_f32_16x16x32_bf16 v[44:47], a[216:219], a[152:155], v[44:47]
    v_exp_f32 v167, v87
    v_mfma_f32_16x16x32_bf16 v[44:47], a[220:223], a[156:159], v[44:47]
    ds_read_b128 a[244:247], v3 offset:21504
    v_or3_b32 v174, v120, v121, v122
    v_mfma_f32_16x16x32_bf16 v[48:51], a[192:195], a[160:163], v[136:139]
    v_exp_f32 v160, v88
    v_mfma_f32_16x16x32_bf16 v[48:51], a[196:199], a[164:167], v[48:51]
    ds_read_b128 a[248:251], v3 offset:22528
    v_cvt_pk_bf16_f32 v123, v166, v167
    v_mfma_f32_16x16x32_bf16 v[48:51], a[200:203], a[168:171], v[48:51]
    buffer_load_dwordx4 v[216:219], v6, s[24:27], s37 offen sc1
    v_exp_f32 v161, v89
    v_mfma_f32_16x16x32_bf16 v[48:51], a[204:207], a[172:175], v[48:51]
    s_xor_b32 s37, s64, 142336
    v_exp_f32 v162, v90
    v_mfma_f32_16x16x32_bf16 v[52:55], a[208:211], a[160:163], v[136:139]
    ds_read_b128 a[252:255], v3 offset:23552
    v_cvt_pk_bf16_f32 v124, v160, v161
    v_mfma_f32_16x16x32_bf16 v[52:55], a[212:215], a[164:167], v[52:55]
    v_exp_f32 v163, v91
    v_mfma_f32_16x16x32_bf16 v[52:55], a[216:219], a[168:171], v[52:55]
    v_or3_b32 v174, v174, v123, v124
    v_mfma_f32_16x16x32_bf16 v[52:55], a[220:223], a[172:175], v[52:55]
    v_exp_f32 v164, v92
    v_mfma_f32_16x16x32_bf16 v[56:59], a[192:195], a[176:179], v[140:143]
    buffer_load_dwordx4 v[220:223], v6, s[24:27], s37 offen sc1
    v_mfma_f32_16x16x32_bf16 v[56:59], a[196:199], a[180:183], v[56:59]
    v_cvt_pk_bf16_f32 v125, v162, v163
    v_exp_f32 v165, v93
    v_mfma_f32_16x16x32_bf16 v[56:59], a[200:203], a[184:187], v[56:59]
    s_add_u32 m0, s32, s33
    v_exp_f32 v166, v94
    v_mfma_f32_16x16x32_bf16 v[56:59], a[204:207], a[188:191], v[56:59]
    s_add_u32 s32, s32, 32768
    s_and_b32 s32, s32, 0x1ffff
    v_cvt_pk_bf16_f32 v126, v164, v165
    v_mfma_f32_16x16x32_bf16 v[60:63], a[208:211], a[176:179], v[140:143]
    v_exp_f32 v167, v95
    v_mfma_f32_16x16x32_bf16 v[60:63], a[212:215], a[180:183], v[60:63]
    v_or3_b32 v174, v174, v125, v126
    v_cvt_pk_bf16_f32 v127, v166, v167
    v_mfma_f32_16x16x32_bf16 v[60:63], a[216:219], a[184:187], v[60:63]
    v_or_b32 v174, v174, v127
    v_and_b32 v174, s39, v174
    v_cmp_ne_u32 vcc, 0, v174
    v_mfma_f32_16x16x32_bf16 v[60:63], a[220:223], a[188:191], v[60:63]
    v_add_u32 v3, s32, v2
    s_cbranch_vccnz KB_SL18
KB_SL18R:
    s_waitcnt vmcnt(16) lgkmcnt(0)
    v_mfma_f32_16x16x32_bf16 a[0:3], a[224:227], v[112:115], a[0:3]
    s_barrier
    v_cmp_le_i32 s[50:51], 0, v9
    v_cmp_le_i32 s[52:53], 1, v9
    v_mfma_f32_16x16x32_bf16 a[16:19], a[224:227], v[116:119], a[16:19]
    v_cmp_le_i32 s[54:55], 2, v9
    v_cmp_le_i32 s[56:57], 3, v9
    v_mfma_f32_16x16x32_bf16 a[4:7], a[228:231], v[112:115], a[4:7]
    ds_read_b128 a[192:195], v3 offset:0
    v_cndmask_b32 v32, v11, v32, s[50:51]
    v_mfma_f32_16x16x32_bf16 a[20:23], a[228:231], v[116:119], a[20:23]
    s_add_u32 s77, m0, s33
    v_exp_f32 v160, v32
    v_mfma_f32_16x16x32_bf16 a[8:11], a[232:235], v[112:115], a[8:11]
    s_mov_b32 m0, s77
    v_cmp_le_i32 s[50:51], 16, v9
    v_cndmask_b32 v33, v11, v33, s[52:53]
    v_mfma_f32_16x16x32_bf16 a[24:27], a[232:235], v[116:119], a[24:27]
    s_xor_b32 s49, s60, 0
    v_exp_f32 v161, v33
    v_mfma_f32_16x16x32_bf16 a[12:15], a[236:239], v[112:115], a[12:15]
    buffer_load_dwordx4 v16, s[20:23], s49 offen lds
    v_mfma_f32_16x16x32_bf16 a[28:31], a[236:239], v[116:119], a[28:31]
    ds_read_b128 a[196:199], v3 offset:1024
    v_cmp_le_i32 s[52:53], 17, v9
    v_mfma_f32_16x16x32_bf16 a[32:35], a[240:243], v[112:115], a[32:35]
    v_cndmask_b32 v34, v11, v34, s[54:55]
    v_exp_f32 v162, v34
    v_mfma_f32_16x16x32_bf16 a[48:51], a[240:243], v[116:119], a[48:51]
    buffer_load_dwordx4 v17, s[20:23], s49 offen offset:1024 lds
    v_cvt_pk_bf16_f32 v96, v160, v161
    v_mfma_f32_16x16x32_bf16 a[36:39], a[244:247], v[112:115], a[36:39]
    v_cmp_le_i32 s[54:55], 18, v9
    v_cndmask_b32 v35, v11, v35, s[56:57]
    v_mfma_f32_16x16x32_bf16 a[52:55], a[244:247], v[116:119], a[52:55]
    ds_read_b128 a[200:203], v3 offset:2048
    v_exp_f32 v163, v35
    v_cmp_le_i32 s[56:57], 19, v9
    v_mfma_f32_16x16x32_bf16 a[40:43], a[248:251], v[112:115], a[40:43]
    buffer_load_dwordx4 v18, s[20:23], s49 offen offset:2048 lds
    v_cndmask_b32 v36, v11, v36, s[50:51]
    v_exp_f32 v164, v36
    v_mfma_f32_16x16x32_bf16 a[56:59], a[248:251], v[116:119], a[56:59]
    v_cvt_pk_bf16_f32 v97, v162, v163
    v_cmp_le_i32 s[50:51], -16, v9
    v_mfma_f32_16x16x32_bf16 a[44:47], a[252:255], v[112:115], a[44:47]
    ds_read_b128 a[204:207], v3 offset:3072
    buffer_load_dwordx4 v19, s[20:23], s49 offen offset:3072 lds
    v_cndmask_b32 v37, v11, v37, s[52:53]
    v_mfma_f32_16x16x32_bf16 a[60:63], a[252:255], v[116:119], a[60:63]
    s_xor_b32 s37, s64, 12288
    v_exp_f32 v165, v37
    v_mfma_f32_16x16x32_bf16 v[20:23], v[244:247], v[112:115], v[20:23]
    v_cmp_le_i32 s[52:53], -15, v9
    v_cndmask_b32 v38, v11, v38, s[54:55]
    v_exp_f32 v166, v38
    v_mfma_f32_16x16x32_bf16 v[24:27], v[244:247], v[116:119], v[24:27]
    ds_read_b128 a[208:211], v3 offset:4096
    v_cvt_pk_bf16_f32 v98, v164, v165
    v_mfma_f32_16x16x32_bf16 a[64:67], a[224:227], v[120:123], a[64:67]
    buffer_load_dwordx4 v[224:227], v6, s[24:27], s37 offen sc1
    v_cmp_le_i32 s[54:55], -14, v9
    v_cndmask_b32 v39, v11, v39, s[56:57]
    v_mfma_f32_16x16x32_bf16 a[80:83], a[224:227], v[124:127], a[80:83]
    s_xor_b32 s37, s64, 143360
    v_exp_f32 v167, v39
    v_mfma_f32_16x16x32_bf16 a[68:71], a[228:231], v[120:123], a[68:71]
    v_or3_b32 v174, v96, v97, v98
    v_cmp_le_i32 s[56:57], -13, v9
    v_cndmask_b32 v40, v11, v40, s[50:51]
    v_mfma_f32_16x16x32_bf16 a[84:87], a[228:231], v[124:127], a[84:87]
    ds_read_b128 a[212:215], v3 offset:5120
    buffer_load_dwordx4 v[228:231], v6, s[24:27], s37 offen sc1
    v_exp_f32 v160, v40
    v_mfma_f32_16x16x32_bf16 a[72:75], a[232:235], v[120:123], a[72:75]
    s_add_u32 m0, s77, 4096
    v_cvt_pk_bf16_f32 v99, v166, v167
    v_cmp_le_i32 s[50:51], 0, v9
    v_mfma_f32_16x16x32_bf16 a[88:91], a[232:235], v[124:127], a[88:91]
    v_cndmask_b32 v41, v11, v41, s[52:53]
    v_exp_f32 v161, v41
    v_mfma_f32_16x16x32_bf16 a[76:79], a[236:239], v[120:123], a[76:79]
    ds_read_b128 a[216:219], v3 offset:6144
    s_xor_b32 s49, s60, 32768
    v_cmp_le_i32 s[52:53], 1, v9
    v_cndmask_b32 v42, v11, v42, s[54:55]
    v_mfma_f32_16x16x32_bf16 a[92:95], a[236:239], v[124:127], a[92:95]
    buffer_load_dwordx4 v16, s[20:23], s49 offen lds
    v_exp_f32 v162, v42
    v_mfma_f32_16x16x32_bf16 a[96:99], a[240:243], v[120:123], a[96:99]
    v_cvt_pk_bf16_f32 v100, v160, v161
    v_cmp_le_i32 s[54:55], 2, v9
    v_mfma_f32_16x16x32_bf16 a[112:115], a[240:243], v[124:127], a[112:115]
    ds_read_b128 a[220:223], v3 offset:7168
    v_cndmask_b32 v43, v11, v43, s[56:57]
    v_exp_f32 v163, v43
    v_mfma_f32_16x16x32_bf16 a[100:103], a[244:247], v[120:123], a[100:103]
    buffer_load_dwordx4 v17, s[20:23], s49 offen offset:1024 lds
    v_or3_b32 v174, v174, v99, v100
    v_mfma_f32_16x16x32_bf16 a[116:119], a[244:247], v[124:127], a[116:119]
    v_cmp_le_i32 s[56:57], 3, v9
    v_cndmask_b32 v44, v11, v44, s[50:51]
    v_exp_f32 v164, v44
    v_mfma_f32_16x16x32_bf16 a[104:107], a[248:251], v[120:123], a[104:107]
    buffer_load_dwordx4 v18, s[20:23], s49 offen offset:2048 lds
    v_cvt_pk_bf16_f32 v101, v162, v163
    v_mfma_f32_16x16x32_bf16 a[120:123], a[248:251], v[124:127], a[120:123]
    v_cndmask_b32 v45, v11, v45, s[52:53]
    v_exp_f32 v165, v45
    v_mfma_f32_16x16x32_bf16 a[108:111], a[252:255], v[120:123], a[108:111]
    v_cndmask_b32 v46, v11, v46, s[54:55]
    v_mfma_f32_16x16x32_bf16 a[124:127], a[252:255], v[124:127], a[124:127]
    buffer_load_dwordx4 v19, s[20:23], s49 offen offset:3072 lds
    v_exp_f32 v166, v46
    v_cvt_pk_bf16_f32 v102, v164, v165
    v_mfma_f32_16x16x32_bf16 v[28:31], v[244:247], v[120:123], v[28:31]
    v_cndmask_b32 v47, v11, v47, s[56:57]
    v_exp_f32 v167, v47
    v_or3_b32 v174, v174, v101, v102
    v_cvt_pk_bf16_f32 v103, v166, v167
    v_or_b32 v174, v174, v103
    v_and_b32 v174, s39, v174
    v_cmp_ne_u32 vcc, 0, v174
    v_mfma_f32_16x16x32_bf16 v[168:171], v[244:247], v[124:127], v[168:171]
    s_xor_b32 s37, s64, 13312
    buffer_load_dwordx4 v[232:235], v6, s[24:27], s37 offen sc1
    s_cbranch_vccnz KB_SL19
KB_SL19R:
    s_waitcnt lgkmcnt(0)
    v_mfma_f32_16x16x32_bf16 v[80:83], a[192:195], a[160:163], v[136:139]
    ds_read_b128 a[224:227], v3 offset:16384
    ds_read_b128 a[228:231], v3 offset:17408
    v_mfma_f32_16x16x32_bf16 v[80:83], a[196:199], a[164:167], v[80:83]
    s_xor_b32 s37, s64, 144384
    v_exp_f32 v160, v48
    v_mfma_f32_16x16x32_bf16 v[80:83], a[200:203], a[168:171], v[80:83]
    v_exp_f32 v161, v49
    v_mfma_f32_16x16x32_bf16 v[80:83], a[204:207], a[172:175], v[80:83]
    v_exp_f32 v162, v50
    v_mfma_f32_16x16x32_bf16 v[84:87], a[208:211], a[160:163], v[136:139]
    ds_read_b128 a[232:235], v3 offset:18432
    buffer_load_dwordx4 v[236:239], v6, s[24:27], s37 offen sc1
    v_cvt_pk_bf16_f32 v104, v160, v161
    v_mfma_f32_16x16x32_bf16 v[84:87], a[212:215], a[164:167], v[84:87]
    ds_read_b128 a[236:239], v3 offset:19456
    v_exp_f32 v163, v51
    v_exp_f32 v164, v52
    v_mfma_f32_16x16x32_bf16 v[84:87], a[216:219], a[168:171], v[84:87]
    ds_read_b128 a[240:243], v3 offset:20480
    v_cvt_pk_bf16_f32 v105, v162, v163
    v_exp_f32 v165, v53
    v_mfma_f32_16x16x32_bf16 v[84:87], a[220:223], a[172:175], v[84:87]
    ds_read_b128 a[244:247], v3 offset:21504
    ds_read_b128 a[248:251], v3 offset:22528
    ds_read_b128 a[252:255], v3 offset:23552
    s_lshl_b32 s48, s14, 13
    s_add_u32 m0, s48, 131072
    v_exp_f32 v166, v54
    v_mfma_f32_16x16x32_bf16 v[88:91], a[192:195], a[176:179], v[140:143]
    s_xor_b32 s49, s60, 65536
    v_cvt_pk_bf16_f32 v106, v164, v165
    v_exp_f32 v167, v55
    v_mfma_f32_16x16x32_bf16 v[88:91], a[196:199], a[180:183], v[88:91]
    buffer_load_dwordx4 v16, s[20:23], s49 offen lds
    v_or3_b32 v174, v104, v105, v106
    v_exp_f32 v160, v56
    v_mfma_f32_16x16x32_bf16 v[88:91], a[200:203], a[184:187], v[88:91]
    v_cvt_pk_bf16_f32 v107, v166, v167
    v_exp_f32 v161, v57
    v_mfma_f32_16x16x32_bf16 v[88:91], a[204:207], a[188:191], v[88:91]
    buffer_load_dwordx4 v17, s[20:23], s49 offen offset:1024 lds
    v_exp_f32 v162, v58
    v_cvt_pk_bf16_f32 v108, v160, v161
    v_mfma_f32_16x16x32_bf16 v[92:95], a[208:211], a[176:179], v[140:143]
    s_add_u32 s32, s32, 32768
    v_exp_f32 v163, v59
    v_or3_b32 v174, v174, v107, v108
    v_mfma_f32_16x16x32_bf16 v[92:95], a[212:215], a[180:183], v[92:95]
    v_exp_f32 v164, v60
    v_cvt_pk_bf16_f32 v109, v162, v163
    v_mfma_f32_16x16x32_bf16 v[92:95], a[216:219], a[184:187], v[92:95]
    buffer_load_dwordx4 v18, s[20:23], s49 offen offset:2048 lds
    s_and_b32 s32, s32, 0x1ffff
    v_exp_f32 v165, v61
    v_exp_f32 v166, v62
    v_cvt_pk_bf16_f32 v110, v164, v165
    v_exp_f32 v167, v63
    v_or3_b32 v174, v174, v109, v110
    v_cvt_pk_bf16_f32 v111, v166, v167
    v_or_b32 v174, v174, v111
    v_and_b32 v174, s39, v174
    v_cmp_ne_u32 vcc, 0, v174
    v_mfma_f32_16x16x32_bf16 v[92:95], a[220:223], a[188:191], v[92:95]
    buffer_load_dwordx4 v19, s[20:23], s49 offen offset:3072 lds
    v_add_u32 v3, s32, v2
    s_cbranch_vccnz KB_SL20
KB_SL20R:
    s_waitcnt vmcnt(24) lgkmcnt(0)
    v_mfma_f32_16x16x32_bf16 a[0:3], a[224:227], v[96:99], a[0:3]
    s_barrier
    v_cmp_le_i32 s[50:51], 0, v10
    v_cmp_le_i32 s[52:53], 1, v10
    v_mfma_f32_16x16x32_bf16 a[16:19], a[224:227], v[100:103], a[16:19]
    ds_read_b128 a[192:195], v3 offset:16384
    v_cmp_le_i32 s[54:55], 2, v10
    v_mfma_f32_16x16x32_bf16 a[4:7], a[228:231], v[96:99], a[4:7]
    v_cmp_le_i32 s[56:57], 3, v10
    v_cndmask_b32 v80, v11, v80, s[50:51]
    v_mfma_f32_16x16x32_bf16 a[20:23], a[228:231], v[100:103], a[20:23]
    v_exp_f32 v160, v80
    v_mfma_f32_16x16x32_bf16 a[8:11], a[232:235], v[96:99], a[8:11]
    s_xor_b32 s37, s64, 0
    buffer_load_dwordx4 a[128:131], v6, s[24:27], s37 offen sc1
    v_mfma_f32_16x16x32_bf16 a[24:27], a[232:235], v[100:103], a[24:27]
    ds_read_b128 a[196:199], v3 offset:17408
    v_cmp_le_i32 s[50:51], 16, v10
    v_mfma_f32_16x16x32_bf16 a[12:15], a[236:239], v[96:99], a[12:15]
    v_cndmask_b32 v81, v11, v81, s[52:53]
    v_exp_f32 v161, v81
    v_mfma_f32_16x16x32_bf16 a[28:31], a[236:239], v[100:103], a[28:31]
    ds_read_b128 a[200:203], v3 offset:18432
    s_xor_b32 s37, s64, 131072
    buffer_load_dwordx4 a[132:135], v6, s[24:27], s37 offen sc1
    v_cmp_le_i32 s[52:53], 17, v10
    v_cndmask_b32 v82, v11, v82, s[54:55]
    v_mfma_f32_16x16x32_bf16 a[32:35], a[240:243], v[96:99], a[32:35]
    v_exp_f32 v162, v82
    v_cvt_pk_bf16_f32 v120, v160, v161
    v_mfma_f32_16x16x32_bf16 a[48:51], a[240:243], v[100:103], a[48:51]
    ds_read_b128 a[204:207], v3 offset:19456
    s_xor_b32 s37, s64, 1024
    buffer_load_dwordx4 a[136:139], v6, s[24:27], s37 offen sc1
    v_cmp_le_i32 s[54:55], 18, v10
    v_cndmask_b32 v83, v11, v83, s[56:57]
    v_mfma_f32_16x16x32_bf16 a[36:39], a[244:247], v[96:99], a[36:39]
    v_exp_f32 v163, v83
    v_cmp_le_i32 s[56:57], 19, v10
    v_mfma_f32_16x16x32_bf16 a[52:55], a[244:247], v[100:103], a[52:55]
    ds_read_b128 a[208:211], v3 offset:20480
    s_xor_b32 s37, s64, 132096
    buffer_load_dwordx4 a[140:143], v6, s[24:27], s37 offen sc1
    v_cndmask_b32 v84, v11, v84, s[50:51]
    v_exp_f32 v164, v84
    v_mfma_f32_16x16x32_bf16 a[40:43], a[248:251], v[96:99], a[40:43]
    v_cvt_pk_bf16_f32 v121, v162, v163
    v_cmp_le_i32 s[50:51], -16, v10
    v_mfma_f32_16x16x32_bf16 a[56:59], a[248:251], v[100:103], a[56:59]
    ds_read_b128 a[212:215], v3 offset:21504
    s_xor_b32 s37, s64, 2048
    buffer_load_dwordx4 a[144:147], v6, s[24:27], s37 offen sc1
    v_cndmask_b32 v85, v11, v85, s[52:53]
    v_exp_f32 v165, v85
    v_mfma_f32_16x16x32_bf16 a[44:47], a[252:255], v[96:99], a[44:47]
    v_cmp_le_i32 s[52:53], -15, v10
    v_cndmask_b32 v86, v11, v86, s[54:55]
    v_mfma_f32_16x16x32_bf16 a[60:63], a[252:255], v[100:103], a[60:63]
    ds_read_b128 a[216:219], v3 offset:22528
    s_xor_b32 s37, s64, 133120
    buffer_load_dwordx4 a[148:151], v6, s[24:27], s37 offen sc1
    v_exp_f32 v166, v86
    v_mfma_f32_16x16x32_bf16 v[20:23], v[244:247], v[96:99], v[20:23]
    ds_read_b128 a[220:223], v3 offset:23552
    v_cvt_pk_bf16_f32 v122, v164, v165
    v_cmp_le_i32 s[54:55], -14, v10
    v_cndmask_b32 v87, v11, v87, s[56:57]
    v_mfma_f32_16x16x32_bf16 v[24:27], v[244:247], v[100:103], v[24:27]
    s_xor_b32 s37, s64, 3072
    buffer_load_dwordx4 a[152:155], v6, s[24:27], s37 offen sc1
    v_exp_f32 v167, v87
    v_mfma_f32_16x16x32_bf16 a[64:67], a[224:227], v[104:107], a[64:67]
    v_or3_b32 v174, v120, v121, v122
    v_cmp_le_i32 s[56:57], -13, v10
    v_cndmask_b32 v88, v11, v88, s[50:51]
    v_mfma_f32_16x16x32_bf16 a[80:83], a[224:227], v[108:111], a[80:83]
    s_xor_b32 s37, s64, 134144
    buffer_load_dwordx4 a[156:159], v6, s[24:27], s37 offen sc1
    v_exp_f32 v160, v88
    v_mfma_f32_16x16x32_bf16 a[68:71], a[228:231], v[104:107], a[68:71]
    v_cvt_pk_bf16_f32 v123, v166, v167
    v_cmp_le_i32 s[50:51], 0, v10
    v_cndmask_b32 v89, v11, v89, s[52:53]
    v_mfma_f32_16x16x32_bf16 a[84:87], a[228:231], v[108:111], a[84:87]
    s_xor_b32 s37, s64, 4096
    buffer_load_dwordx4 a[160:163], v6, s[24:27], s37 offen sc1
    v_exp_f32 v161, v89
    v_mfma_f32_16x16x32_bf16 a[72:75], a[232:235], v[104:107], a[72:75]
    v_cmp_le_i32 s[52:53], 1, v10
    v_cndmask_b32 v90, v11, v90, s[54:55]
    v_exp_f32 v162, v90
    v_mfma_f32_16x16x32_bf16 a[88:91], a[232:235], v[108:111], a[88:91]
    s_sub_u32 s38, s32, 32768
    v_cvt_pk_bf16_f32 v124, v160, v161
    v_cmp_le_i32 s[54:55], 2, v10
    v_mfma_f32_16x16x32_bf16 a[76:79], a[236:239], v[104:107], a[76:79]
    s_and_b32 s38, s38, 0x1ffff
    s_sub_u32 s38, s38, 131072
    s_xor_b32 s37, s64, 135168
    buffer_load_dwordx4 a[164:167], v6, s[24:27], s37 offen sc1
    v_cndmask_b32 v91, v11, v91, s[56:57]
    v_exp_f32 v163, v91
    v_add_u32 v189, s38, v7
    v_mfma_f32_16x16x32_bf16 a[92:95], a[236:239], v[108:111], a[92:95]
    v_or3_b32 v174, v174, v123, v124
    v_add_u32 v191, s32, v5
    v_xor_b32 v188, 0x10000, v189
    v_mfma_f32_16x16x32_bf16 a[96:99], a[240:243], v[104:107], a[96:99]
    ds_write_b128 v188, a[32:35] offset:0
    s_xor_b32 s37, s64, 5120
    buffer_load_dwordx4 a[168:171], v6, s[24:27], s37 offen sc1
    v_cmp_le_i32 s[56:57], 3, v10
    v_cndmask_b32 v92, v11, v92, s[50:51]
    v_exp_f32 v164, v92
    v_mfma_f32_16x16x32_bf16 a[112:115], a[240:243], v[108:111], a[112:115]
    ds_write_b128 v188, a[36:39] offset:1024
    v_cvt_pk_bf16_f32 v125, v162, v163
    v_mfma_f32_16x16x32_bf16 a[100:103], a[244:247], v[104:107], a[100:103]
    s_xor_b32 s37, s64, 136192
    buffer_load_dwordx4 a[172:175], v6, s[24:27], s37 offen sc1
    v_cndmask_b32 v93, v11, v93, s[52:53]
    v_exp_f32 v165, v93
    v_mfma_f32_16x16x32_bf16 a[116:119], a[244:247], v[108:111], a[116:119]
    ds_write_b128 v188, a[40:43] offset:2048
    v_cndmask_b32 v94, v11, v94, s[54:55]
    v_exp_f32 v166, v94
    v_mfma_f32_16x16x32_bf16 a[104:107], a[248:251], v[104:107], a[104:107]
    s_xor_b32 s37, s64, 6144
    buffer_load_dwordx4 a[176:179], v6, s[24:27], s37 offen sc1
    v_cvt_pk_bf16_f32 v126, v164, v165
    v_cndmask_b32 v95, v11, v95, s[56:57]
    v_exp_f32 v167, v95
    v_or3_b32 v174, v174, v125, v126
    v_cvt_pk_bf16_f32 v127, v166, v167
    v_or_b32 v174, v174, v127
    v_and_b32 v174, s39, v174
    v_cmp_ne_u32 vcc, 0, v174
    v_mfma_f32_16x16x32_bf16 a[120:123], a[248:251], v[108:111], a[120:123]
    ds_write_b128 v188, a[44:47] offset:3072
    v_mfma_f32_16x16x32_bf16 a[108:111], a[252:255], v[104:107], a[108:111]
    ds_write_b128 v188, a[48:51] offset:4096
    s_xor_b32 s37, s64, 137216
    buffer_load_dwordx4 a[180:183], v6, s[24:27], s37 offen sc1
    v_mfma_f32_16x16x32_bf16 a[124:127], a[252:255], v[108:111], a[124:127]
    ds_write_b128 v188, a[52:55] offset:5120
    v_mfma_f32_16x16x32_bf16 v[28:31], v[244:247], v[104:107], v[28:31]
    s_xor_b32 s37, s64, 7168
    buffer_load_dwordx4 a[184:187], v6, s[24:27], s37 offen sc1
    v_mfma_f32_16x16x32_bf16 v[168:171], v[244:247], v[108:111], v[168:171]
    ds_write_b128 v188, a[56:59] offset:6144
    ds_write_b128 v188, a[60:63] offset:7168
    s_xor_b32 s37, s64, 138240
    buffer_load_dwordx4 a[188:191], v6, s[24:27], s37 offen sc1
    s_cbranch_vccnz KB_SL21
KB_SL21R:
    s_waitcnt lgkmcnt(8)
    v_mfma_f32_16x16x32_bf16 v[28:31], v[244:247], v[120:123], v[28:31]
    v_mfma_f32_16x16x32_bf16 v[168:171], v[244:247], v[124:127], v[168:171]
    v_mfma_f32_16x16x32_bf16 a[96:99], a[208:211], v[120:123], a[96:99]
    v_mfma_f32_16x16x32_bf16 a[112:115], a[208:211], v[124:127], a[112:115]
    v_mfma_f32_16x16x32_bf16 a[100:103], a[212:215], v[120:123], a[100:103]
    v_mfma_f32_16x16x32_bf16 a[116:119], a[212:215], v[124:127], a[116:119]
    v_mov_b32 v144, v128
    v_mov_b32 v146, v132
    v_mov_b32 v148, v136
    v_mfma_f32_16x16x32_bf16 a[104:107], a[216:219], v[120:123], a[104:107]
    v_mov_b32 v150, v140
    v_mov_b32 v145, v20
    v_mfma_f32_16x16x32_bf16 a[120:123], a[216:219], v[124:127], a[120:123]
    v_mov_b32 v147, v24
    v_mov_b32 v149, v28
    v_mfma_f32_16x16x32_bf16 a[108:111], a[220:223], v[120:123], a[108:111]
    v_mov_b32 v151, v168
    v_mfma_f32_16x16x32_bf16 a[124:127], a[220:223], v[124:127], a[124:127]
    ds_write_b128 v191, v[144:147] offset:0
    v_mfma_f32_16x16x32_bf16 a[64:67], a[192:195], v[120:123], a[64:67]
    v_mfma_f32_16x16x32_bf16 a[80:83], a[192:195], v[124:127], a[80:83]
    ds_write_b128 v191, v[148:151] offset:1024
    v_mfma_f32_16x16x32_bf16 a[68:71], a[196:199], v[120:123], a[68:71]
    v_mfma_f32_16x16x32_bf16 a[84:87], a[196:199], v[124:127], a[84:87]
    v_mfma_f32_16x16x32_bf16 a[72:75], a[200:203], v[120:123], a[72:75]
    ds_write_b128 v189, a[96:99] offset:0
    v_mfma_f32_16x16x32_bf16 a[88:91], a[200:203], v[124:127], a[88:91]
    ds_write_b128 v189, a[100:103] offset:1024
    v_mfma_f32_16x16x32_bf16 a[76:79], a[204:207], v[120:123], a[76:79]
    ds_write_b128 v189, a[104:107] offset:2048
    v_mfma_f32_16x16x32_bf16 a[92:95], a[204:207], v[124:127], a[92:95]
    ds_write_b128 v189, a[108:111] offset:3072
    ds_write_b128 v189, a[112:115] offset:4096
    ds_write_b128 v189, a[116:119] offset:5120
    ds_write_b128 v189, a[120:123] offset:6144
    ds_write_b128 v189, a[124:127] offset:7168
    v_accvgpr_read_b32 v32, a0
    v_accvgpr_read_b32 v33, a1
    v_accvgpr_read_b32 v34, a2
    v_accvgpr_read_b32 v35, a3
    v_accvgpr_read_b32 v36, a4
    v_accvgpr_read_b32 v37, a5
    v_accvgpr_read_b32 v38, a6
    v_accvgpr_read_b32 v39, a7
    v_accvgpr_read_b32 v40, a8
    v_accvgpr_read_b32 v41, a9
    v_accvgpr_read_b32 v42, a10
    v_accvgpr_read_b32 v43, a11
    v_accvgpr_read_b32 v44, a12
    v_accvgpr_read_b32 v45, a13
    v_accvgpr_read_b32 v46, a14
    v_accvgpr_read_b32 v47, a15
    v_accvgpr_read_b32 v48, a16
    v_accvgpr_read_b32 v49, a17
    v_accvgpr_read_b32 v50, a18
    v_accvgpr_read_b32 v51, a19
    v_accvgpr_read_b32 v52, a20
    v_accvgpr_read_b32 v53, a21
    v_accvgpr_read_b32 v54, a22
    v_accvgpr_read_b32 v55, a23
    v_accvgpr_read_b32 v56, a24
    v_accvgpr_read_b32 v57, a25
    v_accvgpr_read_b32 v58, a26
    v_accvgpr_read_b32 v59, a27
    v_accvgpr_read_b32 v60, a28
    v_accvgpr_read_b32 v61, a29
    v_accvgpr_read_b32 v62, a30
    v_accvgpr_read_b32 v63, a31
    v_xor_b32 v189, 0x2000, v189
    v_xor_b32 v191, 0x1000, v191
    v_xor_b32 v8, 0x2000, v188
    v_accvgpr_read_b32 v64, a64
    v_accvgpr_read_b32 v65, a65
    v_accvgpr_read_b32 v66, a66
    v_accvgpr_read_b32 v67, a67
    v_accvgpr_read_b32 v68, a68
    v_accvgpr_read_b32 v69, a69
    v_accvgpr_read_b32 v70, a70
    v_accvgpr_read_b32 v71, a71
    v_accvgpr_read_b32 v72, a72
    v_accvgpr_read_b32 v73, a73
    v_accvgpr_read_b32 v74, a74
    v_accvgpr_read_b32 v75, a75
    v_accvgpr_read_b32 v76, a76
    v_accvgpr_read_b32 v77, a77
    v_accvgpr_read_b32 v78, a78
    v_accvgpr_read_b32 v79, a79
    v_accvgpr_read_b32 v80, a80
    v_accvgpr_read_b32 v81, a81
    v_accvgpr_read_b32 v82, a82
    v_accvgpr_read_b32 v83, a83
    v_accvgpr_read_b32 v84, a84
    v_accvgpr_read_b32 v85, a85
    v_accvgpr_read_b32 v86, a86
    v_accvgpr_read_b32 v87, a87
    v_accvgpr_read_b32 v88, a88
    v_accvgpr_read_b32 v89, a89
    v_accvgpr_read_b32 v90, a90
    v_accvgpr_read_b32 v91, a91
    v_accvgpr_read_b32 v92, a92
    v_accvgpr_read_b32 v93, a93
    v_accvgpr_read_b32 v94, a94
    v_accvgpr_read_b32 v95, a95
    s_waitcnt vmcnt(16) lgkmcnt(0)
    s_barrier
    ds_read_b128 v[152:155], v191 offset:0
    ds_read_b128 v[156:159], v191 offset:1024
    ds_read_b128 v[128:131], v8 offset:0
    ds_read_b128 v[132:135], v8 offset:1024
    ds_read_b128 v[136:139], v8 offset:2048
    ds_read_b128 v[140:143], v8 offset:3072
    ds_read_b128 v[160:163], v8 offset:4096
    ds_read_b128 v[164:167], v8 offset:5120
    ds_read_b128 v[168:171], v8 offset:6144
    ds_read_b128 v[172:175], v8 offset:7168
    ds_read_b128 v[96:99], v189 offset:0
    ds_read_b128 v[100:103], v189 offset:1024
    ds_read_b128 v[104:107], v189 offset:2048
    ds_read_b128 v[108:111], v189 offset:3072
    ds_read_b128 v[112:115], v189 offset:4096
    s_waitcnt lgkmcnt(13)
    ds_read_b128 v[116:119], v189 offset:5120
    ds_read_b128 v[120:123], v189 offset:6144
    ds_read_b128 v[124:127], v189 offset:7168
    v_min_f32 v240, v144, v152
    v_min_f32 v241, v146, v154
    v_min_f32 v242, v148, v156
    v_min_f32 v243, v150, v158
    v_sub_f32 v180, v240, v144
    v_sub_f32 v182, v241, v146
    v_sub_f32 v184, v242, v148
    v_sub_f32 v186, v243, v150
    v_sub_f32 v181, v240, v152
    v_sub_f32 v183, v241, v154
    v_sub_f32 v185, v242, v156
    v_sub_f32 v187, v243, v158
    v_exp_f32 v180, v180
    v_exp_f32 v182, v182
    v_exp_f32 v184, v184
    v_exp_f32 v186, v186
    v_exp_f32 v181, v181
    v_exp_f32 v183, v183
    v_exp_f32 v185, v185
    v_exp_f32 v187, v187
    v_mul_f32 v240, v180, v145
    v_mul_f32 v241, v182, v147
    v_mul_f32 v242, v184, v149
    v_mul_f32 v243, v186, v151
    v_fma_f32 v240, v181, v153, v240
    v_fma_f32 v241, v183, v155, v241
    v_fma_f32 v242, v185, v157, v242
    v_fma_f32 v243, v187, v159, v243
    v_rcp_f32 v240, v240
    v_rcp_f32 v241, v241
    v_rcp_f32 v242, v242
    v_rcp_f32 v243, v243
    v_mul_f32 v180, v180, v240
    v_mul_f32 v182, v182, v241
    v_mul_f32 v184, v184, v242
    v_mul_f32 v186, v186, v243
    v_mul_f32 v181, v181, v240
    v_mul_f32 v183, v183, v241
    v_mul_f32 v185, v185, v242
    v_mul_f32 v187, v187, v243
    s_waitcnt lgkmcnt(8)
    v_pk_mul_f32 v[32:33], v[32:33], v[180:181] op_sel_hi:[1,0]
    v_pk_mul_f32 v[34:35], v[34:35], v[180:181] op_sel_hi:[1,0]
    v_pk_mul_f32 v[36:37], v[36:37], v[180:181] op_sel_hi:[1,0]
    v_pk_mul_f32 v[38:39], v[38:39], v[180:181] op_sel_hi:[1,0]
    v_pk_fma_f32 v[128:129], v[128:129], v[180:181], v[32:33] op_sel:[0,1,0] op_sel_hi:[1,1,1]
    v_pk_fma_f32 v[130:131], v[130:131], v[180:181], v[34:35] op_sel:[0,1,0] op_sel_hi:[1,1,1]
    v_pk_fma_f32 v[132:133], v[132:133], v[180:181], v[36:37] op_sel:[0,1,0] op_sel_hi:[1,1,1]
    v_pk_fma_f32 v[134:135], v[134:135], v[180:181], v[38:39] op_sel:[0,1,0] op_sel_hi:[1,1,1]
    v_cvt_pk_bf16_f32 v128, v128, v129
    v_cvt_pk_bf16_f32 v129, v130, v131
    v_cvt_pk_bf16_f32 v130, v132, v133
    v_cvt_pk_bf16_f32 v131, v134, v135
    buffer_store_dwordx4 v[128:131], v6, s[24:27], s44 offen offset:0 sc1
    v_pk_mul_f32 v[40:41], v[40:41], v[180:181] op_sel_hi:[1,0]
    v_pk_mul_f32 v[42:43], v[42:43], v[180:181] op_sel_hi:[1,0]
    v_pk_mul_f32 v[44:45], v[44:45], v[180:181] op_sel_hi:[1,0]
    v_pk_mul_f32 v[46:47], v[46:47], v[180:181] op_sel_hi:[1,0]
    v_pk_fma_f32 v[136:137], v[136:137], v[180:181], v[40:41] op_sel:[0,1,0] op_sel_hi:[1,1,1]
    v_pk_fma_f32 v[138:139], v[138:139], v[180:181], v[42:43] op_sel:[0,1,0] op_sel_hi:[1,1,1]
    v_pk_fma_f32 v[140:141], v[140:141], v[180:181], v[44:45] op_sel:[0,1,0] op_sel_hi:[1,1,1]
    v_pk_fma_f32 v[142:143], v[142:143], v[180:181], v[46:47] op_sel:[0,1,0] op_sel_hi:[1,1,1]
    v_cvt_pk_bf16_f32 v136, v136, v137
    v_cvt_pk_bf16_f32 v137, v138, v139
    v_cvt_pk_bf16_f32 v138, v140, v141
    v_cvt_pk_bf16_f32 v139, v142, v143
    buffer_store_dwordx4 v[136:139], v6, s[24:27], s44 offen offset:1024 sc1
    v_pk_mul_f32 v[48:49], v[48:49], v[182:183] op_sel_hi:[1,0]
    v_pk_mul_f32 v[50:51], v[50:51], v[182:183] op_sel_hi:[1,0]
    v_pk_mul_f32 v[52:53], v[52:53], v[182:183] op_sel_hi:[1,0]
    v_pk_mul_f32 v[54:55], v[54:55], v[182:183] op_sel_hi:[1,0]
    v_pk_fma_f32 v[160:161], v[160:161], v[182:183], v[48:49] op_sel:[0,1,0] op_sel_hi:[1,1,1]
    v_pk_fma_f32 v[162:163], v[162:163], v[182:183], v[50:51] op_sel:[0,1,0] op_sel_hi:[1,1,1]
    v_pk_fma_f32 v[164:165], v[164:165], v[182:183], v[52:53] op_sel:[0,1,0] op_sel_hi:[1,1,1]
    v_pk_fma_f32 v[166:167], v[166:167], v[182:183], v[54:55] op_sel:[0,1,0] op_sel_hi:[1,1,1]
    v_cvt_pk_bf16_f32 v160, v160, v161
    v_cvt_pk_bf16_f32 v161, v162, v163
    v_cvt_pk_bf16_f32 v162, v164, v165
    v_cvt_pk_bf16_f32 v163, v166, v167
    s_add_u32 s44, s44, 131072
    buffer_store_dwordx4 v[160:163], v6, s[24:27], s44 offen offset:0 sc1
    v_pk_mul_f32 v[56:57], v[56:57], v[182:183] op_sel_hi:[1,0]
    v_pk_mul_f32 v[58:59], v[58:59], v[182:183] op_sel_hi:[1,0]
    v_pk_mul_f32 v[60:61], v[60:61], v[182:183] op_sel_hi:[1,0]
    v_pk_mul_f32 v[62:63], v[62:63], v[182:183] op_sel_hi:[1,0]
    v_pk_fma_f32 v[168:169], v[168:169], v[182:183], v[56:57] op_sel:[0,1,0] op_sel_hi:[1,1,1]
    v_pk_fma_f32 v[170:171], v[170:171], v[182:183], v[58:59] op_sel:[0,1,0] op_sel_hi:[1,1,1]
    v_pk_fma_f32 v[172:173], v[172:173], v[182:183], v[60:61] op_sel:[0,1,0] op_sel_hi:[1,1,1]
    v_pk_fma_f32 v[174:175], v[174:175], v[182:183], v[62:63] op_sel:[0,1,0] op_sel_hi:[1,1,1]
    v_cvt_pk_bf16_f32 v168, v168, v169
    v_cvt_pk_bf16_f32 v169, v170, v171
    v_cvt_pk_bf16_f32 v170, v172, v173
    v_cvt_pk_bf16_f32 v171, v174, v175
    buffer_store_dwordx4 v[168:171], v6, s[24:27], s44 offen offset:1024 sc1
    s_waitcnt lgkmcnt(0)
    v_pk_mul_f32 v[64:65], v[64:65], v[184:185] op_sel_hi:[1,0]
    v_pk_mul_f32 v[66:67], v[66:67], v[184:185] op_sel_hi:[1,0]
    v_pk_mul_f32 v[68:69], v[68:69], v[184:185] op_sel_hi:[1,0]
    v_pk_mul_f32 v[70:71], v[70:71], v[184:185] op_sel_hi:[1,0]
    v_pk_fma_f32 v[96:97], v[96:97], v[184:185], v[64:65] op_sel:[0,1,0] op_sel_hi:[1,1,1]
    v_pk_fma_f32 v[98:99], v[98:99], v[184:185], v[66:67] op_sel:[0,1,0] op_sel_hi:[1,1,1]
    v_pk_fma_f32 v[100:101], v[100:101], v[184:185], v[68:69] op_sel:[0,1,0] op_sel_hi:[1,1,1]
    v_pk_fma_f32 v[102:103], v[102:103], v[184:185], v[70:71] op_sel:[0,1,0] op_sel_hi:[1,1,1]
    v_cvt_pk_bf16_f32 v96, v96, v97
    v_cvt_pk_bf16_f32 v97, v98, v99
    v_cvt_pk_bf16_f32 v98, v100, v101
    v_cvt_pk_bf16_f32 v99, v102, v103
    buffer_store_dwordx4 v[96:99], v6, s[24:27], s45 offen offset:0 sc1
    v_pk_mul_f32 v[72:73], v[72:73], v[184:185] op_sel_hi:[1,0]
    v_pk_mul_f32 v[74:75], v[74:75], v[184:185] op_sel_hi:[1,0]
    v_pk_mul_f32 v[76:77], v[76:77], v[184:185] op_sel_hi:[1,0]
    v_pk_mul_f32 v[78:79], v[78:79], v[184:185] op_sel_hi:[1,0]
    v_pk_fma_f32 v[104:105], v[104:105], v[184:185], v[72:73] op_sel:[0,1,0] op_sel_hi:[1,1,1]
    v_pk_fma_f32 v[106:107], v[106:107], v[184:185], v[74:75] op_sel:[0,1,0] op_sel_hi:[1,1,1]
    v_pk_fma_f32 v[108:109], v[108:109], v[184:185], v[76:77] op_sel:[0,1,0] op_sel_hi:[1,1,1]
    v_pk_fma_f32 v[110:111], v[110:111], v[184:185], v[78:79] op_sel:[0,1,0] op_sel_hi:[1,1,1]
    v_cvt_pk_bf16_f32 v104, v104, v105
    v_cvt_pk_bf16_f32 v105, v106, v107
    v_cvt_pk_bf16_f32 v106, v108, v109
    v_cvt_pk_bf16_f32 v107, v110, v111
    buffer_store_dwordx4 v[104:107], v6, s[24:27], s45 offen offset:1024 sc1
    v_pk_mul_f32 v[80:81], v[80:81], v[186:187] op_sel_hi:[1,0]
    v_pk_mul_f32 v[82:83], v[82:83], v[186:187] op_sel_hi:[1,0]
    v_pk_mul_f32 v[84:85], v[84:85], v[186:187] op_sel_hi:[1,0]
    v_pk_mul_f32 v[86:87], v[86:87], v[186:187] op_sel_hi:[1,0]
    v_pk_fma_f32 v[112:113], v[112:113], v[186:187], v[80:81] op_sel:[0,1,0] op_sel_hi:[1,1,1]
    v_pk_fma_f32 v[114:115], v[114:115], v[186:187], v[82:83] op_sel:[0,1,0] op_sel_hi:[1,1,1]
    v_pk_fma_f32 v[116:117], v[116:117], v[186:187], v[84:85] op_sel:[0,1,0] op_sel_hi:[1,1,1]
    v_pk_fma_f32 v[118:119], v[118:119], v[186:187], v[86:87] op_sel:[0,1,0] op_sel_hi:[1,1,1]
    v_cvt_pk_bf16_f32 v112, v112, v113
    v_cvt_pk_bf16_f32 v113, v114, v115
    v_cvt_pk_bf16_f32 v114, v116, v117
    v_cvt_pk_bf16_f32 v115, v118, v119
    s_add_u32 s45, s45, 131072
    buffer_store_dwordx4 v[112:115], v6, s[24:27], s45 offen offset:0 sc1
    v_pk_mul_f32 v[88:89], v[88:89], v[186:187] op_sel_hi:[1,0]
    v_pk_mul_f32 v[90:91], v[90:91], v[186:187] op_sel_hi:[1,0]
    v_pk_mul_f32 v[92:93], v[92:93], v[186:187] op_sel_hi:[1,0]
    v_pk_mul_f32 v[94:95], v[94:95], v[186:187] op_sel_hi:[1,0]
    v_pk_fma_f32 v[120:121], v[120:121], v[186:187], v[88:89] op_sel:[0,1,0] op_sel_hi:[1,1,1]
    v_pk_fma_f32 v[122:123], v[122:123], v[186:187], v[90:91] op_sel:[0,1,0] op_sel_hi:[1,1,1]
    v_pk_fma_f32 v[124:125], v[124:125], v[186:187], v[92:93] op_sel:[0,1,0] op_sel_hi:[1,1,1]
    v_pk_fma_f32 v[126:127], v[126:127], v[186:187], v[94:95] op_sel:[0,1,0] op_sel_hi:[1,1,1]
    v_cvt_pk_bf16_f32 v120, v120, v121
    v_cvt_pk_bf16_f32 v121, v122, v123
    v_cvt_pk_bf16_f32 v122, v124, v125
    v_cvt_pk_bf16_f32 v123, v126, v127
    buffer_store_dwordx4 v[120:123], v6, s[24:27], s45 offen offset:1024 sc1
    s_xor_b32 s37, s64, 14336
    buffer_load_dwordx4 v[128:131], v6, s[24:27], s37 offen sc1
    s_xor_b32 s37, s64, 145408
    buffer_load_dwordx4 v[132:135], v6, s[24:27], s37 offen sc1
    s_xor_b32 s37, s64, 15360
    buffer_load_dwordx4 v[136:139], v6, s[24:27], s37 offen sc1
    s_xor_b32 s37, s64, 146432
    buffer_load_dwordx4 v[140:143], v6, s[24:27], s37 offen sc1
    s_xor_b32 s37, s64, 16384
    buffer_load_dwordx4 v[144:147], v6, s[24:27], s37 offen sc1
    s_xor_b32 s37, s64, 147456
    buffer_load_dwordx4 v[148:151], v6, s[24:27], s37 offen sc1
    s_xor_b32 s37, s64, 17408
    buffer_load_dwordx4 v[152:155], v6, s[24:27], s37 offen sc1
    s_xor_b32 s37, s64, 148480
    buffer_load_dwordx4 v[156:159], v6, s[24:27], s37 offen sc1
    v_lshrrev_b32 v13, 2, v0
    v_lshlrev_b32 v13, 7, v13
    v_and_b32 v14, 3, v0
    v_lshl_add_u32 v13, v14, 3, v13
    v_bfe_u32 v15, v0, 3, 2
    v_xor_b32 v14, 0, v15
    v_lshl_add_u32 v20, v14, 5, v13
    v_xor_b32 v14, 1, v15
    v_lshl_add_u32 v21, v14, 5, v13
    v_xor_b32 v14, 2, v15
    v_lshl_add_u32 v22, v14, 5, v13
    v_xor_b32 v14, 3, v15
    v_lshl_add_u32 v23, v14, 5, v13
    s_lshl_b32 s48, s14, 13
    s_add_u32 s48, s48, 131072
    v_add_u32 v176, s77, v20
    v_add_u32 v180, s48, v20
    v_add_u32 v177, s77, v21
    v_add_u32 v181, s48, v21
    v_add_u32 v178, s77, v22
    v_add_u32 v182, s48, v22
    v_add_u32 v179, s77, v23
    v_add_u32 v183, s48, v23
    ds_read_b64_tr_b16 a[0:1], v176 offset:0
    ds_read_b64_tr_b16 a[2:3], v176 offset:2048
    ds_read_b64_tr_b16 a[4:5], v177 offset:0
    ds_read_b64_tr_b16 a[6:7], v177 offset:2048
    ds_read_b64_tr_b16 a[8:9], v178 offset:0
    ds_read_b64_tr_b16 a[10:11], v178 offset:2048
    ds_read_b64_tr_b16 a[12:13], v179 offset:0
    ds_read_b64_tr_b16 a[14:15], v179 offset:2048
    ds_read_b64_tr_b16 a[16:17], v176 offset:4096
    ds_read_b64_tr_b16 a[18:19], v176 offset:6144
    ds_read_b64_tr_b16 a[20:21], v177 offset:4096
    ds_read_b64_tr_b16 a[22:23], v177 offset:6144
    ds_read_b64_tr_b16 a[24:25], v178 offset:4096
    ds_read_b64_tr_b16 a[26:27], v178 offset:6144
    ds_read_b64_tr_b16 a[28:29], v179 offset:4096
    ds_read_b64_tr_b16 a[30:31], v179 offset:6144
    ds_read_b64_tr_b16 a[32:33], v180 offset:0
    ds_read_b64_tr_b16 a[34:35], v180 offset:2048
    ds_read_b64_tr_b16 a[36:37], v181 offset:0
    ds_read_b64_tr_b16 a[38:39], v181 offset:2048
    ds_read_b64_tr_b16 a[40:41], v182 offset:0
    ds_read_b64_tr_b16 a[42:43], v182 offset:2048
    ds_read_b64_tr_b16 a[44:45], v183 offset:0
    ds_read_b64_tr_b16 a[46:47], v183 offset:2048
    ds_read_b64_tr_b16 a[48:49], v180 offset:4096
    ds_read_b64_tr_b16 a[50:51], v180 offset:6144
    ds_read_b64_tr_b16 a[52:53], v181 offset:4096
    ds_read_b64_tr_b16 a[54:55], v181 offset:6144
    ds_read_b64_tr_b16 a[56:57], v182 offset:4096
    ds_read_b64_tr_b16 a[58:59], v182 offset:6144
    ds_read_b64_tr_b16 a[60:61], v183 offset:4096
    ds_read_b64_tr_b16 a[62:63], v183 offset:6144
    v_add_u32 v20, s58, v20
    v_add_u32 v21, s58, v21
    v_add_u32 v22, s58, v22
    v_add_u32 v23, s58, v23
    s_waitcnt vmcnt(8) lgkmcnt(0)
    s_barrier
    s_lshl_b32 s48, s15, 2
    s_add_u32 s48, s48, s68
    v_mov_b32 v15, s70
    buffer_store_dword v15, v1, s[24:27], s48 offen offset:768 sc1
    s_load_dwordx2 s[4:5], s[0:1], 0
    s_load_dwordx4 s[8:11], s[0:1], 56
    s_load_dwordx4 s[76:79], s[0:1], 72
    s_add_u32 m0, s58, 16384
    s_xor_b32 s49, s60, 131072
    buffer_load_dwordx4 v16, s[20:23], s49 offen lds
    buffer_load_dwordx4 v17, s[20:23], s49 offen offset:1024 lds
    buffer_load_dwordx4 v18, s[20:23], s49 offen offset:2048 lds
    buffer_load_dwordx4 v19, s[20:23], s49 offen offset:3072 lds
    s_add_u32 m0, s58, 20480
    s_xor_b32 s49, s60, 163840
    buffer_load_dwordx4 v16, s[20:23], s49 offen lds
    buffer_load_dwordx4 v17, s[20:23], s49 offen offset:1024 lds
    buffer_load_dwordx4 v18, s[20:23], s49 offen offset:2048 lds
    buffer_load_dwordx4 v19, s[20:23], s49 offen offset:3072 lds
    s_add_u32 m0, s58, 24576
    s_xor_b32 s49, s60, 196608
    buffer_load_dwordx4 v16, s[20:23], s49 offen lds
    buffer_load_dwordx4 v17, s[20:23], s49 offen offset:1024 lds
    buffer_load_dwordx4 v18, s[20:23], s49 offen offset:2048 lds
    buffer_load_dwordx4 v19, s[20:23], s49 offen offset:3072 lds
    s_add_u32 m0, s58, 28672
    s_xor_b32 s49, s60, 229376
    buffer_load_dwordx4 v16, s[20:23], s49 offen lds
    buffer_load_dwordx4 v17, s[20:23], s49 offen offset:1024 lds
    buffer_load_dwordx4 v18, s[20:23], s49 offen offset:2048 lds
    buffer_load_dwordx4 v19, s[20:23], s49 offen offset:3072 lds
    s_add_u32 m0, s58, 0
    s_xor_b32 s49, s60, 262144
    buffer_load_dwordx4 v16, s[20:23], s49 offen lds
    buffer_load_dwordx4 v17, s[20:23], s49 offen offset:1024 lds
    buffer_load_dwordx4 v18, s[20:23], s49 offen offset:2048 lds
    buffer_load_dwordx4 v19, s[20:23], s49 offen offset:3072 lds
    s_add_u32 m0, s58, 4096
    s_xor_b32 s49, s60, 294912
    buffer_load_dwordx4 v16, s[20:23], s49 offen lds
    buffer_load_dwordx4 v17, s[20:23], s49 offen offset:1024 lds
    buffer_load_dwordx4 v18, s[20:23], s49 offen offset:2048 lds
    buffer_load_dwordx4 v19, s[20:23], s49 offen offset:3072 lds
    s_add_u32 m0, s58, 8192
    s_xor_b32 s49, s60, 327680
    buffer_load_dwordx4 v16, s[20:23], s49 offen lds
    buffer_load_dwordx4 v17, s[20:23], s49 offen offset:1024 lds
    buffer_load_dwordx4 v18, s[20:23], s49 offen offset:2048 lds
    buffer_load_dwordx4 v19, s[20:23], s49 offen offset:3072 lds
    s_add_u32 m0, s58, 12288
    s_xor_b32 s49, s60, 360448
    buffer_load_dwordx4 v16, s[20:23], s49 offen lds
    buffer_load_dwordx4 v17, s[20:23], s49 offen offset:1024 lds
    buffer_load_dwordx4 v18, s[20:23], s49 offen offset:2048 lds
    buffer_load_dwordx4 v19, s[20:23], s49 offen offset:3072 lds
    s_xor_b32 s37, s64, 18432
    buffer_load_dwordx4 v[160:163], v6, s[24:27], s37 offen sc1
    s_xor_b32 s37, s64, 149504
    buffer_load_dwordx4 v[164:167], v6, s[24:27], s37 offen sc1
    s_xor_b32 s37, s64, 19456
    buffer_load_dwordx4 v[168:171], v6, s[24:27], s37 offen sc1
    s_xor_b32 s37, s64, 150528
    buffer_load_dwordx4 v[172:175], v6, s[24:27], s37 offen sc1
    s_xor_b32 s37, s64, 20480
    buffer_load_dwordx4 v[176:179], v6, s[24:27], s37 offen sc1
    s_xor_b32 s37, s64, 151552
    buffer_load_dwordx4 v[180:183], v6, s[24:27], s37 offen sc1
    s_xor_b32 s37, s64, 21504
    buffer_load_dwordx4 v[184:187], v6, s[24:27], s37 offen sc1
    s_xor_b32 s37, s64, 152576
    buffer_load_dwordx4 v[188:191], v6, s[24:27], s37 offen sc1
    v_add_u32 v5, s58, v6
    s_lshl_b32 s37, s14, 11
    v_add_u32 v7, s37, v6
    v_add_u32 v2, 0x10000, v7
    v_and_b32 v4, 15, v0
    v_bfe_u32 v13, v0, 4, 1
    v_lshrrev_b32 v14, 5, v0
    v_lshl_add_u32 v13, v13, 1, v14
    v_lshlrev_b32 v13, 4, v13
    v_lshl_add_u32 v3, v4, 10, v13
    v_lshrrev_b32 v13, 4, v0
    v_lshl_add_u32 v4, v13, 28, v6
    s_sub_u32 s37, s74, s73
    s_lshl_b32 s37, s37, 18
    s_add_u32 s44, s64, s37
    s_add_u32 s45, s65, s37
    s_add_u32 s46, s66, s37
    s_add_u32 s47, s67, s37
    s_and_b32 s37, s14, 1
    s_lshl_b32 s38, s59, 1
    s_add_u32 s37, s37, s38
    s_lshr_b32 s38, s14, 1
    s_lshl_b32 s72, s73, 1
    s_add_u32 s72, s72, s38
    s_lshl_b32 s50, s72, 14
    s_lshl_b32 s72, s72, 12
    s_lshl_b32 s38, s37, 8
    s_add_u32 s72, s72, s38
    s_add_u32 s72, s72, 4194304
    s_lshl_b32 s51, s37, 10
    s_add_u32 s51, s51, s50
    s_add_u32 s51, s51, 2097152
    s_lshl_b32 s37, s37, 6
    s_add_u32 s50, s50, s37
    s_sub_u32 s37, s74, s73
    s_lshl_b32 s37, s37, 15
    s_add_u32 s13, s50, s37
    s_add_u32 s19, s51, s37
    s_waitcnt lgkmcnt(0)
    s_mov_b32 s28, s4
    s_mov_b32 s29, s5
    s_mov_b32 s30, 0x200000
    s_mov_b32 s31, 0x00020000
    s_mov_b32 s52, s8
    s_mov_b32 s53, s9
    s_mov_b32 s54, 0x1c0000
    s_mov_b32 s55, 0x00020000
    s_mov_b32 s4, s10
    s_mov_b32 s5, s11
    s_mov_b32 s6, 0x1c0000
    s_mov_b32 s7, 0x00020000
    buffer_load_dwordx4 v[24:27], v3, s[28:31], s50 offen
    buffer_load_dwordx4 v[28:31], v3, s[28:31], s13 offen
    s_mov_b32 s32, s15
    s_and_b32 s75, s15, 16
    s_lshl_b32 s75, s75, 2
    s_add_u32 s75, s75, s68
    s_bfe_u32 s37, s32, 0x20002
    s_and_b32 s38, s15, 3
    s_lshl_b32 s39, s37, 2
    s_cmp_eq_u32 s37, 3
    s_cselect_b32 s39, 11, s39
    s_add_u32 s39, s39, s38
    s_and_b32 s17, s16, 0
    s_lshl_b32 s12, s39, 8
    s_mov_b32 s40, 0x3f803f80
    s_mov_b32 s33, 0x3d000000
    s_lshl_b32 s42, s14, 14
    s_lshl_b32 s36, s14, 13
    s_add_u32 s36, s36, 131072
    v_lshrrev_b32 v102, 4, v0
    v_bfe_u32 v100, v0, 1, 3
    v_xor_b32 v100, v100, v102
    v_lshlrev_b32 v100, 5, v100
    v_and_b32 v101, 1, v0
    v_lshl_add_u32 v100, v101, 4, v100
    v_mul_u32_u24 v102, 3584, v102
    s_mul_i32 s37, s14, 57344
    v_add_u32 v102, s37, v102
    v_xor_b32 v101, 0, v100
    v_add_u32 v8, v101, v102
    v_xor_b32 v101, 128, v100
    v_add_u32 v9, v101, v102
    v_add_u32 v9, 13312, v9
    v_xor_b32 v101, 0, v100
    v_add_u32 v10, v101, v102
    v_add_u32 v10, 26624, v10
    v_xor_b32 v101, 128, v100
    v_add_u32 v11, v101, v102
    v_add_u32 v11, 39936, v11
    v_lshrrev_b32 v100, 2, v0
    v_lshlrev_b32 v100, 8, v100
    v_and_b32 v101, 3, v0
    v_lshl_add_u32 v100, v101, 3, v100
    v_bfe_u32 v102, v0, 2, 3
    s_lshl_b32 s37, s14, 1
    v_xor_b32 v102, s37, v102
    v_lshl_add_u32 v12, v102, 5, v100
    v_mfma_f32_16x16x32_bf16 v[32:35], a[0:3], a[128:131], 0
    v_mfma_f32_16x16x32_bf16 v[48:51], a[0:3], a[132:135], 0
    v_mfma_f32_16x16x32_bf16 v[36:39], a[4:7], a[128:131], 0
    v_mfma_f32_16x16x32_bf16 v[52:55], a[4:7], a[132:135], 0
    v_mfma_f32_16x16x32_bf16 v[40:43], a[8:11], a[128:131], 0
    v_mfma_f32_16x16x32_bf16 v[56:59], a[8:11], a[132:135], 0
    v_mfma_f32_16x16x32_bf16 v[44:47], a[12:15], a[128:131], 0
    v_mfma_f32_16x16x32_bf16 v[60:63], a[12:15], a[132:135], 0
    v_mfma_f32_16x16x32_bf16 v[32:35], a[16:19], a[136:139], v[32:35]
    v_mfma_f32_16x16x32_bf16 v[48:51], a[16:19], a[140:143], v[48:51]
    v_mfma_f32_16x16x32_bf16 v[36:39], a[20:23], a[136:139], v[36:39]
    v_mfma_f32_16x16x32_bf16 v[52:55], a[20:23], a[140:143], v[52:55]
    v_mfma_f32_16x16x32_bf16 v[40:43], a[24:27], a[136:139], v[40:43]
    v_mfma_f32_16x16x32_bf16 v[56:59], a[24:27], a[140:143], v[56:59]
    v_mfma_f32_16x16x32_bf16 v[44:47], a[28:31], a[136:139], v[44:47]
    v_mfma_f32_16x16x32_bf16 v[60:63], a[28:31], a[140:143], v[60:63]
    v_mfma_f32_16x16x32_bf16 v[32:35], a[32:35], a[144:147], v[32:35]
    v_mfma_f32_16x16x32_bf16 v[48:51], a[32:35], a[148:151], v[48:51]
    v_mfma_f32_16x16x32_bf16 v[36:39], a[36:39], a[144:147], v[36:39]
    v_mfma_f32_16x16x32_bf16 v[52:55], a[36:39], a[148:151], v[52:55]
    v_mfma_f32_16x16x32_bf16 v[40:43], a[40:43], a[144:147], v[40:43]
    v_mfma_f32_16x16x32_bf16 v[56:59], a[40:43], a[148:151], v[56:59]
    v_mfma_f32_16x16x32_bf16 v[44:47], a[44:47], a[144:147], v[44:47]
    v_mfma_f32_16x16x32_bf16 v[60:63], a[44:47], a[148:151], v[60:63]
    s_waitcnt vmcnt(38) lgkmcnt(0)
    v_mfma_f32_16x16x32_bf16 v[32:35], a[48:51], a[152:155], v[32:35]
    ds_read_b64_tr_b16 a[64:65], v20 offset:16384
    ds_read_b64_tr_b16 a[66:67], v20 offset:18432
    ds_read_b64_tr_b16 a[68:69], v21 offset:16384
    v_mfma_f32_16x16x32_bf16 v[48:51], a[48:51], a[156:159], v[48:51]
    ds_read_b64_tr_b16 a[70:71], v21 offset:18432
    ds_read_b64_tr_b16 a[72:73], v22 offset:16384
    ds_read_b64_tr_b16 a[74:75], v22 offset:18432
    v_mfma_f32_16x16x32_bf16 v[36:39], a[52:55], a[152:155], v[36:39]
    ds_read_b64_tr_b16 a[76:77], v23 offset:16384
    ds_read_b64_tr_b16 a[78:79], v23 offset:18432
    v_mfma_f32_16x16x32_bf16 v[52:55], a[52:55], a[156:159], v[52:55]
    v_mfma_f32_16x16x32_bf16 v[40:43], a[56:59], a[152:155], v[40:43]
    v_mfma_f32_16x16x32_bf16 v[56:59], a[56:59], a[156:159], v[56:59]
    v_mfma_f32_16x16x32_bf16 v[44:47], a[60:63], a[152:155], v[44:47]
    v_mfma_f32_16x16x32_bf16 v[60:63], a[60:63], a[156:159], v[60:63]
    s_waitcnt vmcnt(34) lgkmcnt(0)
    v_mfma_f32_16x16x32_bf16 v[32:35], a[64:67], a[160:163], v[32:35]
    ds_read_b64_tr_b16 a[80:81], v20 offset:20480
    ds_read_b64_tr_b16 a[82:83], v20 offset:22528
    s_add_u32 m0, s58, 16384
    s_xor_b32 s49, s60, 393216
    v_mfma_f32_16x16x32_bf16 v[48:51], a[64:67], a[164:167], v[48:51]
    ds_read_b64_tr_b16 a[84:85], v21 offset:20480
    buffer_load_dwordx4 v16, s[20:23], s49 offen lds
    v_mfma_f32_16x16x32_bf16 v[36:39], a[68:71], a[160:163], v[36:39]
    ds_read_b64_tr_b16 a[86:87], v21 offset:22528
    ds_read_b64_tr_b16 a[88:89], v22 offset:20480
    ds_read_b64_tr_b16 a[90:91], v22 offset:22528
    v_mfma_f32_16x16x32_bf16 v[52:55], a[68:71], a[164:167], v[52:55]
    ds_read_b64_tr_b16 a[92:93], v23 offset:20480
    buffer_load_dwordx4 v17, s[20:23], s49 offen offset:1024 lds
    v_mfma_f32_16x16x32_bf16 v[40:43], a[72:75], a[160:163], v[40:43]
    ds_read_b64_tr_b16 a[94:95], v23 offset:22528
    buffer_load_dwordx4 v18, s[20:23], s49 offen offset:2048 lds
    v_mfma_f32_16x16x32_bf16 v[56:59], a[72:75], a[164:167], v[56:59]
    buffer_load_dwordx4 v19, s[20:23], s49 offen offset:3072 lds
    v_mfma_f32_16x16x32_bf16 v[44:47], a[76:79], a[160:163], v[44:47]
    v_mfma_f32_16x16x32_bf16 v[60:63], a[76:79], a[164:167], v[60:63]
    s_waitcnt vmcnt(34) lgkmcnt(0)
    v_mfma_f32_16x16x32_bf16 v[32:35], a[80:83], a[168:171], v[32:35]
    ds_read_b64_tr_b16 a[96:97], v20 offset:24576
    ds_read_b64_tr_b16 a[98:99], v20 offset:26624
    s_add_u32 m0, s58, 20480
    s_xor_b32 s49, s60, 425984
    v_mfma_f32_16x16x32_bf16 v[48:51], a[80:83], a[172:175], v[48:51]
    ds_read_b64_tr_b16 a[100:101], v21 offset:24576
    buffer_load_dwordx4 v16, s[20:23], s49 offen lds
    v_mfma_f32_16x16x32_bf16 v[36:39], a[84:87], a[168:171], v[36:39]
    ds_read_b64_tr_b16 a[102:103], v21 offset:26624
    ds_read_b64_tr_b16 a[104:105], v22 offset:24576
    ds_read_b64_tr_b16 a[106:107], v22 offset:26624
    v_mfma_f32_16x16x32_bf16 v[52:55], a[84:87], a[172:175], v[52:55]
    ds_read_b64_tr_b16 a[108:109], v23 offset:24576
    buffer_load_dwordx4 v17, s[20:23], s49 offen offset:1024 lds
    v_mfma_f32_16x16x32_bf16 v[40:43], a[88:91], a[168:171], v[40:43]
    ds_read_b64_tr_b16 a[110:111], v23 offset:26624
    buffer_load_dwordx4 v18, s[20:23], s49 offen offset:2048 lds
    v_mfma_f32_16x16x32_bf16 v[56:59], a[88:91], a[172:175], v[56:59]
    buffer_load_dwordx4 v19, s[20:23], s49 offen offset:3072 lds
    v_mfma_f32_16x16x32_bf16 v[44:47], a[92:95], a[168:171], v[44:47]
    v_mfma_f32_16x16x32_bf16 v[60:63], a[92:95], a[172:175], v[60:63]
    s_waitcnt vmcnt(34) lgkmcnt(0)
    v_mfma_f32_16x16x32_bf16 v[32:35], a[96:99], a[176:179], v[32:35]
    ds_read_b64_tr_b16 a[112:113], v20 offset:28672
    ds_read_b64_tr_b16 a[114:115], v20 offset:30720
    s_add_u32 m0, s58, 24576
    s_xor_b32 s49, s60, 458752
    v_mfma_f32_16x16x32_bf16 v[48:51], a[96:99], a[180:183], v[48:51]
    ds_read_b64_tr_b16 a[116:117], v21 offset:28672
    buffer_load_dwordx4 v16, s[20:23], s49 offen lds
    v_mfma_f32_16x16x32_bf16 v[36:39], a[100:103], a[176:179], v[36:39]
    ds_read_b64_tr_b16 a[118:119], v21 offset:30720
    ds_read_b64_tr_b16 a[120:121], v22 offset:28672
    ds_read_b64_tr_b16 a[122:123], v22 offset:30720
    v_mfma_f32_16x16x32_bf16 v[52:55], a[100:103], a[180:183], v[52:55]
    ds_read_b64_tr_b16 a[124:125], v23 offset:28672
    buffer_load_dwordx4 v17, s[20:23], s49 offen offset:1024 lds
    v_mfma_f32_16x16x32_bf16 v[40:43], a[104:107], a[176:179], v[40:43]
    ds_read_b64_tr_b16 a[126:127], v23 offset:30720
    buffer_load_dwordx4 v18, s[20:23], s49 offen offset:2048 lds
    v_mfma_f32_16x16x32_bf16 v[56:59], a[104:107], a[180:183], v[56:59]
    buffer_load_dwordx4 v19, s[20:23], s49 offen offset:3072 lds
    v_mfma_f32_16x16x32_bf16 v[44:47], a[108:111], a[176:179], v[44:47]
    v_mfma_f32_16x16x32_bf16 v[60:63], a[108:111], a[180:183], v[60:63]
    s_waitcnt vmcnt(34) lgkmcnt(0)
    v_mfma_f32_16x16x32_bf16 v[32:35], a[112:115], a[184:187], v[32:35]
    ds_read_b64_tr_b16 a[128:129], v20 offset:0
    ds_read_b64_tr_b16 a[130:131], v20 offset:2048
    s_add_u32 m0, s58, 28672
    s_xor_b32 s49, s60, 491520
    v_mfma_f32_16x16x32_bf16 v[48:51], a[112:115], a[188:191], v[48:51]
    ds_read_b64_tr_b16 a[132:133], v21 offset:0
    buffer_load_dwordx4 v16, s[20:23], s49 offen lds
    v_mfma_f32_16x16x32_bf16 v[36:39], a[116:119], a[184:187], v[36:39]
    ds_read_b64_tr_b16 a[134:135], v21 offset:2048
    ds_read_b64_tr_b16 a[136:137], v22 offset:0
    ds_read_b64_tr_b16 a[138:139], v22 offset:2048
    v_mfma_f32_16x16x32_bf16 v[52:55], a[116:119], a[188:191], v[52:55]
    ds_read_b64_tr_b16 a[140:141], v23 offset:0
    buffer_load_dwordx4 v17, s[20:23], s49 offen offset:1024 lds
    v_mfma_f32_16x16x32_bf16 v[40:43], a[120:123], a[184:187], v[40:43]
    ds_read_b64_tr_b16 a[142:143], v23 offset:2048
    buffer_load_dwordx4 v18, s[20:23], s49 offen offset:2048 lds
    v_mfma_f32_16x16x32_bf16 v[56:59], a[120:123], a[188:191], v[56:59]
    buffer_load_dwordx4 v19, s[20:23], s49 offen offset:3072 lds
    v_mfma_f32_16x16x32_bf16 v[44:47], a[124:127], a[184:187], v[44:47]
    v_mfma_f32_16x16x32_bf16 v[60:63], a[124:127], a[188:191], v[60:63]
    s_waitcnt vmcnt(34) lgkmcnt(0)
    v_mfma_f32_16x16x32_bf16 v[32:35], a[128:131], v[192:195], v[32:35]
    ds_read_b64_tr_b16 a[144:145], v20 offset:4096
    ds_read_b64_tr_b16 a[146:147], v20 offset:6144
    s_add_u32 m0, s58, 0
    s_xor_b32 s49, s60, 524288
    v_mfma_f32_16x16x32_bf16 v[48:51], a[128:131], v[196:199], v[48:51]
    ds_read_b64_tr_b16 a[148:149], v21 offset:4096
    buffer_load_dwordx4 v16, s[20:23], s49 offen lds
    v_mfma_f32_16x16x32_bf16 v[36:39], a[132:135], v[192:195], v[36:39]
    ds_read_b64_tr_b16 a[150:151], v21 offset:6144
    ds_read_b64_tr_b16 a[152:153], v22 offset:4096
    ds_read_b64_tr_b16 a[154:155], v22 offset:6144
    v_mfma_f32_16x16x32_bf16 v[52:55], a[132:135], v[196:199], v[52:55]
    ds_read_b64_tr_b16 a[156:157], v23 offset:4096
    buffer_load_dwordx4 v17, s[20:23], s49 offen offset:1024 lds
    v_mfma_f32_16x16x32_bf16 v[40:43], a[136:139], v[192:195], v[40:43]
    ds_read_b64_tr_b16 a[158:159], v23 offset:6144
    buffer_load_dwordx4 v18, s[20:23], s49 offen offset:2048 lds
    v_mfma_f32_16x16x32_bf16 v[56:59], a[136:139], v[196:199], v[56:59]
    buffer_load_dwordx4 v19, s[20:23], s49 offen offset:3072 lds
    v_mfma_f32_16x16x32_bf16 v[44:47], a[140:143], v[192:195], v[44:47]
    v_mfma_f32_16x16x32_bf16 v[60:63], a[140:143], v[196:199], v[60:63]
    s_waitcnt vmcnt(34) lgkmcnt(0)
    v_mfma_f32_16x16x32_bf16 v[32:35], a[144:147], v[200:203], v[32:35]
    ds_read_b64_tr_b16 a[160:161], v20 offset:8192
    ds_read_b64_tr_b16 a[162:163], v20 offset:10240
    s_add_u32 m0, s58, 4096
    s_xor_b32 s49, s60, 557056
    v_mfma_f32_16x16x32_bf16 v[48:51], a[144:147], v[204:207], v[48:51]
    ds_read_b64_tr_b16 a[164:165], v21 offset:8192
    buffer_load_dwordx4 v16, s[20:23], s49 offen lds
    v_mfma_f32_16x16x32_bf16 v[36:39], a[148:151], v[200:203], v[36:39]
    ds_read_b64_tr_b16 a[166:167], v21 offset:10240
    ds_read_b64_tr_b16 a[168:169], v22 offset:8192
    ds_read_b64_tr_b16 a[170:171], v22 offset:10240
    v_mfma_f32_16x16x32_bf16 v[52:55], a[148:151], v[204:207], v[52:55]
    ds_read_b64_tr_b16 a[172:173], v23 offset:8192
    buffer_load_dwordx4 v17, s[20:23], s49 offen offset:1024 lds
    v_mfma_f32_16x16x32_bf16 v[40:43], a[152:155], v[200:203], v[40:43]
    ds_read_b64_tr_b16 a[174:175], v23 offset:10240
    buffer_load_dwordx4 v18, s[20:23], s49 offen offset:2048 lds
    v_mfma_f32_16x16x32_bf16 v[56:59], a[152:155], v[204:207], v[56:59]
    buffer_load_dwordx4 v19, s[20:23], s49 offen offset:3072 lds
    v_mfma_f32_16x16x32_bf16 v[44:47], a[156:159], v[200:203], v[44:47]
    v_mfma_f32_16x16x32_bf16 v[60:63], a[156:159], v[204:207], v[60:63]
    s_waitcnt vmcnt(34) lgkmcnt(0)
    v_mfma_f32_16x16x32_bf16 v[32:35], a[160:163], v[208:211], v[32:35]
    ds_read_b64_tr_b16 a[176:177], v20 offset:12288
    ds_read_b64_tr_b16 a[178:179], v20 offset:14336
    s_add_u32 m0, s58, 8192
    s_xor_b32 s49, s60, 589824
    v_mfma_f32_16x16x32_bf16 v[48:51], a[160:163], v[212:215], v[48:51]
    ds_read_b64_tr_b16 a[180:181], v21 offset:12288
    buffer_load_dwordx4 v16, s[20:23], s49 offen lds
    v_mfma_f32_16x16x32_bf16 v[36:39], a[164:167], v[208:211], v[36:39]
    ds_read_b64_tr_b16 a[182:183], v21 offset:14336
    ds_read_b64_tr_b16 a[184:185], v22 offset:12288
    ds_read_b64_tr_b16 a[186:187], v22 offset:14336
    v_mfma_f32_16x16x32_bf16 v[52:55], a[164:167], v[212:215], v[52:55]
    ds_read_b64_tr_b16 a[188:189], v23 offset:12288
    buffer_load_dwordx4 v17, s[20:23], s49 offen offset:1024 lds
    v_mfma_f32_16x16x32_bf16 v[40:43], a[168:171], v[208:211], v[40:43]
    ds_read_b64_tr_b16 a[190:191], v23 offset:14336
    buffer_load_dwordx4 v18, s[20:23], s49 offen offset:2048 lds
    v_mfma_f32_16x16x32_bf16 v[56:59], a[168:171], v[212:215], v[56:59]
    buffer_load_dwordx4 v19, s[20:23], s49 offen offset:3072 lds
    v_mfma_f32_16x16x32_bf16 v[44:47], a[172:175], v[208:211], v[44:47]
    v_mfma_f32_16x16x32_bf16 v[60:63], a[172:175], v[212:215], v[60:63]
    s_waitcnt vmcnt(24) lgkmcnt(0)
    v_mfma_f32_16x16x32_bf16 v[32:35], a[176:179], v[216:219], v[32:35]
    ds_read_b64_tr_b16 a[192:193], v20 offset:16384
    ds_read_b64_tr_b16 a[194:195], v20 offset:18432
    s_add_u32 m0, s58, 12288
    s_xor_b32 s49, s60, 622592
    v_mfma_f32_16x16x32_bf16 v[48:51], a[176:179], v[220:223], v[48:51]
    ds_read_b64_tr_b16 a[196:197], v21 offset:16384
    buffer_load_dwordx4 v16, s[20:23], s49 offen lds
    v_mfma_f32_16x16x32_bf16 v[36:39], a[180:183], v[216:219], v[36:39]
    ds_read_b64_tr_b16 a[198:199], v21 offset:18432
    ds_read_b64_tr_b16 a[200:201], v22 offset:16384
    ds_read_b64_tr_b16 a[202:203], v22 offset:18432
    v_mfma_f32_16x16x32_bf16 v[52:55], a[180:183], v[220:223], v[52:55]
    ds_read_b64_tr_b16 a[204:205], v23 offset:16384
    buffer_load_dwordx4 v17, s[20:23], s49 offen offset:1024 lds
    v_mfma_f32_16x16x32_bf16 v[40:43], a[184:187], v[216:219], v[40:43]
    ds_read_b64_tr_b16 a[206:207], v23 offset:18432
    buffer_load_dwordx4 v18, s[20:23], s49 offen offset:2048 lds
    v_mfma_f32_16x16x32_bf16 v[56:59], a[184:187], v[220:223], v[56:59]
    buffer_load_dwordx4 v19, s[20:23], s49 offen offset:3072 lds
    v_mfma_f32_16x16x32_bf16 v[44:47], a[188:191], v[216:219], v[44:47]
    v_mfma_f32_16x16x32_bf16 v[60:63], a[188:191], v[220:223], v[60:63]
    s_waitcnt vmcnt(24) lgkmcnt(0)
    v_mfma_f32_16x16x32_bf16 v[32:35], a[192:195], v[224:227], v[32:35]
    ds_read_b64_tr_b16 a[208:209], v20 offset:20480
    ds_read_b64_tr_b16 a[210:211], v20 offset:22528
    s_add_u32 m0, s58, 16384
    s_xor_b32 s49, s60, 655360
    v_mfma_f32_16x16x32_bf16 v[48:51], a[192:195], v[228:231], v[48:51]
    ds_read_b64_tr_b16 a[212:213], v21 offset:20480
    buffer_load_dwordx4 v16, s[20:23], s49 offen lds
    v_mfma_f32_16x16x32_bf16 v[36:39], a[196:199], v[224:227], v[36:39]
    ds_read_b64_tr_b16 a[214:215], v21 offset:22528
    ds_read_b64_tr_b16 a[216:217], v22 offset:20480
    ds_read_b64_tr_b16 a[218:219], v22 offset:22528
    v_mfma_f32_16x16x32_bf16 v[52:55], a[196:199], v[228:231], v[52:55]
    ds_read_b64_tr_b16 a[220:221], v23 offset:20480
    buffer_load_dwordx4 v17, s[20:23], s49 offen offset:1024 lds
    v_mfma_f32_16x16x32_bf16 v[40:43], a[200:203], v[224:227], v[40:43]
    ds_read_b64_tr_b16 a[222:223], v23 offset:22528
    buffer_load_dwordx4 v18, s[20:23], s49 offen offset:2048 lds
    v_mfma_f32_16x16x32_bf16 v[56:59], a[200:203], v[228:231], v[56:59]
    buffer_load_dwordx4 v19, s[20:23], s49 offen offset:3072 lds
    v_mfma_f32_16x16x32_bf16 v[44:47], a[204:207], v[224:227], v[44:47]
    v_mfma_f32_16x16x32_bf16 v[60:63], a[204:207], v[228:231], v[60:63]
    s_waitcnt vmcnt(24) lgkmcnt(0)
    v_mfma_f32_16x16x32_bf16 v[32:35], a[208:211], v[232:235], v[32:35]
    ds_read_b64_tr_b16 a[224:225], v20 offset:24576
    ds_read_b64_tr_b16 a[226:227], v20 offset:26624
    v_and_b32 v13, 31, v0
    v_mfma_f32_16x16x32_bf16 v[48:51], a[208:211], v[236:239], v[48:51]
    ds_read_b64_tr_b16 a[228:229], v21 offset:24576
    ds_read_b64_tr_b16 a[230:231], v21 offset:26624
    v_lshlrev_b32 v13, 2, v13
    v_mfma_f32_16x16x32_bf16 v[36:39], a[212:215], v[232:235], v[36:39]
    ds_read_b64_tr_b16 a[232:233], v22 offset:24576
    buffer_load_dword v14, v13, s[24:27], s68 offen offset:768 sc1
    s_add_u32 m0, s58, 20480
    v_mfma_f32_16x16x32_bf16 v[52:55], a[212:215], v[236:239], v[52:55]
    ds_read_b64_tr_b16 a[234:235], v22 offset:26624
    s_xor_b32 s49, s60, 688128
    buffer_load_dwordx4 v16, s[20:23], s49 offen lds
    v_mfma_f32_16x16x32_bf16 v[40:43], a[216:219], v[232:235], v[40:43]
    ds_read_b64_tr_b16 a[236:237], v23 offset:24576
    ds_read_b64_tr_b16 a[238:239], v23 offset:26624
    v_mfma_f32_16x16x32_bf16 v[56:59], a[216:219], v[236:239], v[56:59]
    buffer_load_dwordx4 v17, s[20:23], s49 offen offset:1024 lds
    buffer_load_dwordx4 v18, s[20:23], s49 offen offset:2048 lds
    v_mfma_f32_16x16x32_bf16 v[44:47], a[220:223], v[232:235], v[44:47]
    buffer_load_dwordx4 v19, s[20:23], s49 offen offset:3072 lds
    v_mfma_f32_16x16x32_bf16 v[60:63], a[220:223], v[236:239], v[60:63]
    s_waitcnt vmcnt(25) lgkmcnt(0)
    v_mfma_f32_16x16x32_bf16 v[32:35], a[224:227], v[128:131], v[32:35]
    ds_read_b64_tr_b16 a[240:241], v20 offset:28672
    ds_read_b64_tr_b16 a[242:243], v20 offset:30720
    s_add_u32 m0, s58, 24576
    s_xor_b32 s49, s60, 720896
    v_mfma_f32_16x16x32_bf16 v[48:51], a[224:227], v[132:135], v[48:51]
    ds_read_b64_tr_b16 a[244:245], v21 offset:28672
    buffer_load_dwordx4 v16, s[20:23], s49 offen lds
    v_mfma_f32_16x16x32_bf16 v[36:39], a[228:231], v[128:131], v[36:39]
    ds_read_b64_tr_b16 a[246:247], v21 offset:30720
    ds_read_b64_tr_b16 a[248:249], v22 offset:28672
    ds_read_b64_tr_b16 a[250:251], v22 offset:30720
    v_mfma_f32_16x16x32_bf16 v[52:55], a[228:231], v[132:135], v[52:55]
    ds_read_b64_tr_b16 a[252:253], v23 offset:28672
    buffer_load_dwordx4 v17, s[20:23], s49 offen offset:1024 lds
    v_mfma_f32_16x16x32_bf16 v[40:43], a[232:235], v[128:131], v[40:43]
    ds_read_b64_tr_b16 a[254:255], v23 offset:30720
    buffer_load_dwordx4 v18, s[20:23], s49 offen offset:2048 lds
    v_mfma_f32_16x16x32_bf16 v[56:59], a[232:235], v[132:135], v[56:59]
    buffer_load_dwordx4 v19, s[20:23], s49 offen offset:3072 lds
    v_mfma_f32_16x16x32_bf16 v[44:47], a[236:239], v[128:131], v[44:47]
    v_mfma_f32_16x16x32_bf16 v[60:63], a[236:239], v[132:135], v[60:63]
    s_waitcnt vmcnt(25) lgkmcnt(0)
    v_mfma_f32_16x16x32_bf16 v[32:35], a[240:243], v[136:139], v[32:35]
    ds_read_b64_tr_b16 v[96:97], v20 offset:0
    ds_read_b64_tr_b16 v[98:99], v20 offset:2048
    s_add_u32 m0, s58, 28672
    s_xor_b32 s49, s60, 753664
    v_mfma_f32_16x16x32_bf16 v[48:51], a[240:243], v[140:143], v[48:51]
    ds_read_b64_tr_b16 v[100:101], v21 offset:0
    buffer_load_dwordx4 v16, s[20:23], s49 offen lds
    v_mfma_f32_16x16x32_bf16 v[36:39], a[244:247], v[136:139], v[36:39]
    ds_read_b64_tr_b16 v[102:103], v21 offset:2048
    buffer_load_dwordx4 v17, s[20:23], s49 offen offset:1024 lds
    v_mfma_f32_16x16x32_bf16 v[52:55], a[244:247], v[140:143], v[52:55]
    ds_read_b64_tr_b16 v[104:105], v22 offset:0
    buffer_load_dwordx4 v18, s[20:23], s49 offen offset:2048 lds
    v_mfma_f32_16x16x32_bf16 v[40:43], a[248:251], v[136:139], v[40:43]
    ds_read_b64_tr_b16 v[106:107], v22 offset:2048
    ds_read_b64_tr_b16 v[108:109], v23 offset:0
    ds_read_b64_tr_b16 v[110:111], v23 offset:2048
    v_mfma_f32_16x16x32_bf16 v[56:59], a[248:251], v[140:143], v[56:59]
    buffer_load_dwordx4 v19, s[20:23], s49 offen offset:3072 lds
    s_xor_b32 s37, s64, 22528
    v_mfma_f32_16x16x32_bf16 v[44:47], a[252:255], v[136:139], v[44:47]
    buffer_load_dwordx4 v[128:131], v6, s[24:27], s37 offen sc1
    s_xor_b32 s37, s64, 153600
    v_mfma_f32_16x16x32_bf16 v[60:63], a[252:255], v[140:143], v[60:63]
    buffer_load_dwordx4 v[132:135], v6, s[24:27], s37 offen sc1
    s_xor_b32 s37, s64, 23552
    buffer_load_dwordx4 v[136:139], v6, s[24:27], s37 offen sc1
    s_xor_b32 s37, s64, 154624
    buffer_load_dwordx4 v[140:143], v6, s[24:27], s37 offen sc1
    s_waitcnt vmcnt(16)
    v_cmp_ne_u32 vcc, s70, v14
    s_nop 0
    s_cbranch_vccnz T_SPB
T_SPBR:
    s_xor_b32 s38, s44, 0
    buffer_load_dwordx4 v[192:195], v6, s[24:27], s38 offen sc1
    s_xor_b32 s38, s44, 131072
    buffer_load_dwordx4 v[196:199], v6, s[24:27], s38 offen sc1
    s_xor_b32 s38, s44, 16384
    buffer_load_dwordx4 v[200:203], v6, s[24:27], s38 offen sc1
    s_xor_b32 s38, s44, 147456
    buffer_load_dwordx4 v[204:207], v6, s[24:27], s38 offen sc1
    s_xor_b32 s38, s44, 1024
    buffer_load_dwordx4 v[208:211], v6, s[24:27], s38 offen sc1
    s_xor_b32 s38, s44, 132096
    buffer_load_dwordx4 v[212:215], v6, s[24:27], s38 offen sc1
    s_xor_b32 s38, s44, 17408
    buffer_load_dwordx4 v[216:219], v6, s[24:27], s38 offen sc1
    s_xor_b32 s38, s44, 148480
    buffer_load_dwordx4 v[220:223], v6, s[24:27], s38 offen sc1
    s_xor_b32 s38, s44, 2048
    buffer_load_dwordx4 v[224:227], v6, s[24:27], s38 offen sc1
    s_xor_b32 s38, s44, 133120
    buffer_load_dwordx4 v[228:231], v6, s[24:27], s38 offen sc1
    s_xor_b32 s38, s44, 18432
    buffer_load_dwordx4 v[232:235], v6, s[24:27], s38 offen sc1
    s_xor_b32 s38, s44, 149504
    buffer_load_dwordx4 v[236:239], v6, s[24:27], s38 offen sc1
    s_waitcnt vmcnt(8) lgkmcnt(0)
    v_mfma_f32_16x16x32_bf16 v[32:35], v[96:99], v[144:147], v[32:35]
    ds_read_b64_tr_b16 v[112:113], v20 offset:4096
    s_xor_b32 s38, s44, 3072
    buffer_load_dwordx4 v[240:243], v6, s[24:27], s38 offen sc1
    v_mfma_f32_16x16x32_bf16 v[48:51], v[96:99], v[148:151], v[48:51]
    ds_read_b64_tr_b16 v[114:115], v20 offset:6144
    s_xor_b32 s38, s44, 134144
    v_mfma_f32_16x16x32_bf16 v[36:39], v[100:103], v[144:147], v[36:39]
    ds_read_b64_tr_b16 v[116:117], v21 offset:4096
    buffer_load_dwordx4 v[244:247], v6, s[24:27], s38 offen sc1
    v_mfma_f32_16x16x32_bf16 v[52:55], v[100:103], v[148:151], v[52:55]
    v_mfma_f32_16x16x32_bf16 v[40:43], v[104:107], v[144:147], v[40:43]
    ds_read_b64_tr_b16 v[118:119], v21 offset:6144
    s_xor_b32 s38, s44, 19456
    v_mfma_f32_16x16x32_bf16 v[56:59], v[104:107], v[148:151], v[56:59]
    buffer_load_dwordx4 v[248:251], v6, s[24:27], s38 offen sc1
    v_mfma_f32_16x16x32_bf16 v[44:47], v[108:111], v[144:147], v[44:47]
    v_mfma_f32_16x16x32_bf16 v[60:63], v[108:111], v[148:151], v[60:63]
    ds_read_b64_tr_b16 v[120:121], v22 offset:4096
    v_mfma_f32_16x16x32_bf16 v[64:67], a[0:3], v[192:195], 0
    s_xor_b32 s38, s44, 150528
    buffer_load_dwordx4 v[252:255], v6, s[24:27], s38 offen sc1
    v_mfma_f32_16x16x32_bf16 v[80:83], a[0:3], v[196:199], 0
    ds_read_b64_tr_b16 v[122:123], v22 offset:6144
    v_mfma_f32_16x16x32_bf16 v[68:71], a[4:7], v[192:195], 0
    v_mfma_f32_16x16x32_bf16 v[84:87], a[4:7], v[196:199], 0
    ds_read_b64_tr_b16 v[124:125], v23 offset:4096
    s_add_u32 m0, s58, 0
    v_mfma_f32_16x16x32_bf16 v[72:75], a[8:11], v[192:195], 0
    s_xor_b32 s49, s60, 786432
    buffer_load_dwordx4 v16, s[20:23], s49 offen lds
    v_mfma_f32_16x16x32_bf16 v[88:91], a[8:11], v[196:199], 0
    ds_read_b64_tr_b16 v[126:127], v23 offset:6144
    v_mfma_f32_16x16x32_bf16 v[76:79], a[12:15], v[192:195], 0
    v_mfma_f32_16x16x32_bf16 v[92:95], a[12:15], v[196:199], 0
    buffer_load_dwordx4 v17, s[20:23], s49 offen offset:1024 lds
    v_mfma_f32_16x16x32_bf16 v[64:67], v[96:99], v[200:203], v[64:67]
    v_mfma_f32_16x16x32_bf16 v[80:83], v[96:99], v[204:207], v[80:83]
    buffer_load_dwordx4 v18, s[20:23], s49 offen offset:2048 lds
    v_mfma_f32_16x16x32_bf16 v[68:71], v[100:103], v[200:203], v[68:71]
    v_mfma_f32_16x16x32_bf16 v[84:87], v[100:103], v[204:207], v[84:87]
    v_mfma_f32_16x16x32_bf16 v[72:75], v[104:107], v[200:203], v[72:75]
    buffer_load_dwordx4 v19, s[20:23], s49 offen offset:3072 lds
    v_mfma_f32_16x16x32_bf16 v[88:91], v[104:107], v[204:207], v[88:91]
    v_mfma_f32_16x16x32_bf16 v[76:79], v[108:111], v[200:203], v[76:79]
    v_mfma_f32_16x16x32_bf16 v[92:95], v[108:111], v[204:207], v[92:95]
    s_waitcnt vmcnt(12) lgkmcnt(0)
    v_mfma_f32_16x16x32_bf16 v[32:35], v[112:115], v[152:155], v[32:35]
    ds_read_b64_tr_b16 v[96:97], v20 offset:8192
    s_xor_b32 s38, s44, 4096
    buffer_load_dwordx4 v[192:195], v6, s[24:27], s38 offen sc1
    v_mfma_f32_16x16x32_bf16 v[48:51], v[112:115], v[156:159], v[48:51]
    ds_read_b64_tr_b16 v[98:99], v20 offset:10240
    s_xor_b32 s38, s44, 135168
    buffer_load_dwordx4 v[196:199], v6, s[24:27], s38 offen sc1
    v_mfma_f32_16x16x32_bf16 v[36:39], v[116:119], v[152:155], v[36:39]
    ds_read_b64_tr_b16 v[100:101], v21 offset:8192
    v_mfma_f32_16x16x32_bf16 v[52:55], v[116:119], v[156:159], v[52:55]
    s_xor_b32 s38, s44, 20480
    v_mfma_f32_16x16x32_bf16 v[40:43], v[120:123], v[152:155], v[40:43]
    ds_read_b64_tr_b16 v[102:103], v21 offset:10240
    buffer_load_dwordx4 v[200:203], v6, s[24:27], s38 offen sc1
    v_mfma_f32_16x16x32_bf16 v[56:59], v[120:123], v[156:159], v[56:59]
    v_mfma_f32_16x16x32_bf16 v[44:47], v[124:127], v[152:155], v[44:47]
    s_xor_b32 s38, s44, 151552
    buffer_load_dwordx4 v[204:207], v6, s[24:27], s38 offen sc1
    v_mfma_f32_16x16x32_bf16 v[60:63], v[124:127], v[156:159], v[60:63]
    ds_read_b64_tr_b16 v[104:105], v22 offset:8192
    v_mfma_f32_16x16x32_bf16 v[64:67], a[16:19], v[208:211], v[64:67]
    s_xor_b32 s37, s64, 24576
    v_mfma_f32_16x16x32_bf16 v[80:83], a[16:19], v[212:215], v[80:83]
    ds_read_b64_tr_b16 v[106:107], v22 offset:10240
    buffer_load_dwordx4 v[144:147], v6, s[24:27], s37 offen sc1
    v_mfma_f32_16x16x32_bf16 v[68:71], a[20:23], v[208:211], v[68:71]
    v_mfma_f32_16x16x32_bf16 v[84:87], a[20:23], v[212:215], v[84:87]
    ds_read_b64_tr_b16 v[108:109], v23 offset:8192
    s_xor_b32 s37, s64, 155648
    buffer_load_dwordx4 v[148:151], v6, s[24:27], s37 offen sc1
    v_mfma_f32_16x16x32_bf16 v[72:75], a[24:27], v[208:211], v[72:75]
    v_mfma_f32_16x16x32_bf16 v[88:91], a[24:27], v[212:215], v[88:91]
    ds_read_b64_tr_b16 v[110:111], v23 offset:10240
    s_add_u32 m0, s58, 4096
    v_mfma_f32_16x16x32_bf16 v[76:79], a[28:31], v[208:211], v[76:79]
    s_xor_b32 s49, s60, 819200
    buffer_load_dwordx4 v16, s[20:23], s49 offen lds
    v_mfma_f32_16x16x32_bf16 v[92:95], a[28:31], v[212:215], v[92:95]
    v_mfma_f32_16x16x32_bf16 v[64:67], v[112:115], v[216:219], v[64:67]
    buffer_load_dwordx4 v17, s[20:23], s49 offen offset:1024 lds
    v_mfma_f32_16x16x32_bf16 v[80:83], v[112:115], v[220:223], v[80:83]
    v_mfma_f32_16x16x32_bf16 v[68:71], v[116:119], v[216:219], v[68:71]
    buffer_load_dwordx4 v18, s[20:23], s49 offen offset:2048 lds
    v_mfma_f32_16x16x32_bf16 v[84:87], v[116:119], v[220:223], v[84:87]
    v_mfma_f32_16x16x32_bf16 v[72:75], v[120:123], v[216:219], v[72:75]
    buffer_load_dwordx4 v19, s[20:23], s49 offen offset:3072 lds
    v_mfma_f32_16x16x32_bf16 v[88:91], v[120:123], v[220:223], v[88:91]
    v_mfma_f32_16x16x32_bf16 v[76:79], v[124:127], v[216:219], v[76:79]
    v_mfma_f32_16x16x32_bf16 v[92:95], v[124:127], v[220:223], v[92:95]
    s_waitcnt vmcnt(18) lgkmcnt(0)
    v_mfma_f32_16x16x32_bf16 v[32:35], v[96:99], v[160:163], v[32:35]
    ds_read_b64_tr_b16 v[112:113], v20 offset:12288
    s_xor_b32 s38, s44, 5120
    buffer_load_dwordx4 v[208:211], v6, s[24:27], s38 offen sc1
    v_mfma_f32_16x16x32_bf16 v[48:51], v[96:99], v[164:167], v[48:51]
    ds_read_b64_tr_b16 v[114:115], v20 offset:14336
    s_xor_b32 s38, s44, 136192
    buffer_load_dwordx4 v[212:215], v6, s[24:27], s38 offen sc1
    v_mfma_f32_16x16x32_bf16 v[36:39], v[100:103], v[160:163], v[36:39]
    ds_read_b64_tr_b16 v[116:117], v21 offset:12288
    v_mfma_f32_16x16x32_bf16 v[52:55], v[100:103], v[164:167], v[52:55]
    s_xor_b32 s38, s44, 21504
    v_mfma_f32_16x16x32_bf16 v[40:43], v[104:107], v[160:163], v[40:43]
    ds_read_b64_tr_b16 v[118:119], v21 offset:14336
    buffer_load_dwordx4 v[216:219], v6, s[24:27], s38 offen sc1
    v_mfma_f32_16x16x32_bf16 v[56:59], v[104:107], v[164:167], v[56:59]
    v_mfma_f32_16x16x32_bf16 v[44:47], v[108:111], v[160:163], v[44:47]
    s_xor_b32 s38, s44, 152576
    buffer_load_dwordx4 v[220:223], v6, s[24:27], s38 offen sc1
    v_mfma_f32_16x16x32_bf16 v[60:63], v[108:111], v[164:167], v[60:63]
    ds_read_b64_tr_b16 v[120:121], v22 offset:12288
    v_mfma_f32_16x16x32_bf16 v[64:67], a[32:35], v[224:227], v[64:67]
    s_xor_b32 s37, s64, 25600
    v_mfma_f32_16x16x32_bf16 v[80:83], a[32:35], v[228:231], v[80:83]
    ds_read_b64_tr_b16 v[122:123], v22 offset:14336
    buffer_load_dwordx4 v[152:155], v6, s[24:27], s37 offen sc1
    v_mfma_f32_16x16x32_bf16 v[68:71], a[36:39], v[224:227], v[68:71]
    v_mfma_f32_16x16x32_bf16 v[84:87], a[36:39], v[228:231], v[84:87]
    ds_read_b64_tr_b16 v[124:125], v23 offset:12288
    s_xor_b32 s37, s64, 156672
    buffer_load_dwordx4 v[156:159], v6, s[24:27], s37 offen sc1
    v_mfma_f32_16x16x32_bf16 v[72:75], a[40:43], v[224:227], v[72:75]
    v_mfma_f32_16x16x32_bf16 v[88:91], a[40:43], v[228:231], v[88:91]
    ds_read_b64_tr_b16 v[126:127], v23 offset:14336
    s_add_u32 m0, s58, 8192
    v_mfma_f32_16x16x32_bf16 v[76:79], a[44:47], v[224:227], v[76:79]
    s_xor_b32 s49, s60, 851968
    buffer_load_dwordx4 v16, s[20:23], s49 offen lds
    v_mfma_f32_16x16x32_bf16 v[92:95], a[44:47], v[228:231], v[92:95]
    v_mfma_f32_16x16x32_bf16 v[64:67], v[96:99], v[232:235], v[64:67]
    buffer_load_dwordx4 v17, s[20:23], s49 offen offset:1024 lds
    v_mfma_f32_16x16x32_bf16 v[80:83], v[96:99], v[236:239], v[80:83]
    v_mfma_f32_16x16x32_bf16 v[68:71], v[100:103], v[232:235], v[68:71]
    buffer_load_dwordx4 v18, s[20:23], s49 offen offset:2048 lds
    v_mfma_f32_16x16x32_bf16 v[84:87], v[100:103], v[236:239], v[84:87]
    v_mfma_f32_16x16x32_bf16 v[72:75], v[104:107], v[232:235], v[72:75]
    buffer_load_dwordx4 v19, s[20:23], s49 offen offset:3072 lds
    v_mfma_f32_16x16x32_bf16 v[88:91], v[104:107], v[236:239], v[88:91]
    v_mfma_f32_16x16x32_bf16 v[76:79], v[108:111], v[232:235], v[76:79]
    v_mfma_f32_16x16x32_bf16 v[92:95], v[108:111], v[236:239], v[92:95]
    s_waitcnt vmcnt(24) lgkmcnt(0)
    v_mfma_f32_16x16x32_bf16 v[32:35], v[112:115], v[168:171], v[32:35]
    ds_read_b64_tr_b16 v[96:97], v20 offset:16384
    s_xor_b32 s38, s44, 6144
    buffer_load_dwordx4 v[224:227], v6, s[24:27], s38 offen sc1
    v_mfma_f32_16x16x32_bf16 v[48:51], v[112:115], v[172:175], v[48:51]
    ds_read_b64_tr_b16 v[98:99], v20 offset:18432
    v_mfma_f32_16x16x32_bf16 v[36:39], v[116:119], v[168:171], v[36:39]
    ds_read_b64_tr_b16 v[100:101], v21 offset:16384
    s_xor_b32 s38, s44, 137216
    v_mfma_f32_16x16x32_bf16 v[52:55], v[116:119], v[172:175], v[52:55]
    buffer_load_dwordx4 v[228:231], v6, s[24:27], s38 offen sc1
    v_mfma_f32_16x16x32_bf16 v[40:43], v[120:123], v[168:171], v[40:43]
    ds_read_b64_tr_b16 v[102:103], v21 offset:18432
    v_mfma_f32_16x16x32_bf16 v[56:59], v[120:123], v[172:175], v[56:59]
    v_mfma_f32_16x16x32_bf16 v[44:47], v[124:127], v[168:171], v[44:47]
    s_xor_b32 s38, s44, 22528
    v_mfma_f32_16x16x32_bf16 v[60:63], v[124:127], v[172:175], v[60:63]
    ds_read_b64_tr_b16 v[104:105], v22 offset:16384
    buffer_load_dwordx4 v[232:235], v6, s[24:27], s38 offen sc1
    v_mfma_f32_16x16x32_bf16 v[64:67], a[48:51], v[240:243], v[64:67]
    v_mfma_f32_16x16x32_bf16 v[80:83], a[48:51], v[244:247], v[80:83]
    ds_read_b64_tr_b16 v[106:107], v22 offset:18432
    v_mfma_f32_16x16x32_bf16 v[68:71], a[52:55], v[240:243], v[68:71]
    s_xor_b32 s38, s44, 153600
    v_mfma_f32_16x16x32_bf16 v[84:87], a[52:55], v[244:247], v[84:87]
    ds_read_b64_tr_b16 v[108:109], v23 offset:16384
    buffer_load_dwordx4 v[236:239], v6, s[24:27], s38 offen sc1
    v_mfma_f32_16x16x32_bf16 v[72:75], a[56:59], v[240:243], v[72:75]
    v_mfma_f32_16x16x32_bf16 v[88:91], a[56:59], v[244:247], v[88:91]
    ds_read_b64_tr_b16 v[110:111], v23 offset:18432
    v_mfma_f32_16x16x32_bf16 v[76:79], a[60:63], v[240:243], v[76:79]
    s_xor_b32 s37, s64, 26624
    v_mfma_f32_16x16x32_bf16 v[92:95], a[60:63], v[244:247], v[92:95]
    buffer_load_dwordx4 v[160:163], v6, s[24:27], s37 offen sc1
    v_mfma_f32_16x16x32_bf16 v[64:67], v[112:115], v[248:251], v[64:67]
    v_mfma_f32_16x16x32_bf16 v[80:83], v[112:115], v[252:255], v[80:83]
    v_mfma_f32_16x16x32_bf16 v[68:71], v[116:119], v[248:251], v[68:71]
    s_xor_b32 s37, s64, 157696
    v_mfma_f32_16x16x32_bf16 v[84:87], v[116:119], v[252:255], v[84:87]
    buffer_load_dwordx4 v[164:167], v6, s[24:27], s37 offen sc1
    v_mfma_f32_16x16x32_bf16 v[72:75], v[120:123], v[248:251], v[72:75]
    v_mfma_f32_16x16x32_bf16 v[88:91], v[120:123], v[252:255], v[88:91]
    v_mfma_f32_16x16x32_bf16 v[76:79], v[124:127], v[248:251], v[76:79]
    v_mfma_f32_16x16x32_bf16 v[92:95], v[124:127], v[252:255], v[92:95]
    s_waitcnt vmcnt(22) lgkmcnt(0)
    v_mfma_f32_16x16x32_bf16 v[32:35], v[96:99], v[176:179], v[32:35]
    ds_read_b64_tr_b16 v[112:113], v20 offset:20480
    s_xor_b32 s38, s44, 7168
    buffer_load_dwordx4 v[240:243], v6, s[24:27], s38 offen sc1
    v_mfma_f32_16x16x32_bf16 v[48:51], v[96:99], v[180:183], v[48:51]
    ds_read_b64_tr_b16 v[114:115], v20 offset:22528
    s_xor_b32 s38, s44, 138240
    v_mfma_f32_16x16x32_bf16 v[36:39], v[100:103], v[176:179], v[36:39]
    ds_read_b64_tr_b16 v[116:117], v21 offset:20480
    buffer_load_dwordx4 v[244:247], v6, s[24:27], s38 offen sc1
    v_mfma_f32_16x16x32_bf16 v[52:55], v[100:103], v[180:183], v[52:55]
    v_mfma_f32_16x16x32_bf16 v[40:43], v[104:107], v[176:179], v[40:43]
    ds_read_b64_tr_b16 v[118:119], v21 offset:22528
    s_xor_b32 s38, s44, 23552
    v_mfma_f32_16x16x32_bf16 v[56:59], v[104:107], v[180:183], v[56:59]
    buffer_load_dwordx4 v[248:251], v6, s[24:27], s38 offen sc1
    v_mfma_f32_16x16x32_bf16 v[44:47], v[108:111], v[176:179], v[44:47]
    v_mfma_f32_16x16x32_bf16 v[60:63], v[108:111], v[180:183], v[60:63]
    ds_read_b64_tr_b16 v[120:121], v22 offset:20480
    v_mfma_f32_16x16x32_bf16 v[64:67], a[64:67], v[192:195], v[64:67]
    s_xor_b32 s38, s44, 154624
    buffer_load_dwordx4 v[252:255], v6, s[24:27], s38 offen sc1
    v_mfma_f32_16x16x32_bf16 v[80:83], a[64:67], v[196:199], v[80:83]
    ds_read_b64_tr_b16 v[122:123], v22 offset:22528
    v_mfma_f32_16x16x32_bf16 v[68:71], a[68:71], v[192:195], v[68:71]
    v_mfma_f32_16x16x32_bf16 v[84:87], a[68:71], v[196:199], v[84:87]
    ds_read_b64_tr_b16 v[124:125], v23 offset:20480
    s_add_u32 m0, s58, 12288
    v_mfma_f32_16x16x32_bf16 v[72:75], a[72:75], v[192:195], v[72:75]
    s_xor_b32 s49, s60, 884736
    buffer_load_dwordx4 v16, s[20:23], s49 offen lds
    v_mfma_f32_16x16x32_bf16 v[88:91], a[72:75], v[196:199], v[88:91]
    ds_read_b64_tr_b16 v[126:127], v23 offset:22528
    v_mfma_f32_16x16x32_bf16 v[76:79], a[76:79], v[192:195], v[76:79]
    v_mfma_f32_16x16x32_bf16 v[92:95], a[76:79], v[196:199], v[92:95]
    buffer_load_dwordx4 v17, s[20:23], s49 offen offset:1024 lds
    v_mfma_f32_16x16x32_bf16 v[64:67], v[96:99], v[200:203], v[64:67]
    v_mfma_f32_16x16x32_bf16 v[80:83], v[96:99], v[204:207], v[80:83]
    buffer_load_dwordx4 v18, s[20:23], s49 offen offset:2048 lds
    v_mfma_f32_16x16x32_bf16 v[68:71], v[100:103], v[200:203], v[68:71]
    v_mfma_f32_16x16x32_bf16 v[84:87], v[100:103], v[204:207], v[84:87]
    v_mfma_f32_16x16x32_bf16 v[72:75], v[104:107], v[200:203], v[72:75]
    buffer_load_dwordx4 v19, s[20:23], s49 offen offset:3072 lds
    v_mfma_f32_16x16x32_bf16 v[88:91], v[104:107], v[204:207], v[88:91]
    v_mfma_f32_16x16x32_bf16 v[76:79], v[108:111], v[200:203], v[76:79]
    v_mfma_f32_16x16x32_bf16 v[92:95], v[108:111], v[204:207], v[92:95]
    s_waitcnt vmcnt(20) lgkmcnt(0)
    v_mfma_f32_16x16x32_bf16 v[32:35], v[112:115], v[184:187], v[32:35]
    ds_read_b64_tr_b16 v[96:97], v20 offset:24576
    s_xor_b32 s38, s44, 8192
    buffer_load_dwordx4 v[192:195], v6, s[24:27], s38 offen sc1
    v_mfma_f32_16x16x32_bf16 v[48:51], v[112:115], v[188:191], v[48:51]
    ds_read_b64_tr_b16 v[98:99], v20 offset:26624
    s_xor_b32 s38, s44, 139264
    buffer_load_dwordx4 v[196:199], v6, s[24:27], s38 offen sc1
    v_mfma_f32_16x16x32_bf16 v[36:39], v[116:119], v[184:187], v[36:39]
    ds_read_b64_tr_b16 v[100:101], v21 offset:24576
    v_mfma_f32_16x16x32_bf16 v[52:55], v[116:119], v[188:191], v[52:55]
    s_xor_b32 s38, s44, 24576
    v_mfma_f32_16x16x32_bf16 v[40:43], v[120:123], v[184:187], v[40:43]
    ds_read_b64_tr_b16 v[102:103], v21 offset:26624
    buffer_load_dwordx4 v[200:203], v6, s[24:27], s38 offen sc1
    v_mfma_f32_16x16x32_bf16 v[56:59], v[120:123], v[188:191], v[56:59]
    v_mfma_f32_16x16x32_bf16 v[44:47], v[124:127], v[184:187], v[44:47]
    s_xor_b32 s38, s44, 155648
    buffer_load_dwordx4 v[204:207], v6, s[24:27], s38 offen sc1
    v_mfma_f32_16x16x32_bf16 v[60:63], v[124:127], v[188:191], v[60:63]
    ds_read_b64_tr_b16 v[104:105], v22 offset:24576
    v_mfma_f32_16x16x32_bf16 v[64:67], a[80:83], v[208:211], v[64:67]
    s_xor_b32 s37, s64, 27648
    v_mfma_f32_16x16x32_bf16 v[80:83], a[80:83], v[212:215], v[80:83]
    ds_read_b64_tr_b16 v[106:107], v22 offset:26624
    buffer_load_dwordx4 v[168:171], v6, s[24:27], s37 offen sc1
    v_mfma_f32_16x16x32_bf16 v[68:71], a[84:87], v[208:211], v[68:71]
    v_mfma_f32_16x16x32_bf16 v[84:87], a[84:87], v[212:215], v[84:87]
    ds_read_b64_tr_b16 v[108:109], v23 offset:24576
    s_xor_b32 s37, s64, 158720
    buffer_load_dwordx4 v[172:175], v6, s[24:27], s37 offen sc1
    v_mfma_f32_16x16x32_bf16 v[72:75], a[88:91], v[208:211], v[72:75]
    v_mfma_f32_16x16x32_bf16 v[88:91], a[88:91], v[212:215], v[88:91]
    ds_read_b64_tr_b16 v[110:111], v23 offset:26624
    s_add_u32 m0, s58, 16384
    v_mfma_f32_16x16x32_bf16 v[76:79], a[92:95], v[208:211], v[76:79]
    s_xor_b32 s49, s60, 917504
    buffer_load_dwordx4 v16, s[20:23], s49 offen lds
    v_mfma_f32_16x16x32_bf16 v[92:95], a[92:95], v[212:215], v[92:95]
    v_mfma_f32_16x16x32_bf16 v[64:67], v[112:115], v[216:219], v[64:67]
    buffer_load_dwordx4 v17, s[20:23], s49 offen offset:1024 lds
    v_mfma_f32_16x16x32_bf16 v[80:83], v[112:115], v[220:223], v[80:83]
    v_mfma_f32_16x16x32_bf16 v[68:71], v[116:119], v[216:219], v[68:71]
    buffer_load_dwordx4 v18, s[20:23], s49 offen offset:2048 lds
    v_mfma_f32_16x16x32_bf16 v[84:87], v[116:119], v[220:223], v[84:87]
    v_mfma_f32_16x16x32_bf16 v[72:75], v[120:123], v[216:219], v[72:75]
    buffer_load_dwordx4 v19, s[20:23], s49 offen offset:3072 lds
    v_mfma_f32_16x16x32_bf16 v[88:91], v[120:123], v[220:223], v[88:91]
    v_mfma_f32_16x16x32_bf16 v[76:79], v[124:127], v[216:219], v[76:79]
    v_mfma_f32_16x16x32_bf16 v[92:95], v[124:127], v[220:223], v[92:95]
    s_waitcnt vmcnt(20) lgkmcnt(0)
    v_mfma_f32_16x16x32_bf16 v[32:35], v[96:99], v[128:131], v[32:35]
    ds_read_b64_tr_b16 v[112:113], v20 offset:28672
    s_xor_b32 s38, s44, 9216
    buffer_load_dwordx4 v[208:211], v6, s[24:27], s38 offen sc1
    v_mfma_f32_16x16x32_bf16 v[48:51], v[96:99], v[132:135], v[48:51]
    ds_read_b64_tr_b16 v[114:115], v20 offset:30720
    s_xor_b32 s38, s44, 140288
    buffer_load_dwordx4 v[212:215], v6, s[24:27], s38 offen sc1
    v_mfma_f32_16x16x32_bf16 v[36:39], v[100:103], v[128:131], v[36:39]
    ds_read_b64_tr_b16 v[116:117], v21 offset:28672
    s_xor_b32 s38, s44, 25600
    buffer_load_dwordx4 v[216:219], v6, s[24:27], s38 offen sc1
    v_mfma_f32_16x16x32_bf16 v[52:55], v[100:103], v[132:135], v[52:55]
    v_mfma_f32_16x16x32_bf16 v[40:43], v[104:107], v[128:131], v[40:43]
    ds_read_b64_tr_b16 v[118:119], v21 offset:30720
    s_xor_b32 s38, s44, 156672
    buffer_load_dwordx4 v[220:223], v6, s[24:27], s38 offen sc1
    v_mfma_f32_16x16x32_bf16 v[56:59], v[104:107], v[132:135], v[56:59]
    s_xor_b32 s37, s64, 28672
    v_mfma_f32_16x16x32_bf16 v[44:47], v[108:111], v[128:131], v[44:47]
    buffer_load_dwordx4 v[176:179], v6, s[24:27], s37 offen sc1
    v_mfma_f32_16x16x32_bf16 v[60:63], v[108:111], v[132:135], v[60:63]
    ds_read_b64_tr_b16 v[120:121], v22 offset:28672
    s_xor_b32 s37, s64, 159744
    v_mfma_f32_16x16x32_bf16 v[64:67], a[96:99], v[224:227], v[64:67]
    buffer_load_dwordx4 v[180:183], v6, s[24:27], s37 offen sc1
    v_mfma_f32_16x16x32_bf16 v[80:83], a[96:99], v[228:231], v[80:83]
    ds_read_b64_tr_b16 v[122:123], v22 offset:30720
    s_add_u32 m0, s58, 20480
    v_mfma_f32_16x16x32_bf16 v[68:71], a[100:103], v[224:227], v[68:71]
    s_xor_b32 s49, s60, 950272
    buffer_load_dwordx4 v16, s[20:23], s49 offen lds
    v_mfma_f32_16x16x32_bf16 v[84:87], a[100:103], v[228:231], v[84:87]
    ds_read_b64_tr_b16 v[124:125], v23 offset:28672
    buffer_load_dwordx4 v17, s[20:23], s49 offen offset:1024 lds
    v_mfma_f32_16x16x32_bf16 v[72:75], a[104:107], v[224:227], v[72:75]
    v_mfma_f32_16x16x32_bf16 v[88:91], a[104:107], v[228:231], v[88:91]
    ds_read_b64_tr_b16 v[126:127], v23 offset:30720
    buffer_load_dwordx4 v18, s[20:23], s49 offen offset:2048 lds
    v_mfma_f32_16x16x32_bf16 v[76:79], a[108:111], v[224:227], v[76:79]
    buffer_load_dwordx4 v19, s[20:23], s49 offen offset:3072 lds
    v_mfma_f32_16x16x32_bf16 v[92:95], a[108:111], v[228:231], v[92:95]
    v_mfma_f32_16x16x32_bf16 v[64:67], v[96:99], v[232:235], v[64:67]
    s_getpc_b64 s[8:9]
    s_lshr_b32 s10, s2, 3
    s_lshl_b32 s10, s10, 2
    v_mfma_f32_16x16x32_bf16 v[80:83], v[96:99], v[236:239], v[80:83]
    s_add_u32 s10, s10, s14
    s_lshl_b32 s10, s10, 7
    v_mfma_f32_16x16x32_bf16 v[68:71], v[100:103], v[232:235], v[68:71]
    v_min_u32 v14, 1, v0
    v_mfma_f32_16x16x32_bf16 v[84:87], v[100:103], v[236:239], v[84:87]
    v_lshlrev_b32 v14, 14, v14
    v_mfma_f32_16x16x32_bf16 v[72:75], v[104:107], v[232:235], v[72:75]
    v_add_u32 v14, s10, v14
    v_mfma_f32_16x16x32_bf16 v[88:91], v[104:107], v[236:239], v[88:91]
    global_load_dword v14, v14, s[8:9]
    v_mfma_f32_16x16x32_bf16 v[76:79], v[108:111], v[232:235], v[76:79]
    v_mfma_f32_16x16x32_bf16 v[92:95], v[108:111], v[236:239], v[92:95]
    s_waitcnt vmcnt(25) lgkmcnt(0)
    v_mfma_f32_16x16x32_bf16 v[32:35], v[112:115], v[136:139], v[32:35]
    ds_read_b64_tr_b16 v[96:97], v20 offset:0
    s_xor_b32 s38, s44, 10240
    buffer_load_dwordx4 v[224:227], v6, s[24:27], s38 offen sc1
    v_mfma_f32_16x16x32_bf16 v[48:51], v[112:115], v[140:143], v[48:51]
    ds_read_b64_tr_b16 v[98:99], v20 offset:2048
    v_mfma_f32_16x16x32_bf16 v[36:39], v[116:119], v[136:139], v[36:39]
    ds_read_b64_tr_b16 v[100:101], v21 offset:0
    s_xor_b32 s38, s44, 141312
    v_mfma_f32_16x16x32_bf16 v[52:55], v[116:119], v[140:143], v[52:55]
    buffer_load_dwordx4 v[228:231], v6, s[24:27], s38 offen sc1
    v_mfma_f32_16x16x32_bf16 v[40:43], v[120:123], v[136:139], v[40:43]
    ds_read_b64_tr_b16 v[102:103], v21 offset:2048
    v_mfma_f32_16x16x32_bf16 v[56:59], v[120:123], v[140:143], v[56:59]
    v_mfma_f32_16x16x32_bf16 v[44:47], v[124:127], v[136:139], v[44:47]
    s_xor_b32 s38, s44, 26624
    v_mfma_f32_16x16x32_bf16 v[60:63], v[124:127], v[140:143], v[60:63]
    ds_read_b64_tr_b16 v[104:105], v22 offset:0
    buffer_load_dwordx4 v[232:235], v6, s[24:27], s38 offen sc1
    v_mfma_f32_16x16x32_bf16 v[64:67], a[112:115], v[240:243], v[64:67]
    v_mfma_f32_16x16x32_bf16 v[80:83], a[112:115], v[244:247], v[80:83]
    ds_read_b64_tr_b16 v[106:107], v22 offset:2048
    v_mfma_f32_16x16x32_bf16 v[68:71], a[116:119], v[240:243], v[68:71]
    s_xor_b32 s38, s44, 157696
    v_mfma_f32_16x16x32_bf16 v[84:87], a[116:119], v[244:247], v[84:87]
    ds_read_b64_tr_b16 v[108:109], v23 offset:0
    buffer_load_dwordx4 v[236:239], v6, s[24:27], s38 offen sc1
    v_mfma_f32_16x16x32_bf16 v[72:75], a[120:123], v[240:243], v[72:75]
    v_mfma_f32_16x16x32_bf16 v[88:91], a[120:123], v[244:247], v[88:91]
    ds_read_b64_tr_b16 v[110:111], v23 offset:2048
    v_mfma_f32_16x16x32_bf16 v[76:79], a[124:127], v[240:243], v[76:79]
    s_xor_b32 s37, s64, 29696
    v_mfma_f32_16x16x32_bf16 v[92:95], a[124:127], v[244:247], v[92:95]
    buffer_load_dwordx4 v[184:187], v6, s[24:27], s37 offen sc1
    v_mfma_f32_16x16x32_bf16 v[64:67], v[112:115], v[248:251], v[64:67]
    v_mfma_f32_16x16x32_bf16 v[80:83], v[112:115], v[252:255], v[80:83]
    v_mfma_f32_16x16x32_bf16 v[68:71], v[116:119], v[248:251], v[68:71]
    s_xor_b32 s37, s64, 160768
    v_mfma_f32_16x16x32_bf16 v[84:87], v[116:119], v[252:255], v[84:87]
    buffer_load_dwordx4 v[188:191], v6, s[24:27], s37 offen sc1
    v_mfma_f32_16x16x32_bf16 v[72:75], v[120:123], v[248:251], v[72:75]
    v_mfma_f32_16x16x32_bf16 v[88:91], v[120:123], v[252:255], v[88:91]
    v_mfma_f32_16x16x32_bf16 v[76:79], v[124:127], v[248:251], v[76:79]
    v_mfma_f32_16x16x32_bf16 v[92:95], v[124:127], v[252:255], v[92:95]
    s_waitcnt vmcnt(23) lgkmcnt(0)
    v_mfma_f32_16x16x32_bf16 v[32:35], v[96:99], v[144:147], v[32:35]
    ds_read_b64_tr_b16 v[112:113], v20 offset:4096
    s_xor_b32 s38, s44, 11264
    buffer_load_dwordx4 v[240:243], v6, s[24:27], s38 offen sc1
    v_mfma_f32_16x16x32_bf16 v[48:51], v[96:99], v[148:151], v[48:51]
    ds_read_b64_tr_b16 v[114:115], v20 offset:6144
    s_xor_b32 s38, s44, 142336
    v_mfma_f32_16x16x32_bf16 v[36:39], v[100:103], v[144:147], v[36:39]
    ds_read_b64_tr_b16 v[116:117], v21 offset:4096
    buffer_load_dwordx4 v[244:247], v6, s[24:27], s38 offen sc1
    v_mfma_f32_16x16x32_bf16 v[52:55], v[100:103], v[148:151], v[52:55]
    v_mfma_f32_16x16x32_bf16 v[40:43], v[104:107], v[144:147], v[40:43]
    ds_read_b64_tr_b16 v[118:119], v21 offset:6144
    s_xor_b32 s38, s44, 27648
    v_mfma_f32_16x16x32_bf16 v[56:59], v[104:107], v[148:151], v[56:59]
    buffer_load_dwordx4 v[248:251], v6, s[24:27], s38 offen sc1
    v_mfma_f32_16x16x32_bf16 v[44:47], v[108:111], v[144:147], v[44:47]
    v_mfma_f32_16x16x32_bf16 v[60:63], v[108:111], v[148:151], v[60:63]
    ds_read_b64_tr_b16 v[120:121], v22 offset:4096
    v_mfma_f32_16x16x32_bf16 v[64:67], a[128:131], v[192:195], v[64:67]
    s_xor_b32 s38, s44, 158720
    buffer_load_dwordx4 v[252:255], v6, s[24:27], s38 offen sc1
    v_mfma_f32_16x16x32_bf16 v[80:83], a[128:131], v[196:199], v[80:83]
    ds_read_b64_tr_b16 v[122:123], v22 offset:6144
    v_mfma_f32_16x16x32_bf16 v[68:71], a[132:135], v[192:195], v[68:71]
    v_mfma_f32_16x16x32_bf16 v[84:87], a[132:135], v[196:199], v[84:87]
    ds_read_b64_tr_b16 v[124:125], v23 offset:4096
    s_add_u32 m0, s58, 24576
    v_mfma_f32_16x16x32_bf16 v[72:75], a[136:139], v[192:195], v[72:75]
    s_xor_b32 s49, s60, 983040
    buffer_load_dwordx4 v16, s[20:23], s49 offen lds
    v_mfma_f32_16x16x32_bf16 v[88:91], a[136:139], v[196:199], v[88:91]
    ds_read_b64_tr_b16 v[126:127], v23 offset:6144
    v_mfma_f32_16x16x32_bf16 v[76:79], a[140:143], v[192:195], v[76:79]
    v_mfma_f32_16x16x32_bf16 v[92:95], a[140:143], v[196:199], v[92:95]
    buffer_load_dwordx4 v17, s[20:23], s49 offen offset:1024 lds
    v_mfma_f32_16x16x32_bf16 v[64:67], v[96:99], v[200:203], v[64:67]
    v_mfma_f32_16x16x32_bf16 v[80:83], v[96:99], v[204:207], v[80:83]
    buffer_load_dwordx4 v18, s[20:23], s49 offen offset:2048 lds
    v_mfma_f32_16x16x32_bf16 v[68:71], v[100:103], v[200:203], v[68:71]
    v_mfma_f32_16x16x32_bf16 v[84:87], v[100:103], v[204:207], v[84:87]
    v_mfma_f32_16x16x32_bf16 v[72:75], v[104:107], v[200:203], v[72:75]
    buffer_load_dwordx4 v19, s[20:23], s49 offen offset:3072 lds
    v_mfma_f32_16x16x32_bf16 v[88:91], v[104:107], v[204:207], v[88:91]
    v_mfma_f32_16x16x32_bf16 v[76:79], v[108:111], v[200:203], v[76:79]
    v_mfma_f32_16x16x32_bf16 v[92:95], v[108:111], v[204:207], v[92:95]
    s_waitcnt vmcnt(21) lgkmcnt(0)
    v_mfma_f32_16x16x32_bf16 v[32:35], v[112:115], v[152:155], v[32:35]
    ds_read_b64_tr_b16 v[96:97], v20 offset:8192
    s_xor_b32 s38, s44, 12288
    buffer_load_dwordx4 v[192:195], v6, s[24:27], s38 offen sc1
    v_mfma_f32_16x16x32_bf16 v[48:51], v[112:115], v[156:159], v[48:51]
    ds_read_b64_tr_b16 v[98:99], v20 offset:10240
    s_xor_b32 s38, s44, 143360
    buffer_load_dwordx4 v[196:199], v6, s[24:27], s38 offen sc1
    v_mfma_f32_16x16x32_bf16 v[36:39], v[116:119], v[152:155], v[36:39]
    ds_read_b64_tr_b16 v[100:101], v21 offset:8192
    v_mfma_f32_16x16x32_bf16 v[52:55], v[116:119], v[156:159], v[52:55]
    s_xor_b32 s38, s44, 28672
    v_mfma_f32_16x16x32_bf16 v[40:43], v[120:123], v[152:155], v[40:43]
    ds_read_b64_tr_b16 v[102:103], v21 offset:10240
    buffer_load_dwordx4 v[200:203], v6, s[24:27], s38 offen sc1
    v_mfma_f32_16x16x32_bf16 v[56:59], v[120:123], v[156:159], v[56:59]
    v_mfma_f32_16x16x32_bf16 v[44:47], v[124:127], v[152:155], v[44:47]
    s_xor_b32 s38, s44, 159744
    buffer_load_dwordx4 v[204:207], v6, s[24:27], s38 offen sc1
    v_mfma_f32_16x16x32_bf16 v[60:63], v[124:127], v[156:159], v[60:63]
    ds_read_b64_tr_b16 v[104:105], v22 offset:8192
    v_mfma_f32_16x16x32_bf16 v[64:67], a[144:147], v[208:211], v[64:67]
    s_xor_b32 s37, s64, 30720
    v_mfma_f32_16x16x32_bf16 v[80:83], a[144:147], v[212:215], v[80:83]
    ds_read_b64_tr_b16 v[106:107], v22 offset:10240
    buffer_load_dwordx4 v[128:131], v6, s[24:27], s37 offen sc1
    v_mfma_f32_16x16x32_bf16 v[68:71], a[148:151], v[208:211], v[68:71]
    v_mfma_f32_16x16x32_bf16 v[84:87], a[148:151], v[212:215], v[84:87]
    ds_read_b64_tr_b16 v[108:109], v23 offset:8192
    s_xor_b32 s37, s64, 161792
    buffer_load_dwordx4 v[132:135], v6, s[24:27], s37 offen sc1
    v_mfma_f32_16x16x32_bf16 v[72:75], a[152:155], v[208:211], v[72:75]
    v_mfma_f32_16x16x32_bf16 v[88:91], a[152:155], v[212:215], v[88:91]
    ds_read_b64_tr_b16 v[110:111], v23 offset:10240
    s_add_u32 m0, s58, 28672
    v_mfma_f32_16x16x32_bf16 v[76:79], a[156:159], v[208:211], v[76:79]
    s_xor_b32 s49, s60, 1015808
    buffer_load_dwordx4 v16, s[20:23], s49 offen lds
    v_mfma_f32_16x16x32_bf16 v[92:95], a[156:159], v[212:215], v[92:95]
    v_mfma_f32_16x16x32_bf16 v[64:67], v[112:115], v[216:219], v[64:67]
    buffer_load_dwordx4 v17, s[20:23], s49 offen offset:1024 lds
    v_mfma_f32_16x16x32_bf16 v[80:83], v[112:115], v[220:223], v[80:83]
    v_mfma_f32_16x16x32_bf16 v[68:71], v[116:119], v[216:219], v[68:71]
    buffer_load_dwordx4 v18, s[20:23], s49 offen offset:2048 lds
    v_mfma_f32_16x16x32_bf16 v[84:87], v[116:119], v[220:223], v[84:87]
    v_mfma_f32_16x16x32_bf16 v[72:75], v[120:123], v[216:219], v[72:75]
    buffer_load_dwordx4 v19, s[20:23], s49 offen offset:3072 lds
    v_mfma_f32_16x16x32_bf16 v[88:91], v[120:123], v[220:223], v[88:91]
    v_mfma_f32_16x16x32_bf16 v[76:79], v[124:127], v[216:219], v[76:79]
    v_mfma_f32_16x16x32_bf16 v[92:95], v[124:127], v[220:223], v[92:95]
    s_waitcnt vmcnt(20) lgkmcnt(0)
    v_mfma_f32_16x16x32_bf16 v[32:35], v[96:99], v[160:163], v[32:35]
    ds_read_b64_tr_b16 v[112:113], v20 offset:12288
    s_xor_b32 s38, s44, 13312
    buffer_load_dwordx4 v[208:211], v6, s[24:27], s38 offen sc1
    v_mfma_f32_16x16x32_bf16 v[48:51], v[96:99], v[164:167], v[48:51]
    ds_read_b64_tr_b16 v[114:115], v20 offset:14336
    v_mfma_f32_16x16x32_bf16 v[36:39], v[100:103], v[160:163], v[36:39]
    ds_read_b64_tr_b16 v[116:117], v21 offset:12288
    s_xor_b32 s38, s44, 144384
    v_mfma_f32_16x16x32_bf16 v[52:55], v[100:103], v[164:167], v[52:55]
    buffer_load_dwordx4 v[212:215], v6, s[24:27], s38 offen sc1
    v_mfma_f32_16x16x32_bf16 v[40:43], v[104:107], v[160:163], v[40:43]
    ds_read_b64_tr_b16 v[118:119], v21 offset:14336
    v_mfma_f32_16x16x32_bf16 v[56:59], v[104:107], v[164:167], v[56:59]
    v_mfma_f32_16x16x32_bf16 v[44:47], v[108:111], v[160:163], v[44:47]
    s_xor_b32 s38, s44, 29696
    v_mfma_f32_16x16x32_bf16 v[60:63], v[108:111], v[164:167], v[60:63]
    ds_read_b64_tr_b16 v[120:121], v22 offset:12288
    buffer_load_dwordx4 v[216:219], v6, s[24:27], s38 offen sc1
    v_mfma_f32_16x16x32_bf16 v[64:67], a[160:163], v[224:227], v[64:67]
    v_mfma_f32_16x16x32_bf16 v[80:83], a[160:163], v[228:231], v[80:83]
    ds_read_b64_tr_b16 v[122:123], v22 offset:14336
    v_mfma_f32_16x16x32_bf16 v[68:71], a[164:167], v[224:227], v[68:71]
    s_xor_b32 s38, s44, 160768
    v_mfma_f32_16x16x32_bf16 v[84:87], a[164:167], v[228:231], v[84:87]
    ds_read_b64_tr_b16 v[124:125], v23 offset:12288
    buffer_load_dwordx4 v[220:223], v6, s[24:27], s38 offen sc1
    v_mfma_f32_16x16x32_bf16 v[72:75], a[168:171], v[224:227], v[72:75]
    v_mfma_f32_16x16x32_bf16 v[88:91], a[168:171], v[228:231], v[88:91]
    ds_read_b64_tr_b16 v[126:127], v23 offset:14336
    v_mfma_f32_16x16x32_bf16 v[76:79], a[172:175], v[224:227], v[76:79]
    s_xor_b32 s37, s64, 31744
    v_mfma_f32_16x16x32_bf16 v[92:95], a[172:175], v[228:231], v[92:95]
    buffer_load_dwordx4 v[136:139], v6, s[24:27], s37 offen sc1
    v_mfma_f32_16x16x32_bf16 v[64:67], v[96:99], v[232:235], v[64:67]
    v_mfma_f32_16x16x32_bf16 v[80:83], v[96:99], v[236:239], v[80:83]
    v_mfma_f32_16x16x32_bf16 v[68:71], v[100:103], v[232:235], v[68:71]
    s_xor_b32 s37, s64, 162816
    v_mfma_f32_16x16x32_bf16 v[84:87], v[100:103], v[236:239], v[84:87]
    buffer_load_dwordx4 v[140:143], v6, s[24:27], s37 offen sc1
    v_mfma_f32_16x16x32_bf16 v[72:75], v[104:107], v[232:235], v[72:75]
    v_mfma_f32_16x16x32_bf16 v[88:91], v[104:107], v[236:239], v[88:91]
    v_mfma_f32_16x16x32_bf16 v[76:79], v[108:111], v[232:235], v[76:79]
    v_mfma_f32_16x16x32_bf16 v[92:95], v[108:111], v[236:239], v[92:95]
    s_waitcnt vmcnt(20) lgkmcnt(0)
    v_mfma_f32_16x16x32_bf16 v[32:35], v[112:115], v[168:171], v[32:35]
    ds_read_b64_tr_b16 v[96:97], v20 offset:16384
    s_xor_b32 s38, s44, 14336
    buffer_load_dwordx4 v[224:227], v6, s[24:27], s38 offen sc1
    v_mfma_f32_16x16x32_bf16 v[48:51], v[112:115], v[172:175], v[48:51]
    ds_read_b64_tr_b16 v[98:99], v20 offset:18432
    v_mfma_f32_16x16x32_bf16 v[36:39], v[116:119], v[168:171], v[36:39]
    ds_read_b64_tr_b16 v[100:101], v21 offset:16384
    v_mfma_f32_16x16x32_bf16 v[52:55], v[116:119], v[172:175], v[52:55]
    v_mfma_f32_16x16x32_bf16 v[40:43], v[120:123], v[168:171], v[40:43]
    ds_read_b64_tr_b16 v[102:103], v21 offset:18432
    s_xor_b32 s38, s44, 145408
    v_mfma_f32_16x16x32_bf16 v[56:59], v[120:123], v[172:175], v[56:59]
    v_mfma_f32_16x16x32_bf16 v[44:47], v[124:127], v[168:171], v[44:47]
    buffer_load_dwordx4 v[228:231], v6, s[24:27], s38 offen sc1
    v_mfma_f32_16x16x32_bf16 v[60:63], v[124:127], v[172:175], v[60:63]
    ds_read_b64_tr_b16 v[104:105], v22 offset:16384
    v_mfma_f32_16x16x32_bf16 v[64:67], a[176:179], v[240:243], v[64:67]
    v_mfma_f32_16x16x32_bf16 v[80:83], a[176:179], v[244:247], v[80:83]
    ds_read_b64_tr_b16 v[106:107], v22 offset:18432
    v_mfma_f32_16x16x32_bf16 v[68:71], a[180:183], v[240:243], v[68:71]
    s_xor_b32 s38, s44, 30720
    v_mfma_f32_16x16x32_bf16 v[84:87], a[180:183], v[244:247], v[84:87]
    ds_read_b64_tr_b16 v[108:109], v23 offset:16384
    v_mfma_f32_16x16x32_bf16 v[72:75], a[184:187], v[240:243], v[72:75]
    buffer_load_dwordx4 v[232:235], v6, s[24:27], s38 offen sc1
    v_mfma_f32_16x16x32_bf16 v[88:91], a[184:187], v[244:247], v[88:91]
    ds_read_b64_tr_b16 v[110:111], v23 offset:18432
    v_mfma_f32_16x16x32_bf16 v[76:79], a[188:191], v[240:243], v[76:79]
    v_mfma_f32_16x16x32_bf16 v[92:95], a[188:191], v[244:247], v[92:95]
    v_mfma_f32_16x16x32_bf16 v[64:67], v[112:115], v[248:251], v[64:67]
    s_xor_b32 s38, s44, 161792
    v_mfma_f32_16x16x32_bf16 v[80:83], v[112:115], v[252:255], v[80:83]
    v_mfma_f32_16x16x32_bf16 v[68:71], v[116:119], v[248:251], v[68:71]
    buffer_load_dwordx4 v[236:239], v6, s[24:27], s38 offen sc1
    v_mfma_f32_16x16x32_bf16 v[84:87], v[116:119], v[252:255], v[84:87]
    v_mfma_f32_16x16x32_bf16 v[72:75], v[120:123], v[248:251], v[72:75]
    v_mfma_f32_16x16x32_bf16 v[88:91], v[120:123], v[252:255], v[88:91]
    v_mfma_f32_16x16x32_bf16 v[76:79], v[124:127], v[248:251], v[76:79]
    v_mfma_f32_16x16x32_bf16 v[92:95], v[124:127], v[252:255], v[92:95]
    s_waitcnt vmcnt(16) lgkmcnt(0)
    v_mfma_f32_16x16x32_bf16 v[32:35], v[96:99], v[176:179], v[32:35]
    ds_read_b64_tr_b16 v[112:113], v20 offset:20480
    s_xor_b32 s38, s44, 15360
    buffer_load_dwordx4 v[240:243], v6, s[24:27], s38 offen sc1
    v_mfma_f32_16x16x32_bf16 v[48:51], v[96:99], v[180:183], v[48:51]
    ds_read_b64_tr_b16 v[114:115], v20 offset:22528
    s_xor_b32 s38, s44, 146432
    v_mfma_f32_16x16x32_bf16 v[36:39], v[100:103], v[176:179], v[36:39]
    ds_read_b64_tr_b16 v[116:117], v21 offset:20480
    buffer_load_dwordx4 v[244:247], v6, s[24:27], s38 offen sc1
    v_mfma_f32_16x16x32_bf16 v[52:55], v[100:103], v[180:183], v[52:55]
    v_mfma_f32_16x16x32_bf16 v[40:43], v[104:107], v[176:179], v[40:43]
    ds_read_b64_tr_b16 v[118:119], v21 offset:22528
    s_xor_b32 s38, s44, 31744
    v_mfma_f32_16x16x32_bf16 v[56:59], v[104:107], v[180:183], v[56:59]
    buffer_load_dwordx4 v[248:251], v6, s[24:27], s38 offen sc1
    v_mfma_f32_16x16x32_bf16 v[44:47], v[108:111], v[176:179], v[44:47]
    v_mfma_f32_16x16x32_bf16 v[60:63], v[108:111], v[180:183], v[60:63]
    ds_read_b64_tr_b16 v[120:121], v22 offset:20480
    v_mfma_f32_16x16x32_bf16 v[64:67], a[192:195], v[192:195], v[64:67]
    s_xor_b32 s38, s44, 162816
    buffer_load_dwordx4 v[252:255], v6, s[24:27], s38 offen sc1
    v_mfma_f32_16x16x32_bf16 v[80:83], a[192:195], v[196:199], v[80:83]
    ds_read_b64_tr_b16 v[122:123], v22 offset:22528
    v_mfma_f32_16x16x32_bf16 v[68:71], a[196:199], v[192:195], v[68:71]
    v_mfma_f32_16x16x32_bf16 v[84:87], a[196:199], v[196:199], v[84:87]
    ds_read_b64_tr_b16 v[124:125], v23 offset:20480
    s_add_u32 m0, s36, 0
    v_mfma_f32_16x16x32_bf16 v[72:75], a[200:203], v[192:195], v[72:75]
    s_add_u32 s49, s12, 0
    buffer_load_dwordx4 v8, s[52:55], s49 offen lds
    v_mfma_f32_16x16x32_bf16 v[88:91], a[200:203], v[196:199], v[88:91]
    ds_read_b64_tr_b16 v[126:127], v23 offset:22528
    v_mfma_f32_16x16x32_bf16 v[76:79], a[204:207], v[192:195], v[76:79]
    v_mfma_f32_16x16x32_bf16 v[92:95], a[204:207], v[196:199], v[92:95]
    buffer_load_dwordx4 v9, s[52:55], s49 offen offset:1024 lds
    v_mfma_f32_16x16x32_bf16 v[64:67], v[96:99], v[200:203], v[64:67]
    v_mfma_f32_16x16x32_bf16 v[80:83], v[96:99], v[204:207], v[80:83]
    buffer_load_dwordx4 v10, s[52:55], s49 offen offset:2048 lds
    v_mfma_f32_16x16x32_bf16 v[68:71], v[100:103], v[200:203], v[68:71]
    v_mfma_f32_16x16x32_bf16 v[84:87], v[100:103], v[204:207], v[84:87]
    v_mfma_f32_16x16x32_bf16 v[72:75], v[104:107], v[200:203], v[72:75]
    buffer_load_dwordx4 v11, s[52:55], s49 offen offset:3072 lds
    v_mfma_f32_16x16x32_bf16 v[88:91], v[104:107], v[204:207], v[88:91]
    v_mfma_f32_16x16x32_bf16 v[76:79], v[108:111], v[200:203], v[76:79]
    v_mfma_f32_16x16x32_bf16 v[92:95], v[108:111], v[204:207], v[92:95]
    s_waitcnt vmcnt(14) lgkmcnt(0)
    v_mfma_f32_16x16x32_bf16 v[32:35], v[112:115], v[184:187], v[32:35]
    ds_read_b64_tr_b16 v[96:97], v20 offset:24576
    s_add_u32 m0, s36, 4096
    s_add_u32 s49, s12, 0
    s_lshl_b32 s41, s39, 12
    s_lshl_b32 s38, s14, 10
    v_mfma_f32_16x16x32_bf16 v[48:51], v[112:115], v[188:191], v[48:51]
    ds_read_b64_tr_b16 v[98:99], v20 offset:26624
    buffer_load_dwordx4 v8, s[4:7], s49 offen lds
    v_mfma_f32_16x16x32_bf16 v[36:39], v[116:119], v[184:187], v[36:39]
    ds_read_b64_tr_b16 v[100:101], v21 offset:24576
    buffer_load_dwordx4 v9, s[4:7], s49 offen offset:1024 lds
    s_add_u32 s41, s41, s38
    v_mfma_f32_16x16x32_bf16 v[52:55], v[116:119], v[188:191], v[52:55]
    v_mfma_f32_16x16x32_bf16 v[40:43], v[120:123], v[184:187], v[40:43]
    ds_read_b64_tr_b16 v[102:103], v21 offset:26624
    v_mfma_f32_16x16x32_bf16 v[56:59], v[120:123], v[188:191], v[56:59]
    buffer_load_dwordx4 v10, s[4:7], s49 offen offset:2048 lds
    s_add_u32 s41, s41, 8388608
    v_mfma_f32_16x16x32_bf16 v[44:47], v[124:127], v[184:187], v[44:47]
    v_mfma_f32_16x16x32_bf16 v[60:63], v[124:127], v[188:191], v[60:63]
    ds_read_b64_tr_b16 v[104:105], v22 offset:24576
    buffer_load_dwordx4 v11, s[4:7], s49 offen offset:3072 lds
    s_and_b32 s37, s73, 0xfffffffe
    v_mfma_f32_16x16x32_bf16 v[64:67], a[208:211], v[208:211], v[64:67]
    v_mfma_f32_16x16x32_bf16 v[80:83], a[208:211], v[212:215], v[80:83]
    ds_read_b64_tr_b16 v[106:107], v22 offset:26624
    s_lshl_b32 s46, s37, 13
    v_mfma_f32_16x16x32_bf16 v[68:71], a[212:215], v[208:211], v[68:71]
    s_add_u32 m0, s58, 0
    v_mfma_f32_16x16x32_bf16 v[84:87], a[212:215], v[212:215], v[84:87]
    ds_read_b64_tr_b16 v[108:109], v23 offset:24576
    s_add_u32 s49, s12, 229376
    s_add_u32 s46, s46, 4194304
    v_mfma_f32_16x16x32_bf16 v[72:75], a[216:219], v[208:211], v[72:75]
    buffer_load_dwordx4 v8, s[52:55], s49 offen lds
    v_mfma_f32_16x16x32_bf16 v[88:91], a[216:219], v[212:215], v[88:91]
    ds_read_b64_tr_b16 v[110:111], v23 offset:26624
    s_add_u32 s47, s46, 8192
    v_mfma_f32_16x16x32_bf16 v[76:79], a[220:223], v[208:211], v[76:79]
    buffer_load_dwordx4 v9, s[52:55], s49 offen offset:1024 lds
    v_mfma_f32_16x16x32_bf16 v[92:95], a[220:223], v[212:215], v[92:95]
    s_mul_i32 s44, s37, 114688
    v_mfma_f32_16x16x32_bf16 v[64:67], v[112:115], v[216:219], v[64:67]
    v_mfma_f32_16x16x32_bf16 v[80:83], v[112:115], v[220:223], v[80:83]
    buffer_load_dwordx4 v10, s[52:55], s49 offen offset:2048 lds
    v_mfma_f32_16x16x32_bf16 v[68:71], v[116:119], v[216:219], v[68:71]
    s_add_u32 s44, s44, s41
    v_mfma_f32_16x16x32_bf16 v[84:87], v[116:119], v[220:223], v[84:87]
    buffer_load_dwordx4 v11, s[52:55], s49 offen offset:3072 lds
    v_mfma_f32_16x16x32_bf16 v[72:75], v[120:123], v[216:219], v[72:75]
    s_lshl_b32 s34, s37, 15
    v_mfma_f32_16x16x32_bf16 v[88:91], v[120:123], v[220:223], v[88:91]
    v_mfma_f32_16x16x32_bf16 v[76:79], v[124:127], v[216:219], v[76:79]
    v_mfma_f32_16x16x32_bf16 v[92:95], v[124:127], v[220:223], v[92:95]
    s_waitcnt vmcnt(16) lgkmcnt(0)
    v_mfma_f32_16x16x32_bf16 v[32:35], v[96:99], v[128:131], v[32:35]
    ds_read_b64_tr_b16 v[112:113], v20 offset:28672
    s_add_u32 m0, s58, 4096
    s_add_u32 s49, s12, 229376
    s_add_u32 s34, s34, s42
    s_add_u32 s34, s34, 2097152
    v_mfma_f32_16x16x32_bf16 v[48:51], v[96:99], v[132:135], v[48:51]
    ds_read_b64_tr_b16 v[114:115], v20 offset:30720
    buffer_load_dwordx4 v8, s[4:7], s49 offen lds
    v_mfma_f32_16x16x32_bf16 v[36:39], v[100:103], v[128:131], v[36:39]
    ds_read_b64_tr_b16 v[116:117], v21 offset:28672
    buffer_load_dwordx4 v9, s[4:7], s49 offen offset:1024 lds
    s_and_b32 s37, s74, 0xfffffffe
    v_mfma_f32_16x16x32_bf16 v[52:55], v[100:103], v[132:135], v[52:55]
    v_mfma_f32_16x16x32_bf16 v[40:43], v[104:107], v[128:131], v[40:43]
    ds_read_b64_tr_b16 v[118:119], v21 offset:30720
    v_mfma_f32_16x16x32_bf16 v[56:59], v[104:107], v[132:135], v[56:59]
    buffer_load_dwordx4 v10, s[4:7], s49 offen offset:2048 lds
    s_mul_i32 s45, s37, 114688
    v_mfma_f32_16x16x32_bf16 v[44:47], v[108:111], v[128:131], v[44:47]
    v_mfma_f32_16x16x32_bf16 v[60:63], v[108:111], v[132:135], v[60:63]
    ds_read_b64_tr_b16 v[120:121], v22 offset:28672
    buffer_load_dwordx4 v11, s[4:7], s49 offen offset:3072 lds
    s_add_u32 s45, s45, s41
    v_mfma_f32_16x16x32_bf16 v[64:67], a[224:227], v[224:227], v[64:67]
    v_mfma_f32_16x16x32_bf16 v[80:83], a[224:227], v[228:231], v[80:83]
    ds_read_b64_tr_b16 v[122:123], v22 offset:30720
    s_lshl_b32 s35, s37, 15
    v_mfma_f32_16x16x32_bf16 v[68:71], a[228:231], v[224:227], v[68:71]
    s_add_u32 m0, s58, 8192
    v_mfma_f32_16x16x32_bf16 v[84:87], a[228:231], v[228:231], v[84:87]
    ds_read_b64_tr_b16 v[124:125], v23 offset:28672
    s_add_u32 s49, s12, 458752
    s_add_u32 s35, s35, s42
    v_mfma_f32_16x16x32_bf16 v[72:75], a[232:235], v[224:227], v[72:75]
    buffer_load_dwordx4 v8, s[52:55], s49 offen lds
    v_mfma_f32_16x16x32_bf16 v[88:91], a[232:235], v[228:231], v[88:91]
    ds_read_b64_tr_b16 v[126:127], v23 offset:30720
    s_add_u32 s35, s35, 2097152
    v_mfma_f32_16x16x32_bf16 v[76:79], a[236:239], v[224:227], v[76:79]
    buffer_load_dwordx4 v9, s[52:55], s49 offen offset:1024 lds
    v_mfma_f32_16x16x32_bf16 v[92:95], a[236:239], v[228:231], v[92:95]
    s_mov_b32 s20, s76
    v_mfma_f32_16x16x32_bf16 v[64:67], v[96:99], v[232:235], v[64:67]
    v_mfma_f32_16x16x32_bf16 v[80:83], v[96:99], v[236:239], v[80:83]
    buffer_load_dwordx4 v10, s[52:55], s49 offen offset:2048 lds
    v_mfma_f32_16x16x32_bf16 v[68:71], v[100:103], v[232:235], v[68:71]
    s_mov_b32 s21, s77
    v_mfma_f32_16x16x32_bf16 v[84:87], v[100:103], v[236:239], v[84:87]
    buffer_load_dwordx4 v11, s[52:55], s49 offen offset:3072 lds
    v_mfma_f32_16x16x32_bf16 v[72:75], v[104:107], v[232:235], v[72:75]
    s_mov_b32 s22, 0x1c0000
    v_mfma_f32_16x16x32_bf16 v[88:91], v[104:107], v[236:239], v[88:91]
    v_mfma_f32_16x16x32_bf16 v[76:79], v[108:111], v[232:235], v[76:79]
    v_mfma_f32_16x16x32_bf16 v[92:95], v[108:111], v[236:239], v[92:95]
    s_waitcnt vmcnt(20) lgkmcnt(0)
    v_mfma_f32_16x16x32_bf16 v[32:35], v[112:115], v[136:139], v[32:35]
    s_add_u32 m0, s58, 12288
    s_add_u32 s49, s12, 458752
    s_mul_i32 s41, s14, 458752
    s_lshl_b32 s38, s59, 7
    v_mfma_f32_16x16x32_bf16 v[48:51], v[112:115], v[140:143], v[48:51]
    buffer_load_dwordx4 v8, s[4:7], s49 offen lds
    v_mfma_f32_16x16x32_bf16 v[36:39], v[116:119], v[136:139], v[36:39]
    s_add_u32 s41, s41, s38
    v_mfma_f32_16x16x32_bf16 v[52:55], v[116:119], v[140:143], v[52:55]
    v_mfma_f32_16x16x32_bf16 v[40:43], v[120:123], v[136:139], v[40:43]
    v_mfma_f32_16x16x32_bf16 v[56:59], v[120:123], v[140:143], v[56:59]
    s_mul_i32 s37, s14, 14336
    v_mfma_f32_16x16x32_bf16 v[44:47], v[124:127], v[136:139], v[44:47]
    v_mfma_f32_16x16x32_bf16 v[60:63], v[124:127], v[140:143], v[60:63]
    buffer_load_dwordx4 v9, s[4:7], s49 offen offset:1024 lds
    s_add_u32 s37, s37, 8388608
    v_mfma_f32_16x16x32_bf16 v[64:67], a[240:243], v[240:243], v[64:67]
    v_mfma_f32_16x16x32_bf16 v[80:83], a[240:243], v[244:247], v[80:83]
    s_mul_i32 s56, s73, 114688
    v_mfma_f32_16x16x32_bf16 v[68:71], a[244:247], v[240:243], v[68:71]
    v_mfma_f32_16x16x32_bf16 v[84:87], a[244:247], v[244:247], v[84:87]
    s_add_u32 s56, s56, s37
    v_mfma_f32_16x16x32_bf16 v[72:75], a[248:251], v[240:243], v[72:75]
    ds_write_b128 v5, v[32:35] offset:16384
    v_mfma_f32_16x16x32_bf16 v[88:91], a[248:251], v[244:247], v[88:91]
    ds_write_b128 v5, v[36:39] offset:17408
    v_mfma_f32_16x16x32_bf16 v[76:79], a[252:255], v[240:243], v[76:79]
    buffer_load_dwordx4 v10, s[4:7], s49 offen offset:2048 lds
    s_mul_i32 s57, s74, 114688
    v_mfma_f32_16x16x32_bf16 v[92:95], a[252:255], v[244:247], v[92:95]
    ds_write_b128 v5, v[40:43] offset:18432
    v_mfma_f32_16x16x32_bf16 v[64:67], v[112:115], v[248:251], v[64:67]
    ds_write_b128 v5, v[44:47] offset:19456
    v_mfma_f32_16x16x32_bf16 v[80:83], v[112:115], v[252:255], v[80:83]
    ds_write_b128 v5, v[48:51] offset:20480
    s_add_u32 s57, s57, s37
    v_mfma_f32_16x16x32_bf16 v[68:71], v[116:119], v[248:251], v[68:71]
    buffer_load_dwordx4 v11, s[4:7], s49 offen offset:3072 lds
    s_mov_b32 s28, s78
    v_mfma_f32_16x16x32_bf16 v[84:87], v[116:119], v[252:255], v[84:87]
    ds_write_b128 v5, v[52:55] offset:21504
    v_mfma_f32_16x16x32_bf16 v[72:75], v[120:123], v[248:251], v[72:75]
    ds_write_b128 v5, v[56:59] offset:22528
    v_mfma_f32_16x16x32_bf16 v[88:91], v[120:123], v[252:255], v[88:91]
    ds_write_b128 v5, v[60:63] offset:23552
    s_mov_b32 s29, s79
    v_mfma_f32_16x16x32_bf16 v[76:79], v[124:127], v[248:251], v[76:79]
    v_mfma_f32_16x16x32_bf16 v[92:95], v[124:127], v[252:255], v[92:95]
    ds_write_b128 v5, v[64:67] offset:24576
    ds_write_b128 v5, v[68:71] offset:25600
    ds_write_b128 v5, v[72:75] offset:26624
    s_nop 3
    ds_write_b128 v5, v[76:79] offset:27648
    ds_write_b128 v5, v[80:83] offset:28672
    ds_write_b128 v5, v[84:87] offset:29696
    ds_write_b128 v5, v[88:91] offset:30720
    ds_write_b128 v5, v[92:95] offset:31744
    v_permlane16_swap_b32 v24, v26
    v_permlane16_swap_b32 v25, v27
    v_permlane16_swap_b32 v28, v30
    v_permlane16_swap_b32 v29, v31
    v_lshlrev_b32 v96, 16, v24
    v_and_b32 v97, 0xffff0000, v24
    v_lshlrev_b32 v98, 16, v25
    v_and_b32 v99, 0xffff0000, v25
    v_lshlrev_b32 v100, 16, v26
    v_and_b32 v101, 0xffff0000, v26
    v_lshlrev_b32 v102, 16, v27
    v_and_b32 v103, 0xffff0000, v27
    v_lshlrev_b32 v104, 16, v28
    v_and_b32 v105, 0xffff0000, v28
    v_lshlrev_b32 v106, 16, v29
    v_and_b32 v107, 0xffff0000, v29
    v_lshlrev_b32 v108, 16, v30
    v_and_b32 v109, 0xffff0000, v30
    v_lshlrev_b32 v110, 16, v31
    v_and_b32 v111, 0xffff0000, v31
    s_waitcnt lgkmcnt(0)
    s_barrier
    ds_read_b128 v[32:35], v7 offset:16384
    ds_read_b128 v[36:39], v7 offset:17408
    ds_read_b128 v[40:43], v7 offset:49152
    ds_read_b128 v[44:47], v7 offset:50176
    ds_read_b128 v[48:51], v2 offset:16384
    ds_read_b128 v[52:55], v2 offset:17408
    ds_read_b128 v[56:59], v2 offset:49152
    ds_read_b128 v[60:63], v2 offset:50176
    ds_read_b128 v[64:67], v7 offset:24576
    ds_read_b128 v[68:71], v7 offset:25600
    ds_read_b128 v[72:75], v7 offset:57344
    ds_read_b128 v[76:79], v7 offset:58368
    ds_read_b128 v[80:83], v2 offset:24576
    ds_read_b128 v[84:87], v2 offset:25600
    ds_read_b128 v[88:91], v2 offset:57344
    ds_read_b128 v[92:95], v2 offset:58368
    s_waitcnt lgkmcnt(8)
    v_pk_add_f32 v[32:33], v[32:33], v[40:41]
    v_pk_add_f32 v[34:35], v[34:35], v[42:43]
    v_pk_add_f32 v[36:37], v[36:37], v[44:45]
    v_pk_add_f32 v[38:39], v[38:39], v[46:47]
    v_pk_add_f32 v[48:49], v[48:49], v[56:57]
    v_pk_add_f32 v[50:51], v[50:51], v[58:59]
    v_pk_add_f32 v[52:53], v[52:53], v[60:61]
    v_pk_add_f32 v[54:55], v[54:55], v[62:63]
    v_pk_add_f32 v[32:33], v[32:33], v[48:49]
    v_pk_add_f32 v[34:35], v[34:35], v[50:51]
    v_pk_add_f32 v[36:37], v[36:37], v[52:53]
    v_pk_add_f32 v[38:39], v[38:39], v[54:55]
    v_cvt_pk_bf16_f32 v40, v32, v33
    v_cvt_pk_bf16_f32 v41, v34, v35
    v_cvt_pk_bf16_f32 v42, v36, v37
    v_cvt_pk_bf16_f32 v43, v38, v39
    v_lshlrev_b32 v32, 16, v40
    v_and_b32 v33, 0xffff0000, v40
    v_lshlrev_b32 v34, 16, v41
    v_and_b32 v35, 0xffff0000, v41
    v_lshlrev_b32 v36, 16, v42
    v_and_b32 v37, 0xffff0000, v42
    v_lshlrev_b32 v38, 16, v43
    v_and_b32 v39, 0xffff0000, v43
    v_pk_add_f32 v[32:33], v[32:33], v[96:97]
    v_pk_add_f32 v[34:35], v[34:35], v[98:99]
    v_pk_add_f32 v[36:37], v[36:37], v[100:101]
    v_pk_add_f32 v[38:39], v[38:39], v[102:103]
    v_cvt_pk_bf16_f32 v24, v32, v33
    v_cvt_pk_bf16_f32 v25, v34, v35
    v_cvt_pk_bf16_f32 v26, v36, v37
    v_cvt_pk_bf16_f32 v27, v38, v39
    buffer_store_dwordx4 v[24:27], v6, s[24:27], s51 offen sc1
    s_waitcnt lgkmcnt(0)
    v_pk_add_f32 v[64:65], v[64:65], v[72:73]
    v_pk_add_f32 v[66:67], v[66:67], v[74:75]
    v_pk_add_f32 v[68:69], v[68:69], v[76:77]
    v_pk_add_f32 v[70:71], v[70:71], v[78:79]
    v_pk_add_f32 v[80:81], v[80:81], v[88:89]
    v_pk_add_f32 v[82:83], v[82:83], v[90:91]
    v_pk_add_f32 v[84:85], v[84:85], v[92:93]
    v_pk_add_f32 v[86:87], v[86:87], v[94:95]
    v_pk_add_f32 v[64:65], v[64:65], v[80:81]
    v_pk_add_f32 v[66:67], v[66:67], v[82:83]
    v_pk_add_f32 v[68:69], v[68:69], v[84:85]
    v_pk_add_f32 v[70:71], v[70:71], v[86:87]
    v_cvt_pk_bf16_f32 v72, v64, v65
    v_cvt_pk_bf16_f32 v73, v66, v67
    v_cvt_pk_bf16_f32 v74, v68, v69
    v_cvt_pk_bf16_f32 v75, v70, v71
    v_lshlrev_b32 v64, 16, v72
    v_and_b32 v65, 0xffff0000, v72
    v_lshlrev_b32 v66, 16, v73
    v_and_b32 v67, 0xffff0000, v73
    v_lshlrev_b32 v68, 16, v74
    v_and_b32 v69, 0xffff0000, v74
    v_lshlrev_b32 v70, 16, v75
    v_and_b32 v71, 0xffff0000, v75
    v_pk_add_f32 v[64:65], v[64:65], v[104:105]
    v_pk_add_f32 v[66:67], v[66:67], v[106:107]
    v_pk_add_f32 v[68:69], v[68:69], v[108:109]
    v_pk_add_f32 v[70:71], v[70:71], v[110:111]
    v_cvt_pk_bf16_f32 v28, v64, v65
    v_cvt_pk_bf16_f32 v29, v66, v67
    v_cvt_pk_bf16_f32 v30, v68, v69
    v_cvt_pk_bf16_f32 v31, v70, v71
    buffer_store_dwordx4 v[28:31], v6, s[24:27], s19 offen sc1
    v_lshlrev_b32 v32, 16, v24
    v_and_b32 v33, 0xffff0000, v24
    v_lshlrev_b32 v34, 16, v25
    v_and_b32 v35, 0xffff0000, v25
    v_lshlrev_b32 v36, 16, v26
    v_and_b32 v37, 0xffff0000, v26
    v_lshlrev_b32 v38, 16, v27
    v_and_b32 v39, 0xffff0000, v27
    v_lshlrev_b32 v40, 16, v28
    v_and_b32 v41, 0xffff0000, v28
    v_lshlrev_b32 v42, 16, v29
    v_and_b32 v43, 0xffff0000, v29
    v_lshlrev_b32 v44, 16, v30
    v_and_b32 v45, 0xffff0000, v30
    v_lshlrev_b32 v46, 16, v31
    v_and_b32 v47, 0xffff0000, v31
    v_add_f32 v64, v32, v33
    v_mul_f32 v65, v32, v32
    v_add_f32 v66, v40, v41
    v_mul_f32 v67, v40, v40
    v_add_f32 v64, v64, v34
    v_fmac_f32 v65, v33, v33
    v_add_f32 v66, v66, v42
    v_fmac_f32 v67, v41, v41
    v_add_f32 v64, v64, v35
    v_fmac_f32 v65, v34, v34
    v_add_f32 v66, v66, v43
    v_fmac_f32 v67, v42, v42
    v_add_f32 v64, v64, v36
    v_fmac_f32 v65, v35, v35
    v_add_f32 v66, v66, v44
    v_fmac_f32 v67, v43, v43
    v_add_f32 v64, v64, v37
    v_fmac_f32 v65, v36, v36
    v_add_f32 v66, v66, v45
    v_fmac_f32 v67, v44, v44
    v_add_f32 v64, v64, v38
    v_fmac_f32 v65, v37, v37
    v_add_f32 v66, v66, v46
    v_fmac_f32 v67, v45, v45
    v_add_f32 v64, v64, v39
    v_fmac_f32 v65, v38, v38
    v_add_f32 v66, v66, v47
    v_fmac_f32 v67, v46, v46
    v_fmac_f32 v65, v39, v39
    v_fmac_f32 v67, v47, v47
    v_mov_b32 v68, v64
    v_mov_b32 v69, v65
    v_mov_b32 v70, v66
    v_mov_b32 v71, v67
    v_permlane32_swap_b32 v64, v68
    v_permlane32_swap_b32 v65, v69
    v_permlane32_swap_b32 v66, v70
    v_permlane32_swap_b32 v67, v71
    v_add_f32 v64, v64, v68
    v_add_f32 v65, v65, v69
    v_add_f32 v66, v66, v70
    v_add_f32 v67, v67, v71
    v_mov_b32 v68, v64
    v_mov_b32 v69, v65
    v_mov_b32 v70, v66
    v_mov_b32 v71, v67
    v_permlane16_swap_b32 v64, v68
    v_permlane16_swap_b32 v65, v69
    v_permlane16_swap_b32 v66, v70
    v_permlane16_swap_b32 v67, v71
    v_add_f32 v64, v64, v68
    v_add_f32 v65, v65, v69
    v_add_f32 v66, v66, v70
    v_add_f32 v67, v67, v71
    buffer_store_dwordx4 v[64:67], v4, s[24:27], s72 offen sc1
    s_and_b32 s37, s32, 11
    s_cmp_eq_u32 s37, 11
    s_cbranch_scc1 T_IDLE
    v_add_u32 v192, 0, v12
    v_xor_b32 v193, 32, v192
    v_add_u32 v194, 65536, v12
    v_xor_b32 v195, 32, v194
    v_add_u32 v196, 131072, v12
    v_xor_b32 v197, 32, v196
    v_mov_b32 v200, s40
    v_mov_b32 v201, s40
    v_mov_b32 v202, s40
    v_mov_b32 v203, s40
    s_waitcnt vmcnt(19)
    s_barrier
    s_add_u32 m0, s58, 16384
    s_add_u32 s49, s12, 688128
    buffer_load_dwordx4 v8, s[52:55], s49 offen lds
    buffer_load_dwordx4 v9, s[52:55], s49 offen offset:1024 lds
    buffer_load_dwordx4 v10, s[52:55], s49 offen offset:2048 lds
    buffer_load_dwordx4 v11, s[52:55], s49 offen offset:3072 lds
    s_add_u32 m0, s58, 20480
    s_add_u32 s49, s12, 688128
    buffer_load_dwordx4 v8, s[4:7], s49 offen lds
    buffer_load_dwordx4 v9, s[4:7], s49 offen offset:1024 lds
    buffer_load_dwordx4 v10, s[4:7], s49 offen offset:2048 lds
    buffer_load_dwordx4 v11, s[4:7], s49 offen offset:3072 lds
    s_waitcnt vmcnt(8) lgkmcnt(0)
    s_barrier
    s_lshl_b32 s48, s15, 2
    s_add_u32 s48, s48, s68
    v_mov_b32 v15, s70
    buffer_store_dword v15, v1, s[24:27], s48 offen offset:1024 sc1
    ds_read_b64_tr_b16 a[0:1], v196 offset:0
    ds_read_b64_tr_b16 a[2:3], v196 offset:8192
    ds_read_b64_tr_b16 a[4:5], v197 offset:0
    ds_read_b64_tr_b16 a[6:7], v197 offset:8192
    ds_read_b64_tr_b16 a[8:9], v196 offset:4096
    ds_read_b64_tr_b16 a[10:11], v196 offset:12288
    ds_read_b64_tr_b16 a[12:13], v197 offset:4096
    ds_read_b64_tr_b16 a[14:15], v197 offset:12288
    ds_read_b64_tr_b16 a[16:17], v196 offset:16384
    ds_read_b64_tr_b16 a[18:19], v196 offset:24576
    ds_read_b64_tr_b16 a[20:21], v197 offset:16384
    ds_read_b64_tr_b16 a[22:23], v197 offset:24576
    ds_read_b64_tr_b16 a[24:25], v196 offset:20480
    ds_read_b64_tr_b16 a[26:27], v196 offset:28672
    ds_read_b64_tr_b16 a[28:29], v197 offset:20480
    ds_read_b64_tr_b16 a[30:31], v197 offset:28672
    s_add_u32 m0, s58, 24576
    s_add_u32 s49, s12, 917504
    buffer_load_dwordx4 v8, s[52:55], s49 offen lds
    buffer_load_dwordx4 v9, s[52:55], s49 offen offset:1024 lds
    buffer_load_dwordx4 v10, s[52:55], s49 offen offset:2048 lds
    buffer_load_dwordx4 v11, s[52:55], s49 offen offset:3072 lds
    s_add_u32 m0, s58, 28672
    s_add_u32 s49, s12, 917504
    buffer_load_dwordx4 v8, s[4:7], s49 offen lds
    buffer_load_dwordx4 v9, s[4:7], s49 offen offset:1024 lds
    buffer_load_dwordx4 v10, s[4:7], s49 offen offset:2048 lds
    buffer_load_dwordx4 v11, s[4:7], s49 offen offset:3072 lds
    s_waitcnt vmcnt(28) lgkmcnt(0)
    s_barrier
    v_mfma_f32_16x16x32_bf16 v[204:207], v[200:203], a[0:3], 0
    ds_read_b64_tr_b16 a[32:33], v192 offset:0
    s_add_u32 m0, s36, 0
    s_add_u32 s49, s12, 1146880
    buffer_load_dwordx4 v8, s[52:55], s49 offen lds
    v_mfma_f32_16x16x32_bf16 v[204:207], v[200:203], a[16:19], v[204:207]
    ds_read_b64_tr_b16 a[34:35], v192 offset:32768
    ds_read_b64_tr_b16 a[36:37], v193 offset:0
    ds_read_b64_tr_b16 a[38:39], v193 offset:32768
    ds_read_b64_tr_b16 a[40:41], v192 offset:4096
    v_mfma_f32_16x16x32_bf16 v[208:211], v[200:203], a[4:7], 0
    ds_read_b64_tr_b16 a[42:43], v192 offset:36864
    ds_read_b64_tr_b16 a[44:45], v193 offset:4096
    buffer_load_dwordx4 v9, s[52:55], s49 offen offset:1024 lds
    v_mfma_f32_16x16x32_bf16 v[208:211], v[200:203], a[20:23], v[208:211]
    ds_read_b64_tr_b16 a[46:47], v193 offset:36864
    ds_read_b64_tr_b16 a[48:49], v194 offset:0
    buffer_load_dwordx4 v10, s[52:55], s49 offen offset:2048 lds
    v_mfma_f32_16x16x32_bf16 v[212:215], v[200:203], a[8:11], 0
    ds_read_b64_tr_b16 a[50:51], v194 offset:32768
    ds_read_b64_tr_b16 a[52:53], v195 offset:0
    buffer_load_dwordx4 v11, s[52:55], s49 offen offset:3072 lds
    v_mfma_f32_16x16x32_bf16 v[212:215], v[200:203], a[24:27], v[212:215]
    ds_read_b64_tr_b16 a[54:55], v195 offset:32768
    ds_read_b64_tr_b16 a[56:57], v194 offset:4096
    ds_read_b64_tr_b16 a[58:59], v194 offset:36864
    ds_read_b64_tr_b16 a[60:61], v195 offset:4096
    ds_read_b64_tr_b16 a[62:63], v195 offset:36864
    v_mfma_f32_16x16x32_bf16 v[216:219], v[200:203], a[12:15], 0
    s_add_u32 m0, s36, 4096
    s_add_u32 s49, s12, 1146880
    buffer_load_dwordx4 v8, s[4:7], s49 offen lds
    buffer_load_dwordx4 v9, s[4:7], s49 offen offset:1024 lds
    v_mfma_f32_16x16x32_bf16 v[216:219], v[200:203], a[28:31], v[216:219]
    buffer_load_dwordx4 v10, s[4:7], s49 offen offset:2048 lds
    buffer_load_dwordx4 v11, s[4:7], s49 offen offset:3072 lds
    s_waitcnt vmcnt(28) lgkmcnt(0)
    s_barrier
    v_mfma_f32_16x16x32_bf16 v[204:207], v[200:203], a[32:35], v[204:207]
    ds_read_b64_tr_b16 a[64:65], v192 offset:8192
    s_add_u32 m0, s58, 0
    s_add_u32 s49, s12, 1376256
    buffer_load_dwordx4 v8, s[52:55], s49 offen lds
    v_mfma_f32_16x16x32_bf16 v[204:207], v[200:203], a[48:51], v[204:207]
    ds_read_b64_tr_b16 a[66:67], v192 offset:40960
    ds_read_b64_tr_b16 a[68:69], v193 offset:8192
    ds_read_b64_tr_b16 a[70:71], v193 offset:40960
    ds_read_b64_tr_b16 a[72:73], v192 offset:12288
    v_mfma_f32_16x16x32_bf16 v[208:211], v[200:203], a[36:39], v[208:211]
    ds_read_b64_tr_b16 a[74:75], v192 offset:45056
    ds_read_b64_tr_b16 a[76:77], v193 offset:12288
    buffer_load_dwordx4 v9, s[52:55], s49 offen offset:1024 lds
    v_mfma_f32_16x16x32_bf16 v[208:211], v[200:203], a[52:55], v[208:211]
    ds_read_b64_tr_b16 a[78:79], v193 offset:45056
    ds_read_b64_tr_b16 a[80:81], v194 offset:8192
    buffer_load_dwordx4 v10, s[52:55], s49 offen offset:2048 lds
    v_mfma_f32_16x16x32_bf16 v[212:215], v[200:203], a[40:43], v[212:215]
    ds_read_b64_tr_b16 a[82:83], v194 offset:40960
    ds_read_b64_tr_b16 a[84:85], v195 offset:8192
    buffer_load_dwordx4 v11, s[52:55], s49 offen offset:3072 lds
    v_mfma_f32_16x16x32_bf16 v[212:215], v[200:203], a[56:59], v[212:215]
    ds_read_b64_tr_b16 a[86:87], v195 offset:40960
    ds_read_b64_tr_b16 a[88:89], v194 offset:12288
    ds_read_b64_tr_b16 a[90:91], v194 offset:45056
    ds_read_b64_tr_b16 a[92:93], v195 offset:12288
    ds_read_b64_tr_b16 a[94:95], v195 offset:45056
    v_mfma_f32_16x16x32_bf16 v[216:219], v[200:203], a[44:47], v[216:219]
    s_add_u32 m0, s58, 4096
    s_add_u32 s49, s12, 1376256
    buffer_load_dwordx4 v8, s[4:7], s49 offen lds
    buffer_load_dwordx4 v9, s[4:7], s49 offen offset:1024 lds
    v_mfma_f32_16x16x32_bf16 v[216:219], v[200:203], a[60:63], v[216:219]
    buffer_load_dwordx4 v10, s[4:7], s49 offen offset:2048 lds
    buffer_load_dwordx4 v11, s[4:7], s49 offen offset:3072 lds
    s_waitcnt vmcnt(25) lgkmcnt(0)
    s_barrier
    v_mfma_f32_16x16x32_bf16 v[204:207], v[200:203], a[64:67], v[204:207]
    ds_read_b64_tr_b16 a[96:97], v192 offset:16384
    s_add_u32 m0, s58, 8192
    s_add_u32 s49, s12, 1605632
    buffer_load_dwordx4 v8, s[52:55], s49 offen lds
    v_mfma_f32_16x16x32_bf16 v[204:207], v[200:203], a[80:83], v[204:207]
    ds_read_b64_tr_b16 a[98:99], v192 offset:49152
    ds_read_b64_tr_b16 a[100:101], v193 offset:16384
    ds_read_b64_tr_b16 a[102:103], v193 offset:49152
    ds_read_b64_tr_b16 a[104:105], v192 offset:20480
    v_mfma_f32_16x16x32_bf16 v[208:211], v[200:203], a[68:71], v[208:211]
    ds_read_b64_tr_b16 a[106:107], v192 offset:53248
    ds_read_b64_tr_b16 a[108:109], v193 offset:20480
    buffer_load_dwordx4 v9, s[52:55], s49 offen offset:1024 lds
    v_mfma_f32_16x16x32_bf16 v[208:211], v[200:203], a[84:87], v[208:211]
    ds_read_b64_tr_b16 a[110:111], v193 offset:53248
    ds_read_b64_tr_b16 a[112:113], v194 offset:16384
    buffer_load_dwordx4 v10, s[52:55], s49 offen offset:2048 lds
    v_mfma_f32_16x16x32_bf16 v[212:215], v[200:203], a[72:75], v[212:215]
    ds_read_b64_tr_b16 a[114:115], v194 offset:49152
    ds_read_b64_tr_b16 a[116:117], v195 offset:16384
    buffer_load_dwordx4 v11, s[52:55], s49 offen offset:3072 lds
    v_mfma_f32_16x16x32_bf16 v[212:215], v[200:203], a[88:91], v[212:215]
    ds_read_b64_tr_b16 a[118:119], v195 offset:49152
    ds_read_b64_tr_b16 a[120:121], v194 offset:20480
    ds_read_b64_tr_b16 a[122:123], v194 offset:53248
    ds_read_b64_tr_b16 a[124:125], v195 offset:20480
    ds_read_b64_tr_b16 a[126:127], v195 offset:53248
    v_mfma_f32_16x16x32_bf16 v[216:219], v[200:203], a[76:79], v[216:219]
    s_add_u32 m0, s58, 12288
    s_add_u32 s49, s12, 1605632
    buffer_load_dwordx4 v8, s[4:7], s49 offen lds
    buffer_load_dwordx4 v9, s[4:7], s49 offen offset:1024 lds
    v_mfma_f32_16x16x32_bf16 v[216:219], v[200:203], a[92:95], v[216:219]
    buffer_load_dwordx4 v10, s[4:7], s49 offen offset:2048 lds
    buffer_load_dwordx4 v11, s[4:7], s49 offen offset:3072 lds
    s_waitcnt vmcnt(24) lgkmcnt(0)
    s_barrier
    v_mfma_f32_16x16x32_bf16 v[204:207], v[200:203], a[96:99], v[204:207]
    ds_read_b64_tr_b16 a[128:129], v192 offset:24576
    ds_read_b64_tr_b16 a[130:131], v192 offset:57344
    ds_read_b64_tr_b16 a[132:133], v193 offset:24576
    ds_read_b64_tr_b16 a[134:135], v193 offset:57344
    v_mfma_f32_16x16x32_bf16 v[204:207], v[200:203], a[112:115], v[204:207]
    ds_read_b64_tr_b16 a[136:137], v192 offset:28672
    ds_read_b64_tr_b16 a[138:139], v192 offset:61440
    ds_read_b64_tr_b16 a[140:141], v193 offset:28672
    ds_read_b64_tr_b16 a[142:143], v193 offset:61440
    v_mfma_f32_16x16x32_bf16 v[208:211], v[200:203], a[100:103], v[208:211]
    ds_read_b64_tr_b16 a[144:145], v194 offset:24576
    ds_read_b64_tr_b16 a[146:147], v194 offset:57344
    ds_read_b64_tr_b16 a[148:149], v195 offset:24576
    ds_read_b64_tr_b16 a[150:151], v195 offset:57344
    v_mfma_f32_16x16x32_bf16 v[208:211], v[200:203], a[116:119], v[208:211]
    ds_read_b64_tr_b16 a[152:153], v194 offset:28672
    ds_read_b64_tr_b16 a[154:155], v194 offset:61440
    ds_read_b64_tr_b16 a[156:157], v195 offset:28672
    v_mfma_f32_16x16x32_bf16 v[212:215], v[200:203], a[104:107], v[212:215]
    ds_read_b64_tr_b16 a[158:159], v195 offset:61440
    v_mfma_f32_16x16x32_bf16 v[212:215], v[200:203], a[120:123], v[212:215]
    v_mfma_f32_16x16x32_bf16 v[216:219], v[200:203], a[108:111], v[216:219]
    v_mfma_f32_16x16x32_bf16 v[216:219], v[200:203], a[124:127], v[216:219]
    s_waitcnt vmcnt(16) lgkmcnt(0)
    s_barrier
    v_mfma_f32_16x16x32_bf16 v[204:207], v[200:203], a[128:131], v[204:207]
    ds_read_b64_tr_b16 a[160:161], v196 offset:0
    ds_read_b64_tr_b16 a[162:163], v196 offset:8192
    ds_read_b64_tr_b16 a[164:165], v197 offset:0
    ds_read_b64_tr_b16 a[166:167], v197 offset:8192
    v_mfma_f32_16x16x32_bf16 v[204:207], v[200:203], a[144:147], v[204:207]
    v_subrev_u32 v20, s58, v20
    v_add_u32 v8, s36, v20
    v_add_u32 v20, s42, v20
    v_subrev_u32 v21, s58, v21
    v_add_u32 v9, s36, v21
    v_add_u32 v21, s42, v21
    v_subrev_u32 v22, s58, v22
    v_add_u32 v10, s36, v22
    v_add_u32 v22, s42, v22
    v_subrev_u32 v23, s58, v23
    v_add_u32 v11, s36, v23
    v_add_u32 v23, s42, v23
    v_mfma_f32_16x16x32_bf16 v[208:211], v[200:203], a[132:135], v[208:211]
    ds_read_b64_tr_b16 a[168:169], v196 offset:4096
    ds_read_b64_tr_b16 a[170:171], v196 offset:12288
    ds_read_b64_tr_b16 a[172:173], v197 offset:4096
    ds_read_b64_tr_b16 a[174:175], v197 offset:12288
    v_mfma_f32_16x16x32_bf16 v[208:211], v[200:203], a[148:151], v[208:211]
    ds_read_b64_tr_b16 a[176:177], v196 offset:16384
    ds_read_b64_tr_b16 a[178:179], v196 offset:24576
    ds_read_b64_tr_b16 a[180:181], v197 offset:16384
    ds_read_b64_tr_b16 a[182:183], v197 offset:24576
    v_mfma_f32_16x16x32_bf16 v[212:215], v[200:203], a[136:139], v[212:215]
    ds_read_b64_tr_b16 a[184:185], v196 offset:20480
    ds_read_b64_tr_b16 a[186:187], v196 offset:28672
    ds_read_b64_tr_b16 a[188:189], v197 offset:20480
    ds_read_b64_tr_b16 a[190:191], v197 offset:28672
    v_mfma_f32_16x16x32_bf16 v[212:215], v[200:203], a[152:155], v[212:215]
    v_mfma_f32_16x16x32_bf16 v[216:219], v[200:203], a[140:143], v[216:219]
    v_mfma_f32_16x16x32_bf16 v[216:219], v[200:203], a[156:159], v[216:219]
    s_waitcnt vmcnt(8) lgkmcnt(0)
    s_barrier
    v_mfma_f32_16x16x32_bf16 v[204:207], v[200:203], a[160:163], v[204:207]
    ds_read_b64_tr_b16 a[192:193], v192 offset:0
    ds_read_b64_tr_b16 a[194:195], v192 offset:32768
    ds_read_b64_tr_b16 a[196:197], v193 offset:0
    ds_read_b64_tr_b16 a[198:199], v193 offset:32768
    v_mfma_f32_16x16x32_bf16 v[204:207], v[200:203], a[176:179], v[204:207]
    v_and_b32 v13, 15, v0
    v_lshlrev_b32 v13, 2, v13
    buffer_load_dword v14, v13, s[24:27], s75 offen offset:1024 sc1
    v_mfma_f32_16x16x32_bf16 v[208:211], v[200:203], a[164:167], v[208:211]
    ds_read_b64_tr_b16 a[200:201], v192 offset:4096
    ds_read_b64_tr_b16 a[202:203], v192 offset:36864
    ds_read_b64_tr_b16 a[204:205], v193 offset:4096
    ds_read_b64_tr_b16 a[206:207], v193 offset:36864
    v_mfma_f32_16x16x32_bf16 v[208:211], v[200:203], a[180:183], v[208:211]
    ds_read_b64_tr_b16 a[208:209], v194 offset:0
    ds_read_b64_tr_b16 a[210:211], v194 offset:32768
    ds_read_b64_tr_b16 a[212:213], v195 offset:0
    ds_read_b64_tr_b16 a[214:215], v195 offset:32768
    v_mfma_f32_16x16x32_bf16 v[212:215], v[200:203], a[168:171], v[212:215]
    ds_read_b64_tr_b16 a[216:217], v194 offset:4096
    ds_read_b64_tr_b16 a[218:219], v194 offset:36864
    ds_read_b64_tr_b16 a[220:221], v195 offset:4096
    ds_read_b64_tr_b16 a[222:223], v195 offset:36864
    v_mfma_f32_16x16x32_bf16 v[212:215], v[200:203], a[184:187], v[212:215]
    v_mfma_f32_16x16x32_bf16 v[216:219], v[200:203], a[172:175], v[216:219]
    v_mfma_f32_16x16x32_bf16 v[216:219], v[200:203], a[188:191], v[216:219]
    s_waitcnt vmcnt(1) lgkmcnt(0)
    s_barrier
    v_mfma_f32_16x16x32_bf16 v[204:207], v[200:203], a[192:195], v[204:207]
    ds_read_b64_tr_b16 a[224:225], v192 offset:8192
    ds_read_b64_tr_b16 a[226:227], v192 offset:40960
    ds_read_b64_tr_b16 a[228:229], v193 offset:8192
    ds_read_b64_tr_b16 a[230:231], v193 offset:40960
    v_mfma_f32_16x16x32_bf16 v[204:207], v[200:203], a[208:211], v[204:207]
    ds_read_b64_tr_b16 a[232:233], v192 offset:12288
    ds_read_b64_tr_b16 a[234:235], v192 offset:45056
    ds_read_b64_tr_b16 a[236:237], v193 offset:12288
    ds_read_b64_tr_b16 a[238:239], v193 offset:45056
    v_mfma_f32_16x16x32_bf16 v[208:211], v[200:203], a[196:199], v[208:211]
    ds_read_b64_tr_b16 a[240:241], v194 offset:8192
    ds_read_b64_tr_b16 a[242:243], v194 offset:40960
    ds_read_b64_tr_b16 a[244:245], v195 offset:8192
    ds_read_b64_tr_b16 a[246:247], v195 offset:40960
    v_mfma_f32_16x16x32_bf16 v[208:211], v[200:203], a[212:215], v[208:211]
    ds_read_b64_tr_b16 a[248:249], v194 offset:12288
    ds_read_b64_tr_b16 a[250:251], v194 offset:45056
    ds_read_b64_tr_b16 a[252:253], v195 offset:12288
    v_mfma_f32_16x16x32_bf16 v[212:215], v[200:203], a[200:203], v[212:215]
    ds_read_b64_tr_b16 a[254:255], v195 offset:45056
    v_mfma_f32_16x16x32_bf16 v[212:215], v[200:203], a[216:219], v[212:215]
    v_mfma_f32_16x16x32_bf16 v[216:219], v[200:203], a[204:207], v[216:219]
    v_mfma_f32_16x16x32_bf16 v[216:219], v[200:203], a[220:223], v[216:219]
    s_waitcnt vmcnt(0) lgkmcnt(0)
    s_barrier
    v_mfma_f32_16x16x32_bf16 v[204:207], v[200:203], a[224:227], v[204:207]
    v_mfma_f32_16x16x32_bf16 v[204:207], v[200:203], a[240:243], v[204:207]
    v_mfma_f32_16x16x32_bf16 v[208:211], v[200:203], a[228:231], v[208:211]
    v_mfma_f32_16x16x32_bf16 v[208:211], v[200:203], a[244:247], v[208:211]
    v_mfma_f32_16x16x32_bf16 v[212:215], v[200:203], a[232:235], v[212:215]
    v_mfma_f32_16x16x32_bf16 v[212:215], v[200:203], a[248:251], v[212:215]
    v_mfma_f32_16x16x32_bf16 v[216:219], v[200:203], a[236:239], v[216:219]
    v_mfma_f32_16x16x32_bf16 v[216:219], v[200:203], a[252:255], v[216:219]
    v_cmp_ne_u32 vcc, s70, v14
    s_nop 0
    s_cbranch_vccnz T_SPH
T_SPHR:
    v_add_u32 v12, 0x10000, v6
    s_add_u32 m0, s42, 0
    s_add_u32 s37, s34, 0
    buffer_load_dwordx4 v6, s[24:27], s37 offen sc1 lds
    buffer_load_dwordx4 v6, s[24:27], s37 offen offset:1024 sc1 lds
    buffer_load_dwordx4 v6, s[24:27], s37 offen offset:2048 sc1 lds
    buffer_load_dwordx4 v6, s[24:27], s37 offen offset:3072 sc1 lds
    s_add_u32 m0, s42, 4096
    s_add_u32 s37, s34, 4096
    buffer_load_dwordx4 v6, s[24:27], s37 offen sc1 lds
    buffer_load_dwordx4 v6, s[24:27], s37 offen offset:1024 sc1 lds
    buffer_load_dwordx4 v6, s[24:27], s37 offen offset:2048 sc1 lds
    buffer_load_dwordx4 v6, s[24:27], s37 offen offset:3072 sc1 lds
    s_add_u32 s38, s46, 0
    buffer_load_dwordx4 v[32:35], v6, s[24:27], s38 offen offset:0 sc1
    buffer_load_dwordx4 v[36:39], v6, s[24:27], s38 offen offset:1024 sc1
    buffer_load_dwordx4 v[40:43], v6, s[24:27], s38 offen offset:2048 sc1
    buffer_load_dwordx4 v[44:47], v6, s[24:27], s38 offen offset:3072 sc1
    s_add_u32 s38, s46, 4096
    buffer_load_dwordx4 v[48:51], v6, s[24:27], s38 offen offset:0 sc1
    buffer_load_dwordx4 v[52:55], v6, s[24:27], s38 offen offset:1024 sc1
    buffer_load_dwordx4 v[56:59], v6, s[24:27], s38 offen offset:2048 sc1
    buffer_load_dwordx4 v[60:63], v6, s[24:27], s38 offen offset:3072 sc1
    s_add_u32 m0, s42, 8192
    s_add_u32 s37, s34, 8192
    buffer_load_dwordx4 v6, s[24:27], s37 offen sc1 lds
    buffer_load_dwordx4 v6, s[24:27], s37 offen offset:1024 sc1 lds
    buffer_load_dwordx4 v6, s[24:27], s37 offen offset:2048 sc1 lds
    buffer_load_dwordx4 v6, s[24:27], s37 offen offset:3072 sc1 lds
    v_mul_f32 v163, 0x3e800000, v204
    v_mul_f32 v167, 0x3e800000, v208
    v_mul_f32 v171, 0x3e800000, v212
    v_mul_f32 v175, 0x3e800000, v216
    v_cvt_pk_bf16_f32 v160, v163, v163
    v_cvt_pk_bf16_f32 v164, v167, v167
    v_cvt_pk_bf16_f32 v168, v171, v171
    v_cvt_pk_bf16_f32 v172, v175, v175
    v_lshlrev_b32 v160, 16, v160
    v_lshlrev_b32 v164, 16, v164
    v_lshlrev_b32 v168, 16, v168
    v_lshlrev_b32 v172, 16, v172
    v_sub_f32 v161, v163, v160
    v_sub_f32 v165, v167, v164
    v_sub_f32 v169, v171, v168
    v_sub_f32 v173, v175, v172
    v_cvt_pk_bf16_f32 v204, v160, v161
    v_cvt_pk_bf16_f32 v208, v164, v165
    v_cvt_pk_bf16_f32 v212, v168, v169
    v_cvt_pk_bf16_f32 v216, v172, v173
    v_and_b32 v162, 0xffff0000, v204
    v_and_b32 v166, 0xffff0000, v208
    v_and_b32 v170, 0xffff0000, v212
    v_and_b32 v174, 0xffff0000, v216
    v_sub_f32 v161, v161, v162
    v_sub_f32 v165, v165, v166
    v_sub_f32 v169, v169, v170
    v_sub_f32 v173, v173, v174
    v_cvt_pk_bf16_f32 v205, v161, 0
    v_cvt_pk_bf16_f32 v209, v165, 0
    v_cvt_pk_bf16_f32 v213, v169, 0
    v_cvt_pk_bf16_f32 v217, v173, 0
    v_mov_b32 v206, 0
    v_mov_b32 v210, 0
    v_mov_b32 v214, 0
    v_mov_b32 v218, 0
    v_mov_b32 v207, 0
    v_mov_b32 v211, 0
    v_mov_b32 v215, 0
    v_mov_b32 v219, 0
    v_mov_b32 v238, 0
    v_mov_b32 v242, 0
    v_mov_b32 v246, 0
    v_mov_b32 v250, 0
    v_mov_b32 v239, 0
    v_mov_b32 v243, 0
    v_mov_b32 v247, 0
    v_mov_b32 v251, 0
    s_waitcnt vmcnt(16)
    s_barrier
    ds_read_b128 v[160:163], v6 offset:0
    ds_read_b128 v[164:167], v6 offset:1024
    ds_read_b128 v[168:171], v6 offset:16384
    ds_read_b128 v[172:175], v6 offset:17408
    s_waitcnt lgkmcnt(0)
    v_mfma_f32_16x16x32_bf16 v[96:99], a[0:3], v[160:163], 0
    ds_read_b128 v[176:179], v6 offset:32768
    v_mfma_f32_16x16x32_bf16 v[96:99], a[16:19], v[164:167], v[96:99]
    s_add_u32 m0, s42, 12288
    s_add_u32 s37, s34, 12288
    buffer_load_dwordx4 v6, s[24:27], s37 offen sc1 lds
    v_mfma_f32_16x16x32_bf16 v[100:103], a[4:7], v[160:163], 0
    ds_read_b128 v[180:183], v6 offset:33792
    v_mfma_f32_16x16x32_bf16 v[100:103], a[20:23], v[164:167], v[100:103]
    v_mfma_f32_16x16x32_bf16 v[128:131], a[8:11], v[160:163], 0
    buffer_load_dwordx4 v6, s[24:27], s37 offen offset:1024 sc1 lds
    v_mfma_f32_16x16x32_bf16 v[128:131], a[24:27], v[164:167], v[128:131]
    ds_read_b128 v[184:187], v6 offset:49152
    v_mfma_f32_16x16x32_bf16 v[132:135], a[12:15], v[160:163], 0
    v_mfma_f32_16x16x32_bf16 v[132:135], a[28:31], v[164:167], v[132:135]
    v_mfma_f32_16x16x32_bf16 v[104:107], a[0:3], v[168:171], 0
    buffer_load_dwordx4 v6, s[24:27], s37 offen offset:2048 sc1 lds
    v_mfma_f32_16x16x32_bf16 v[104:107], a[16:19], v[172:175], v[104:107]
    ds_read_b128 v[188:191], v6 offset:50176
    v_mfma_f32_16x16x32_bf16 v[108:111], a[4:7], v[168:171], 0
    v_mfma_f32_16x16x32_bf16 v[108:111], a[20:23], v[172:175], v[108:111]
    buffer_load_dwordx4 v6, s[24:27], s37 offen offset:3072 sc1 lds
    v_mfma_f32_16x16x32_bf16 v[136:139], a[8:11], v[168:171], 0
    v_mfma_f32_16x16x32_bf16 v[136:139], a[24:27], v[172:175], v[136:139]
    v_mfma_f32_16x16x32_bf16 v[140:143], a[12:15], v[168:171], 0
    v_mfma_f32_16x16x32_bf16 v[140:143], a[28:31], v[172:175], v[140:143]
    s_waitcnt lgkmcnt(0)
    v_mfma_f32_16x16x32_bf16 v[112:115], a[0:3], v[176:179], 0
    ds_read_b128 v[160:163], v6 offset:2048
    v_mfma_f32_16x16x32_bf16 v[112:115], a[16:19], v[180:183], v[112:115]
    s_add_u32 s38, s47, 0
    buffer_load_dwordx4 v[64:67], v6, s[24:27], s38 offen offset:0 sc1
    v_mfma_f32_16x16x32_bf16 v[116:119], a[4:7], v[176:179], 0
    ds_read_b128 v[164:167], v6 offset:3072
    v_mfma_f32_16x16x32_bf16 v[116:119], a[20:23], v[180:183], v[116:119]
    v_mfma_f32_16x16x32_bf16 v[144:147], a[8:11], v[176:179], 0
    buffer_load_dwordx4 v[68:71], v6, s[24:27], s38 offen offset:1024 sc1
    v_mfma_f32_16x16x32_bf16 v[144:147], a[24:27], v[180:183], v[144:147]
    ds_read_b128 v[168:171], v6 offset:18432
    v_mfma_f32_16x16x32_bf16 v[148:151], a[12:15], v[176:179], 0
    v_mfma_f32_16x16x32_bf16 v[148:151], a[28:31], v[180:183], v[148:151]
    buffer_load_dwordx4 v[72:75], v6, s[24:27], s38 offen offset:2048 sc1
    v_mfma_f32_16x16x32_bf16 v[120:123], a[0:3], v[184:187], 0
    ds_read_b128 v[172:175], v6 offset:19456
    v_mfma_f32_16x16x32_bf16 v[120:123], a[16:19], v[188:191], v[120:123]
    v_mfma_f32_16x16x32_bf16 v[124:127], a[4:7], v[184:187], 0
    v_mfma_f32_16x16x32_bf16 v[124:127], a[20:23], v[188:191], v[124:127]
    buffer_load_dwordx4 v[76:79], v6, s[24:27], s38 offen offset:3072 sc1
    v_mfma_f32_16x16x32_bf16 v[152:155], a[8:11], v[184:187], 0
    v_mfma_f32_16x16x32_bf16 v[152:155], a[24:27], v[188:191], v[152:155]
    v_mfma_f32_16x16x32_bf16 v[156:159], a[12:15], v[184:187], 0
    v_mfma_f32_16x16x32_bf16 v[156:159], a[28:31], v[188:191], v[156:159]
    s_waitcnt lgkmcnt(0)
    v_mfma_f32_16x16x32_bf16 v[96:99], a[32:35], v[160:163], v[96:99]
    ds_read_b128 v[176:179], v6 offset:34816
    v_mfma_f32_16x16x32_bf16 v[96:99], a[48:51], v[164:167], v[96:99]
    s_add_u32 s38, s47, 4096
    buffer_load_dwordx4 v[80:83], v6, s[24:27], s38 offen offset:0 sc1
    v_mfma_f32_16x16x32_bf16 v[100:103], a[36:39], v[160:163], v[100:103]
    ds_read_b128 v[180:183], v6 offset:35840
    v_mfma_f32_16x16x32_bf16 v[100:103], a[52:55], v[164:167], v[100:103]
    v_mfma_f32_16x16x32_bf16 v[128:131], a[40:43], v[160:163], v[128:131]
    buffer_load_dwordx4 v[84:87], v6, s[24:27], s38 offen offset:1024 sc1
    v_mfma_f32_16x16x32_bf16 v[128:131], a[56:59], v[164:167], v[128:131]
    ds_read_b128 v[184:187], v6 offset:51200
    v_mfma_f32_16x16x32_bf16 v[132:135], a[44:47], v[160:163], v[132:135]
    v_mfma_f32_16x16x32_bf16 v[132:135], a[60:63], v[164:167], v[132:135]
    buffer_load_dwordx4 v[88:91], v6, s[24:27], s38 offen offset:2048 sc1
    v_mfma_f32_16x16x32_bf16 v[104:107], a[32:35], v[168:171], v[104:107]
    ds_read_b128 v[188:191], v6 offset:52224
    v_mfma_f32_16x16x32_bf16 v[104:107], a[48:51], v[172:175], v[104:107]
    v_mfma_f32_16x16x32_bf16 v[108:111], a[36:39], v[168:171], v[108:111]
    v_mfma_f32_16x16x32_bf16 v[108:111], a[52:55], v[172:175], v[108:111]
    buffer_load_dwordx4 v[92:95], v6, s[24:27], s38 offen offset:3072 sc1
    v_mfma_f32_16x16x32_bf16 v[136:139], a[40:43], v[168:171], v[136:139]
    v_mfma_f32_16x16x32_bf16 v[136:139], a[56:59], v[172:175], v[136:139]
    v_mfma_f32_16x16x32_bf16 v[140:143], a[44:47], v[168:171], v[140:143]
    v_mfma_f32_16x16x32_bf16 v[140:143], a[60:63], v[172:175], v[140:143]
    s_waitcnt vmcnt(24) lgkmcnt(0)
    v_mfma_f32_16x16x32_bf16 v[112:115], a[32:35], v[176:179], v[112:115]
    s_barrier
    ds_read_b128 v[160:163], v6 offset:4096
    v_mfma_f32_16x16x32_bf16 v[112:115], a[48:51], v[180:183], v[112:115]
    s_add_u32 m0, s42, 65536
    s_add_u32 s37, s35, 0
    buffer_load_dwordx4 v6, s[24:27], s37 offen sc1 lds
    v_mfma_f32_16x16x32_bf16 v[116:119], a[36:39], v[176:179], v[116:119]
    ds_read_b128 v[164:167], v6 offset:5120
    v_mfma_f32_16x16x32_bf16 v[116:119], a[52:55], v[180:183], v[116:119]
    v_mfma_f32_16x16x32_bf16 v[144:147], a[40:43], v[176:179], v[144:147]
    buffer_load_dwordx4 v6, s[24:27], s37 offen offset:1024 sc1 lds
    v_mfma_f32_16x16x32_bf16 v[144:147], a[56:59], v[180:183], v[144:147]
    ds_read_b128 v[168:171], v6 offset:20480
    v_mfma_f32_16x16x32_bf16 v[148:151], a[44:47], v[176:179], v[148:151]
    v_mfma_f32_16x16x32_bf16 v[148:151], a[60:63], v[180:183], v[148:151]
    v_mfma_f32_16x16x32_bf16 v[120:123], a[32:35], v[184:187], v[120:123]
    buffer_load_dwordx4 v6, s[24:27], s37 offen offset:2048 sc1 lds
    v_mfma_f32_16x16x32_bf16 v[120:123], a[48:51], v[188:191], v[120:123]
    ds_read_b128 v[172:175], v6 offset:21504
    v_mfma_f32_16x16x32_bf16 v[124:127], a[36:39], v[184:187], v[124:127]
    v_mfma_f32_16x16x32_bf16 v[124:127], a[52:55], v[188:191], v[124:127]
    buffer_load_dwordx4 v6, s[24:27], s37 offen offset:3072 sc1 lds
    v_mfma_f32_16x16x32_bf16 v[152:155], a[40:43], v[184:187], v[152:155]
    v_mfma_f32_16x16x32_bf16 v[152:155], a[56:59], v[188:191], v[152:155]
    v_mfma_f32_16x16x32_bf16 v[156:159], a[44:47], v[184:187], v[156:159]
    v_mfma_f32_16x16x32_bf16 v[156:159], a[60:63], v[188:191], v[156:159]
    s_waitcnt lgkmcnt(0)
    v_mfma_f32_16x16x32_bf16 v[96:99], a[64:67], v[160:163], v[96:99]
    ds_read_b128 v[176:179], v6 offset:36864
    v_mfma_f32_16x16x32_bf16 v[96:99], a[80:83], v[164:167], v[96:99]
    s_add_u32 m0, s42, 69632
    s_add_u32 s37, s35, 4096
    buffer_load_dwordx4 v6, s[24:27], s37 offen sc1 lds
    v_mfma_f32_16x16x32_bf16 v[100:103], a[68:71], v[160:163], v[100:103]
    ds_read_b128 v[180:183], v6 offset:37888
    v_mfma_f32_16x16x32_bf16 v[100:103], a[84:87], v[164:167], v[100:103]
    v_mfma_f32_16x16x32_bf16 v[128:131], a[72:75], v[160:163], v[128:131]
    buffer_load_dwordx4 v6, s[24:27], s37 offen offset:1024 sc1 lds
    v_mfma_f32_16x16x32_bf16 v[128:131], a[88:91], v[164:167], v[128:131]
    ds_read_b128 v[184:187], v6 offset:53248
    v_mfma_f32_16x16x32_bf16 v[132:135], a[76:79], v[160:163], v[132:135]
    v_mfma_f32_16x16x32_bf16 v[132:135], a[92:95], v[164:167], v[132:135]
    v_mfma_f32_16x16x32_bf16 v[104:107], a[64:67], v[168:171], v[104:107]
    buffer_load_dwordx4 v6, s[24:27], s37 offen offset:2048 sc1 lds
    v_mfma_f32_16x16x32_bf16 v[104:107], a[80:83], v[172:175], v[104:107]
    ds_read_b128 v[188:191], v6 offset:54272
    v_mfma_f32_16x16x32_bf16 v[108:111], a[68:71], v[168:171], v[108:111]
    v_mfma_f32_16x16x32_bf16 v[108:111], a[84:87], v[172:175], v[108:111]
    buffer_load_dwordx4 v6, s[24:27], s37 offen offset:3072 sc1 lds
    v_mfma_f32_16x16x32_bf16 v[136:139], a[72:75], v[168:171], v[136:139]
    v_mfma_f32_16x16x32_bf16 v[136:139], a[88:91], v[172:175], v[136:139]
    v_mfma_f32_16x16x32_bf16 v[140:143], a[76:79], v[168:171], v[140:143]
    v_mfma_f32_16x16x32_bf16 v[140:143], a[92:95], v[172:175], v[140:143]
    s_waitcnt vmcnt(8) lgkmcnt(0)
    v_mfma_f32_16x16x32_bf16 v[112:115], a[64:67], v[176:179], v[112:115]
    ds_read_b128 v[160:163], v6 offset:6144
    v_add_f32 v192, v32, v36
    v_mfma_f32_16x16x32_bf16 v[112:115], a[80:83], v[180:183], v[112:115]
    s_add_u32 m0, s42, 73728
    s_add_u32 s37, s35, 8192
    v_add_f32 v193, v48, v52
    v_mfma_f32_16x16x32_bf16 v[116:119], a[68:71], v[176:179], v[116:119]
    ds_read_b128 v[164:167], v6 offset:7168
    v_add_f32 v194, v64, v68
    v_mfma_f32_16x16x32_bf16 v[116:119], a[84:87], v[180:183], v[116:119]
    buffer_load_dwordx4 v6, s[24:27], s37 offen sc1 lds
    v_mfma_f32_16x16x32_bf16 v[144:147], a[72:75], v[176:179], v[144:147]
    v_add_f32 v195, v80, v84
    v_add_f32 v196, v33, v37
    v_mfma_f32_16x16x32_bf16 v[144:147], a[88:91], v[180:183], v[144:147]
    ds_read_b128 v[168:171], v6 offset:22528
    v_add_f32 v197, v49, v53
    v_mfma_f32_16x16x32_bf16 v[148:151], a[76:79], v[176:179], v[148:151]
    buffer_load_dwordx4 v6, s[24:27], s37 offen offset:1024 sc1 lds
    v_mfma_f32_16x16x32_bf16 v[148:151], a[92:95], v[180:183], v[148:151]
    v_add_f32 v198, v65, v69
    v_add_f32 v199, v81, v85
    v_mfma_f32_16x16x32_bf16 v[120:123], a[64:67], v[184:187], v[120:123]
    buffer_load_dwordx4 v6, s[24:27], s37 offen offset:2048 sc1 lds
    v_mfma_f32_16x16x32_bf16 v[120:123], a[80:83], v[188:191], v[120:123]
    ds_read_b128 v[172:175], v6 offset:23552
    v_add_f32 v192, v192, v40
    v_mfma_f32_16x16x32_bf16 v[124:127], a[68:71], v[184:187], v[124:127]
    v_add_f32 v193, v193, v56
    v_add_f32 v194, v194, v72
    v_mfma_f32_16x16x32_bf16 v[124:127], a[84:87], v[188:191], v[124:127]
    buffer_load_dwordx4 v6, s[24:27], s37 offen offset:3072 sc1 lds
    v_mfma_f32_16x16x32_bf16 v[152:155], a[72:75], v[184:187], v[152:155]
    v_add_f32 v195, v195, v88
    v_mfma_f32_16x16x32_bf16 v[152:155], a[88:91], v[188:191], v[152:155]
    v_add_f32 v196, v196, v41
    v_mfma_f32_16x16x32_bf16 v[156:159], a[76:79], v[184:187], v[156:159]
    v_mfma_f32_16x16x32_bf16 v[156:159], a[92:95], v[188:191], v[156:159]
    s_waitcnt lgkmcnt(0)
    v_mfma_f32_16x16x32_bf16 v[96:99], a[96:99], v[160:163], v[96:99]
    ds_read_b128 v[176:179], v6 offset:38912
    v_add_f32 v197, v197, v57
    v_mfma_f32_16x16x32_bf16 v[96:99], a[112:115], v[164:167], v[96:99]
    s_add_u32 m0, s42, 77824
    s_add_u32 s37, s35, 12288
    v_add_f32 v198, v198, v73
    v_mfma_f32_16x16x32_bf16 v[100:103], a[100:103], v[160:163], v[100:103]
    ds_read_b128 v[180:183], v6 offset:39936
    v_add_f32 v199, v199, v89
    v_mfma_f32_16x16x32_bf16 v[100:103], a[116:119], v[164:167], v[100:103]
    buffer_load_dwordx4 v6, s[24:27], s37 offen sc1 lds
    v_mfma_f32_16x16x32_bf16 v[128:131], a[104:107], v[160:163], v[128:131]
    v_add_f32 v192, v192, v44
    v_add_f32 v193, v193, v60
    v_mfma_f32_16x16x32_bf16 v[128:131], a[120:123], v[164:167], v[128:131]
    ds_read_b128 v[184:187], v6 offset:55296
    v_add_f32 v194, v194, v76
    v_mfma_f32_16x16x32_bf16 v[132:135], a[108:111], v[160:163], v[132:135]
    buffer_load_dwordx4 v6, s[24:27], s37 offen offset:1024 sc1 lds
    v_mfma_f32_16x16x32_bf16 v[132:135], a[124:127], v[164:167], v[132:135]
    v_add_f32 v195, v195, v92
    v_add_f32 v196, v196, v45
    v_mfma_f32_16x16x32_bf16 v[104:107], a[96:99], v[168:171], v[104:107]
    buffer_load_dwordx4 v6, s[24:27], s37 offen offset:2048 sc1 lds
    v_mfma_f32_16x16x32_bf16 v[104:107], a[112:115], v[172:175], v[104:107]
    ds_read_b128 v[188:191], v6 offset:56320
    v_add_f32 v197, v197, v61
    v_mfma_f32_16x16x32_bf16 v[108:111], a[100:103], v[168:171], v[108:111]
    v_add_f32 v198, v198, v77
    v_add_f32 v199, v199, v93
    v_mfma_f32_16x16x32_bf16 v[108:111], a[116:119], v[172:175], v[108:111]
    buffer_load_dwordx4 v6, s[24:27], s37 offen offset:3072 sc1 lds
    v_mfma_f32_16x16x32_bf16 v[136:139], a[104:107], v[168:171], v[136:139]
    v_permlane32_swap_b32 v192, v194
    v_mfma_f32_16x16x32_bf16 v[136:139], a[120:123], v[172:175], v[136:139]
    v_permlane32_swap_b32 v193, v195
    v_mfma_f32_16x16x32_bf16 v[140:143], a[108:111], v[168:171], v[140:143]
    v_mfma_f32_16x16x32_bf16 v[140:143], a[124:127], v[172:175], v[140:143]
    s_waitcnt vmcnt(28) lgkmcnt(0)
    v_mfma_f32_16x16x32_bf16 v[112:115], a[96:99], v[176:179], v[112:115]
    s_barrier
    v_permlane32_swap_b32 v196, v198
    v_permlane32_swap_b32 v197, v199
    v_mfma_f32_16x16x32_bf16 v[112:115], a[112:115], v[180:183], v[112:115]
    ds_read_b128 v[160:163], v6 offset:8192
    s_add_u32 m0, s36, 0
    s_add_u32 s49, s41, 0
    v_mfma_f32_16x16x32_bf16 v[116:119], a[100:103], v[176:179], v[116:119]
    v_add_f32 v192, v192, v194
    v_add_f32 v193, v193, v195
    v_mfma_f32_16x16x32_bf16 v[116:119], a[116:119], v[180:183], v[116:119]
    buffer_load_dwordx4 v16, s[20:23], s49 offen lds
    v_mfma_f32_16x16x32_bf16 v[144:147], a[104:107], v[176:179], v[144:147]
    ds_read_b128 v[164:167], v6 offset:9216
    v_add_f32 v196, v196, v198
    v_mfma_f32_16x16x32_bf16 v[144:147], a[120:123], v[180:183], v[144:147]
    ds_read_b128 v[168:171], v6 offset:24576
    v_add_f32 v197, v197, v199
    v_mfma_f32_16x16x32_bf16 v[148:151], a[108:111], v[176:179], v[148:151]
    buffer_load_dwordx4 v17, s[20:23], s49 offen offset:1024 lds
    v_mfma_f32_16x16x32_bf16 v[148:151], a[124:127], v[180:183], v[148:151]
    v_permlane16_swap_b32 v192, v193
    v_permlane16_swap_b32 v196, v197
    v_mfma_f32_16x16x32_bf16 v[120:123], a[96:99], v[184:187], v[120:123]
    buffer_load_dwordx4 v18, s[20:23], s49 offen offset:2048 lds
    v_mfma_f32_16x16x32_bf16 v[120:123], a[112:115], v[188:191], v[120:123]
    ds_read_b128 v[172:175], v6 offset:25600
    v_add_f32 v192, v192, v193
    v_mfma_f32_16x16x32_bf16 v[124:127], a[100:103], v[184:187], v[124:127]
    v_add_f32 v196, v196, v197
    v_mul_f32 v192, 0x3b000000, v192
    v_mfma_f32_16x16x32_bf16 v[124:127], a[116:119], v[188:191], v[124:127]
    buffer_load_dwordx4 v19, s[20:23], s49 offen offset:3072 lds
    v_mfma_f32_16x16x32_bf16 v[152:155], a[104:107], v[184:187], v[152:155]
    v_mul_f32 v196, 0x3b000000, v196
    v_mfma_f32_16x16x32_bf16 v[152:155], a[120:123], v[188:191], v[152:155]
    v_fma_f32 v196, -v192, v192, v196
    v_mfma_f32_16x16x32_bf16 v[156:159], a[108:111], v[184:187], v[156:159]
    v_mfma_f32_16x16x32_bf16 v[156:159], a[124:127], v[188:191], v[156:159]
    s_waitcnt lgkmcnt(0)
    v_mfma_f32_16x16x32_bf16 v[96:99], a[128:131], v[160:163], v[96:99]
    ds_read_b128 v[176:179], v6 offset:40960
    v_max_f32 v196, 0, v196
    v_mfma_f32_16x16x32_bf16 v[96:99], a[144:147], v[164:167], v[96:99]
    s_add_u32 m0, s36, 4096
    s_add_u32 s49, s41, 32768
    v_cvt_pk_bf16_f32 v228, -v192, -v192
    v_mfma_f32_16x16x32_bf16 v[100:103], a[132:135], v[160:163], v[100:103]
    v_cvt_pk_bf16_f32 v196, v196, v196
    v_lshlrev_b32 v196, 16, v196
    v_mfma_f32_16x16x32_bf16 v[100:103], a[148:151], v[164:167], v[100:103]
    buffer_load_dwordx4 v16, s[20:23], s49 offen lds
    v_mfma_f32_16x16x32_bf16 v[128:131], a[136:139], v[160:163], v[128:131]
    ds_read_b128 v[180:183], v6 offset:41984
    v_add_f32 v196, 0x3727c5ac, v196
    v_mfma_f32_16x16x32_bf16 v[128:131], a[152:155], v[164:167], v[128:131]
    v_cvt_pk_bf16_f32 v196, v196, v196
    v_lshlrev_b32 v196, 16, v196
    v_mfma_f32_16x16x32_bf16 v[132:135], a[140:143], v[160:163], v[132:135]
    buffer_load_dwordx4 v17, s[20:23], s49 offen offset:1024 lds
    v_mfma_f32_16x16x32_bf16 v[132:135], a[156:159], v[164:167], v[132:135]
    ds_read_b128 v[184:187], v6 offset:57344
    v_mfma_f32_16x16x32_bf16 v[104:107], a[128:131], v[168:171], v[104:107]
    v_sqrt_f32 v196, v196
    v_mfma_f32_16x16x32_bf16 v[104:107], a[144:147], v[172:175], v[104:107]
    buffer_load_dwordx4 v18, s[20:23], s49 offen offset:2048 lds
    v_mfma_f32_16x16x32_bf16 v[108:111], a[132:135], v[168:171], v[108:111]
    ds_read_b128 v[188:191], v6 offset:58368
    v_mov_b32 v230, v228
    v_mfma_f32_16x16x32_bf16 v[108:111], a[148:151], v[172:175], v[108:111]
    v_cvt_pk_bf16_f32 v196, v196, v196
    v_lshlrev_b32 v196, 16, v196
    v_mfma_f32_16x16x32_bf16 v[136:139], a[136:139], v[168:171], v[136:139]
    buffer_load_dwordx4 v19, s[20:23], s49 offen offset:3072 lds
    v_mfma_f32_16x16x32_bf16 v[136:139], a[152:155], v[172:175], v[136:139]
    v_rcp_f32 v196, v196
    v_mfma_f32_16x16x32_bf16 v[140:143], a[140:143], v[168:171], v[140:143]
    v_permlane32_swap_b32 v228, v230
    v_mfma_f32_16x16x32_bf16 v[140:143], a[156:159], v[172:175], v[140:143]
    s_waitcnt lgkmcnt(0)
    v_mfma_f32_16x16x32_bf16 v[112:115], a[128:131], v[176:179], v[112:115]
    ds_read_b128 v[160:163], v6 offset:10240
    v_mul_f32 v220, v196, v196
    v_mfma_f32_16x16x32_bf16 v[112:115], a[144:147], v[180:183], v[112:115]
    v_mul_f32 v222, v196, v196
    v_mov_b32 v229, v228
    v_mfma_f32_16x16x32_bf16 v[116:119], a[132:135], v[176:179], v[116:119]
    ds_read_b128 v[164:167], v6 offset:11264
    v_mov_b32 v231, v230
    v_mfma_f32_16x16x32_bf16 v[116:119], a[148:151], v[180:183], v[116:119]
    v_permlane32_swap_b32 v220, v222
    v_mfma_f32_16x16x32_bf16 v[144:147], a[136:139], v[176:179], v[144:147]
    v_mov_b32 v221, v220
    v_mfma_f32_16x16x32_bf16 v[144:147], a[152:155], v[180:183], v[144:147]
    ds_read_b128 v[168:171], v6 offset:26624
    v_mov_b32 v223, v222
    v_mfma_f32_16x16x32_bf16 v[148:151], a[140:143], v[176:179], v[148:151]
    v_mfma_f32_16x16x32_bf16 v[148:151], a[156:159], v[180:183], v[148:151]
    v_permlane16_swap_b32 v228, v229
    v_mfma_f32_16x16x32_bf16 v[120:123], a[128:131], v[184:187], v[120:123]
    ds_read_b128 v[172:175], v6 offset:27648
    v_permlane16_swap_b32 v230, v231
    v_mfma_f32_16x16x32_bf16 v[120:123], a[144:147], v[188:191], v[120:123]
    v_permlane16_swap_b32 v220, v221
    v_mfma_f32_16x16x32_bf16 v[124:127], a[132:135], v[184:187], v[124:127]
    v_permlane16_swap_b32 v222, v223
    v_mfma_f32_16x16x32_bf16 v[124:127], a[148:151], v[188:191], v[124:127]
    v_mfma_f32_16x16x32_bf16 v[152:155], a[136:139], v[184:187], v[152:155]
    v_mov_b32 v236, v228
    v_mfma_f32_16x16x32_bf16 v[152:155], a[152:155], v[188:191], v[152:155]
    v_mov_b32 v237, v228
    v_mfma_f32_16x16x32_bf16 v[156:159], a[140:143], v[184:187], v[156:159]
    v_mfma_f32_16x16x32_bf16 v[156:159], a[156:159], v[188:191], v[156:159]
    s_waitcnt lgkmcnt(0)
    v_mfma_f32_16x16x32_bf16 v[96:99], a[160:163], v[160:163], v[96:99]
    ds_read_b128 v[176:179], v6 offset:43008
    v_mov_b32 v240, v229
    v_mfma_f32_16x16x32_bf16 v[96:99], a[176:179], v[164:167], v[96:99]
    v_mov_b32 v241, v229
    v_mov_b32 v244, v230
    v_mfma_f32_16x16x32_bf16 v[100:103], a[164:167], v[160:163], v[100:103]
    ds_read_b128 v[180:183], v6 offset:44032
    v_mov_b32 v245, v230
    v_mfma_f32_16x16x32_bf16 v[100:103], a[180:183], v[164:167], v[100:103]
    v_mov_b32 v248, v231
    v_mfma_f32_16x16x32_bf16 v[128:131], a[168:171], v[160:163], v[128:131]
    v_mov_b32 v249, v231
    v_mfma_f32_16x16x32_bf16 v[128:131], a[184:187], v[164:167], v[128:131]
    ds_read_b128 v[184:187], v6 offset:59392
    v_add_f32 v192, v34, v38
    v_mfma_f32_16x16x32_bf16 v[132:135], a[172:175], v[160:163], v[132:135]
    v_mfma_f32_16x16x32_bf16 v[132:135], a[188:191], v[164:167], v[132:135]
    v_add_f32 v193, v50, v54
    v_mfma_f32_16x16x32_bf16 v[104:107], a[160:163], v[168:171], v[104:107]
    ds_read_b128 v[188:191], v6 offset:60416
    v_add_f32 v194, v66, v70
    v_mfma_f32_16x16x32_bf16 v[104:107], a[176:179], v[172:175], v[104:107]
    v_add_f32 v195, v82, v86
    v_mfma_f32_16x16x32_bf16 v[108:111], a[164:167], v[168:171], v[108:111]
    v_add_f32 v196, v35, v39
    v_mfma_f32_16x16x32_bf16 v[108:111], a[180:183], v[172:175], v[108:111]
    v_mfma_f32_16x16x32_bf16 v[136:139], a[168:171], v[168:171], v[136:139]
    v_add_f32 v197, v51, v55
    v_mfma_f32_16x16x32_bf16 v[136:139], a[184:187], v[172:175], v[136:139]
    v_add_f32 v198, v67, v71
    v_mfma_f32_16x16x32_bf16 v[140:143], a[172:175], v[168:171], v[140:143]
    v_mfma_f32_16x16x32_bf16 v[140:143], a[188:191], v[172:175], v[140:143]
    s_waitcnt vmcnt(32) lgkmcnt(0)
    v_mfma_f32_16x16x32_bf16 v[112:115], a[160:163], v[176:179], v[112:115]
    s_barrier
    v_add_f32 v199, v83, v87
    v_add_f32 v192, v192, v42
    v_mfma_f32_16x16x32_bf16 v[112:115], a[176:179], v[180:183], v[112:115]
    ds_read_b128 v[160:163], v6 offset:12288
    v_add_f32 v193, v193, v58
    v_mfma_f32_16x16x32_bf16 v[116:119], a[164:167], v[176:179], v[116:119]
    ds_read_b128 v[164:167], v6 offset:13312
    v_add_f32 v194, v194, v74
    v_mfma_f32_16x16x32_bf16 v[116:119], a[180:183], v[180:183], v[116:119]
    v_add_f32 v195, v195, v90
    v_mfma_f32_16x16x32_bf16 v[144:147], a[168:171], v[176:179], v[144:147]
    v_add_f32 v196, v196, v43
    v_mfma_f32_16x16x32_bf16 v[144:147], a[184:187], v[180:183], v[144:147]
    ds_read_b128 v[168:171], v6 offset:28672
    v_add_f32 v197, v197, v59
    v_mfma_f32_16x16x32_bf16 v[148:151], a[172:175], v[176:179], v[148:151]
    v_mfma_f32_16x16x32_bf16 v[148:151], a[188:191], v[180:183], v[148:151]
    v_add_f32 v198, v198, v75
    v_mfma_f32_16x16x32_bf16 v[120:123], a[160:163], v[184:187], v[120:123]
    ds_read_b128 v[172:175], v6 offset:29696
    v_add_f32 v199, v199, v91
    v_mfma_f32_16x16x32_bf16 v[120:123], a[176:179], v[188:191], v[120:123]
    v_add_f32 v192, v192, v46
    v_mfma_f32_16x16x32_bf16 v[124:127], a[164:167], v[184:187], v[124:127]
    v_add_f32 v193, v193, v62
    v_mfma_f32_16x16x32_bf16 v[124:127], a[180:183], v[188:191], v[124:127]
    v_mfma_f32_16x16x32_bf16 v[152:155], a[168:171], v[184:187], v[152:155]
    v_add_f32 v194, v194, v78
    v_mfma_f32_16x16x32_bf16 v[152:155], a[184:187], v[188:191], v[152:155]
    v_add_f32 v195, v195, v94
    v_mfma_f32_16x16x32_bf16 v[156:159], a[172:175], v[184:187], v[156:159]
    v_mfma_f32_16x16x32_bf16 v[156:159], a[188:191], v[188:191], v[156:159]
    s_waitcnt lgkmcnt(0)
    v_mfma_f32_16x16x32_bf16 v[96:99], a[192:195], v[160:163], v[96:99]
    ds_read_b128 v[176:179], v6 offset:45056
    v_add_f32 v196, v196, v47
    v_mfma_f32_16x16x32_bf16 v[96:99], a[208:211], v[164:167], v[96:99]
    v_add_f32 v197, v197, v63
    v_add_f32 v198, v198, v79
    v_mfma_f32_16x16x32_bf16 v[100:103], a[196:199], v[160:163], v[100:103]
    ds_read_b128 v[180:183], v6 offset:46080
    v_add_f32 v199, v199, v95
    v_mfma_f32_16x16x32_bf16 v[100:103], a[212:215], v[164:167], v[100:103]
    v_permlane32_swap_b32 v192, v194
    v_mfma_f32_16x16x32_bf16 v[128:131], a[200:203], v[160:163], v[128:131]
    v_permlane32_swap_b32 v193, v195
    v_mfma_f32_16x16x32_bf16 v[128:131], a[216:219], v[164:167], v[128:131]
    ds_read_b128 v[184:187], v6 offset:61440
    v_permlane32_swap_b32 v196, v198
    v_mfma_f32_16x16x32_bf16 v[132:135], a[204:207], v[160:163], v[132:135]
    v_mfma_f32_16x16x32_bf16 v[132:135], a[220:223], v[164:167], v[132:135]
    v_permlane32_swap_b32 v197, v199
    v_mfma_f32_16x16x32_bf16 v[104:107], a[192:195], v[168:171], v[104:107]
    ds_read_b128 v[188:191], v6 offset:62464
    v_add_f32 v192, v192, v194
    v_mfma_f32_16x16x32_bf16 v[104:107], a[208:211], v[172:175], v[104:107]
    v_add_f32 v193, v193, v195
    v_mfma_f32_16x16x32_bf16 v[108:111], a[196:199], v[168:171], v[108:111]
    v_add_f32 v196, v196, v198
    v_mfma_f32_16x16x32_bf16 v[108:111], a[212:215], v[172:175], v[108:111]
    v_mfma_f32_16x16x32_bf16 v[136:139], a[200:203], v[168:171], v[136:139]
    v_add_f32 v197, v197, v199
    v_mfma_f32_16x16x32_bf16 v[136:139], a[216:219], v[172:175], v[136:139]
    v_permlane16_swap_b32 v192, v193
    v_mfma_f32_16x16x32_bf16 v[140:143], a[204:207], v[168:171], v[140:143]
    v_mfma_f32_16x16x32_bf16 v[140:143], a[220:223], v[172:175], v[140:143]
    s_waitcnt lgkmcnt(0)
    v_mfma_f32_16x16x32_bf16 v[112:115], a[192:195], v[176:179], v[112:115]
    ds_read_b128 v[160:163], v6 offset:14336
    v_permlane16_swap_b32 v196, v197
    v_mfma_f32_16x16x32_bf16 v[112:115], a[208:211], v[180:183], v[112:115]
    v_add_f32 v192, v192, v193
    v_add_f32 v196, v196, v197
    v_mfma_f32_16x16x32_bf16 v[116:119], a[196:199], v[176:179], v[116:119]
    ds_read_b128 v[164:167], v6 offset:15360
    v_mul_f32 v192, 0x3b000000, v192
    v_mfma_f32_16x16x32_bf16 v[116:119], a[212:215], v[180:183], v[116:119]
    v_mul_f32 v196, 0x3b000000, v196
    v_mfma_f32_16x16x32_bf16 v[144:147], a[200:203], v[176:179], v[144:147]
    v_fma_f32 v196, -v192, v192, v196
    v_mfma_f32_16x16x32_bf16 v[144:147], a[216:219], v[180:183], v[144:147]
    ds_read_b128 v[168:171], v6 offset:30720
    v_max_f32 v196, 0, v196
    v_mfma_f32_16x16x32_bf16 v[148:151], a[204:207], v[176:179], v[148:151]
    v_mfma_f32_16x16x32_bf16 v[148:151], a[220:223], v[180:183], v[148:151]
    v_cvt_pk_bf16_f32 v232, -v192, -v192
    v_mfma_f32_16x16x32_bf16 v[120:123], a[192:195], v[184:187], v[120:123]
    ds_read_b128 v[172:175], v6 offset:31744
    v_cvt_pk_bf16_f32 v196, v196, v196
    v_mfma_f32_16x16x32_bf16 v[120:123], a[208:211], v[188:191], v[120:123]
    v_lshlrev_b32 v196, 16, v196
    v_mfma_f32_16x16x32_bf16 v[124:127], a[196:199], v[184:187], v[124:127]
    v_add_f32 v196, 0x3727c5ac, v196
    v_mfma_f32_16x16x32_bf16 v[124:127], a[212:215], v[188:191], v[124:127]
    v_mfma_f32_16x16x32_bf16 v[152:155], a[200:203], v[184:187], v[152:155]
    v_cvt_pk_bf16_f32 v196, v196, v196
    v_mfma_f32_16x16x32_bf16 v[152:155], a[216:219], v[188:191], v[152:155]
    v_lshlrev_b32 v196, 16, v196
    v_mfma_f32_16x16x32_bf16 v[156:159], a[204:207], v[184:187], v[156:159]
    v_mfma_f32_16x16x32_bf16 v[156:159], a[220:223], v[188:191], v[156:159]
    s_waitcnt lgkmcnt(0)
    v_mfma_f32_16x16x32_bf16 v[96:99], a[224:227], v[160:163], v[96:99]
    ds_read_b128 v[176:179], v6 offset:47104
    v_mfma_f32_16x16x32_bf16 v[96:99], a[240:243], v[164:167], v[96:99]
    v_sqrt_f32 v196, v196
    v_mfma_f32_16x16x32_bf16 v[96:99], v[204:207], v[236:239], v[96:99]
    ds_read_b128 v[180:183], v6 offset:48128
    v_mov_b32 v234, v232
    v_mfma_f32_16x16x32_bf16 v[100:103], a[228:231], v[160:163], v[100:103]
    v_cvt_pk_bf16_f32 v196, v196, v196
    v_mfma_f32_16x16x32_bf16 v[100:103], a[244:247], v[164:167], v[100:103]
    v_lshlrev_b32 v196, 16, v196
    v_mfma_f32_16x16x32_bf16 v[100:103], v[208:211], v[236:239], v[100:103]
    ds_read_b128 v[184:187], v6 offset:63488
    v_mfma_f32_16x16x32_bf16 v[128:131], a[232:235], v[160:163], v[128:131]
    v_rcp_f32 v196, v196
    v_mfma_f32_16x16x32_bf16 v[128:131], a[248:251], v[164:167], v[128:131]
    v_mfma_f32_16x16x32_bf16 v[128:131], v[212:215], v[236:239], v[128:131]
    ds_read_b128 v[188:191], v6 offset:64512
    v_mfma_f32_16x16x32_bf16 v[132:135], a[236:239], v[160:163], v[132:135]
    v_permlane32_swap_b32 v232, v234
    v_mfma_f32_16x16x32_bf16 v[132:135], a[252:255], v[164:167], v[132:135]
    v_mfma_f32_16x16x32_bf16 v[132:135], v[216:219], v[236:239], v[132:135]
    v_mul_f32 v224, v196, v196
    v_mfma_f32_16x16x32_bf16 v[104:107], a[224:227], v[168:171], v[104:107]
    v_mul_f32 v226, v196, v196
    v_mfma_f32_16x16x32_bf16 v[104:107], a[240:243], v[172:175], v[104:107]
    v_mfma_f32_16x16x32_bf16 v[104:107], v[204:207], v[240:243], v[104:107]
    v_mov_b32 v233, v232
    v_mfma_f32_16x16x32_bf16 v[108:111], a[228:231], v[168:171], v[108:111]
    v_mfma_f32_16x16x32_bf16 v[108:111], a[244:247], v[172:175], v[108:111]
    v_mov_b32 v235, v234
    v_mfma_f32_16x16x32_bf16 v[108:111], v[208:211], v[240:243], v[108:111]
    v_permlane32_swap_b32 v224, v226
    v_mfma_f32_16x16x32_bf16 v[136:139], a[232:235], v[168:171], v[136:139]
    v_mfma_f32_16x16x32_bf16 v[136:139], a[248:251], v[172:175], v[136:139]
    v_mov_b32 v225, v224
    v_mfma_f32_16x16x32_bf16 v[136:139], v[212:215], v[240:243], v[136:139]
    v_mov_b32 v227, v226
    v_mfma_f32_16x16x32_bf16 v[140:143], a[236:239], v[168:171], v[140:143]
    v_mfma_f32_16x16x32_bf16 v[140:143], a[252:255], v[172:175], v[140:143]
    v_mfma_f32_16x16x32_bf16 v[140:143], v[216:219], v[240:243], v[140:143]
    s_waitcnt vmcnt(20) lgkmcnt(0)
    v_mfma_f32_16x16x32_bf16 v[112:115], a[224:227], v[176:179], v[112:115]
    s_barrier
    ds_read_b128 v[160:163], v12 offset:0
    v_permlane16_swap_b32 v232, v233
    v_mfma_f32_16x16x32_bf16 v[112:115], a[240:243], v[180:183], v[112:115]
    s_add_u32 m0, s42, 0
    s_add_u32 s49, s41, 65536
    buffer_load_dwordx4 v16, s[20:23], s49 offen lds
    v_mfma_f32_16x16x32_bf16 v[112:115], v[204:207], v[244:247], v[112:115]
    buffer_load_dwordx4 v17, s[20:23], s49 offen offset:1024 lds
    v_mfma_f32_16x16x32_bf16 v[116:119], a[228:231], v[176:179], v[116:119]
    ds_read_b128 v[164:167], v12 offset:1024
    v_mfma_f32_16x16x32_bf16 v[116:119], a[244:247], v[180:183], v[116:119]
    buffer_load_dwordx4 v18, s[20:23], s49 offen offset:2048 lds
    v_mfma_f32_16x16x32_bf16 v[116:119], v[208:211], v[244:247], v[116:119]
    ds_read_b128 v[168:171], v12 offset:16384
    v_permlane16_swap_b32 v234, v235
    v_mfma_f32_16x16x32_bf16 v[144:147], a[232:235], v[176:179], v[144:147]
    buffer_load_dwordx4 v19, s[20:23], s49 offen offset:3072 lds
    v_mfma_f32_16x16x32_bf16 v[144:147], a[248:251], v[180:183], v[144:147]
    s_add_u32 m0, s42, 4096
    s_add_u32 s49, s41, 98304
    v_mfma_f32_16x16x32_bf16 v[144:147], v[212:215], v[244:247], v[144:147]
    buffer_load_dwordx4 v16, s[20:23], s49 offen lds
    v_mfma_f32_16x16x32_bf16 v[148:151], a[236:239], v[176:179], v[148:151]
    ds_read_b128 v[172:175], v12 offset:17408
    v_mfma_f32_16x16x32_bf16 v[148:151], a[252:255], v[180:183], v[148:151]
    buffer_load_dwordx4 v17, s[20:23], s49 offen offset:1024 lds
    v_mfma_f32_16x16x32_bf16 v[148:151], v[216:219], v[244:247], v[148:151]
    v_permlane16_swap_b32 v224, v225
    v_mfma_f32_16x16x32_bf16 v[120:123], a[224:227], v[184:187], v[120:123]
    buffer_load_dwordx4 v18, s[20:23], s49 offen offset:2048 lds
    v_mfma_f32_16x16x32_bf16 v[120:123], a[240:243], v[188:191], v[120:123]
    buffer_load_dwordx4 v19, s[20:23], s49 offen offset:3072 lds
    v_mfma_f32_16x16x32_bf16 v[120:123], v[204:207], v[248:251], v[120:123]
    v_mfma_f32_16x16x32_bf16 v[124:127], a[228:231], v[184:187], v[124:127]
    v_mfma_f32_16x16x32_bf16 v[124:127], a[244:247], v[188:191], v[124:127]
    v_permlane16_swap_b32 v226, v227
    v_mfma_f32_16x16x32_bf16 v[124:127], v[208:211], v[248:251], v[124:127]
    v_mfma_f32_16x16x32_bf16 v[152:155], a[232:235], v[184:187], v[152:155]
    v_mfma_f32_16x16x32_bf16 v[152:155], a[248:251], v[188:191], v[152:155]
    v_mfma_f32_16x16x32_bf16 v[152:155], v[212:215], v[248:251], v[152:155]
    v_mfma_f32_16x16x32_bf16 v[156:159], a[236:239], v[184:187], v[156:159]
    v_mfma_f32_16x16x32_bf16 v[156:159], a[252:255], v[188:191], v[156:159]
    v_mfma_f32_16x16x32_bf16 v[156:159], v[216:219], v[248:251], v[156:159]
    s_waitcnt lgkmcnt(0)
    v_mfma_f32_16x16x32_bf16 v[32:35], a[0:3], v[160:163], 0
    ds_read_b128 v[176:179], v12 offset:32768
    v_mul_f32 v96, v96, v128
    v_mfma_f32_16x16x32_bf16 v[32:35], a[16:19], v[164:167], v[32:35]
    s_add_u32 m0, s42, 8192
    s_add_u32 s49, s41, 131072
    v_mul_f32 v97, v97, v129
    v_mfma_f32_16x16x32_bf16 v[36:39], a[4:7], v[160:163], 0
    buffer_load_dwordx4 v16, s[20:23], s49 offen lds
    v_mfma_f32_16x16x32_bf16 v[36:39], a[20:23], v[164:167], v[36:39]
    ds_read_b128 v[180:183], v12 offset:33792
    v_mul_f32 v98, v98, v130
    v_mfma_f32_16x16x32_bf16 v[64:67], a[8:11], v[160:163], 0
    buffer_load_dwordx4 v17, s[20:23], s49 offen offset:1024 lds
    v_mfma_f32_16x16x32_bf16 v[64:67], a[24:27], v[164:167], v[64:67]
    v_mul_f32 v99, v99, v131
    v_mul_f32 v100, v100, v132
    v_mfma_f32_16x16x32_bf16 v[68:71], a[12:15], v[160:163], 0
    buffer_load_dwordx4 v18, s[20:23], s49 offen offset:2048 lds
    v_mfma_f32_16x16x32_bf16 v[68:71], a[28:31], v[164:167], v[68:71]
    ds_read_b128 v[184:187], v12 offset:49152
    v_mul_f32 v101, v101, v133
    v_mfma_f32_16x16x32_bf16 v[40:43], a[0:3], v[168:171], 0
    buffer_load_dwordx4 v19, s[20:23], s49 offen offset:3072 lds
    s_add_u32 m0, s42, 12288
    v_mfma_f32_16x16x32_bf16 v[40:43], a[16:19], v[172:175], v[40:43]
    s_add_u32 s49, s41, 163840
    buffer_load_dwordx4 v16, s[20:23], s49 offen lds
    v_mfma_f32_16x16x32_bf16 v[44:47], a[4:7], v[168:171], 0
    ds_read_b128 v[188:191], v12 offset:50176
    v_mul_f32 v102, v102, v134
    v_mfma_f32_16x16x32_bf16 v[44:47], a[20:23], v[172:175], v[44:47]
    buffer_load_dwordx4 v17, s[20:23], s49 offen offset:1024 lds
    v_mfma_f32_16x16x32_bf16 v[72:75], a[8:11], v[168:171], 0
    v_mul_f32 v103, v103, v135
    v_mul_f32 v96, v96, v220
    v_mfma_f32_16x16x32_bf16 v[72:75], a[24:27], v[172:175], v[72:75]
    buffer_load_dwordx4 v18, s[20:23], s49 offen offset:2048 lds
    v_mfma_f32_16x16x32_bf16 v[76:79], a[12:15], v[168:171], 0
    buffer_load_dwordx4 v19, s[20:23], s49 offen offset:3072 lds
    v_mfma_f32_16x16x32_bf16 v[76:79], a[28:31], v[172:175], v[76:79]
    v_mul_f32 v97, v97, v220
    s_waitcnt lgkmcnt(0)
    v_mfma_f32_16x16x32_bf16 v[48:51], a[0:3], v[176:179], 0
    ds_read_b128 v[160:163], v12 offset:2048
    v_mul_f32 v98, v98, v220
    v_mfma_f32_16x16x32_bf16 v[48:51], a[16:19], v[180:183], v[48:51]
    v_mul_f32 v99, v99, v220
    v_mul_f32 v100, v100, v220
    v_mfma_f32_16x16x32_bf16 v[52:55], a[4:7], v[176:179], 0
    ds_read_b128 v[164:167], v12 offset:3072
    v_mfma_f32_16x16x32_bf16 v[52:55], a[20:23], v[180:183], v[52:55]
    v_mul_f32 v101, v101, v220
    v_mfma_f32_16x16x32_bf16 v[80:83], a[8:11], v[176:179], 0
    v_mul_f32 v102, v102, v220
    v_mfma_f32_16x16x32_bf16 v[80:83], a[24:27], v[180:183], v[80:83]
    ds_read_b128 v[168:171], v12 offset:18432
    v_mfma_f32_16x16x32_bf16 v[84:87], a[12:15], v[176:179], 0
    v_mul_f32 v103, v103, v220
    v_mfma_f32_16x16x32_bf16 v[84:87], a[28:31], v[180:183], v[84:87]
    v_mfma_f32_16x16x32_bf16 v[56:59], a[0:3], v[184:187], 0
    ds_read_b128 v[172:175], v12 offset:19456
    v_cvt_pk_bf16_f32 v96, v96, v97
    v_mfma_f32_16x16x32_bf16 v[56:59], a[16:19], v[188:191], v[56:59]
    v_cvt_pk_bf16_f32 v97, v98, v99
    v_mfma_f32_16x16x32_bf16 v[60:63], a[4:7], v[184:187], 0
    v_mfma_f32_16x16x32_bf16 v[60:63], a[20:23], v[188:191], v[60:63]
    v_cvt_pk_bf16_f32 v98, v100, v101
    v_mfma_f32_16x16x32_bf16 v[88:91], a[8:11], v[184:187], 0
    v_cvt_pk_bf16_f32 v99, v102, v103
    v_mfma_f32_16x16x32_bf16 v[88:91], a[24:27], v[188:191], v[88:91]
    v_mfma_f32_16x16x32_bf16 v[92:95], a[12:15], v[184:187], 0
    v_mfma_f32_16x16x32_bf16 v[92:95], a[28:31], v[188:191], v[92:95]
    s_waitcnt vmcnt(20) lgkmcnt(0)
    v_mfma_f32_16x16x32_bf16 v[32:35], a[32:35], v[160:163], v[32:35]
    ds_read_b128 v[176:179], v12 offset:34816
    v_mul_f32 v104, v104, v136
    v_mfma_f32_16x16x32_bf16 v[32:35], a[48:51], v[164:167], v[32:35]
    ds_read_b128 v[180:183], v12 offset:35840
    s_add_u32 s48, s44, 0
    v_mul_f32 v105, v105, v137
    v_mfma_f32_16x16x32_bf16 v[36:39], a[36:39], v[160:163], v[36:39]
    ds_read_b128 v[184:187], v12 offset:51200
    v_mul_f32 v106, v106, v138
    v_mfma_f32_16x16x32_bf16 v[36:39], a[52:55], v[164:167], v[36:39]
    ds_read_b128 v[188:191], v12 offset:52224
    ds_read_b64_tr_b16 a[0:1], v8 offset:0
    v_mfma_f32_16x16x32_bf16 v[64:67], a[40:43], v[160:163], v[64:67]
    buffer_store_dwordx4 v[96:99], v6, s[24:27], s48 offen sc1
    v_mfma_f32_16x16x32_bf16 v[64:67], a[56:59], v[164:167], v[64:67]
    ds_read_b64_tr_b16 a[2:3], v8 offset:2048
    v_mul_f32 v107, v107, v139
    v_mfma_f32_16x16x32_bf16 v[68:71], a[44:47], v[160:163], v[68:71]
    ds_read_b64_tr_b16 a[4:5], v9 offset:0
    v_mul_f32 v108, v108, v140
    v_mfma_f32_16x16x32_bf16 v[68:71], a[60:63], v[164:167], v[68:71]
    ds_read_b64_tr_b16 a[6:7], v9 offset:2048
    v_mul_f32 v109, v109, v141
    v_mfma_f32_16x16x32_bf16 v[40:43], a[32:35], v[168:171], v[40:43]
    ds_read_b64_tr_b16 a[8:9], v10 offset:0
    v_mul_f32 v110, v110, v142
    v_mfma_f32_16x16x32_bf16 v[40:43], a[48:51], v[172:175], v[40:43]
    ds_read_b64_tr_b16 a[10:11], v10 offset:2048
    ds_read_b64_tr_b16 a[12:13], v11 offset:0
    v_mfma_f32_16x16x32_bf16 v[44:47], a[36:39], v[168:171], v[44:47]
    ds_read_b64_tr_b16 a[14:15], v11 offset:2048
    v_mul_f32 v111, v111, v143
    v_mfma_f32_16x16x32_bf16 v[44:47], a[52:55], v[172:175], v[44:47]
    v_mul_f32 v104, v104, v221
    v_mfma_f32_16x16x32_bf16 v[72:75], a[40:43], v[168:171], v[72:75]
    v_mul_f32 v105, v105, v221
    v_mfma_f32_16x16x32_bf16 v[72:75], a[56:59], v[172:175], v[72:75]
    v_mfma_f32_16x16x32_bf16 v[76:79], a[44:47], v[168:171], v[76:79]
    v_mfma_f32_16x16x32_bf16 v[76:79], a[60:63], v[172:175], v[76:79]
    s_waitcnt vmcnt(17) lgkmcnt(0)
    v_mfma_f32_16x16x32_bf16 v[48:51], a[32:35], v[176:179], v[48:51]
    s_barrier
    ds_read_b128 v[160:163], v12 offset:4096
    v_mul_f32 v106, v106, v221
    v_mfma_f32_16x16x32_bf16 v[48:51], a[48:51], v[180:183], v[48:51]
    ds_read_b128 v[164:167], v12 offset:5120
    s_add_u32 m0, s36, 0
    v_mul_f32 v107, v107, v221
    v_mfma_f32_16x16x32_bf16 v[52:55], a[36:39], v[176:179], v[52:55]
    ds_read_b128 v[168:171], v12 offset:20480
    s_add_u32 s49, s41, 196608
    v_mul_f32 v108, v108, v221
    v_mfma_f32_16x16x32_bf16 v[52:55], a[52:55], v[180:183], v[52:55]
    buffer_load_dwordx4 v16, s[20:23], s49 offen lds
    v_mfma_f32_16x16x32_bf16 v[80:83], a[40:43], v[176:179], v[80:83]
    ds_read_b128 v[172:175], v12 offset:21504
    ds_read_b64_tr_b16 a[16:17], v8 offset:4096
    v_mfma_f32_16x16x32_bf16 v[80:83], a[56:59], v[180:183], v[80:83]
    ds_read_b64_tr_b16 a[18:19], v8 offset:6144
    v_mul_f32 v109, v109, v221
    v_mfma_f32_16x16x32_bf16 v[84:87], a[44:47], v[176:179], v[84:87]
    buffer_load_dwordx4 v17, s[20:23], s49 offen offset:1024 lds
    v_mfma_f32_16x16x32_bf16 v[84:87], a[60:63], v[180:183], v[84:87]
    ds_read_b64_tr_b16 a[20:21], v9 offset:4096
    v_mul_f32 v110, v110, v221
    v_mfma_f32_16x16x32_bf16 v[56:59], a[32:35], v[184:187], v[56:59]
    ds_read_b64_tr_b16 a[22:23], v9 offset:6144
    v_mul_f32 v111, v111, v221
    v_mfma_f32_16x16x32_bf16 v[56:59], a[48:51], v[188:191], v[56:59]
    ds_read_b64_tr_b16 a[24:25], v10 offset:4096
    v_cvt_pk_bf16_f32 v104, v104, v105
    v_mfma_f32_16x16x32_bf16 v[60:63], a[36:39], v[184:187], v[60:63]
    buffer_load_dwordx4 v18, s[20:23], s49 offen offset:2048 lds
    v_mfma_f32_16x16x32_bf16 v[60:63], a[52:55], v[188:191], v[60:63]
    ds_read_b64_tr_b16 a[26:27], v10 offset:6144
    ds_read_b64_tr_b16 a[28:29], v11 offset:4096
    v_mfma_f32_16x16x32_bf16 v[88:91], a[40:43], v[184:187], v[88:91]
    ds_read_b64_tr_b16 a[30:31], v11 offset:6144
    v_cvt_pk_bf16_f32 v105, v106, v107
    v_mfma_f32_16x16x32_bf16 v[88:91], a[56:59], v[188:191], v[88:91]
    buffer_load_dwordx4 v19, s[20:23], s49 offen offset:3072 lds
    v_mfma_f32_16x16x32_bf16 v[92:95], a[44:47], v[184:187], v[92:95]
    v_cvt_pk_bf16_f32 v106, v108, v109
    v_cvt_pk_bf16_f32 v107, v110, v111
    v_mfma_f32_16x16x32_bf16 v[92:95], a[60:63], v[188:191], v[92:95]
    s_waitcnt vmcnt(17) lgkmcnt(0)
    v_mfma_f32_16x16x32_bf16 v[32:35], a[64:67], v[160:163], v[32:35]
    ds_read_b128 v[176:179], v12 offset:36864
    v_mul_f32 v112, v112, v144
    v_mfma_f32_16x16x32_bf16 v[32:35], a[80:83], v[164:167], v[32:35]
    ds_read_b128 v[180:183], v12 offset:37888
    s_add_u32 m0, s36, 4096
    v_mul_f32 v113, v113, v145
    v_mfma_f32_16x16x32_bf16 v[36:39], a[68:71], v[160:163], v[36:39]
    ds_read_b128 v[184:187], v12 offset:53248
    s_add_u32 s49, s41, 229376
    v_mul_f32 v114, v114, v146
    v_mfma_f32_16x16x32_bf16 v[36:39], a[84:87], v[164:167], v[36:39]
    buffer_load_dwordx4 v16, s[20:23], s49 offen lds
    v_mfma_f32_16x16x32_bf16 v[64:67], a[72:75], v[160:163], v[64:67]
    ds_read_b128 v[188:191], v12 offset:54272
    ds_read_b64_tr_b16 a[32:33], v20 offset:0
    v_mfma_f32_16x16x32_bf16 v[64:67], a[88:91], v[164:167], v[64:67]
    ds_read_b64_tr_b16 a[34:35], v20 offset:2048
    v_mul_f32 v115, v115, v147
    v_mfma_f32_16x16x32_bf16 v[68:71], a[76:79], v[160:163], v[68:71]
    buffer_load_dwordx4 v17, s[20:23], s49 offen offset:1024 lds
    v_mfma_f32_16x16x32_bf16 v[68:71], a[92:95], v[164:167], v[68:71]
    ds_read_b64_tr_b16 a[36:37], v21 offset:0
    v_mul_f32 v116, v116, v148
    v_mfma_f32_16x16x32_bf16 v[40:43], a[64:67], v[168:171], v[40:43]
    ds_read_b64_tr_b16 a[38:39], v21 offset:2048
    v_mul_f32 v117, v117, v149
    v_mfma_f32_16x16x32_bf16 v[40:43], a[80:83], v[172:175], v[40:43]
    buffer_load_dwordx4 v18, s[20:23], s49 offen offset:2048 lds
    v_mfma_f32_16x16x32_bf16 v[44:47], a[68:71], v[168:171], v[44:47]
    ds_read_b64_tr_b16 a[40:41], v22 offset:0
    v_mul_f32 v118, v118, v150
    v_mfma_f32_16x16x32_bf16 v[44:47], a[84:87], v[172:175], v[44:47]
    ds_read_b64_tr_b16 a[42:43], v22 offset:2048
    ds_read_b64_tr_b16 a[44:45], v23 offset:0
    v_mfma_f32_16x16x32_bf16 v[72:75], a[72:75], v[168:171], v[72:75]
    ds_read_b64_tr_b16 a[46:47], v23 offset:2048
    v_mul_f32 v119, v119, v151
    v_mfma_f32_16x16x32_bf16 v[72:75], a[88:91], v[172:175], v[72:75]
    buffer_load_dwordx4 v19, s[20:23], s49 offen offset:3072 lds
    s_add_u32 s48, s44, 57344
    v_mfma_f32_16x16x32_bf16 v[76:79], a[76:79], v[168:171], v[76:79]
    v_mul_f32 v112, v112, v222
    v_mul_f32 v113, v113, v222
    v_mfma_f32_16x16x32_bf16 v[76:79], a[92:95], v[172:175], v[76:79]
    buffer_store_dwordx4 v[104:107], v6, s[24:27], s48 offen sc1
    s_waitcnt vmcnt(18) lgkmcnt(0)
    v_mfma_f32_16x16x32_bf16 v[48:51], a[64:67], v[176:179], v[48:51]
    ds_read_b128 v[160:163], v12 offset:6144
    v_mul_f32 v114, v114, v222
    v_mfma_f32_16x16x32_bf16 v[48:51], a[80:83], v[180:183], v[48:51]
    ds_read_b128 v[164:167], v12 offset:7168
    s_add_u32 m0, s42, 0
    v_mul_f32 v115, v115, v222
    v_mfma_f32_16x16x32_bf16 v[52:55], a[68:71], v[176:179], v[52:55]
    ds_read_b128 v[168:171], v12 offset:22528
    s_add_u32 s49, s41, 262144
    v_mul_f32 v116, v116, v222
    v_mfma_f32_16x16x32_bf16 v[52:55], a[84:87], v[180:183], v[52:55]
    buffer_load_dwordx4 v16, s[20:23], s49 offen lds
    v_mfma_f32_16x16x32_bf16 v[80:83], a[72:75], v[176:179], v[80:83]
    ds_read_b128 v[172:175], v12 offset:23552
    ds_read_b64_tr_b16 a[48:49], v20 offset:4096
    v_mfma_f32_16x16x32_bf16 v[80:83], a[88:91], v[180:183], v[80:83]
    ds_read_b64_tr_b16 a[50:51], v20 offset:6144
    v_mul_f32 v117, v117, v222
    v_mfma_f32_16x16x32_bf16 v[84:87], a[76:79], v[176:179], v[84:87]
    buffer_load_dwordx4 v17, s[20:23], s49 offen offset:1024 lds
    v_mfma_f32_16x16x32_bf16 v[84:87], a[92:95], v[180:183], v[84:87]
    ds_read_b64_tr_b16 a[52:53], v21 offset:4096
    v_mul_f32 v118, v118, v222
    v_mfma_f32_16x16x32_bf16 v[56:59], a[64:67], v[184:187], v[56:59]
    ds_read_b64_tr_b16 a[54:55], v21 offset:6144
    v_mul_f32 v119, v119, v222
    v_mfma_f32_16x16x32_bf16 v[56:59], a[80:83], v[188:191], v[56:59]
    ds_read_b64_tr_b16 a[56:57], v22 offset:4096
    v_cvt_pk_bf16_f32 v112, v112, v113
    v_mfma_f32_16x16x32_bf16 v[60:63], a[68:71], v[184:187], v[60:63]
    buffer_load_dwordx4 v18, s[20:23], s49 offen offset:2048 lds
    v_mfma_f32_16x16x32_bf16 v[60:63], a[84:87], v[188:191], v[60:63]
    ds_read_b64_tr_b16 a[58:59], v22 offset:6144
    ds_read_b64_tr_b16 a[60:61], v23 offset:4096
    v_mfma_f32_16x16x32_bf16 v[88:91], a[72:75], v[184:187], v[88:91]
    ds_read_b64_tr_b16 a[62:63], v23 offset:6144
    v_cvt_pk_bf16_f32 v113, v114, v115
    v_mfma_f32_16x16x32_bf16 v[88:91], a[88:91], v[188:191], v[88:91]
    buffer_load_dwordx4 v19, s[20:23], s49 offen offset:3072 lds
    v_mfma_f32_16x16x32_bf16 v[92:95], a[76:79], v[184:187], v[92:95]
    v_cvt_pk_bf16_f32 v114, v116, v117
    v_cvt_pk_bf16_f32 v115, v118, v119
    v_mfma_f32_16x16x32_bf16 v[92:95], a[92:95], v[188:191], v[92:95]
    s_waitcnt vmcnt(18) lgkmcnt(0)
    v_mfma_f32_16x16x32_bf16 v[32:35], a[96:99], v[160:163], v[32:35]
    ds_read_b128 v[176:179], v12 offset:38912
    v_mul_f32 v120, v120, v152
    v_mfma_f32_16x16x32_bf16 v[32:35], a[112:115], v[164:167], v[32:35]
    ds_read_b128 v[180:183], v12 offset:39936
    s_add_u32 m0, s42, 4096
    v_mul_f32 v121, v121, v153
    v_mfma_f32_16x16x32_bf16 v[36:39], a[100:103], v[160:163], v[36:39]
    ds_read_b128 v[184:187], v12 offset:55296
    s_add_u32 s49, s41, 294912
    v_mul_f32 v122, v122, v154
    v_mfma_f32_16x16x32_bf16 v[36:39], a[116:119], v[164:167], v[36:39]
    buffer_load_dwordx4 v16, s[20:23], s49 offen lds
    v_mfma_f32_16x16x32_bf16 v[64:67], a[104:107], v[160:163], v[64:67]
    ds_read_b128 v[188:191], v12 offset:56320
    ds_read_b64_tr_b16 a[64:65], v20 offset:8192
    v_mfma_f32_16x16x32_bf16 v[64:67], a[120:123], v[164:167], v[64:67]
    ds_read_b64_tr_b16 a[66:67], v20 offset:10240
    v_mul_f32 v123, v123, v155
    v_mfma_f32_16x16x32_bf16 v[68:71], a[108:111], v[160:163], v[68:71]
    buffer_load_dwordx4 v17, s[20:23], s49 offen offset:1024 lds
    v_mfma_f32_16x16x32_bf16 v[68:71], a[124:127], v[164:167], v[68:71]
    ds_read_b64_tr_b16 a[68:69], v21 offset:8192
    v_mul_f32 v124, v124, v156
    v_mfma_f32_16x16x32_bf16 v[40:43], a[96:99], v[168:171], v[40:43]
    ds_read_b64_tr_b16 a[70:71], v21 offset:10240
    v_mul_f32 v125, v125, v157
    v_mfma_f32_16x16x32_bf16 v[40:43], a[112:115], v[172:175], v[40:43]
    buffer_load_dwordx4 v18, s[20:23], s49 offen offset:2048 lds
    v_mfma_f32_16x16x32_bf16 v[44:47], a[100:103], v[168:171], v[44:47]
    ds_read_b64_tr_b16 a[72:73], v22 offset:8192
    v_mul_f32 v126, v126, v158
    v_mfma_f32_16x16x32_bf16 v[44:47], a[116:119], v[172:175], v[44:47]
    ds_read_b64_tr_b16 a[74:75], v22 offset:10240
    ds_read_b64_tr_b16 a[76:77], v23 offset:8192
    v_mfma_f32_16x16x32_bf16 v[72:75], a[104:107], v[168:171], v[72:75]
    ds_read_b64_tr_b16 a[78:79], v23 offset:10240
    v_mul_f32 v127, v127, v159
    v_mfma_f32_16x16x32_bf16 v[72:75], a[120:123], v[172:175], v[72:75]
    buffer_load_dwordx4 v19, s[20:23], s49 offen offset:3072 lds
    s_add_u32 s48, s44, 114688
    v_mfma_f32_16x16x32_bf16 v[76:79], a[108:111], v[168:171], v[76:79]
    v_mul_f32 v120, v120, v223
    v_mul_f32 v121, v121, v223
    v_mfma_f32_16x16x32_bf16 v[76:79], a[124:127], v[172:175], v[76:79]
    buffer_store_dwordx4 v[112:115], v6, s[24:27], s48 offen sc1
    s_waitcnt vmcnt(19) lgkmcnt(0)
    v_mfma_f32_16x16x32_bf16 v[48:51], a[96:99], v[176:179], v[48:51]
    s_barrier
    ds_read_b128 v[160:163], v12 offset:8192
    v_mul_f32 v122, v122, v223
    v_mfma_f32_16x16x32_bf16 v[48:51], a[112:115], v[180:183], v[48:51]
    ds_read_b128 v[164:167], v12 offset:9216
    s_add_u32 m0, s42, 8192
    v_mul_f32 v123, v123, v223
    v_mfma_f32_16x16x32_bf16 v[52:55], a[100:103], v[176:179], v[52:55]
    ds_read_b128 v[168:171], v12 offset:24576
    s_add_u32 s49, s41, 327680
    v_mul_f32 v124, v124, v223
    v_mfma_f32_16x16x32_bf16 v[52:55], a[116:119], v[180:183], v[52:55]
    buffer_load_dwordx4 v16, s[20:23], s49 offen lds
    v_mfma_f32_16x16x32_bf16 v[80:83], a[104:107], v[176:179], v[80:83]
    ds_read_b128 v[172:175], v12 offset:25600
    ds_read_b64_tr_b16 a[80:81], v20 offset:12288
    v_mfma_f32_16x16x32_bf16 v[80:83], a[120:123], v[180:183], v[80:83]
    ds_read_b64_tr_b16 a[82:83], v20 offset:14336
    v_mul_f32 v125, v125, v223
    v_mfma_f32_16x16x32_bf16 v[84:87], a[108:111], v[176:179], v[84:87]
    buffer_load_dwordx4 v17, s[20:23], s49 offen offset:1024 lds
    v_mfma_f32_16x16x32_bf16 v[84:87], a[124:127], v[180:183], v[84:87]
    ds_read_b64_tr_b16 a[84:85], v21 offset:12288
    v_mul_f32 v126, v126, v223
    v_mfma_f32_16x16x32_bf16 v[56:59], a[96:99], v[184:187], v[56:59]
    ds_read_b64_tr_b16 a[86:87], v21 offset:14336
    v_mul_f32 v127, v127, v223
    v_mfma_f32_16x16x32_bf16 v[56:59], a[112:115], v[188:191], v[56:59]
    ds_read_b64_tr_b16 a[88:89], v22 offset:12288
    v_cvt_pk_bf16_f32 v120, v120, v121
    v_mfma_f32_16x16x32_bf16 v[60:63], a[100:103], v[184:187], v[60:63]
    buffer_load_dwordx4 v18, s[20:23], s49 offen offset:2048 lds
    v_mfma_f32_16x16x32_bf16 v[60:63], a[116:119], v[188:191], v[60:63]
    ds_read_b64_tr_b16 a[90:91], v22 offset:14336
    ds_read_b64_tr_b16 a[92:93], v23 offset:12288
    v_mfma_f32_16x16x32_bf16 v[88:91], a[104:107], v[184:187], v[88:91]
    ds_read_b64_tr_b16 a[94:95], v23 offset:14336
    v_cvt_pk_bf16_f32 v121, v122, v123
    v_mfma_f32_16x16x32_bf16 v[88:91], a[120:123], v[188:191], v[88:91]
    buffer_load_dwordx4 v19, s[20:23], s49 offen offset:3072 lds
    v_mfma_f32_16x16x32_bf16 v[92:95], a[108:111], v[184:187], v[92:95]
    v_cvt_pk_bf16_f32 v122, v124, v125
    v_cvt_pk_bf16_f32 v123, v126, v127
    v_mfma_f32_16x16x32_bf16 v[92:95], a[124:127], v[188:191], v[92:95]
    s_waitcnt vmcnt(18) lgkmcnt(0)
    v_mfma_f32_16x16x32_bf16 v[32:35], a[128:131], v[160:163], v[32:35]
    ds_read_b128 v[176:179], v12 offset:40960
    ds_read_b128 v[180:183], v12 offset:41984
    v_mfma_f32_16x16x32_bf16 v[32:35], a[144:147], v[164:167], v[32:35]
    ds_read_b128 v[184:187], v12 offset:57344
    s_add_u32 m0, s42, 12288
    s_add_u32 s49, s41, 360448
    v_mfma_f32_16x16x32_bf16 v[36:39], a[132:135], v[160:163], v[36:39]
    buffer_load_dwordx4 v16, s[20:23], s49 offen lds
    v_mfma_f32_16x16x32_bf16 v[36:39], a[148:151], v[164:167], v[36:39]
    ds_read_b128 v[188:191], v12 offset:58368
    ds_read_b64_tr_b16 a[96:97], v8 offset:0
    v_mfma_f32_16x16x32_bf16 v[64:67], a[136:139], v[160:163], v[64:67]
    buffer_load_dwordx4 v17, s[20:23], s49 offen offset:1024 lds
    v_mfma_f32_16x16x32_bf16 v[64:67], a[152:155], v[164:167], v[64:67]
    ds_read_b64_tr_b16 a[98:99], v8 offset:2048
    ds_read_b64_tr_b16 a[100:101], v9 offset:0
    v_mfma_f32_16x16x32_bf16 v[68:71], a[140:143], v[160:163], v[68:71]
    ds_read_b64_tr_b16 a[102:103], v9 offset:2048
    v_mfma_f32_16x16x32_bf16 v[68:71], a[156:159], v[164:167], v[68:71]
    buffer_load_dwordx4 v18, s[20:23], s49 offen offset:2048 lds
    v_mfma_f32_16x16x32_bf16 v[40:43], a[128:131], v[168:171], v[40:43]
    ds_read_b64_tr_b16 a[104:105], v10 offset:0
    ds_read_b64_tr_b16 a[106:107], v10 offset:2048
    v_mfma_f32_16x16x32_bf16 v[40:43], a[144:147], v[172:175], v[40:43]
    buffer_load_dwordx4 v19, s[20:23], s49 offen offset:3072 lds
    v_mfma_f32_16x16x32_bf16 v[44:47], a[132:135], v[168:171], v[44:47]
    ds_read_b64_tr_b16 a[108:109], v11 offset:0
    ds_read_b64_tr_b16 a[110:111], v11 offset:2048
    v_mfma_f32_16x16x32_bf16 v[44:47], a[148:151], v[172:175], v[44:47]
    s_add_u32 s48, s44, 172032
    v_mfma_f32_16x16x32_bf16 v[72:75], a[136:139], v[168:171], v[72:75]
    buffer_store_dwordx4 v[120:123], v6, s[24:27], s48 offen sc1
    v_mfma_f32_16x16x32_bf16 v[72:75], a[152:155], v[172:175], v[72:75]
    v_mfma_f32_16x16x32_bf16 v[76:79], a[140:143], v[168:171], v[76:79]
    v_mfma_f32_16x16x32_bf16 v[76:79], a[156:159], v[172:175], v[76:79]
    s_waitcnt vmcnt(19) lgkmcnt(0)
    v_mfma_f32_16x16x32_bf16 v[48:51], a[128:131], v[176:179], v[48:51]
    ds_read_b128 v[160:163], v12 offset:10240
    ds_read_b128 v[164:167], v12 offset:11264
    v_mfma_f32_16x16x32_bf16 v[48:51], a[144:147], v[180:183], v[48:51]
    ds_read_b128 v[168:171], v12 offset:26624
    s_add_u32 m0, s36, 0
    s_add_u32 s49, s41, 393216
    v_mfma_f32_16x16x32_bf16 v[52:55], a[132:135], v[176:179], v[52:55]
    buffer_load_dwordx4 v16, s[20:23], s49 offen lds
    v_mfma_f32_16x16x32_bf16 v[52:55], a[148:151], v[180:183], v[52:55]
    ds_read_b128 v[172:175], v12 offset:27648
    ds_read_b64_tr_b16 a[112:113], v8 offset:4096
    v_mfma_f32_16x16x32_bf16 v[80:83], a[136:139], v[176:179], v[80:83]
    ds_read_b64_tr_b16 a[114:115], v8 offset:6144
    v_mfma_f32_16x16x32_bf16 v[80:83], a[152:155], v[180:183], v[80:83]
    buffer_load_dwordx4 v17, s[20:23], s49 offen offset:1024 lds
    v_mfma_f32_16x16x32_bf16 v[84:87], a[140:143], v[176:179], v[84:87]
    ds_read_b64_tr_b16 a[116:117], v9 offset:4096
    ds_read_b64_tr_b16 a[118:119], v9 offset:6144
    v_mfma_f32_16x16x32_bf16 v[84:87], a[156:159], v[180:183], v[84:87]
    ds_read_b64_tr_b16 a[120:121], v10 offset:4096
    v_mfma_f32_16x16x32_bf16 v[56:59], a[128:131], v[184:187], v[56:59]
    buffer_load_dwordx4 v18, s[20:23], s49 offen offset:2048 lds
    v_mfma_f32_16x16x32_bf16 v[56:59], a[144:147], v[188:191], v[56:59]
    ds_read_b64_tr_b16 a[122:123], v10 offset:6144
    ds_read_b64_tr_b16 a[124:125], v11 offset:4096
    v_mfma_f32_16x16x32_bf16 v[60:63], a[132:135], v[184:187], v[60:63]
    ds_read_b64_tr_b16 a[126:127], v11 offset:6144
    v_mfma_f32_16x16x32_bf16 v[60:63], a[148:151], v[188:191], v[60:63]
    buffer_load_dwordx4 v19, s[20:23], s49 offen offset:3072 lds
    v_mfma_f32_16x16x32_bf16 v[88:91], a[136:139], v[184:187], v[88:91]
    v_mfma_f32_16x16x32_bf16 v[88:91], a[152:155], v[188:191], v[88:91]
    v_mfma_f32_16x16x32_bf16 v[92:95], a[140:143], v[184:187], v[92:95]
    v_mfma_f32_16x16x32_bf16 v[92:95], a[156:159], v[188:191], v[92:95]
    s_waitcnt vmcnt(18) lgkmcnt(0)
    v_mfma_f32_16x16x32_bf16 v[32:35], a[160:163], v[160:163], v[32:35]
    ds_read_b128 v[176:179], v12 offset:43008
    v_mov_b32 v236, v232
    v_mfma_f32_16x16x32_bf16 v[32:35], a[176:179], v[164:167], v[32:35]
    ds_read_b128 v[180:183], v12 offset:44032
    s_add_u32 m0, s36, 4096
    v_mov_b32 v237, v232
    v_mfma_f32_16x16x32_bf16 v[36:39], a[164:167], v[160:163], v[36:39]
    ds_read_b128 v[184:187], v12 offset:59392
    ds_read_b128 v[188:191], v12 offset:60416
    s_add_u32 s49, s41, 425984
    v_mfma_f32_16x16x32_bf16 v[36:39], a[180:183], v[164:167], v[36:39]
    buffer_load_dwordx4 v16, s[20:23], s49 offen lds
    v_mfma_f32_16x16x32_bf16 v[64:67], a[168:171], v[160:163], v[64:67]
    ds_read_b64_tr_b16 a[128:129], v20 offset:0
    v_mov_b32 v240, v233
    v_mfma_f32_16x16x32_bf16 v[64:67], a[184:187], v[164:167], v[64:67]
    ds_read_b64_tr_b16 a[130:131], v20 offset:2048
    v_mov_b32 v241, v233
    v_mfma_f32_16x16x32_bf16 v[68:71], a[172:175], v[160:163], v[68:71]
    buffer_load_dwordx4 v17, s[20:23], s49 offen offset:1024 lds
    v_mfma_f32_16x16x32_bf16 v[68:71], a[188:191], v[164:167], v[68:71]
    ds_read_b64_tr_b16 a[132:133], v21 offset:0
    ds_read_b64_tr_b16 a[134:135], v21 offset:2048
    v_mfma_f32_16x16x32_bf16 v[40:43], a[160:163], v[168:171], v[40:43]
    ds_read_b64_tr_b16 a[136:137], v22 offset:0
    v_mov_b32 v244, v234
    v_mfma_f32_16x16x32_bf16 v[40:43], a[176:179], v[172:175], v[40:43]
    buffer_load_dwordx4 v18, s[20:23], s49 offen offset:2048 lds
    v_mfma_f32_16x16x32_bf16 v[44:47], a[164:167], v[168:171], v[44:47]
    ds_read_b64_tr_b16 a[138:139], v22 offset:2048
    v_mov_b32 v245, v234
    v_mfma_f32_16x16x32_bf16 v[44:47], a[180:183], v[172:175], v[44:47]
    ds_read_b64_tr_b16 a[140:141], v23 offset:0
    ds_read_b64_tr_b16 a[142:143], v23 offset:2048
    v_mfma_f32_16x16x32_bf16 v[72:75], a[168:171], v[168:171], v[72:75]
    v_mov_b32 v248, v235
    v_mov_b32 v249, v235
    v_mfma_f32_16x16x32_bf16 v[72:75], a[184:187], v[172:175], v[72:75]
    buffer_load_dwordx4 v19, s[20:23], s49 offen offset:3072 lds
    v_mfma_f32_16x16x32_bf16 v[76:79], a[172:175], v[168:171], v[76:79]
    v_mfma_f32_16x16x32_bf16 v[76:79], a[188:191], v[172:175], v[76:79]
    s_waitcnt vmcnt(8) lgkmcnt(0)
    v_mfma_f32_16x16x32_bf16 v[48:51], a[160:163], v[176:179], v[48:51]
    s_barrier
    ds_read_b128 v[160:163], v12 offset:12288
    ds_read_b128 v[164:167], v12 offset:13312
    v_mfma_f32_16x16x32_bf16 v[48:51], a[176:179], v[180:183], v[48:51]
    ds_read_b128 v[168:171], v12 offset:28672
    s_lshl_b32 s48, s15, 2
    s_add_u32 s48, s48, s68
    v_mfma_f32_16x16x32_bf16 v[52:55], a[164:167], v[176:179], v[52:55]
    ds_read_b128 v[172:175], v12 offset:29696
    v_mfma_f32_16x16x32_bf16 v[52:55], a[180:183], v[180:183], v[52:55]
    ds_read_b64_tr_b16 a[144:145], v20 offset:4096
    v_mov_b32 v15, s70
    v_mfma_f32_16x16x32_bf16 v[80:83], a[168:171], v[176:179], v[80:83]
    ds_read_b64_tr_b16 a[146:147], v20 offset:6144
    v_mfma_f32_16x16x32_bf16 v[80:83], a[184:187], v[180:183], v[80:83]
    ds_read_b64_tr_b16 a[148:149], v21 offset:4096
    v_mfma_f32_16x16x32_bf16 v[84:87], a[172:175], v[176:179], v[84:87]
    ds_read_b64_tr_b16 a[150:151], v21 offset:6144
    v_mfma_f32_16x16x32_bf16 v[84:87], a[188:191], v[180:183], v[84:87]
    ds_read_b64_tr_b16 a[152:153], v22 offset:4096
    v_mfma_f32_16x16x32_bf16 v[56:59], a[160:163], v[184:187], v[56:59]
    buffer_store_dword v15, v1, s[24:27], s48 offen offset:1280 sc1
    v_mfma_f32_16x16x32_bf16 v[56:59], a[176:179], v[188:191], v[56:59]
    ds_read_b64_tr_b16 a[154:155], v22 offset:6144
    ds_read_b64_tr_b16 a[156:157], v23 offset:4096
    v_mfma_f32_16x16x32_bf16 v[60:63], a[164:167], v[184:187], v[60:63]
    ds_read_b64_tr_b16 a[158:159], v23 offset:6144
    v_mfma_f32_16x16x32_bf16 v[60:63], a[180:183], v[188:191], v[60:63]
    v_mfma_f32_16x16x32_bf16 v[88:91], a[168:171], v[184:187], v[88:91]
    v_mfma_f32_16x16x32_bf16 v[88:91], a[184:187], v[188:191], v[88:91]
    v_mfma_f32_16x16x32_bf16 v[92:95], a[172:175], v[184:187], v[92:95]
    v_mfma_f32_16x16x32_bf16 v[92:95], a[188:191], v[188:191], v[92:95]
    s_waitcnt vmcnt(14) lgkmcnt(0)
    v_mfma_f32_16x16x32_bf16 v[32:35], a[192:195], v[160:163], v[32:35]
    ds_read_b128 v[176:179], v12 offset:45056
    ds_read_b128 v[180:183], v12 offset:46080
    v_mfma_f32_16x16x32_bf16 v[32:35], a[208:211], v[164:167], v[32:35]
    ds_read_b128 v[184:187], v12 offset:61440
    ds_read_b128 v[188:191], v12 offset:62464
    v_mfma_f32_16x16x32_bf16 v[36:39], a[196:199], v[160:163], v[36:39]
    ds_read_b64_tr_b16 a[160:161], v20 offset:8192
    v_mfma_f32_16x16x32_bf16 v[36:39], a[212:215], v[164:167], v[36:39]
    ds_read_b64_tr_b16 a[162:163], v20 offset:10240
    v_mfma_f32_16x16x32_bf16 v[64:67], a[200:203], v[160:163], v[64:67]
    v_mfma_f32_16x16x32_bf16 v[64:67], a[216:219], v[164:167], v[64:67]
    ds_read_b64_tr_b16 a[164:165], v21 offset:8192
    v_mfma_f32_16x16x32_bf16 v[68:71], a[204:207], v[160:163], v[68:71]
    ds_read_b64_tr_b16 a[166:167], v21 offset:10240
    v_mfma_f32_16x16x32_bf16 v[68:71], a[220:223], v[164:167], v[68:71]
    ds_read_b64_tr_b16 a[168:169], v22 offset:8192
    v_mfma_f32_16x16x32_bf16 v[40:43], a[192:195], v[168:171], v[40:43]
    ds_read_b64_tr_b16 a[170:171], v22 offset:10240
    v_mfma_f32_16x16x32_bf16 v[40:43], a[208:211], v[172:175], v[40:43]
    ds_read_b64_tr_b16 a[172:173], v23 offset:8192
    v_mfma_f32_16x16x32_bf16 v[44:47], a[196:199], v[168:171], v[44:47]
    ds_read_b64_tr_b16 a[174:175], v23 offset:10240
    v_mfma_f32_16x16x32_bf16 v[44:47], a[212:215], v[172:175], v[44:47]
    v_mfma_f32_16x16x32_bf16 v[72:75], a[200:203], v[168:171], v[72:75]
    v_mfma_f32_16x16x32_bf16 v[72:75], a[216:219], v[172:175], v[72:75]
    v_mfma_f32_16x16x32_bf16 v[76:79], a[204:207], v[168:171], v[76:79]
    v_mfma_f32_16x16x32_bf16 v[76:79], a[220:223], v[172:175], v[76:79]
    s_waitcnt vmcnt(10) lgkmcnt(0)
    v_mfma_f32_16x16x32_bf16 v[48:51], a[192:195], v[176:179], v[48:51]
    ds_read_b128 v[160:163], v12 offset:14336
    ds_read_b128 v[164:167], v12 offset:15360
    v_mfma_f32_16x16x32_bf16 v[48:51], a[208:211], v[180:183], v[48:51]
    ds_read_b128 v[168:171], v12 offset:30720
    ds_read_b128 v[172:175], v12 offset:31744
    v_mfma_f32_16x16x32_bf16 v[52:55], a[196:199], v[176:179], v[52:55]
    ds_read_b64_tr_b16 a[176:177], v20 offset:12288
    v_mfma_f32_16x16x32_bf16 v[52:55], a[212:215], v[180:183], v[52:55]
    ds_read_b64_tr_b16 a[178:179], v20 offset:14336
    v_mfma_f32_16x16x32_bf16 v[80:83], a[200:203], v[176:179], v[80:83]
    v_mfma_f32_16x16x32_bf16 v[80:83], a[216:219], v[180:183], v[80:83]
    ds_read_b64_tr_b16 a[180:181], v21 offset:12288
    v_mfma_f32_16x16x32_bf16 v[84:87], a[204:207], v[176:179], v[84:87]
    ds_read_b64_tr_b16 a[182:183], v21 offset:14336
    v_mfma_f32_16x16x32_bf16 v[84:87], a[220:223], v[180:183], v[84:87]
    ds_read_b64_tr_b16 a[184:185], v22 offset:12288
    v_mfma_f32_16x16x32_bf16 v[56:59], a[192:195], v[184:187], v[56:59]
    ds_read_b64_tr_b16 a[186:187], v22 offset:14336
    v_mfma_f32_16x16x32_bf16 v[56:59], a[208:211], v[188:191], v[56:59]
    ds_read_b64_tr_b16 a[188:189], v23 offset:12288
    v_mfma_f32_16x16x32_bf16 v[60:63], a[196:199], v[184:187], v[60:63]
    ds_read_b64_tr_b16 a[190:191], v23 offset:14336
    v_mfma_f32_16x16x32_bf16 v[60:63], a[212:215], v[188:191], v[60:63]
    v_mfma_f32_16x16x32_bf16 v[88:91], a[200:203], v[184:187], v[88:91]
    v_mfma_f32_16x16x32_bf16 v[88:91], a[216:219], v[188:191], v[88:91]
    v_mfma_f32_16x16x32_bf16 v[92:95], a[204:207], v[184:187], v[92:95]
    v_mfma_f32_16x16x32_bf16 v[92:95], a[220:223], v[188:191], v[92:95]
    s_waitcnt vmcnt(5) lgkmcnt(0)
    v_mfma_f32_16x16x32_bf16 v[32:35], a[224:227], v[160:163], v[32:35]
    ds_read_b128 v[176:179], v12 offset:47104
    ds_read_b128 v[180:183], v12 offset:48128
    v_mfma_f32_16x16x32_bf16 v[32:35], a[240:243], v[164:167], v[32:35]
    ds_read_b128 v[184:187], v12 offset:63488
    ds_read_b128 v[188:191], v12 offset:64512
    v_mfma_f32_16x16x32_bf16 v[32:35], v[204:207], v[236:239], v[32:35]
    ds_read_b64_tr_b16 a[192:193], v8 offset:0
    v_mfma_f32_16x16x32_bf16 v[36:39], a[228:231], v[160:163], v[36:39]
    ds_read_b64_tr_b16 a[194:195], v8 offset:2048
    v_mfma_f32_16x16x32_bf16 v[36:39], a[244:247], v[164:167], v[36:39]
    v_mfma_f32_16x16x32_bf16 v[36:39], v[208:211], v[236:239], v[36:39]
    ds_read_b64_tr_b16 a[196:197], v9 offset:0
    v_mfma_f32_16x16x32_bf16 v[64:67], a[232:235], v[160:163], v[64:67]
    ds_read_b64_tr_b16 a[198:199], v9 offset:2048
    v_mfma_f32_16x16x32_bf16 v[64:67], a[248:251], v[164:167], v[64:67]
    ds_read_b64_tr_b16 a[200:201], v10 offset:0
    v_mfma_f32_16x16x32_bf16 v[64:67], v[212:215], v[236:239], v[64:67]
    ds_read_b64_tr_b16 a[202:203], v10 offset:2048
    v_mfma_f32_16x16x32_bf16 v[68:71], a[236:239], v[160:163], v[68:71]
    ds_read_b64_tr_b16 a[204:205], v11 offset:0
    v_mfma_f32_16x16x32_bf16 v[68:71], a[252:255], v[164:167], v[68:71]
    ds_read_b64_tr_b16 a[206:207], v11 offset:2048
    v_mfma_f32_16x16x32_bf16 v[68:71], v[216:219], v[236:239], v[68:71]
    v_mfma_f32_16x16x32_bf16 v[40:43], a[224:227], v[168:171], v[40:43]
    v_mfma_f32_16x16x32_bf16 v[40:43], a[240:243], v[172:175], v[40:43]
    v_mfma_f32_16x16x32_bf16 v[40:43], v[204:207], v[240:243], v[40:43]
    v_mfma_f32_16x16x32_bf16 v[44:47], a[228:231], v[168:171], v[44:47]
    v_mfma_f32_16x16x32_bf16 v[44:47], a[244:247], v[172:175], v[44:47]
    v_mfma_f32_16x16x32_bf16 v[44:47], v[208:211], v[240:243], v[44:47]
    v_mfma_f32_16x16x32_bf16 v[72:75], a[232:235], v[168:171], v[72:75]
    v_mfma_f32_16x16x32_bf16 v[72:75], a[248:251], v[172:175], v[72:75]
    v_mfma_f32_16x16x32_bf16 v[72:75], v[212:215], v[240:243], v[72:75]
    v_mfma_f32_16x16x32_bf16 v[76:79], a[236:239], v[168:171], v[76:79]
    v_mfma_f32_16x16x32_bf16 v[76:79], a[252:255], v[172:175], v[76:79]
    v_mfma_f32_16x16x32_bf16 v[76:79], v[216:219], v[240:243], v[76:79]
    s_waitcnt vmcnt(1) lgkmcnt(0)
    v_mfma_f32_16x16x32_bf16 v[48:51], a[224:227], v[176:179], v[48:51]
    ds_read_b64_tr_b16 a[208:209], v8 offset:4096
    ds_read_b64_tr_b16 a[210:211], v8 offset:6144
    v_mfma_f32_16x16x32_bf16 v[48:51], a[240:243], v[180:183], v[48:51]
    ds_read_b64_tr_b16 a[212:213], v9 offset:4096
    v_mfma_f32_16x16x32_bf16 v[48:51], v[204:207], v[244:247], v[48:51]
    v_mul_f32 v32, v32, v64
    v_mul_f32 v33, v33, v65
    v_mfma_f32_16x16x32_bf16 v[52:55], a[228:231], v[176:179], v[52:55]
    v_mul_f32 v34, v34, v66
    v_mul_f32 v35, v35, v67
    v_mfma_f32_16x16x32_bf16 v[52:55], a[244:247], v[180:183], v[52:55]
    v_mul_f32 v36, v36, v68
    v_mul_f32 v37, v37, v69
    v_mfma_f32_16x16x32_bf16 v[52:55], v[208:211], v[244:247], v[52:55]
    ds_read_b64_tr_b16 a[214:215], v9 offset:6144
    v_mul_f32 v38, v38, v70
    v_mfma_f32_16x16x32_bf16 v[80:83], a[232:235], v[176:179], v[80:83]
    v_mul_f32 v39, v39, v71
    v_mul_f32 v32, v32, v224
    v_mfma_f32_16x16x32_bf16 v[80:83], a[248:251], v[180:183], v[80:83]
    ds_read_b64_tr_b16 a[216:217], v10 offset:4096
    v_mul_f32 v33, v33, v224
    v_mfma_f32_16x16x32_bf16 v[80:83], v[212:215], v[244:247], v[80:83]
    v_mul_f32 v34, v34, v224
    v_mul_f32 v35, v35, v224
    v_mfma_f32_16x16x32_bf16 v[84:87], a[236:239], v[176:179], v[84:87]
    ds_read_b64_tr_b16 a[218:219], v10 offset:6144
    v_mul_f32 v36, v36, v224
    v_mfma_f32_16x16x32_bf16 v[84:87], a[252:255], v[180:183], v[84:87]
    v_mul_f32 v37, v37, v224
    v_mul_f32 v38, v38, v224
    v_mfma_f32_16x16x32_bf16 v[84:87], v[216:219], v[244:247], v[84:87]
    ds_read_b64_tr_b16 a[220:221], v11 offset:4096
    v_mul_f32 v39, v39, v224
    v_mfma_f32_16x16x32_bf16 v[56:59], a[224:227], v[184:187], v[56:59]
    ds_read_b64_tr_b16 a[222:223], v11 offset:6144
    v_cvt_pk_bf16_f32 v32, v32, v33
    v_mfma_f32_16x16x32_bf16 v[56:59], a[240:243], v[188:191], v[56:59]
    v_cvt_pk_bf16_f32 v33, v34, v35
    v_cvt_pk_bf16_f32 v34, v36, v37
    v_mfma_f32_16x16x32_bf16 v[56:59], v[204:207], v[248:251], v[56:59]
    v_cvt_pk_bf16_f32 v35, v38, v39
    s_add_u32 s48, s45, 0
    buffer_store_dwordx4 v[32:35], v6, s[24:27], s48 offen sc1
    v_mfma_f32_16x16x32_bf16 v[60:63], a[228:231], v[184:187], v[60:63]
    v_mul_f32 v40, v40, v72
    v_mul_f32 v41, v41, v73
    v_mfma_f32_16x16x32_bf16 v[60:63], a[244:247], v[188:191], v[60:63]
    v_mul_f32 v42, v42, v74
    v_mul_f32 v43, v43, v75
    v_mfma_f32_16x16x32_bf16 v[60:63], v[208:211], v[248:251], v[60:63]
    v_mul_f32 v44, v44, v76
    v_mul_f32 v45, v45, v77
    v_mfma_f32_16x16x32_bf16 v[88:91], a[232:235], v[184:187], v[88:91]
    v_mul_f32 v46, v46, v78
    v_mul_f32 v47, v47, v79
    v_mfma_f32_16x16x32_bf16 v[88:91], a[248:251], v[188:191], v[88:91]
    v_mul_f32 v40, v40, v225
    v_mul_f32 v41, v41, v225
    v_mfma_f32_16x16x32_bf16 v[88:91], v[212:215], v[248:251], v[88:91]
    v_mul_f32 v42, v42, v225
    v_mul_f32 v43, v43, v225
    v_mfma_f32_16x16x32_bf16 v[92:95], a[236:239], v[184:187], v[92:95]
    v_mul_f32 v44, v44, v225
    v_mul_f32 v45, v45, v225
    v_mfma_f32_16x16x32_bf16 v[92:95], a[252:255], v[188:191], v[92:95]
    v_mul_f32 v46, v46, v225
    v_mul_f32 v47, v47, v225
    v_mfma_f32_16x16x32_bf16 v[92:95], v[216:219], v[248:251], v[92:95]
    v_cvt_pk_bf16_f32 v40, v40, v41
    v_cvt_pk_bf16_f32 v41, v42, v43
    v_cvt_pk_bf16_f32 v42, v44, v45
    v_cvt_pk_bf16_f32 v43, v46, v47
    s_add_u32 s48, s45, 57344
    buffer_store_dwordx4 v[40:43], v6, s[24:27], s48 offen sc1
    v_mul_f32 v48, v48, v80
    v_mul_f32 v49, v49, v81
    v_mul_f32 v50, v50, v82
    v_mul_f32 v51, v51, v83
    v_mul_f32 v52, v52, v84
    v_mul_f32 v53, v53, v85
    v_mul_f32 v54, v54, v86
    v_mul_f32 v55, v55, v87
    v_mul_f32 v48, v48, v226
    v_mul_f32 v49, v49, v226
    v_mul_f32 v50, v50, v226
    v_mul_f32 v51, v51, v226
    v_mul_f32 v52, v52, v226
    v_mul_f32 v53, v53, v226
    v_mul_f32 v54, v54, v226
    v_mul_f32 v55, v55, v226
    v_cvt_pk_bf16_f32 v48, v48, v49
    v_cvt_pk_bf16_f32 v49, v50, v51
    v_cvt_pk_bf16_f32 v50, v52, v53
    v_cvt_pk_bf16_f32 v51, v54, v55
    s_add_u32 s48, s45, 114688
    buffer_store_dwordx4 v[48:51], v6, s[24:27], s48 offen sc1
    v_mul_f32 v56, v56, v88
    v_mul_f32 v57, v57, v89
    v_mul_f32 v58, v58, v90
    v_mul_f32 v59, v59, v91
    v_mul_f32 v60, v60, v92
    v_mul_f32 v61, v61, v93
    v_mul_f32 v62, v62, v94
    v_mul_f32 v63, v63, v95
    v_mul_f32 v56, v56, v227
    v_mul_f32 v57, v57, v227
    v_mul_f32 v58, v58, v227
    v_mul_f32 v59, v59, v227
    v_mul_f32 v60, v60, v227
    v_mul_f32 v61, v61, v227
    v_mul_f32 v62, v62, v227
    v_mul_f32 v63, v63, v227
    v_cvt_pk_bf16_f32 v56, v56, v57
    v_cvt_pk_bf16_f32 v57, v58, v59
    v_cvt_pk_bf16_f32 v58, v60, v61
    v_cvt_pk_bf16_f32 v59, v62, v63
    s_add_u32 s48, s45, 172032
    buffer_store_dwordx4 v[56:59], v6, s[24:27], s48 offen sc1
T_D:
    v_and_b32 v13, 15, v0
    v_lshlrev_b32 v13, 2, v13
    buffer_load_dword v14, v13, s[24:27], s75 offen offset:1280 sc1
    s_waitcnt vmcnt(1) lgkmcnt(0)
    s_barrier
    s_lshl_b32 s48, s15, 2
    s_add_u32 s48, s48, s68
    v_mov_b32 v15, s70
    buffer_store_dword v15, v1, s[24:27], s48 offen offset:1536 sc1
    s_waitcnt vmcnt(1)
    v_cmp_ne_u32 vcc, s70, v14
    s_nop 0
    s_cbranch_vccnz T_SPD
T_SPDR:
    s_add_u32 s37, s56, 0
    buffer_load_dwordx4 v[96:99], v6, s[24:27], s37 offen offset:0 sc1
    s_add_u32 s38, s56, 57344
    buffer_load_dwordx4 v[100:103], v6, s[24:27], s38 offen offset:0 sc1
    buffer_load_dwordx4 v[104:107], v6, s[24:27], s37 offen offset:1024 sc1
    buffer_load_dwordx4 v[108:111], v6, s[24:27], s38 offen offset:1024 sc1
    buffer_load_dwordx4 v[112:115], v6, s[24:27], s37 offen offset:2048 sc1
    buffer_load_dwordx4 v[116:119], v6, s[24:27], s38 offen offset:2048 sc1
    buffer_load_dwordx4 v[120:123], v6, s[24:27], s37 offen offset:3072 sc1
    buffer_load_dwordx4 v[124:127], v6, s[24:27], s38 offen offset:3072 sc1
    s_add_u32 s37, s56, 4096
    buffer_load_dwordx4 v[128:131], v6, s[24:27], s37 offen offset:0 sc1
    s_add_u32 s38, s56, 61440
    buffer_load_dwordx4 v[132:135], v6, s[24:27], s38 offen offset:0 sc1
    buffer_load_dwordx4 v[136:139], v6, s[24:27], s37 offen offset:1024 sc1
    buffer_load_dwordx4 v[140:143], v6, s[24:27], s38 offen offset:1024 sc1
    s_waitcnt vmcnt(8)
    v_mfma_f32_16x16x32_bf16 v[32:35], a[0:3], v[96:99], 0
    buffer_load_dwordx4 v[144:147], v6, s[24:27], s37 offen offset:2048 sc1
    v_mfma_f32_16x16x32_bf16 v[32:35], a[16:19], v[104:107], v[32:35]
    buffer_load_dwordx4 v[148:151], v6, s[24:27], s38 offen offset:2048 sc1
    v_mfma_f32_16x16x32_bf16 v[36:39], a[4:7], v[96:99], 0
    buffer_load_dwordx4 v[152:155], v6, s[24:27], s37 offen offset:3072 sc1
    v_mfma_f32_16x16x32_bf16 v[36:39], a[20:23], v[104:107], v[36:39]
    v_mfma_f32_16x16x32_bf16 v[40:43], a[8:11], v[96:99], 0
    buffer_load_dwordx4 v[156:159], v6, s[24:27], s38 offen offset:3072 sc1
    v_mfma_f32_16x16x32_bf16 v[40:43], a[24:27], v[104:107], v[40:43]
    v_mfma_f32_16x16x32_bf16 v[44:47], a[12:15], v[96:99], 0
    s_add_u32 s37, s56, 8192
    buffer_load_dwordx4 v[160:163], v6, s[24:27], s37 offen offset:0 sc1
    v_mfma_f32_16x16x32_bf16 v[44:47], a[28:31], v[104:107], v[44:47]
    v_mfma_f32_16x16x32_bf16 v[48:51], a[0:3], v[100:103], 0
    s_add_u32 s38, s56, 65536
    v_mfma_f32_16x16x32_bf16 v[48:51], a[16:19], v[108:111], v[48:51]
    buffer_load_dwordx4 v[164:167], v6, s[24:27], s38 offen offset:0 sc1
    v_mfma_f32_16x16x32_bf16 v[52:55], a[4:7], v[100:103], 0
    v_mfma_f32_16x16x32_bf16 v[52:55], a[20:23], v[108:111], v[52:55]
    v_mfma_f32_16x16x32_bf16 v[56:59], a[8:11], v[100:103], 0
    v_mfma_f32_16x16x32_bf16 v[56:59], a[24:27], v[108:111], v[56:59]
    v_mfma_f32_16x16x32_bf16 v[60:63], a[12:15], v[100:103], 0
    v_mfma_f32_16x16x32_bf16 v[60:63], a[28:31], v[108:111], v[60:63]
    s_waitcnt vmcnt(10)
    v_mfma_f32_16x16x32_bf16 v[32:35], a[32:35], v[112:115], v[32:35]
    buffer_load_dwordx4 v[168:171], v6, s[24:27], s37 offen offset:1024 sc1
    v_mfma_f32_16x16x32_bf16 v[32:35], a[48:51], v[120:123], v[32:35]
    buffer_load_dwordx4 v[172:175], v6, s[24:27], s38 offen offset:1024 sc1
    v_mfma_f32_16x16x32_bf16 v[36:39], a[36:39], v[112:115], v[36:39]
    buffer_load_dwordx4 v[176:179], v6, s[24:27], s37 offen offset:2048 sc1
    v_mfma_f32_16x16x32_bf16 v[36:39], a[52:55], v[120:123], v[36:39]
    v_mfma_f32_16x16x32_bf16 v[40:43], a[40:43], v[112:115], v[40:43]
    v_mfma_f32_16x16x32_bf16 v[40:43], a[56:59], v[120:123], v[40:43]
    buffer_load_dwordx4 v[180:183], v6, s[24:27], s38 offen offset:2048 sc1
    v_mfma_f32_16x16x32_bf16 v[44:47], a[44:47], v[112:115], v[44:47]
    v_mfma_f32_16x16x32_bf16 v[44:47], a[60:63], v[120:123], v[44:47]
    buffer_load_dwordx4 v[184:187], v6, s[24:27], s37 offen offset:3072 sc1
    v_mfma_f32_16x16x32_bf16 v[48:51], a[32:35], v[116:119], v[48:51]
    v_mfma_f32_16x16x32_bf16 v[48:51], a[48:51], v[124:127], v[48:51]
    buffer_load_dwordx4 v[188:191], v6, s[24:27], s38 offen offset:3072 sc1
    v_mfma_f32_16x16x32_bf16 v[52:55], a[36:39], v[116:119], v[52:55]
    v_mfma_f32_16x16x32_bf16 v[52:55], a[52:55], v[124:127], v[52:55]
    v_mfma_f32_16x16x32_bf16 v[56:59], a[40:43], v[116:119], v[56:59]
    v_mfma_f32_16x16x32_bf16 v[56:59], a[56:59], v[124:127], v[56:59]
    v_mfma_f32_16x16x32_bf16 v[60:63], a[44:47], v[116:119], v[60:63]
    v_mfma_f32_16x16x32_bf16 v[60:63], a[60:63], v[124:127], v[60:63]
    s_waitcnt vmcnt(12)
    v_mfma_f32_16x16x32_bf16 v[32:35], a[64:67], v[128:131], v[32:35]
    s_add_u32 s37, s56, 12288
    buffer_load_dwordx4 v[192:195], v6, s[24:27], s37 offen offset:0 sc1
    v_mfma_f32_16x16x32_bf16 v[32:35], a[80:83], v[136:139], v[32:35]
    v_mfma_f32_16x16x32_bf16 v[36:39], a[68:71], v[128:131], v[36:39]
    s_add_u32 s38, s56, 69632
    v_mfma_f32_16x16x32_bf16 v[36:39], a[84:87], v[136:139], v[36:39]
    buffer_load_dwordx4 v[196:199], v6, s[24:27], s38 offen offset:0 sc1
    v_mfma_f32_16x16x32_bf16 v[40:43], a[72:75], v[128:131], v[40:43]
    v_mfma_f32_16x16x32_bf16 v[40:43], a[88:91], v[136:139], v[40:43]
    buffer_load_dwordx4 v[200:203], v6, s[24:27], s37 offen offset:1024 sc1
    v_mfma_f32_16x16x32_bf16 v[44:47], a[76:79], v[128:131], v[44:47]
    v_mfma_f32_16x16x32_bf16 v[44:47], a[92:95], v[136:139], v[44:47]
    v_mfma_f32_16x16x32_bf16 v[48:51], a[64:67], v[132:135], v[48:51]
    buffer_load_dwordx4 v[204:207], v6, s[24:27], s38 offen offset:1024 sc1
    v_mfma_f32_16x16x32_bf16 v[48:51], a[80:83], v[140:143], v[48:51]
    v_mfma_f32_16x16x32_bf16 v[52:55], a[68:71], v[132:135], v[52:55]
    v_mfma_f32_16x16x32_bf16 v[52:55], a[84:87], v[140:143], v[52:55]
    v_mfma_f32_16x16x32_bf16 v[56:59], a[72:75], v[132:135], v[56:59]
    v_mfma_f32_16x16x32_bf16 v[56:59], a[88:91], v[140:143], v[56:59]
    v_mfma_f32_16x16x32_bf16 v[60:63], a[76:79], v[132:135], v[60:63]
    v_mfma_f32_16x16x32_bf16 v[60:63], a[92:95], v[140:143], v[60:63]
    s_waitcnt vmcnt(12)
    v_mfma_f32_16x16x32_bf16 v[32:35], a[96:99], v[144:147], v[32:35]
    v_and_b32 v13, 15, v0
    v_mfma_f32_16x16x32_bf16 v[32:35], a[112:115], v[152:155], v[32:35]
    v_mfma_f32_16x16x32_bf16 v[36:39], a[100:103], v[144:147], v[36:39]
    v_lshlrev_b32 v13, 2, v13
    v_mfma_f32_16x16x32_bf16 v[36:39], a[116:119], v[152:155], v[36:39]
    v_mfma_f32_16x16x32_bf16 v[40:43], a[104:107], v[144:147], v[40:43]
    v_mfma_f32_16x16x32_bf16 v[40:43], a[120:123], v[152:155], v[40:43]
    buffer_load_dword v14, v13, s[24:27], s75 offen offset:1536 sc1
    v_mfma_f32_16x16x32_bf16 v[44:47], a[108:111], v[144:147], v[44:47]
    v_mfma_f32_16x16x32_bf16 v[44:47], a[124:127], v[152:155], v[44:47]
    v_mfma_f32_16x16x32_bf16 v[48:51], a[96:99], v[148:151], v[48:51]
    v_mfma_f32_16x16x32_bf16 v[48:51], a[112:115], v[156:159], v[48:51]
    v_mfma_f32_16x16x32_bf16 v[52:55], a[100:103], v[148:151], v[52:55]
    v_mfma_f32_16x16x32_bf16 v[52:55], a[116:119], v[156:159], v[52:55]
    v_mfma_f32_16x16x32_bf16 v[56:59], a[104:107], v[148:151], v[56:59]
    v_mfma_f32_16x16x32_bf16 v[56:59], a[120:123], v[156:159], v[56:59]
    v_mfma_f32_16x16x32_bf16 v[60:63], a[108:111], v[148:151], v[60:63]
    v_mfma_f32_16x16x32_bf16 v[60:63], a[124:127], v[156:159], v[60:63]
    s_waitcnt vmcnt(9)
    v_mfma_f32_16x16x32_bf16 v[32:35], a[128:131], v[160:163], v[32:35]
    v_mfma_f32_16x16x32_bf16 v[32:35], a[144:147], v[168:171], v[32:35]
    v_mfma_f32_16x16x32_bf16 v[36:39], a[132:135], v[160:163], v[36:39]
    v_mfma_f32_16x16x32_bf16 v[36:39], a[148:151], v[168:171], v[36:39]
    v_mfma_f32_16x16x32_bf16 v[40:43], a[136:139], v[160:163], v[40:43]
    v_mfma_f32_16x16x32_bf16 v[40:43], a[152:155], v[168:171], v[40:43]
    v_mfma_f32_16x16x32_bf16 v[44:47], a[140:143], v[160:163], v[44:47]
    v_mfma_f32_16x16x32_bf16 v[44:47], a[156:159], v[168:171], v[44:47]
    v_mfma_f32_16x16x32_bf16 v[48:51], a[128:131], v[164:167], v[48:51]
    v_mfma_f32_16x16x32_bf16 v[48:51], a[144:147], v[172:175], v[48:51]
    v_mfma_f32_16x16x32_bf16 v[52:55], a[132:135], v[164:167], v[52:55]
    v_mfma_f32_16x16x32_bf16 v[52:55], a[148:151], v[172:175], v[52:55]
    v_mfma_f32_16x16x32_bf16 v[56:59], a[136:139], v[164:167], v[56:59]
    v_mfma_f32_16x16x32_bf16 v[56:59], a[152:155], v[172:175], v[56:59]
    v_mfma_f32_16x16x32_bf16 v[60:63], a[140:143], v[164:167], v[60:63]
    v_mfma_f32_16x16x32_bf16 v[60:63], a[156:159], v[172:175], v[60:63]
    s_waitcnt vmcnt(0)
    v_cmp_ne_u32 vcc, s70, v14
    s_nop 0
    s_cbranch_vccnz T_DS
    v_mfma_f32_16x16x32_bf16 v[32:35], a[160:163], v[176:179], v[32:35]
    s_add_u32 s37, s57, 0
    buffer_load_dwordx4 v[208:211], v6, s[24:27], s37 offen offset:0 sc1
    s_add_u32 s38, s57, 57344
    v_mfma_f32_16x16x32_bf16 v[32:35], a[176:179], v[184:187], v[32:35]
    buffer_load_dwordx4 v[212:215], v6, s[24:27], s38 offen offset:0 sc1
    v_mfma_f32_16x16x32_bf16 v[36:39], a[164:167], v[176:179], v[36:39]
    buffer_load_dwordx4 v[216:219], v6, s[24:27], s37 offen offset:1024 sc1
    v_mfma_f32_16x16x32_bf16 v[36:39], a[180:183], v[184:187], v[36:39]
    buffer_load_dwordx4 v[220:223], v6, s[24:27], s38 offen offset:1024 sc1
    v_mfma_f32_16x16x32_bf16 v[40:43], a[168:171], v[176:179], v[40:43]
    buffer_load_dwordx4 v[224:227], v6, s[24:27], s37 offen offset:2048 sc1
    v_mfma_f32_16x16x32_bf16 v[40:43], a[184:187], v[184:187], v[40:43]
    buffer_load_dwordx4 v[228:231], v6, s[24:27], s38 offen offset:2048 sc1
    v_mfma_f32_16x16x32_bf16 v[44:47], a[172:175], v[176:179], v[44:47]
    v_mfma_f32_16x16x32_bf16 v[44:47], a[188:191], v[184:187], v[44:47]
    buffer_load_dwordx4 v[232:235], v6, s[24:27], s37 offen offset:3072 sc1
    v_mfma_f32_16x16x32_bf16 v[48:51], a[160:163], v[180:183], v[48:51]
    buffer_load_dwordx4 v[236:239], v6, s[24:27], s38 offen offset:3072 sc1
    v_mfma_f32_16x16x32_bf16 v[48:51], a[176:179], v[188:191], v[48:51]
    s_add_u32 s37, s57, 4096
    buffer_load_dwordx4 v[240:243], v6, s[24:27], s37 offen offset:0 sc1
    v_mfma_f32_16x16x32_bf16 v[52:55], a[164:167], v[180:183], v[52:55]
    v_mfma_f32_16x16x32_bf16 v[52:55], a[180:183], v[188:191], v[52:55]
    s_add_u32 s38, s57, 61440
    buffer_load_dwordx4 v[244:247], v6, s[24:27], s38 offen offset:0 sc1
    v_mfma_f32_16x16x32_bf16 v[56:59], a[168:171], v[180:183], v[56:59]
    buffer_load_dwordx4 v[248:251], v6, s[24:27], s37 offen offset:1024 sc1
    v_mfma_f32_16x16x32_bf16 v[56:59], a[184:187], v[188:191], v[56:59]
    v_mfma_f32_16x16x32_bf16 v[60:63], a[172:175], v[180:183], v[60:63]
    buffer_load_dwordx4 v[252:255], v6, s[24:27], s38 offen offset:1024 sc1
    v_mfma_f32_16x16x32_bf16 v[60:63], a[188:191], v[188:191], v[60:63]
    v_mfma_f32_16x16x32_bf16 v[32:35], a[192:195], v[192:195], v[32:35]
    v_mfma_f32_16x16x32_bf16 v[32:35], a[208:211], v[200:203], v[32:35]
    v_mfma_f32_16x16x32_bf16 v[36:39], a[196:199], v[192:195], v[36:39]
    v_mfma_f32_16x16x32_bf16 v[36:39], a[212:215], v[200:203], v[36:39]
    v_mfma_f32_16x16x32_bf16 v[40:43], a[200:203], v[192:195], v[40:43]
    v_mfma_f32_16x16x32_bf16 v[40:43], a[216:219], v[200:203], v[40:43]
    v_mfma_f32_16x16x32_bf16 v[44:47], a[204:207], v[192:195], v[44:47]
    v_mfma_f32_16x16x32_bf16 v[44:47], a[220:223], v[200:203], v[44:47]
    v_mfma_f32_16x16x32_bf16 v[48:51], a[192:195], v[196:199], v[48:51]
    v_mfma_f32_16x16x32_bf16 v[48:51], a[208:211], v[204:207], v[48:51]
    v_mfma_f32_16x16x32_bf16 v[52:55], a[196:199], v[196:199], v[52:55]
    v_mfma_f32_16x16x32_bf16 v[52:55], a[212:215], v[204:207], v[52:55]
    v_mfma_f32_16x16x32_bf16 v[56:59], a[200:203], v[196:199], v[56:59]
    v_mfma_f32_16x16x32_bf16 v[56:59], a[216:219], v[204:207], v[56:59]
    v_mfma_f32_16x16x32_bf16 v[60:63], a[204:207], v[196:199], v[60:63]
    v_mfma_f32_16x16x32_bf16 v[60:63], a[220:223], v[204:207], v[60:63]
T_DB:
    s_waitcnt vmcnt(8)
    v_mfma_f32_16x16x32_bf16 v[64:67], a[0:3], v[208:211], 0
    buffer_load_dwordx4 v[96:99], v6, s[24:27], s37 offen offset:2048 sc1
    buffer_load_dwordx4 v[100:103], v6, s[24:27], s38 offen offset:2048 sc1
    v_mfma_f32_16x16x32_bf16 v[64:67], a[16:19], v[216:219], v[64:67]
    ds_write_b128 v5, v[32:35] offset:16384
    v_mfma_f32_16x16x32_bf16 v[68:71], a[4:7], v[208:211], 0
    ds_write_b128 v5, v[36:39] offset:17408
    v_mfma_f32_16x16x32_bf16 v[68:71], a[20:23], v[216:219], v[68:71]
    ds_write_b128 v5, v[40:43] offset:18432
    v_mfma_f32_16x16x32_bf16 v[72:75], a[8:11], v[208:211], 0
    buffer_load_dwordx4 v[104:107], v6, s[24:27], s37 offen offset:3072 sc1
    v_mfma_f32_16x16x32_bf16 v[72:75], a[24:27], v[216:219], v[72:75]
    ds_write_b128 v5, v[44:47] offset:19456
    v_mfma_f32_16x16x32_bf16 v[76:79], a[12:15], v[208:211], 0
    buffer_load_dwordx4 v[108:111], v6, s[24:27], s38 offen offset:3072 sc1
    v_mfma_f32_16x16x32_bf16 v[76:79], a[28:31], v[216:219], v[76:79]
    ds_write_b128 v5, v[48:51] offset:20480
    v_mfma_f32_16x16x32_bf16 v[80:83], a[0:3], v[212:215], 0
    ds_write_b128 v5, v[52:55] offset:21504
    v_mfma_f32_16x16x32_bf16 v[80:83], a[16:19], v[220:223], v[80:83]
    v_mfma_f32_16x16x32_bf16 v[84:87], a[4:7], v[212:215], 0
    ds_write_b128 v5, v[56:59] offset:22528
    v_mfma_f32_16x16x32_bf16 v[84:87], a[20:23], v[220:223], v[84:87]
    v_mfma_f32_16x16x32_bf16 v[88:91], a[8:11], v[212:215], 0
    ds_write_b128 v5, v[60:63] offset:23552
    v_mfma_f32_16x16x32_bf16 v[88:91], a[24:27], v[220:223], v[88:91]
    v_mfma_f32_16x16x32_bf16 v[92:95], a[12:15], v[212:215], 0
    v_mfma_f32_16x16x32_bf16 v[92:95], a[28:31], v[220:223], v[92:95]
    s_waitcnt vmcnt(8)
    v_mfma_f32_16x16x32_bf16 v[64:67], a[32:35], v[224:227], v[64:67]
    s_add_u32 s37, s57, 8192
    buffer_load_dwordx4 v[112:115], v6, s[24:27], s37 offen offset:0 sc1
    v_lshlrev_b32 v16, 16, v24
    v_mfma_f32_16x16x32_bf16 v[64:67], a[48:51], v[232:235], v[64:67]
    s_add_u32 s38, s57, 65536
    buffer_load_dwordx4 v[116:119], v6, s[24:27], s38 offen offset:0 sc1
    v_and_b32 v17, 0xffff0000, v24
    v_mfma_f32_16x16x32_bf16 v[68:71], a[36:39], v[224:227], v[68:71]
    v_lshlrev_b32 v18, 16, v25
    v_mfma_f32_16x16x32_bf16 v[68:71], a[52:55], v[232:235], v[68:71]
    buffer_load_dwordx4 v[120:123], v6, s[24:27], s37 offen offset:1024 sc1
    v_mfma_f32_16x16x32_bf16 v[72:75], a[40:43], v[224:227], v[72:75]
    v_and_b32 v19, 0xffff0000, v25
    v_mfma_f32_16x16x32_bf16 v[72:75], a[56:59], v[232:235], v[72:75]
    buffer_load_dwordx4 v[124:127], v6, s[24:27], s38 offen offset:1024 sc1
    v_mfma_f32_16x16x32_bf16 v[76:79], a[44:47], v[224:227], v[76:79]
    v_lshlrev_b32 v20, 16, v26
    v_mfma_f32_16x16x32_bf16 v[76:79], a[60:63], v[232:235], v[76:79]
    v_mfma_f32_16x16x32_bf16 v[80:83], a[32:35], v[228:231], v[80:83]
    v_and_b32 v21, 0xffff0000, v26
    v_mfma_f32_16x16x32_bf16 v[80:83], a[48:51], v[236:239], v[80:83]
    v_mfma_f32_16x16x32_bf16 v[84:87], a[36:39], v[228:231], v[84:87]
    v_lshlrev_b32 v22, 16, v27
    v_mfma_f32_16x16x32_bf16 v[84:87], a[52:55], v[236:239], v[84:87]
    v_mfma_f32_16x16x32_bf16 v[88:91], a[40:43], v[228:231], v[88:91]
    v_and_b32 v23, 0xffff0000, v27
    v_mfma_f32_16x16x32_bf16 v[88:91], a[56:59], v[236:239], v[88:91]
    v_mfma_f32_16x16x32_bf16 v[92:95], a[44:47], v[228:231], v[92:95]
    v_mfma_f32_16x16x32_bf16 v[92:95], a[60:63], v[236:239], v[92:95]
    s_waitcnt vmcnt(8)
    v_mfma_f32_16x16x32_bf16 v[64:67], a[64:67], v[240:243], v[64:67]
    buffer_load_dwordx4 v[128:131], v6, s[24:27], s37 offen offset:2048 sc1
    s_waitcnt lgkmcnt(0)
    s_barrier
    v_mfma_f32_16x16x32_bf16 v[64:67], a[80:83], v[248:251], v[64:67]
    buffer_load_dwordx4 v[132:135], v6, s[24:27], s38 offen offset:2048 sc1
    ds_read_b128 v[32:35], v7 offset:16384
    v_mfma_f32_16x16x32_bf16 v[68:71], a[68:71], v[240:243], v[68:71]
    ds_read_b128 v[36:39], v7 offset:17408
    v_mfma_f32_16x16x32_bf16 v[68:71], a[84:87], v[248:251], v[68:71]
    buffer_load_dwordx4 v[136:139], v6, s[24:27], s37 offen offset:3072 sc1
    ds_read_b128 v[40:43], v7 offset:49152
    v_mfma_f32_16x16x32_bf16 v[72:75], a[72:75], v[240:243], v[72:75]
    v_mfma_f32_16x16x32_bf16 v[72:75], a[88:91], v[248:251], v[72:75]
    buffer_load_dwordx4 v[140:143], v6, s[24:27], s38 offen offset:3072 sc1
    ds_read_b128 v[44:47], v7 offset:50176
    v_mfma_f32_16x16x32_bf16 v[76:79], a[76:79], v[240:243], v[76:79]
    v_mfma_f32_16x16x32_bf16 v[76:79], a[92:95], v[248:251], v[76:79]
    ds_read_b128 v[48:51], v2 offset:16384
    v_mfma_f32_16x16x32_bf16 v[80:83], a[64:67], v[244:247], v[80:83]
    v_mfma_f32_16x16x32_bf16 v[80:83], a[80:83], v[252:255], v[80:83]
    ds_read_b128 v[52:55], v2 offset:17408
    v_mfma_f32_16x16x32_bf16 v[84:87], a[68:71], v[244:247], v[84:87]
    ds_read_b128 v[56:59], v2 offset:49152
    v_mfma_f32_16x16x32_bf16 v[84:87], a[84:87], v[252:255], v[84:87]
    v_mfma_f32_16x16x32_bf16 v[88:91], a[72:75], v[244:247], v[88:91]
    ds_read_b128 v[60:63], v2 offset:50176
    v_mfma_f32_16x16x32_bf16 v[88:91], a[88:91], v[252:255], v[88:91]
    v_mfma_f32_16x16x32_bf16 v[92:95], a[76:79], v[244:247], v[92:95]
    v_mfma_f32_16x16x32_bf16 v[92:95], a[92:95], v[252:255], v[92:95]
    s_waitcnt vmcnt(8)
    v_mfma_f32_16x16x32_bf16 v[64:67], a[96:99], v[96:99], v[64:67]
    s_add_u32 s37, s57, 12288
    buffer_load_dwordx4 v[144:147], v6, s[24:27], s37 offen offset:0 sc1
    s_waitcnt lgkmcnt(0)
    v_pk_add_f32 v[32:33], v[32:33], v[40:41]
    v_mfma_f32_16x16x32_bf16 v[64:67], a[112:115], v[104:107], v[64:67]
    s_add_u32 s38, s57, 69632
    v_pk_add_f32 v[34:35], v[34:35], v[42:43]
    v_pk_add_f32 v[36:37], v[36:37], v[44:45]
    v_pk_add_f32 v[38:39], v[38:39], v[46:47]
    v_mfma_f32_16x16x32_bf16 v[68:71], a[100:103], v[96:99], v[68:71]
    buffer_load_dwordx4 v[148:151], v6, s[24:27], s38 offen offset:0 sc1
    v_pk_add_f32 v[48:49], v[48:49], v[56:57]
    v_mfma_f32_16x16x32_bf16 v[68:71], a[116:119], v[104:107], v[68:71]
    buffer_load_dwordx4 v[152:155], v6, s[24:27], s37 offen offset:1024 sc1
    v_pk_add_f32 v[50:51], v[50:51], v[58:59]
    v_mfma_f32_16x16x32_bf16 v[72:75], a[104:107], v[96:99], v[72:75]
    v_pk_add_f32 v[52:53], v[52:53], v[60:61]
    v_mfma_f32_16x16x32_bf16 v[72:75], a[120:123], v[104:107], v[72:75]
    buffer_load_dwordx4 v[156:159], v6, s[24:27], s38 offen offset:1024 sc1
    v_pk_add_f32 v[54:55], v[54:55], v[62:63]
    v_mfma_f32_16x16x32_bf16 v[76:79], a[108:111], v[96:99], v[76:79]
    v_pk_add_f32 v[32:33], v[32:33], v[48:49]
    v_mfma_f32_16x16x32_bf16 v[76:79], a[124:127], v[104:107], v[76:79]
    v_pk_add_f32 v[34:35], v[34:35], v[50:51]
    v_mfma_f32_16x16x32_bf16 v[80:83], a[96:99], v[100:103], v[80:83]
    v_pk_add_f32 v[36:37], v[36:37], v[52:53]
    v_mfma_f32_16x16x32_bf16 v[80:83], a[112:115], v[108:111], v[80:83]
    v_pk_add_f32 v[38:39], v[38:39], v[54:55]
    v_mfma_f32_16x16x32_bf16 v[84:87], a[100:103], v[100:103], v[84:87]
    v_cvt_pk_bf16_f32 v40, v32, v33
    v_mfma_f32_16x16x32_bf16 v[84:87], a[116:119], v[108:111], v[84:87]
    v_cvt_pk_bf16_f32 v41, v34, v35
    v_mfma_f32_16x16x32_bf16 v[88:91], a[104:107], v[100:103], v[88:91]
    v_cvt_pk_bf16_f32 v42, v36, v37
    v_mfma_f32_16x16x32_bf16 v[88:91], a[120:123], v[108:111], v[88:91]
    v_cvt_pk_bf16_f32 v43, v38, v39
    v_mfma_f32_16x16x32_bf16 v[92:95], a[108:111], v[100:103], v[92:95]
    v_mfma_f32_16x16x32_bf16 v[92:95], a[124:127], v[108:111], v[92:95]
    s_waitcnt vmcnt(8)
    v_mfma_f32_16x16x32_bf16 v[64:67], a[128:131], v[112:115], v[64:67]
    v_lshlrev_b32 v32, 16, v40
    v_and_b32 v33, 0xffff0000, v40
    v_lshlrev_b32 v34, 16, v41
    v_mfma_f32_16x16x32_bf16 v[64:67], a[144:147], v[120:123], v[64:67]
    v_and_b32 v35, 0xffff0000, v41
    v_lshlrev_b32 v36, 16, v42
    v_mfma_f32_16x16x32_bf16 v[68:71], a[132:135], v[112:115], v[68:71]
    v_and_b32 v37, 0xffff0000, v42
    v_mfma_f32_16x16x32_bf16 v[68:71], a[148:151], v[120:123], v[68:71]
    v_lshlrev_b32 v38, 16, v43
    v_mfma_f32_16x16x32_bf16 v[72:75], a[136:139], v[112:115], v[72:75]
    v_and_b32 v39, 0xffff0000, v43
    v_mfma_f32_16x16x32_bf16 v[72:75], a[152:155], v[120:123], v[72:75]
    v_pk_add_f32 v[32:33], v[32:33], v[16:17]
    v_pk_add_f32 v[34:35], v[34:35], v[18:19]
    v_mfma_f32_16x16x32_bf16 v[76:79], a[140:143], v[112:115], v[76:79]
    v_pk_add_f32 v[36:37], v[36:37], v[20:21]
    v_mfma_f32_16x16x32_bf16 v[76:79], a[156:159], v[120:123], v[76:79]
    v_pk_add_f32 v[38:39], v[38:39], v[22:23]
    v_mfma_f32_16x16x32_bf16 v[80:83], a[128:131], v[116:119], v[80:83]
    v_cvt_pk_bf16_f32 v44, v32, v33
    v_mfma_f32_16x16x32_bf16 v[80:83], a[144:147], v[124:127], v[80:83]
    v_cvt_pk_bf16_f32 v45, v34, v35
    v_cvt_pk_bf16_f32 v46, v36, v37
    v_mfma_f32_16x16x32_bf16 v[84:87], a[132:135], v[116:119], v[84:87]
    v_cvt_pk_bf16_f32 v47, v38, v39
    v_mfma_f32_16x16x32_bf16 v[84:87], a[148:151], v[124:127], v[84:87]
    v_permlane16_swap_b32 v44, v46
    v_mfma_f32_16x16x32_bf16 v[88:91], a[136:139], v[116:119], v[88:91]
    v_permlane16_swap_b32 v45, v47
    v_mfma_f32_16x16x32_bf16 v[88:91], a[152:155], v[124:127], v[88:91]
    buffer_store_dwordx4 v[44:47], v3, s[28:31], s50 offen
    v_mfma_f32_16x16x32_bf16 v[92:95], a[140:143], v[116:119], v[92:95]
    v_mfma_f32_16x16x32_bf16 v[92:95], a[156:159], v[124:127], v[92:95]
    s_waitcnt vmcnt(5)
    v_mfma_f32_16x16x32_bf16 v[64:67], a[160:163], v[128:131], v[64:67]
    v_lshlrev_b32 v16, 16, v28
    v_and_b32 v17, 0xffff0000, v28
    v_mfma_f32_16x16x32_bf16 v[64:67], a[176:179], v[136:139], v[64:67]
    v_mfma_f32_16x16x32_bf16 v[68:71], a[164:167], v[128:131], v[68:71]
    v_lshlrev_b32 v18, 16, v29
    v_mfma_f32_16x16x32_bf16 v[68:71], a[180:183], v[136:139], v[68:71]
    v_mfma_f32_16x16x32_bf16 v[72:75], a[168:171], v[128:131], v[72:75]
    v_and_b32 v19, 0xffff0000, v29
    v_mfma_f32_16x16x32_bf16 v[72:75], a[184:187], v[136:139], v[72:75]
    v_mfma_f32_16x16x32_bf16 v[76:79], a[172:175], v[128:131], v[76:79]
    v_lshlrev_b32 v20, 16, v30
    v_mfma_f32_16x16x32_bf16 v[76:79], a[188:191], v[136:139], v[76:79]
    v_mfma_f32_16x16x32_bf16 v[80:83], a[160:163], v[132:135], v[80:83]
    v_and_b32 v21, 0xffff0000, v30
    v_mfma_f32_16x16x32_bf16 v[80:83], a[176:179], v[140:143], v[80:83]
    v_mfma_f32_16x16x32_bf16 v[84:87], a[164:167], v[132:135], v[84:87]
    v_lshlrev_b32 v22, 16, v31
    v_mfma_f32_16x16x32_bf16 v[84:87], a[180:183], v[140:143], v[84:87]
    v_mfma_f32_16x16x32_bf16 v[88:91], a[168:171], v[132:135], v[88:91]
    v_and_b32 v23, 0xffff0000, v31
    v_mfma_f32_16x16x32_bf16 v[88:91], a[184:187], v[140:143], v[88:91]
    v_mfma_f32_16x16x32_bf16 v[92:95], a[172:175], v[132:135], v[92:95]
    v_mfma_f32_16x16x32_bf16 v[92:95], a[188:191], v[140:143], v[92:95]
    s_waitcnt vmcnt(1)
    v_mfma_f32_16x16x32_bf16 v[64:67], a[192:195], v[144:147], v[64:67]
    v_mfma_f32_16x16x32_bf16 v[64:67], a[208:211], v[152:155], v[64:67]
    v_mfma_f32_16x16x32_bf16 v[68:71], a[196:199], v[144:147], v[68:71]
    v_mfma_f32_16x16x32_bf16 v[68:71], a[212:215], v[152:155], v[68:71]
    v_mfma_f32_16x16x32_bf16 v[72:75], a[200:203], v[144:147], v[72:75]
    v_mfma_f32_16x16x32_bf16 v[72:75], a[216:219], v[152:155], v[72:75]
    v_mfma_f32_16x16x32_bf16 v[76:79], a[204:207], v[144:147], v[76:79]
    v_mfma_f32_16x16x32_bf16 v[76:79], a[220:223], v[152:155], v[76:79]
    v_mfma_f32_16x16x32_bf16 v[80:83], a[192:195], v[148:151], v[80:83]
    v_mfma_f32_16x16x32_bf16 v[80:83], a[208:211], v[156:159], v[80:83]
    v_mfma_f32_16x16x32_bf16 v[84:87], a[196:199], v[148:151], v[84:87]
    v_mfma_f32_16x16x32_bf16 v[84:87], a[212:215], v[156:159], v[84:87]
    v_mfma_f32_16x16x32_bf16 v[88:91], a[200:203], v[148:151], v[88:91]
    v_mfma_f32_16x16x32_bf16 v[88:91], a[216:219], v[156:159], v[88:91]
    v_mfma_f32_16x16x32_bf16 v[92:95], a[204:207], v[148:151], v[92:95]
    v_mfma_f32_16x16x32_bf16 v[92:95], a[220:223], v[156:159], v[92:95]
    ds_write_b128 v5, v[64:67] offset:24576
    ds_write_b128 v5, v[68:71] offset:25600
    ds_write_b128 v5, v[72:75] offset:26624
    ds_write_b128 v5, v[76:79] offset:27648
    ds_write_b128 v5, v[80:83] offset:28672
    ds_write_b128 v5, v[84:87] offset:29696
    ds_write_b128 v5, v[88:91] offset:30720
    s_nop 0
    ds_write_b128 v5, v[92:95] offset:31744
    s_waitcnt lgkmcnt(0)
    s_barrier
    ds_read_b128 v[64:67], v7 offset:24576
    ds_read_b128 v[68:71], v7 offset:25600
    ds_read_b128 v[72:75], v7 offset:57344
    ds_read_b128 v[76:79], v7 offset:58368
    ds_read_b128 v[80:83], v2 offset:24576
    ds_read_b128 v[84:87], v2 offset:25600
    ds_read_b128 v[88:91], v2 offset:57344
    ds_read_b128 v[92:95], v2 offset:58368
    s_waitcnt lgkmcnt(0)
    v_pk_add_f32 v[64:65], v[64:65], v[72:73]
    v_pk_add_f32 v[66:67], v[66:67], v[74:75]
    v_pk_add_f32 v[68:69], v[68:69], v[76:77]
    v_pk_add_f32 v[70:71], v[70:71], v[78:79]
    v_pk_add_f32 v[80:81], v[80:81], v[88:89]
    v_pk_add_f32 v[82:83], v[82:83], v[90:91]
    v_pk_add_f32 v[84:85], v[84:85], v[92:93]
    v_pk_add_f32 v[86:87], v[86:87], v[94:95]
    v_pk_add_f32 v[64:65], v[64:65], v[80:81]
    v_pk_add_f32 v[66:67], v[66:67], v[82:83]
    v_pk_add_f32 v[68:69], v[68:69], v[84:85]
    v_pk_add_f32 v[70:71], v[70:71], v[86:87]
    v_cvt_pk_bf16_f32 v72, v64, v65
    v_cvt_pk_bf16_f32 v73, v66, v67
    v_cvt_pk_bf16_f32 v74, v68, v69
    v_cvt_pk_bf16_f32 v75, v70, v71
    v_lshlrev_b32 v64, 16, v72
    v_and_b32 v65, 0xffff0000, v72
    v_lshlrev_b32 v66, 16, v73
    v_and_b32 v67, 0xffff0000, v73
    v_lshlrev_b32 v68, 16, v74
    v_and_b32 v69, 0xffff0000, v74
    v_lshlrev_b32 v70, 16, v75
    v_and_b32 v71, 0xffff0000, v75
    v_pk_add_f32 v[64:65], v[64:65], v[16:17]
    v_pk_add_f32 v[66:67], v[66:67], v[18:19]
    v_pk_add_f32 v[68:69], v[68:69], v[20:21]
    v_pk_add_f32 v[70:71], v[70:71], v[22:23]
    v_cvt_pk_bf16_f32 v76, v64, v65
    v_cvt_pk_bf16_f32 v77, v66, v67
    v_cvt_pk_bf16_f32 v78, v68, v69
    v_cvt_pk_bf16_f32 v79, v70, v71
    s_nop 0
    v_permlane16_swap_b32 v76, v78
    v_permlane16_swap_b32 v77, v79
    buffer_store_dwordx4 v[76:79], v3, s[28:31], s13 offen
    s_endpgm
T_SPA:
    s_mov_b32 s43, 0x40000
T_SPAL:
    buffer_load_dword v14, v13, s[24:27], s68 offen offset:512 sc1
    s_waitcnt vmcnt(0)
    v_cmp_ne_u32 vcc, s70, v14
    s_nop 1
    s_cbranch_vccz T_SPAR
    s_sleep 1
    s_sub_u32 s43, s43, 1
    s_cmp_lg_u32 s43, 0
    s_cbranch_scc1 T_SPAL
    s_branch T_SPAR
KB_SPX:
    s_mov_b32 s43, 0x40000
KB_SPXL:
    buffer_load_dword v14, v13, s[24:27], s68 offen offset:256 sc1
    s_waitcnt vmcnt(0)
    v_cmp_ne_u32 vcc, s70, v14
    s_nop 1
    s_cbranch_vccz KB_SPXR
    s_sleep 1
    s_sub_u32 s43, s43, 1
    s_cmp_lg_u32 s43, 0
    s_cbranch_scc1 KB_SPXL
    s_branch KB_SPXR
KB_SPK:
    s_mov_b32 s43, 0x40000
KB_SPKL:
    buffer_load_dword v14, v13, s[24:27], s69 offen offset:256 sc1
    s_waitcnt vmcnt(0)
    v_cmp_ne_u32 vcc, s71, v14
    s_nop 1
    s_cbranch_vccz KB_SPKR
    s_sleep 1
    s_sub_u32 s43, s43, 1
    s_cmp_lg_u32 s43, 0
    s_cbranch_scc1 KB_SPKL
    s_branch KB_SPKR
KB_SPV:
    s_mov_b32 s43, 0x40000
KB_SPVL:
    buffer_load_dword v14, v13, s[24:27], s69 offen offset:512 sc1
    s_waitcnt vmcnt(0)
    v_cmp_ne_u32 vcc, s71, v14
    s_nop 1
    s_cbranch_vccz KB_SPVR
    s_sleep 1
    s_sub_u32 s43, s43, 1
    s_cmp_lg_u32 s43, 0
    s_cbranch_scc1 KB_SPVL
    s_branch KB_SPVR
T_SPB:
    s_mov_b32 s43, 0x40000
T_SPBL:
    buffer_load_dword v14, v13, s[24:27], s68 offen offset:768 sc1
    s_waitcnt vmcnt(0)
    v_cmp_ne_u32 vcc, s70, v14
    s_nop 1
    s_cbranch_vccz T_SPBR
    s_sleep 1
    s_sub_u32 s43, s43, 1
    s_cmp_lg_u32 s43, 0
    s_cbranch_scc1 T_SPBL
    s_branch T_SPBR
T_SPH:
    s_mov_b32 s43, 0x40000
T_SPHL:
    buffer_load_dword v14, v13, s[24:27], s75 offen offset:1024 sc1
    s_waitcnt vmcnt(0)
    v_cmp_ne_u32 vcc, s70, v14
    s_nop 1
    s_cbranch_vccz T_SPHR
    s_sleep 1
    s_sub_u32 s43, s43, 1
    s_cmp_lg_u32 s43, 0
    s_cbranch_scc1 T_SPHL
    s_branch T_SPHR
T_SPD:
    s_mov_b32 s43, 0x40000
T_SPDL:
    buffer_load_dword v14, v13, s[24:27], s75 offen offset:1280 sc1
    s_waitcnt vmcnt(0)
    v_cmp_ne_u32 vcc, s70, v14
    s_nop 1
    s_cbranch_vccz T_SPDR
    s_sleep 1
    s_sub_u32 s43, s43, 1
    s_cmp_lg_u32 s43, 0
    s_cbranch_scc1 T_SPDL
    s_branch T_SPDR
T_IDLE:
    s_waitcnt vmcnt(0)
    s_barrier
    s_lshl_b32 s48, s15, 2
    s_add_u32 s48, s48, s68
    v_mov_b32 v15, s70
    buffer_store_dword v15, v1, s[24:27], s48 offen offset:1024 sc1
    s_lshl_b32 s48, s15, 2
    s_add_u32 s48, s48, s68
    v_mov_b32 v15, s70
    buffer_store_dword v15, v1, s[24:27], s48 offen offset:1280 sc1
    v_subrev_u32 v20, s58, v20
    v_add_u32 v8, s36, v20
    v_add_u32 v20, s42, v20
    v_subrev_u32 v21, s58, v21
    v_add_u32 v9, s36, v21
    v_add_u32 v21, s42, v21
    v_subrev_u32 v22, s58, v22
    v_add_u32 v10, s36, v22
    v_add_u32 v22, s42, v22
    v_subrev_u32 v23, s58, v23
    v_add_u32 v11, s36, v23
    v_add_u32 v23, s42, v23
    s_add_u32 m0, s36, 0
    s_add_u32 s49, s41, 0
    buffer_load_dwordx4 v16, s[20:23], s49 offen lds
    buffer_load_dwordx4 v17, s[20:23], s49 offen offset:1024 lds
    buffer_load_dwordx4 v18, s[20:23], s49 offen offset:2048 lds
    buffer_load_dwordx4 v19, s[20:23], s49 offen offset:3072 lds
    s_add_u32 m0, s36, 4096
    s_add_u32 s49, s41, 32768
    buffer_load_dwordx4 v16, s[20:23], s49 offen lds
    buffer_load_dwordx4 v17, s[20:23], s49 offen offset:1024 lds
    buffer_load_dwordx4 v18, s[20:23], s49 offen offset:2048 lds
    buffer_load_dwordx4 v19, s[20:23], s49 offen offset:3072 lds
    s_add_u32 m0, s42, 0
    s_add_u32 s49, s41, 65536
    buffer_load_dwordx4 v16, s[20:23], s49 offen lds
    buffer_load_dwordx4 v17, s[20:23], s49 offen offset:1024 lds
    buffer_load_dwordx4 v18, s[20:23], s49 offen offset:2048 lds
    buffer_load_dwordx4 v19, s[20:23], s49 offen offset:3072 lds
    s_add_u32 m0, s42, 4096
    s_add_u32 s49, s41, 98304
    buffer_load_dwordx4 v16, s[20:23], s49 offen lds
    buffer_load_dwordx4 v17, s[20:23], s49 offen offset:1024 lds
    buffer_load_dwordx4 v18, s[20:23], s49 offen offset:2048 lds
    buffer_load_dwordx4 v19, s[20:23], s49 offen offset:3072 lds
    s_add_u32 m0, s42, 8192
    s_add_u32 s49, s41, 131072
    buffer_load_dwordx4 v16, s[20:23], s49 offen lds
    buffer_load_dwordx4 v17, s[20:23], s49 offen offset:1024 lds
    buffer_load_dwordx4 v18, s[20:23], s49 offen offset:2048 lds
    buffer_load_dwordx4 v19, s[20:23], s49 offen offset:3072 lds
    s_add_u32 m0, s42, 12288
    s_add_u32 s49, s41, 163840
    buffer_load_dwordx4 v16, s[20:23], s49 offen lds
    buffer_load_dwordx4 v17, s[20:23], s49 offen offset:1024 lds
    buffer_load_dwordx4 v18, s[20:23], s49 offen offset:2048 lds
    buffer_load_dwordx4 v19, s[20:23], s49 offen offset:3072 lds
    s_waitcnt vmcnt(20)
    ds_read_b64_tr_b16 a[0:1], v8 offset:0
    ds_read_b64_tr_b16 a[2:3], v8 offset:2048
    ds_read_b64_tr_b16 a[4:5], v9 offset:0
    ds_read_b64_tr_b16 a[6:7], v9 offset:2048
    ds_read_b64_tr_b16 a[8:9], v10 offset:0
    ds_read_b64_tr_b16 a[10:11], v10 offset:2048
    ds_read_b64_tr_b16 a[12:13], v11 offset:0
    ds_read_b64_tr_b16 a[14:15], v11 offset:2048
    s_waitcnt lgkmcnt(0)
    s_add_u32 m0, s36, 0
    s_add_u32 s49, s41, 196608
    buffer_load_dwordx4 v16, s[20:23], s49 offen lds
    buffer_load_dwordx4 v17, s[20:23], s49 offen offset:1024 lds
    buffer_load_dwordx4 v18, s[20:23], s49 offen offset:2048 lds
    buffer_load_dwordx4 v19, s[20:23], s49 offen offset:3072 lds
    s_waitcnt vmcnt(20)
    ds_read_b64_tr_b16 a[16:17], v8 offset:4096
    ds_read_b64_tr_b16 a[18:19], v8 offset:6144
    ds_read_b64_tr_b16 a[20:21], v9 offset:4096
    ds_read_b64_tr_b16 a[22:23], v9 offset:6144
    ds_read_b64_tr_b16 a[24:25], v10 offset:4096
    ds_read_b64_tr_b16 a[26:27], v10 offset:6144
    ds_read_b64_tr_b16 a[28:29], v11 offset:4096
    ds_read_b64_tr_b16 a[30:31], v11 offset:6144
    s_waitcnt lgkmcnt(0)
    s_add_u32 m0, s36, 4096
    s_add_u32 s49, s41, 229376
    buffer_load_dwordx4 v16, s[20:23], s49 offen lds
    buffer_load_dwordx4 v17, s[20:23], s49 offen offset:1024 lds
    buffer_load_dwordx4 v18, s[20:23], s49 offen offset:2048 lds
    buffer_load_dwordx4 v19, s[20:23], s49 offen offset:3072 lds
    s_waitcnt vmcnt(20)
    ds_read_b64_tr_b16 a[32:33], v20 offset:0
    ds_read_b64_tr_b16 a[34:35], v20 offset:2048
    ds_read_b64_tr_b16 a[36:37], v21 offset:0
    ds_read_b64_tr_b16 a[38:39], v21 offset:2048
    ds_read_b64_tr_b16 a[40:41], v22 offset:0
    ds_read_b64_tr_b16 a[42:43], v22 offset:2048
    ds_read_b64_tr_b16 a[44:45], v23 offset:0
    ds_read_b64_tr_b16 a[46:47], v23 offset:2048
    s_waitcnt lgkmcnt(0)
    s_add_u32 m0, s42, 0
    s_add_u32 s49, s41, 262144
    buffer_load_dwordx4 v16, s[20:23], s49 offen lds
    buffer_load_dwordx4 v17, s[20:23], s49 offen offset:1024 lds
    buffer_load_dwordx4 v18, s[20:23], s49 offen offset:2048 lds
    buffer_load_dwordx4 v19, s[20:23], s49 offen offset:3072 lds
    s_waitcnt vmcnt(20)
    ds_read_b64_tr_b16 a[48:49], v20 offset:4096
    ds_read_b64_tr_b16 a[50:51], v20 offset:6144
    ds_read_b64_tr_b16 a[52:53], v21 offset:4096
    ds_read_b64_tr_b16 a[54:55], v21 offset:6144
    ds_read_b64_tr_b16 a[56:57], v22 offset:4096
    ds_read_b64_tr_b16 a[58:59], v22 offset:6144
    ds_read_b64_tr_b16 a[60:61], v23 offset:4096
    ds_read_b64_tr_b16 a[62:63], v23 offset:6144
    s_waitcnt lgkmcnt(0)
    s_add_u32 m0, s42, 4096
    s_add_u32 s49, s41, 294912
    buffer_load_dwordx4 v16, s[20:23], s49 offen lds
    buffer_load_dwordx4 v17, s[20:23], s49 offen offset:1024 lds
    buffer_load_dwordx4 v18, s[20:23], s49 offen offset:2048 lds
    buffer_load_dwordx4 v19, s[20:23], s49 offen offset:3072 lds
    s_waitcnt vmcnt(20)
    ds_read_b64_tr_b16 a[64:65], v20 offset:8192
    ds_read_b64_tr_b16 a[66:67], v20 offset:10240
    ds_read_b64_tr_b16 a[68:69], v21 offset:8192
    ds_read_b64_tr_b16 a[70:71], v21 offset:10240
    ds_read_b64_tr_b16 a[72:73], v22 offset:8192
    ds_read_b64_tr_b16 a[74:75], v22 offset:10240
    ds_read_b64_tr_b16 a[76:77], v23 offset:8192
    ds_read_b64_tr_b16 a[78:79], v23 offset:10240
    s_waitcnt lgkmcnt(0)
    s_add_u32 m0, s42, 8192
    s_add_u32 s49, s41, 327680
    buffer_load_dwordx4 v16, s[20:23], s49 offen lds
    buffer_load_dwordx4 v17, s[20:23], s49 offen offset:1024 lds
    buffer_load_dwordx4 v18, s[20:23], s49 offen offset:2048 lds
    buffer_load_dwordx4 v19, s[20:23], s49 offen offset:3072 lds
    s_waitcnt vmcnt(20)
    ds_read_b64_tr_b16 a[80:81], v20 offset:12288
    ds_read_b64_tr_b16 a[82:83], v20 offset:14336
    ds_read_b64_tr_b16 a[84:85], v21 offset:12288
    ds_read_b64_tr_b16 a[86:87], v21 offset:14336
    ds_read_b64_tr_b16 a[88:89], v22 offset:12288
    ds_read_b64_tr_b16 a[90:91], v22 offset:14336
    ds_read_b64_tr_b16 a[92:93], v23 offset:12288
    ds_read_b64_tr_b16 a[94:95], v23 offset:14336
    s_waitcnt lgkmcnt(0)
    s_add_u32 m0, s42, 12288
    s_add_u32 s49, s41, 360448
    buffer_load_dwordx4 v16, s[20:23], s49 offen lds
    buffer_load_dwordx4 v17, s[20:23], s49 offen offset:1024 lds
    buffer_load_dwordx4 v18, s[20:23], s49 offen offset:2048 lds
    buffer_load_dwordx4 v19, s[20:23], s49 offen offset:3072 lds
    s_waitcnt vmcnt(20)
    ds_read_b64_tr_b16 a[96:97], v8 offset:0
    ds_read_b64_tr_b16 a[98:99], v8 offset:2048
    ds_read_b64_tr_b16 a[100:101], v9 offset:0
    ds_read_b64_tr_b16 a[102:103], v9 offset:2048
    ds_read_b64_tr_b16 a[104:105], v10 offset:0
    ds_read_b64_tr_b16 a[106:107], v10 offset:2048
    ds_read_b64_tr_b16 a[108:109], v11 offset:0
    ds_read_b64_tr_b16 a[110:111], v11 offset:2048
    s_waitcnt lgkmcnt(0)
    s_add_u32 m0, s36, 0
    s_add_u32 s49, s41, 393216
    buffer_load_dwordx4 v16, s[20:23], s49 offen lds
    buffer_load_dwordx4 v17, s[20:23], s49 offen offset:1024 lds
    buffer_load_dwordx4 v18, s[20:23], s49 offen offset:2048 lds
    buffer_load_dwordx4 v19, s[20:23], s49 offen offset:3072 lds
    s_waitcnt vmcnt(20)
    ds_read_b64_tr_b16 a[112:113], v8 offset:4096
    ds_read_b64_tr_b16 a[114:115], v8 offset:6144
    ds_read_b64_tr_b16 a[116:117], v9 offset:4096
    ds_read_b64_tr_b16 a[118:119], v9 offset:6144
    ds_read_b64_tr_b16 a[120:121], v10 offset:4096
    ds_read_b64_tr_b16 a[122:123], v10 offset:6144
    ds_read_b64_tr_b16 a[124:125], v11 offset:4096
    ds_read_b64_tr_b16 a[126:127], v11 offset:6144
    s_waitcnt lgkmcnt(0)
    s_add_u32 m0, s36, 4096
    s_add_u32 s49, s41, 425984
    buffer_load_dwordx4 v16, s[20:23], s49 offen lds
    buffer_load_dwordx4 v17, s[20:23], s49 offen offset:1024 lds
    buffer_load_dwordx4 v18, s[20:23], s49 offen offset:2048 lds
    buffer_load_dwordx4 v19, s[20:23], s49 offen offset:3072 lds
    s_waitcnt vmcnt(20)
    ds_read_b64_tr_b16 a[128:129], v20 offset:0
    ds_read_b64_tr_b16 a[130:131], v20 offset:2048
    ds_read_b64_tr_b16 a[132:133], v21 offset:0
    ds_read_b64_tr_b16 a[134:135], v21 offset:2048
    ds_read_b64_tr_b16 a[136:137], v22 offset:0
    ds_read_b64_tr_b16 a[138:139], v22 offset:2048
    ds_read_b64_tr_b16 a[140:141], v23 offset:0
    ds_read_b64_tr_b16 a[142:143], v23 offset:2048
    s_waitcnt vmcnt(16)
    ds_read_b64_tr_b16 a[144:145], v20 offset:4096
    ds_read_b64_tr_b16 a[146:147], v20 offset:6144
    ds_read_b64_tr_b16 a[148:149], v21 offset:4096
    ds_read_b64_tr_b16 a[150:151], v21 offset:6144
    ds_read_b64_tr_b16 a[152:153], v22 offset:4096
    ds_read_b64_tr_b16 a[154:155], v22 offset:6144
    ds_read_b64_tr_b16 a[156:157], v23 offset:4096
    ds_read_b64_tr_b16 a[158:159], v23 offset:6144
    s_waitcnt vmcnt(12)
    ds_read_b64_tr_b16 a[160:161], v20 offset:8192
    ds_read_b64_tr_b16 a[162:163], v20 offset:10240
    ds_read_b64_tr_b16 a[164:165], v21 offset:8192
    ds_read_b64_tr_b16 a[166:167], v21 offset:10240
    ds_read_b64_tr_b16 a[168:169], v22 offset:8192
    ds_read_b64_tr_b16 a[170:171], v22 offset:10240
    ds_read_b64_tr_b16 a[172:173], v23 offset:8192
    ds_read_b64_tr_b16 a[174:175], v23 offset:10240
    s_waitcnt vmcnt(8)
    ds_read_b64_tr_b16 a[176:177], v20 offset:12288
    ds_read_b64_tr_b16 a[178:179], v20 offset:14336
    ds_read_b64_tr_b16 a[180:181], v21 offset:12288
    ds_read_b64_tr_b16 a[182:183], v21 offset:14336
    ds_read_b64_tr_b16 a[184:185], v22 offset:12288
    ds_read_b64_tr_b16 a[186:187], v22 offset:14336
    ds_read_b64_tr_b16 a[188:189], v23 offset:12288
    ds_read_b64_tr_b16 a[190:191], v23 offset:14336
    s_waitcnt vmcnt(4)
    ds_read_b64_tr_b16 a[192:193], v8 offset:0
    ds_read_b64_tr_b16 a[194:195], v8 offset:2048
    ds_read_b64_tr_b16 a[196:197], v9 offset:0
    ds_read_b64_tr_b16 a[198:199], v9 offset:2048
    ds_read_b64_tr_b16 a[200:201], v10 offset:0
    ds_read_b64_tr_b16 a[202:203], v10 offset:2048
    ds_read_b64_tr_b16 a[204:205], v11 offset:0
    ds_read_b64_tr_b16 a[206:207], v11 offset:2048
    s_waitcnt vmcnt(0)
    ds_read_b64_tr_b16 a[208:209], v8 offset:4096
    ds_read_b64_tr_b16 a[210:211], v8 offset:6144
    ds_read_b64_tr_b16 a[212:213], v9 offset:4096
    ds_read_b64_tr_b16 a[214:215], v9 offset:6144
    ds_read_b64_tr_b16 a[216:217], v10 offset:4096
    ds_read_b64_tr_b16 a[218:219], v10 offset:6144
    ds_read_b64_tr_b16 a[220:221], v11 offset:4096
    ds_read_b64_tr_b16 a[222:223], v11 offset:6144
    s_branch T_D
T_DS:
    v_mfma_f32_16x16x32_bf16 v[32:35], a[160:163], v[176:179], v[32:35]
    v_mfma_f32_16x16x32_bf16 v[32:35], a[176:179], v[184:187], v[32:35]
    v_mfma_f32_16x16x32_bf16 v[36:39], a[164:167], v[176:179], v[36:39]
    v_mfma_f32_16x16x32_bf16 v[36:39], a[180:183], v[184:187], v[36:39]
    v_mfma_f32_16x16x32_bf16 v[40:43], a[168:171], v[176:179], v[40:43]
    v_mfma_f32_16x16x32_bf16 v[40:43], a[184:187], v[184:187], v[40:43]
    v_mfma_f32_16x16x32_bf16 v[44:47], a[172:175], v[176:179], v[44:47]
    v_mfma_f32_16x16x32_bf16 v[44:47], a[188:191], v[184:187], v[44:47]
    v_mfma_f32_16x16x32_bf16 v[48:51], a[160:163], v[180:183], v[48:51]
    v_mfma_f32_16x16x32_bf16 v[48:51], a[176:179], v[188:191], v[48:51]
    v_mfma_f32_16x16x32_bf16 v[52:55], a[164:167], v[180:183], v[52:55]
    v_mfma_f32_16x16x32_bf16 v[52:55], a[180:183], v[188:191], v[52:55]
    v_mfma_f32_16x16x32_bf16 v[56:59], a[168:171], v[180:183], v[56:59]
    v_mfma_f32_16x16x32_bf16 v[56:59], a[184:187], v[188:191], v[56:59]
    v_mfma_f32_16x16x32_bf16 v[60:63], a[172:175], v[180:183], v[60:63]
    v_mfma_f32_16x16x32_bf16 v[60:63], a[188:191], v[188:191], v[60:63]
    v_mfma_f32_16x16x32_bf16 v[32:35], a[192:195], v[192:195], v[32:35]
    v_mfma_f32_16x16x32_bf16 v[32:35], a[208:211], v[200:203], v[32:35]
    v_mfma_f32_16x16x32_bf16 v[36:39], a[196:199], v[192:195], v[36:39]
    v_mfma_f32_16x16x32_bf16 v[36:39], a[212:215], v[200:203], v[36:39]
    v_mfma_f32_16x16x32_bf16 v[40:43], a[200:203], v[192:195], v[40:43]
    v_mfma_f32_16x16x32_bf16 v[40:43], a[216:219], v[200:203], v[40:43]
    v_mfma_f32_16x16x32_bf16 v[44:47], a[204:207], v[192:195], v[44:47]
    v_mfma_f32_16x16x32_bf16 v[44:47], a[220:223], v[200:203], v[44:47]
    v_mfma_f32_16x16x32_bf16 v[48:51], a[192:195], v[196:199], v[48:51]
    v_mfma_f32_16x16x32_bf16 v[48:51], a[208:211], v[204:207], v[48:51]
    v_mfma_f32_16x16x32_bf16 v[52:55], a[196:199], v[196:199], v[52:55]
    v_mfma_f32_16x16x32_bf16 v[52:55], a[212:215], v[204:207], v[52:55]
    v_mfma_f32_16x16x32_bf16 v[56:59], a[200:203], v[196:199], v[56:59]
    v_mfma_f32_16x16x32_bf16 v[56:59], a[216:219], v[204:207], v[56:59]
    v_mfma_f32_16x16x32_bf16 v[60:63], a[204:207], v[196:199], v[60:63]
    v_mfma_f32_16x16x32_bf16 v[60:63], a[220:223], v[204:207], v[60:63]
    s_branch T_SPE
T_SPER:
    s_add_u32 s37, s57, 0
    buffer_load_dwordx4 v[208:211], v6, s[24:27], s37 offen offset:0 sc1
    s_add_u32 s38, s57, 57344
    buffer_load_dwordx4 v[212:215], v6, s[24:27], s38 offen offset:0 sc1
    buffer_load_dwordx4 v[216:219], v6, s[24:27], s37 offen offset:1024 sc1
    buffer_load_dwordx4 v[220:223], v6, s[24:27], s38 offen offset:1024 sc1
    buffer_load_dwordx4 v[224:227], v6, s[24:27], s37 offen offset:2048 sc1
    buffer_load_dwordx4 v[228:231], v6, s[24:27], s38 offen offset:2048 sc1
    buffer_load_dwordx4 v[232:235], v6, s[24:27], s37 offen offset:3072 sc1
    buffer_load_dwordx4 v[236:239], v6, s[24:27], s38 offen offset:3072 sc1
    s_add_u32 s37, s57, 4096
    buffer_load_dwordx4 v[240:243], v6, s[24:27], s37 offen offset:0 sc1
    s_add_u32 s38, s57, 61440
    buffer_load_dwordx4 v[244:247], v6, s[24:27], s38 offen offset:0 sc1
    buffer_load_dwordx4 v[248:251], v6, s[24:27], s37 offen offset:1024 sc1
    buffer_load_dwordx4 v[252:255], v6, s[24:27], s38 offen offset:1024 sc1
    s_branch T_DB
T_SPE:
    s_mov_b32 s43, 0x40000
T_SPEL:
    buffer_load_dword v14, v13, s[24:27], s75 offen offset:1536 sc1
    s_waitcnt vmcnt(0)
    v_cmp_ne_u32 vcc, s70, v14
    s_nop 1
    s_cbranch_vccz T_SPER
    s_sleep 1
    s_sub_u32 s43, s43, 1
    s_cmp_lg_u32 s43, 0
    s_cbranch_scc1 T_SPEL
    s_branch T_SPER
KB_SL1:
    s_nop 15
    v_max3_f32 v176, v32, v33, v34
    v_max3_f32 v176, v176, v35, v36
    v_max3_f32 v176, v176, v37, v38
    v_max_f32 v176, v176, v39
    v_mov_b32 v177, v176
    s_nop 1
    v_permlane32_swap_b32 v176, v177
    v_max_f32 v176, v176, v177
    v_mov_b32 v177, v176
    s_nop 1
    v_permlane16_swap_b32 v176, v177
    v_max_f32 v176, v176, v177
    v_sub_f32 v176, v176, v248
    v_max_f32 v176, 0xf149f2ca, v176
    v_sub_f32 v128, v128, v176
    v_sub_f32 v129, v129, v176
    v_sub_f32 v130, v130, v176
    v_sub_f32 v131, v131, v176
    v_sub_f32 v32, v32, v176
    v_sub_f32 v33, v33, v176
    v_sub_f32 v34, v34, v176
    v_sub_f32 v35, v35, v176
    v_sub_f32 v36, v36, v176
    v_sub_f32 v37, v37, v176
    v_sub_f32 v38, v38, v176
    v_sub_f32 v39, v39, v176
    v_max3_f32 v176, v40, v41, v42
    v_max3_f32 v176, v176, v43, v44
    v_max3_f32 v176, v176, v45, v46
    v_max_f32 v176, v176, v47
    v_mov_b32 v177, v176
    s_nop 1
    v_permlane32_swap_b32 v176, v177
    v_max_f32 v176, v176, v177
    v_mov_b32 v177, v176
    s_nop 1
    v_permlane16_swap_b32 v176, v177
    v_max_f32 v176, v176, v177
    v_sub_f32 v176, v176, v248
    v_max_f32 v176, 0xf149f2ca, v176
    v_sub_f32 v132, v132, v176
    v_sub_f32 v133, v133, v176
    v_sub_f32 v134, v134, v176
    v_sub_f32 v135, v135, v176
    v_sub_f32 v40, v40, v176
    v_sub_f32 v41, v41, v176
    v_sub_f32 v42, v42, v176
    v_sub_f32 v43, v43, v176
    v_sub_f32 v44, v44, v176
    v_sub_f32 v45, v45, v176
    v_sub_f32 v46, v46, v176
    v_sub_f32 v47, v47, v176
    v_exp_f32 v160, v32
    v_exp_f32 v161, v33
    v_exp_f32 v162, v34
    v_cvt_pk_bf16_f32 v96, v160, v161
    v_exp_f32 v163, v35
    v_exp_f32 v164, v36
    v_cvt_pk_bf16_f32 v97, v162, v163
    v_exp_f32 v165, v37
    v_exp_f32 v166, v38
    v_cvt_pk_bf16_f32 v98, v164, v165
    v_exp_f32 v167, v39
    v_or3_b32 v174, v96, v97, v98
    v_exp_f32 v160, v40
    v_cvt_pk_bf16_f32 v99, v166, v167
    v_exp_f32 v161, v41
    v_exp_f32 v162, v42
    v_cvt_pk_bf16_f32 v100, v160, v161
    v_exp_f32 v163, v43
    v_or3_b32 v174, v174, v99, v100
    v_exp_f32 v164, v44
    v_cvt_pk_bf16_f32 v101, v162, v163
    v_exp_f32 v165, v45
    v_exp_f32 v166, v46
    v_cvt_pk_bf16_f32 v102, v164, v165
    v_exp_f32 v167, v47
    v_or3_b32 v174, v174, v101, v102
    v_cvt_pk_bf16_f32 v103, v166, v167
    v_or_b32 v174, v174, v103
    v_and_b32 v174, s39, v174
    s_nop 1
    s_branch KB_SL1R
KB_SL2:
    s_nop 15
    v_max3_f32 v176, v48, v49, v50
    v_max3_f32 v176, v176, v51, v52
    v_max3_f32 v176, v176, v53, v54
    v_max_f32 v176, v176, v55
    v_mov_b32 v177, v176
    s_nop 1
    v_permlane32_swap_b32 v176, v177
    v_max_f32 v176, v176, v177
    v_mov_b32 v177, v176
    s_nop 1
    v_permlane16_swap_b32 v176, v177
    v_max_f32 v176, v176, v177
    v_sub_f32 v176, v176, v248
    v_max_f32 v176, 0xf149f2ca, v176
    v_sub_f32 v136, v136, v176
    v_sub_f32 v137, v137, v176
    v_sub_f32 v138, v138, v176
    v_sub_f32 v139, v139, v176
    v_sub_f32 v48, v48, v176
    v_sub_f32 v49, v49, v176
    v_sub_f32 v50, v50, v176
    v_sub_f32 v51, v51, v176
    v_sub_f32 v52, v52, v176
    v_sub_f32 v53, v53, v176
    v_sub_f32 v54, v54, v176
    v_sub_f32 v55, v55, v176
    v_sub_f32 v80, v80, v176
    v_sub_f32 v81, v81, v176
    v_sub_f32 v82, v82, v176
    v_sub_f32 v83, v83, v176
    v_sub_f32 v84, v84, v176
    v_sub_f32 v85, v85, v176
    v_sub_f32 v86, v86, v176
    v_sub_f32 v87, v87, v176
    v_max3_f32 v176, v56, v57, v58
    v_max3_f32 v176, v176, v59, v60
    v_max3_f32 v176, v176, v61, v62
    v_max_f32 v176, v176, v63
    v_mov_b32 v177, v176
    s_nop 1
    v_permlane32_swap_b32 v176, v177
    v_max_f32 v176, v176, v177
    v_mov_b32 v177, v176
    s_nop 1
    v_permlane16_swap_b32 v176, v177
    v_max_f32 v176, v176, v177
    v_sub_f32 v176, v176, v248
    v_max_f32 v176, 0xf149f2ca, v176
    v_sub_f32 v140, v140, v176
    v_sub_f32 v141, v141, v176
    v_sub_f32 v142, v142, v176
    v_sub_f32 v143, v143, v176
    v_sub_f32 v56, v56, v176
    v_sub_f32 v57, v57, v176
    v_sub_f32 v58, v58, v176
    v_sub_f32 v59, v59, v176
    v_sub_f32 v60, v60, v176
    v_sub_f32 v61, v61, v176
    v_sub_f32 v62, v62, v176
    v_sub_f32 v63, v63, v176
    v_sub_f32 v88, v88, v176
    v_sub_f32 v89, v89, v176
    v_sub_f32 v90, v90, v176
    v_sub_f32 v91, v91, v176
    v_sub_f32 v92, v92, v176
    v_sub_f32 v93, v93, v176
    v_sub_f32 v94, v94, v176
    v_sub_f32 v95, v95, v176
    v_exp_f32 v160, v48
    v_exp_f32 v161, v49
    v_exp_f32 v162, v50
    v_cvt_pk_bf16_f32 v104, v160, v161
    v_exp_f32 v163, v51
    v_exp_f32 v164, v52
    v_cvt_pk_bf16_f32 v105, v162, v163
    v_exp_f32 v165, v53
    v_exp_f32 v166, v54
    v_cvt_pk_bf16_f32 v106, v164, v165
    v_exp_f32 v167, v55
    v_or3_b32 v174, v104, v105, v106
    v_exp_f32 v160, v56
    v_cvt_pk_bf16_f32 v107, v166, v167
    v_exp_f32 v161, v57
    v_exp_f32 v162, v58
    v_cvt_pk_bf16_f32 v108, v160, v161
    v_exp_f32 v163, v59
    v_or3_b32 v174, v174, v107, v108
    v_exp_f32 v164, v60
    v_cvt_pk_bf16_f32 v109, v162, v163
    v_exp_f32 v165, v61
    v_exp_f32 v166, v62
    v_cvt_pk_bf16_f32 v110, v164, v165
    v_exp_f32 v167, v63
    v_or3_b32 v174, v174, v109, v110
    v_cvt_pk_bf16_f32 v111, v166, v167
    v_or_b32 v174, v174, v111
    v_and_b32 v174, s39, v174
    s_nop 1
    s_branch KB_SL2R
KB_SL3:
    s_nop 15
    v_max3_f32 v176, v64, v65, v66
    v_max3_f32 v176, v176, v67, v68
    v_max3_f32 v176, v176, v69, v70
    v_max_f32 v176, v176, v71
    v_mov_b32 v177, v176
    s_nop 1
    v_permlane32_swap_b32 v176, v177
    v_max_f32 v176, v176, v177
    v_mov_b32 v177, v176
    s_nop 1
    v_permlane16_swap_b32 v176, v177
    v_max_f32 v176, v176, v177
    v_sub_f32 v176, v176, v248
    v_max_f32 v176, 0, v176
    v_exp_f32 v178, -v176
    v_sub_f32 v128, v128, v176
    v_sub_f32 v129, v129, v176
    v_sub_f32 v130, v130, v176
    v_sub_f32 v131, v131, v176
    v_sub_f32 v64, v64, v176
    v_sub_f32 v65, v65, v176
    v_sub_f32 v66, v66, v176
    v_sub_f32 v67, v67, v176
    v_sub_f32 v68, v68, v176
    v_sub_f32 v69, v69, v176
    v_sub_f32 v70, v70, v176
    v_sub_f32 v71, v71, v176
    v_mul_f32 v20, v20, v178
    v_mul_f32 v21, v21, v178
    v_mul_f32 v22, v22, v178
    v_mul_f32 v23, v23, v178
    v_accvgpr_read_b32 v160, a0
    v_accvgpr_read_b32 v161, a1
    v_accvgpr_read_b32 v162, a2
    v_accvgpr_read_b32 v163, a3
    v_accvgpr_read_b32 v164, a4
    v_accvgpr_read_b32 v165, a5
    v_accvgpr_read_b32 v166, a6
    v_accvgpr_read_b32 v167, a7
    v_mul_f32 v160, v160, v178
    v_mul_f32 v161, v161, v178
    v_mul_f32 v162, v162, v178
    v_mul_f32 v163, v163, v178
    v_mul_f32 v164, v164, v178
    v_mul_f32 v165, v165, v178
    v_mul_f32 v166, v166, v178
    v_mul_f32 v167, v167, v178
    v_accvgpr_write_b32 a0, v160
    v_accvgpr_write_b32 a1, v161
    v_accvgpr_write_b32 a2, v162
    v_accvgpr_write_b32 a3, v163
    v_accvgpr_write_b32 a4, v164
    v_accvgpr_write_b32 a5, v165
    v_accvgpr_write_b32 a6, v166
    v_accvgpr_write_b32 a7, v167
    v_accvgpr_read_b32 v160, a8
    v_accvgpr_read_b32 v161, a9
    v_accvgpr_read_b32 v162, a10
    v_accvgpr_read_b32 v163, a11
    v_accvgpr_read_b32 v164, a12
    v_accvgpr_read_b32 v165, a13
    v_accvgpr_read_b32 v166, a14
    v_accvgpr_read_b32 v167, a15
    v_mul_f32 v160, v160, v178
    v_mul_f32 v161, v161, v178
    v_mul_f32 v162, v162, v178
    v_mul_f32 v163, v163, v178
    v_mul_f32 v164, v164, v178
    v_mul_f32 v165, v165, v178
    v_mul_f32 v166, v166, v178
    v_mul_f32 v167, v167, v178
    v_accvgpr_write_b32 a8, v160
    v_accvgpr_write_b32 a9, v161
    v_accvgpr_write_b32 a10, v162
    v_accvgpr_write_b32 a11, v163
    v_accvgpr_write_b32 a12, v164
    v_accvgpr_write_b32 a13, v165
    v_accvgpr_write_b32 a14, v166
    v_accvgpr_write_b32 a15, v167
    v_accvgpr_read_b32 v160, a32
    v_accvgpr_read_b32 v161, a33
    v_accvgpr_read_b32 v162, a34
    v_accvgpr_read_b32 v163, a35
    v_accvgpr_read_b32 v164, a36
    v_accvgpr_read_b32 v165, a37
    v_accvgpr_read_b32 v166, a38
    v_accvgpr_read_b32 v167, a39
    v_mul_f32 v160, v160, v178
    v_mul_f32 v161, v161, v178
    v_mul_f32 v162, v162, v178
    v_mul_f32 v163, v163, v178
    v_mul_f32 v164, v164, v178
    v_mul_f32 v165, v165, v178
    v_mul_f32 v166, v166, v178
    v_mul_f32 v167, v167, v178
    v_accvgpr_write_b32 a32, v160
    v_accvgpr_write_b32 a33, v161
    v_accvgpr_write_b32 a34, v162
    v_accvgpr_write_b32 a35, v163
    v_accvgpr_write_b32 a36, v164
    v_accvgpr_write_b32 a37, v165
    v_accvgpr_write_b32 a38, v166
    v_accvgpr_write_b32 a39, v167
    v_accvgpr_read_b32 v160, a40
    v_accvgpr_read_b32 v161, a41
    v_accvgpr_read_b32 v162, a42
    v_accvgpr_read_b32 v163, a43
    v_accvgpr_read_b32 v164, a44
    v_accvgpr_read_b32 v165, a45
    v_accvgpr_read_b32 v166, a46
    v_accvgpr_read_b32 v167, a47
    v_mul_f32 v160, v160, v178
    v_mul_f32 v161, v161, v178
    v_mul_f32 v162, v162, v178
    v_mul_f32 v163, v163, v178
    v_mul_f32 v164, v164, v178
    v_mul_f32 v165, v165, v178
    v_mul_f32 v166, v166, v178
    v_mul_f32 v167, v167, v178
    v_accvgpr_write_b32 a40, v160
    v_accvgpr_write_b32 a41, v161
    v_accvgpr_write_b32 a42, v162
    v_accvgpr_write_b32 a43, v163
    v_accvgpr_write_b32 a44, v164
    v_accvgpr_write_b32 a45, v165
    v_accvgpr_write_b32 a46, v166
    v_accvgpr_write_b32 a47, v167
    v_max3_f32 v176, v72, v73, v74
    v_max3_f32 v176, v176, v75, v76
    v_max3_f32 v176, v176, v77, v78
    v_max_f32 v176, v176, v79
    v_mov_b32 v177, v176
    s_nop 1
    v_permlane32_swap_b32 v176, v177
    v_max_f32 v176, v176, v177
    v_mov_b32 v177, v176
    s_nop 1
    v_permlane16_swap_b32 v176, v177
    v_max_f32 v176, v176, v177
    v_sub_f32 v176, v176, v248
    v_max_f32 v176, 0, v176
    v_exp_f32 v178, -v176
    v_sub_f32 v132, v132, v176
    v_sub_f32 v133, v133, v176
    v_sub_f32 v134, v134, v176
    v_sub_f32 v135, v135, v176
    v_sub_f32 v72, v72, v176
    v_sub_f32 v73, v73, v176
    v_sub_f32 v74, v74, v176
    v_sub_f32 v75, v75, v176
    v_sub_f32 v76, v76, v176
    v_sub_f32 v77, v77, v176
    v_sub_f32 v78, v78, v176
    v_sub_f32 v79, v79, v176
    v_mul_f32 v24, v24, v178
    v_mul_f32 v25, v25, v178
    v_mul_f32 v26, v26, v178
    v_mul_f32 v27, v27, v178
    v_accvgpr_read_b32 v160, a16
    v_accvgpr_read_b32 v161, a17
    v_accvgpr_read_b32 v162, a18
    v_accvgpr_read_b32 v163, a19
    v_accvgpr_read_b32 v164, a20
    v_accvgpr_read_b32 v165, a21
    v_accvgpr_read_b32 v166, a22
    v_accvgpr_read_b32 v167, a23
    v_mul_f32 v160, v160, v178
    v_mul_f32 v161, v161, v178
    v_mul_f32 v162, v162, v178
    v_mul_f32 v163, v163, v178
    v_mul_f32 v164, v164, v178
    v_mul_f32 v165, v165, v178
    v_mul_f32 v166, v166, v178
    v_mul_f32 v167, v167, v178
    v_accvgpr_write_b32 a16, v160
    v_accvgpr_write_b32 a17, v161
    v_accvgpr_write_b32 a18, v162
    v_accvgpr_write_b32 a19, v163
    v_accvgpr_write_b32 a20, v164
    v_accvgpr_write_b32 a21, v165
    v_accvgpr_write_b32 a22, v166
    v_accvgpr_write_b32 a23, v167
    v_accvgpr_read_b32 v160, a24
    v_accvgpr_read_b32 v161, a25
    v_accvgpr_read_b32 v162, a26
    v_accvgpr_read_b32 v163, a27
    v_accvgpr_read_b32 v164, a28
    v_accvgpr_read_b32 v165, a29
    v_accvgpr_read_b32 v166, a30
    v_accvgpr_read_b32 v167, a31
    v_mul_f32 v160, v160, v178
    v_mul_f32 v161, v161, v178
    v_mul_f32 v162, v162, v178
    v_mul_f32 v163, v163, v178
    v_mul_f32 v164, v164, v178
    v_mul_f32 v165, v165, v178
    v_mul_f32 v166, v166, v178
    v_mul_f32 v167, v167, v178
    v_accvgpr_write_b32 a24, v160
    v_accvgpr_write_b32 a25, v161
    v_accvgpr_write_b32 a26, v162
    v_accvgpr_write_b32 a27, v163
    v_accvgpr_write_b32 a28, v164
    v_accvgpr_write_b32 a29, v165
    v_accvgpr_write_b32 a30, v166
    v_accvgpr_write_b32 a31, v167
    v_accvgpr_read_b32 v160, a48
    v_accvgpr_read_b32 v161, a49
    v_accvgpr_read_b32 v162, a50
    v_accvgpr_read_b32 v163, a51
    v_accvgpr_read_b32 v164, a52
    v_accvgpr_read_b32 v165, a53
    v_accvgpr_read_b32 v166, a54
    v_accvgpr_read_b32 v167, a55
    v_mul_f32 v160, v160, v178
    v_mul_f32 v161, v161, v178
    v_mul_f32 v162, v162, v178
    v_mul_f32 v163, v163, v178
    v_mul_f32 v164, v164, v178
    v_mul_f32 v165, v165, v178
    v_mul_f32 v166, v166, v178
    v_mul_f32 v167, v167, v178
    v_accvgpr_write_b32 a48, v160
    v_accvgpr_write_b32 a49, v161
    v_accvgpr_write_b32 a50, v162
    v_accvgpr_write_b32 a51, v163
    v_accvgpr_write_b32 a52, v164
    v_accvgpr_write_b32 a53, v165
    v_accvgpr_write_b32 a54, v166
    v_accvgpr_write_b32 a55, v167
    v_accvgpr_read_b32 v160, a56
    v_accvgpr_read_b32 v161, a57
    v_accvgpr_read_b32 v162, a58
    v_accvgpr_read_b32 v163, a59
    v_accvgpr_read_b32 v164, a60
    v_accvgpr_read_b32 v165, a61
    v_accvgpr_read_b32 v166, a62
    v_accvgpr_read_b32 v167, a63
    v_mul_f32 v160, v160, v178
    v_mul_f32 v161, v161, v178
    v_mul_f32 v162, v162, v178
    v_mul_f32 v163, v163, v178
    v_mul_f32 v164, v164, v178
    v_mul_f32 v165, v165, v178
    v_mul_f32 v166, v166, v178
    v_mul_f32 v167, v167, v178
    v_accvgpr_write_b32 a56, v160
    v_accvgpr_write_b32 a57, v161
    v_accvgpr_write_b32 a58, v162
    v_accvgpr_write_b32 a59, v163
    v_accvgpr_write_b32 a60, v164
    v_accvgpr_write_b32 a61, v165
    v_accvgpr_write_b32 a62, v166
    v_accvgpr_write_b32 a63, v167
    v_exp_f32 v160, v64
    v_exp_f32 v161, v65
    v_exp_f32 v162, v66
    v_cvt_pk_bf16_f32 v112, v160, v161
    v_exp_f32 v163, v67
    v_exp_f32 v164, v68
    v_cvt_pk_bf16_f32 v113, v162, v163
    v_exp_f32 v165, v69
    v_exp_f32 v166, v70
    v_cvt_pk_bf16_f32 v114, v164, v165
    v_exp_f32 v167, v71
    v_or3_b32 v174, v112, v113, v114
    v_exp_f32 v160, v72
    v_cvt_pk_bf16_f32 v115, v166, v167
    v_exp_f32 v161, v73
    v_exp_f32 v162, v74
    v_cvt_pk_bf16_f32 v116, v160, v161
    v_exp_f32 v163, v75
    v_or3_b32 v174, v174, v115, v116
    v_exp_f32 v164, v76
    v_cvt_pk_bf16_f32 v117, v162, v163
    v_exp_f32 v165, v77
    v_exp_f32 v166, v78
    v_cvt_pk_bf16_f32 v118, v164, v165
    v_exp_f32 v167, v79
    v_or3_b32 v174, v174, v117, v118
    v_cvt_pk_bf16_f32 v119, v166, v167
    v_or_b32 v174, v174, v119
    v_and_b32 v174, s39, v174
    s_nop 1
    s_branch KB_SL3R
KB_SL4:
    s_nop 15
    v_max3_f32 v176, v80, v81, v82
    v_max3_f32 v176, v176, v83, v84
    v_max3_f32 v176, v176, v85, v86
    v_max_f32 v176, v176, v87
    v_mov_b32 v177, v176
    s_nop 1
    v_permlane32_swap_b32 v176, v177
    v_max_f32 v176, v176, v177
    v_mov_b32 v177, v176
    s_nop 1
    v_permlane16_swap_b32 v176, v177
    v_max_f32 v176, v176, v177
    v_sub_f32 v176, v176, v248
    v_max_f32 v176, 0, v176
    v_exp_f32 v178, -v176
    v_sub_f32 v136, v136, v176
    v_sub_f32 v137, v137, v176
    v_sub_f32 v138, v138, v176
    v_sub_f32 v139, v139, v176
    v_sub_f32 v80, v80, v176
    v_sub_f32 v81, v81, v176
    v_sub_f32 v82, v82, v176
    v_sub_f32 v83, v83, v176
    v_sub_f32 v84, v84, v176
    v_sub_f32 v85, v85, v176
    v_sub_f32 v86, v86, v176
    v_sub_f32 v87, v87, v176
    v_sub_f32 v48, v48, v176
    v_sub_f32 v49, v49, v176
    v_sub_f32 v50, v50, v176
    v_sub_f32 v51, v51, v176
    v_sub_f32 v52, v52, v176
    v_sub_f32 v53, v53, v176
    v_sub_f32 v54, v54, v176
    v_sub_f32 v55, v55, v176
    v_mul_f32 v28, v28, v178
    v_mul_f32 v29, v29, v178
    v_mul_f32 v30, v30, v178
    v_mul_f32 v31, v31, v178
    v_accvgpr_read_b32 v160, a64
    v_accvgpr_read_b32 v161, a65
    v_accvgpr_read_b32 v162, a66
    v_accvgpr_read_b32 v163, a67
    v_accvgpr_read_b32 v164, a68
    v_accvgpr_read_b32 v165, a69
    v_accvgpr_read_b32 v166, a70
    v_accvgpr_read_b32 v167, a71
    v_mul_f32 v160, v160, v178
    v_mul_f32 v161, v161, v178
    v_mul_f32 v162, v162, v178
    v_mul_f32 v163, v163, v178
    v_mul_f32 v164, v164, v178
    v_mul_f32 v165, v165, v178
    v_mul_f32 v166, v166, v178
    v_mul_f32 v167, v167, v178
    v_accvgpr_write_b32 a64, v160
    v_accvgpr_write_b32 a65, v161
    v_accvgpr_write_b32 a66, v162
    v_accvgpr_write_b32 a67, v163
    v_accvgpr_write_b32 a68, v164
    v_accvgpr_write_b32 a69, v165
    v_accvgpr_write_b32 a70, v166
    v_accvgpr_write_b32 a71, v167
    v_accvgpr_read_b32 v160, a72
    v_accvgpr_read_b32 v161, a73
    v_accvgpr_read_b32 v162, a74
    v_accvgpr_read_b32 v163, a75
    v_accvgpr_read_b32 v164, a76
    v_accvgpr_read_b32 v165, a77
    v_accvgpr_read_b32 v166, a78
    v_accvgpr_read_b32 v167, a79
    v_mul_f32 v160, v160, v178
    v_mul_f32 v161, v161, v178
    v_mul_f32 v162, v162, v178
    v_mul_f32 v163, v163, v178
    v_mul_f32 v164, v164, v178
    v_mul_f32 v165, v165, v178
    v_mul_f32 v166, v166, v178
    v_mul_f32 v167, v167, v178
    v_accvgpr_write_b32 a72, v160
    v_accvgpr_write_b32 a73, v161
    v_accvgpr_write_b32 a74, v162
    v_accvgpr_write_b32 a75, v163
    v_accvgpr_write_b32 a76, v164
    v_accvgpr_write_b32 a77, v165
    v_accvgpr_write_b32 a78, v166
    v_accvgpr_write_b32 a79, v167
    v_accvgpr_read_b32 v160, a96
    v_accvgpr_read_b32 v161, a97
    v_accvgpr_read_b32 v162, a98
    v_accvgpr_read_b32 v163, a99
    v_accvgpr_read_b32 v164, a100
    v_accvgpr_read_b32 v165, a101
    v_accvgpr_read_b32 v166, a102
    v_accvgpr_read_b32 v167, a103
    v_mul_f32 v160, v160, v178
    v_mul_f32 v161, v161, v178
    v_mul_f32 v162, v162, v178
    v_mul_f32 v163, v163, v178
    v_mul_f32 v164, v164, v178
    v_mul_f32 v165, v165, v178
    v_mul_f32 v166, v166, v178
    v_mul_f32 v167, v167, v178
    v_accvgpr_write_b32 a96, v160
    v_accvgpr_write_b32 a97, v161
    v_accvgpr_write_b32 a98, v162
    v_accvgpr_write_b32 a99, v163
    v_accvgpr_write_b32 a100, v164
    v_accvgpr_write_b32 a101, v165
    v_accvgpr_write_b32 a102, v166
    v_accvgpr_write_b32 a103, v167
    v_accvgpr_read_b32 v160, a104
    v_accvgpr_read_b32 v161, a105
    v_accvgpr_read_b32 v162, a106
    v_accvgpr_read_b32 v163, a107
    v_accvgpr_read_b32 v164, a108
    v_accvgpr_read_b32 v165, a109
    v_accvgpr_read_b32 v166, a110
    v_accvgpr_read_b32 v167, a111
    v_mul_f32 v160, v160, v178
    v_mul_f32 v161, v161, v178
    v_mul_f32 v162, v162, v178
    v_mul_f32 v163, v163, v178
    v_mul_f32 v164, v164, v178
    v_mul_f32 v165, v165, v178
    v_mul_f32 v166, v166, v178
    v_mul_f32 v167, v167, v178
    v_accvgpr_write_b32 a104, v160
    v_accvgpr_write_b32 a105, v161
    v_accvgpr_write_b32 a106, v162
    v_accvgpr_write_b32 a107, v163
    v_accvgpr_write_b32 a108, v164
    v_accvgpr_write_b32 a109, v165
    v_accvgpr_write_b32 a110, v166
    v_accvgpr_write_b32 a111, v167
    v_max3_f32 v176, v88, v89, v90
    v_max3_f32 v176, v176, v91, v92
    v_max3_f32 v176, v176, v93, v94
    v_max_f32 v176, v176, v95
    v_mov_b32 v177, v176
    s_nop 1
    v_permlane32_swap_b32 v176, v177
    v_max_f32 v176, v176, v177
    v_mov_b32 v177, v176
    s_nop 1
    v_permlane16_swap_b32 v176, v177
    v_max_f32 v176, v176, v177
    v_sub_f32 v176, v176, v248
    v_max_f32 v176, 0, v176
    v_exp_f32 v178, -v176
    v_sub_f32 v140, v140, v176
    v_sub_f32 v141, v141, v176
    v_sub_f32 v142, v142, v176
    v_sub_f32 v143, v143, v176
    v_sub_f32 v88, v88, v176
    v_sub_f32 v89, v89, v176
    v_sub_f32 v90, v90, v176
    v_sub_f32 v91, v91, v176
    v_sub_f32 v92, v92, v176
    v_sub_f32 v93, v93, v176
    v_sub_f32 v94, v94, v176
    v_sub_f32 v95, v95, v176
    v_sub_f32 v56, v56, v176
    v_sub_f32 v57, v57, v176
    v_sub_f32 v58, v58, v176
    v_sub_f32 v59, v59, v176
    v_sub_f32 v60, v60, v176
    v_sub_f32 v61, v61, v176
    v_sub_f32 v62, v62, v176
    v_sub_f32 v63, v63, v176
    v_mul_f32 v168, v168, v178
    v_mul_f32 v169, v169, v178
    v_mul_f32 v170, v170, v178
    v_mul_f32 v171, v171, v178
    v_accvgpr_read_b32 v160, a80
    v_accvgpr_read_b32 v161, a81
    v_accvgpr_read_b32 v162, a82
    v_accvgpr_read_b32 v163, a83
    v_accvgpr_read_b32 v164, a84
    v_accvgpr_read_b32 v165, a85
    v_accvgpr_read_b32 v166, a86
    v_accvgpr_read_b32 v167, a87
    v_mul_f32 v160, v160, v178
    v_mul_f32 v161, v161, v178
    v_mul_f32 v162, v162, v178
    v_mul_f32 v163, v163, v178
    v_mul_f32 v164, v164, v178
    v_mul_f32 v165, v165, v178
    v_mul_f32 v166, v166, v178
    v_mul_f32 v167, v167, v178
    v_accvgpr_write_b32 a80, v160
    v_accvgpr_write_b32 a81, v161
    v_accvgpr_write_b32 a82, v162
    v_accvgpr_write_b32 a83, v163
    v_accvgpr_write_b32 a84, v164
    v_accvgpr_write_b32 a85, v165
    v_accvgpr_write_b32 a86, v166
    v_accvgpr_write_b32 a87, v167
    v_accvgpr_read_b32 v160, a88
    v_accvgpr_read_b32 v161, a89
    v_accvgpr_read_b32 v162, a90
    v_accvgpr_read_b32 v163, a91
    v_accvgpr_read_b32 v164, a92
    v_accvgpr_read_b32 v165, a93
    v_accvgpr_read_b32 v166, a94
    v_accvgpr_read_b32 v167, a95
    v_mul_f32 v160, v160, v178
    v_mul_f32 v161, v161, v178
    v_mul_f32 v162, v162, v178
    v_mul_f32 v163, v163, v178
    v_mul_f32 v164, v164, v178
    v_mul_f32 v165, v165, v178
    v_mul_f32 v166, v166, v178
    v_mul_f32 v167, v167, v178
    v_accvgpr_write_b32 a88, v160
    v_accvgpr_write_b32 a89, v161
    v_accvgpr_write_b32 a90, v162
    v_accvgpr_write_b32 a91, v163
    v_accvgpr_write_b32 a92, v164
    v_accvgpr_write_b32 a93, v165
    v_accvgpr_write_b32 a94, v166
    v_accvgpr_write_b32 a95, v167
    v_accvgpr_read_b32 v160, a112
    v_accvgpr_read_b32 v161, a113
    v_accvgpr_read_b32 v162, a114
    v_accvgpr_read_b32 v163, a115
    v_accvgpr_read_b32 v164, a116
    v_accvgpr_read_b32 v165, a117
    v_accvgpr_read_b32 v166, a118
    v_accvgpr_read_b32 v167, a119
    v_mul_f32 v160, v160, v178
    v_mul_f32 v161, v161, v178
    v_mul_f32 v162, v162, v178
    v_mul_f32 v163, v163, v178
    v_mul_f32 v164, v164, v178
    v_mul_f32 v165, v165, v178
    v_mul_f32 v166, v166, v178
    v_mul_f32 v167, v167, v178
    v_accvgpr_write_b32 a112, v160
    v_accvgpr_write_b32 a113, v161
    v_accvgpr_write_b32 a114, v162
    v_accvgpr_write_b32 a115, v163
    v_accvgpr_write_b32 a116, v164
    v_accvgpr_write_b32 a117, v165
    v_accvgpr_write_b32 a118, v166
    v_accvgpr_write_b32 a119, v167
    v_accvgpr_read_b32 v160, a120
    v_accvgpr_read_b32 v161, a121
    v_accvgpr_read_b32 v162, a122
    v_accvgpr_read_b32 v163, a123
    v_accvgpr_read_b32 v164, a124
    v_accvgpr_read_b32 v165, a125
    v_accvgpr_read_b32 v166, a126
    v_accvgpr_read_b32 v167, a127
    v_mul_f32 v160, v160, v178
    v_mul_f32 v161, v161, v178
    v_mul_f32 v162, v162, v178
    v_mul_f32 v163, v163, v178
    v_mul_f32 v164, v164, v178
    v_mul_f32 v165, v165, v178
    v_mul_f32 v166, v166, v178
    v_mul_f32 v167, v167, v178
    v_accvgpr_write_b32 a120, v160
    v_accvgpr_write_b32 a121, v161
    v_accvgpr_write_b32 a122, v162
    v_accvgpr_write_b32 a123, v163
    v_accvgpr_write_b32 a124, v164
    v_accvgpr_write_b32 a125, v165
    v_accvgpr_write_b32 a126, v166
    v_accvgpr_write_b32 a127, v167
    v_exp_f32 v160, v80
    v_exp_f32 v161, v81
    v_exp_f32 v162, v82
    v_cvt_pk_bf16_f32 v120, v160, v161
    v_exp_f32 v163, v83
    v_exp_f32 v164, v84
    v_cvt_pk_bf16_f32 v121, v162, v163
    v_exp_f32 v165, v85
    v_exp_f32 v166, v86
    v_cvt_pk_bf16_f32 v122, v164, v165
    v_exp_f32 v167, v87
    v_or3_b32 v174, v120, v121, v122
    v_exp_f32 v160, v88
    v_cvt_pk_bf16_f32 v123, v166, v167
    v_exp_f32 v161, v89
    v_exp_f32 v162, v90
    v_cvt_pk_bf16_f32 v124, v160, v161
    v_exp_f32 v163, v91
    v_or3_b32 v174, v174, v123, v124
    v_exp_f32 v164, v92
    v_cvt_pk_bf16_f32 v125, v162, v163
    v_exp_f32 v165, v93
    v_exp_f32 v166, v94
    v_cvt_pk_bf16_f32 v126, v164, v165
    v_exp_f32 v167, v95
    v_or3_b32 v174, v174, v125, v126
    v_cvt_pk_bf16_f32 v127, v166, v167
    v_or_b32 v174, v174, v127
    v_and_b32 v174, s39, v174
    s_nop 1
    s_branch KB_SL4R
KB_SL5:
    s_nop 15
    v_max3_f32 v176, v32, v33, v34
    v_max3_f32 v176, v176, v35, v36
    v_max3_f32 v176, v176, v37, v38
    v_max_f32 v176, v176, v39
    v_mov_b32 v177, v176
    s_nop 1
    v_permlane32_swap_b32 v176, v177
    v_max_f32 v176, v176, v177
    v_mov_b32 v177, v176
    s_nop 1
    v_permlane16_swap_b32 v176, v177
    v_max_f32 v176, v176, v177
    v_sub_f32 v176, v176, v248
    v_max_f32 v176, 0, v176
    v_exp_f32 v178, -v176
    v_sub_f32 v128, v128, v176
    v_sub_f32 v129, v129, v176
    v_sub_f32 v130, v130, v176
    v_sub_f32 v131, v131, v176
    v_sub_f32 v32, v32, v176
    v_sub_f32 v33, v33, v176
    v_sub_f32 v34, v34, v176
    v_sub_f32 v35, v35, v176
    v_sub_f32 v36, v36, v176
    v_sub_f32 v37, v37, v176
    v_sub_f32 v38, v38, v176
    v_sub_f32 v39, v39, v176
    v_mul_f32 v20, v20, v178
    v_mul_f32 v21, v21, v178
    v_mul_f32 v22, v22, v178
    v_mul_f32 v23, v23, v178
    v_accvgpr_read_b32 v160, a0
    v_accvgpr_read_b32 v161, a1
    v_accvgpr_read_b32 v162, a2
    v_accvgpr_read_b32 v163, a3
    v_accvgpr_read_b32 v164, a4
    v_accvgpr_read_b32 v165, a5
    v_accvgpr_read_b32 v166, a6
    v_accvgpr_read_b32 v167, a7
    v_mul_f32 v160, v160, v178
    v_mul_f32 v161, v161, v178
    v_mul_f32 v162, v162, v178
    v_mul_f32 v163, v163, v178
    v_mul_f32 v164, v164, v178
    v_mul_f32 v165, v165, v178
    v_mul_f32 v166, v166, v178
    v_mul_f32 v167, v167, v178
    v_accvgpr_write_b32 a0, v160
    v_accvgpr_write_b32 a1, v161
    v_accvgpr_write_b32 a2, v162
    v_accvgpr_write_b32 a3, v163
    v_accvgpr_write_b32 a4, v164
    v_accvgpr_write_b32 a5, v165
    v_accvgpr_write_b32 a6, v166
    v_accvgpr_write_b32 a7, v167
    v_accvgpr_read_b32 v160, a8
    v_accvgpr_read_b32 v161, a9
    v_accvgpr_read_b32 v162, a10
    v_accvgpr_read_b32 v163, a11
    v_accvgpr_read_b32 v164, a12
    v_accvgpr_read_b32 v165, a13
    v_accvgpr_read_b32 v166, a14
    v_accvgpr_read_b32 v167, a15
    v_mul_f32 v160, v160, v178
    v_mul_f32 v161, v161, v178
    v_mul_f32 v162, v162, v178
    v_mul_f32 v163, v163, v178
    v_mul_f32 v164, v164, v178
    v_mul_f32 v165, v165, v178
    v_mul_f32 v166, v166, v178
    v_mul_f32 v167, v167, v178
    v_accvgpr_write_b32 a8, v160
    v_accvgpr_write_b32 a9, v161
    v_accvgpr_write_b32 a10, v162
    v_accvgpr_write_b32 a11, v163
    v_accvgpr_write_b32 a12, v164
    v_accvgpr_write_b32 a13, v165
    v_accvgpr_write_b32 a14, v166
    v_accvgpr_write_b32 a15, v167
    v_accvgpr_read_b32 v160, a32
    v_accvgpr_read_b32 v161, a33
    v_accvgpr_read_b32 v162, a34
    v_accvgpr_read_b32 v163, a35
    v_accvgpr_read_b32 v164, a36
    v_accvgpr_read_b32 v165, a37
    v_accvgpr_read_b32 v166, a38
    v_accvgpr_read_b32 v167, a39
    v_mul_f32 v160, v160, v178
    v_mul_f32 v161, v161, v178
    v_mul_f32 v162, v162, v178
    v_mul_f32 v163, v163, v178
    v_mul_f32 v164, v164, v178
    v_mul_f32 v165, v165, v178
    v_mul_f32 v166, v166, v178
    v_mul_f32 v167, v167, v178
    v_accvgpr_write_b32 a32, v160
    v_accvgpr_write_b32 a33, v161
    v_accvgpr_write_b32 a34, v162
    v_accvgpr_write_b32 a35, v163
    v_accvgpr_write_b32 a36, v164
    v_accvgpr_write_b32 a37, v165
    v_accvgpr_write_b32 a38, v166
    v_accvgpr_write_b32 a39, v167
    v_accvgpr_read_b32 v160, a40
    v_accvgpr_read_b32 v161, a41
    v_accvgpr_read_b32 v162, a42
    v_accvgpr_read_b32 v163, a43
    v_accvgpr_read_b32 v164, a44
    v_accvgpr_read_b32 v165, a45
    v_accvgpr_read_b32 v166, a46
    v_accvgpr_read_b32 v167, a47
    v_mul_f32 v160, v160, v178
    v_mul_f32 v161, v161, v178
    v_mul_f32 v162, v162, v178
    v_mul_f32 v163, v163, v178
    v_mul_f32 v164, v164, v178
    v_mul_f32 v165, v165, v178
    v_mul_f32 v166, v166, v178
    v_mul_f32 v167, v167, v178
    v_accvgpr_write_b32 a40, v160
    v_accvgpr_write_b32 a41, v161
    v_accvgpr_write_b32 a42, v162
    v_accvgpr_write_b32 a43, v163
    v_accvgpr_write_b32 a44, v164
    v_accvgpr_write_b32 a45, v165
    v_accvgpr_write_b32 a46, v166
    v_accvgpr_write_b32 a47, v167
    v_max3_f32 v176, v40, v41, v42
    v_max3_f32 v176, v176, v43, v44
    v_max3_f32 v176, v176, v45, v46
    v_max_f32 v176, v176, v47
    v_mov_b32 v177, v176
    s_nop 1
    v_permlane32_swap_b32 v176, v177
    v_max_f32 v176, v176, v177
    v_mov_b32 v177, v176
    s_nop 1
    v_permlane16_swap_b32 v176, v177
    v_max_f32 v176, v176, v177
    v_sub_f32 v176, v176, v248
    v_max_f32 v176, 0, v176
    v_exp_f32 v178, -v176
    v_sub_f32 v132, v132, v176
    v_sub_f32 v133, v133, v176
    v_sub_f32 v134, v134, v176
    v_sub_f32 v135, v135, v176
    v_sub_f32 v40, v40, v176
    v_sub_f32 v41, v41, v176
    v_sub_f32 v42, v42, v176
    v_sub_f32 v43, v43, v176
    v_sub_f32 v44, v44, v176
    v_sub_f32 v45, v45, v176
    v_sub_f32 v46, v46, v176
    v_sub_f32 v47, v47, v176
    v_mul_f32 v24, v24, v178
    v_mul_f32 v25, v25, v178
    v_mul_f32 v26, v26, v178
    v_mul_f32 v27, v27, v178
    v_accvgpr_read_b32 v160, a16
    v_accvgpr_read_b32 v161, a17
    v_accvgpr_read_b32 v162, a18
    v_accvgpr_read_b32 v163, a19
    v_accvgpr_read_b32 v164, a20
    v_accvgpr_read_b32 v165, a21
    v_accvgpr_read_b32 v166, a22
    v_accvgpr_read_b32 v167, a23
    v_mul_f32 v160, v160, v178
    v_mul_f32 v161, v161, v178
    v_mul_f32 v162, v162, v178
    v_mul_f32 v163, v163, v178
    v_mul_f32 v164, v164, v178
    v_mul_f32 v165, v165, v178
    v_mul_f32 v166, v166, v178
    v_mul_f32 v167, v167, v178
    v_accvgpr_write_b32 a16, v160
    v_accvgpr_write_b32 a17, v161
    v_accvgpr_write_b32 a18, v162
    v_accvgpr_write_b32 a19, v163
    v_accvgpr_write_b32 a20, v164
    v_accvgpr_write_b32 a21, v165
    v_accvgpr_write_b32 a22, v166
    v_accvgpr_write_b32 a23, v167
    v_accvgpr_read_b32 v160, a24
    v_accvgpr_read_b32 v161, a25
    v_accvgpr_read_b32 v162, a26
    v_accvgpr_read_b32 v163, a27
    v_accvgpr_read_b32 v164, a28
    v_accvgpr_read_b32 v165, a29
    v_accvgpr_read_b32 v166, a30
    v_accvgpr_read_b32 v167, a31
    v_mul_f32 v160, v160, v178
    v_mul_f32 v161, v161, v178
    v_mul_f32 v162, v162, v178
    v_mul_f32 v163, v163, v178
    v_mul_f32 v164, v164, v178
    v_mul_f32 v165, v165, v178
    v_mul_f32 v166, v166, v178
    v_mul_f32 v167, v167, v178
    v_accvgpr_write_b32 a24, v160
    v_accvgpr_write_b32 a25, v161
    v_accvgpr_write_b32 a26, v162
    v_accvgpr_write_b32 a27, v163
    v_accvgpr_write_b32 a28, v164
    v_accvgpr_write_b32 a29, v165
    v_accvgpr_write_b32 a30, v166
    v_accvgpr_write_b32 a31, v167
    v_accvgpr_read_b32 v160, a48
    v_accvgpr_read_b32 v161, a49
    v_accvgpr_read_b32 v162, a50
    v_accvgpr_read_b32 v163, a51
    v_accvgpr_read_b32 v164, a52
    v_accvgpr_read_b32 v165, a53
    v_accvgpr_read_b32 v166, a54
    v_accvgpr_read_b32 v167, a55
    v_mul_f32 v160, v160, v178
    v_mul_f32 v161, v161, v178
    v_mul_f32 v162, v162, v178
    v_mul_f32 v163, v163, v178
    v_mul_f32 v164, v164, v178
    v_mul_f32 v165, v165, v178
    v_mul_f32 v166, v166, v178
    v_mul_f32 v167, v167, v178
    v_accvgpr_write_b32 a48, v160
    v_accvgpr_write_b32 a49, v161
    v_accvgpr_write_b32 a50, v162
    v_accvgpr_write_b32 a51, v163
    v_accvgpr_write_b32 a52, v164
    v_accvgpr_write_b32 a53, v165
    v_accvgpr_write_b32 a54, v166
    v_accvgpr_write_b32 a55, v167
    v_accvgpr_read_b32 v160, a56
    v_accvgpr_read_b32 v161, a57
    v_accvgpr_read_b32 v162, a58
    v_accvgpr_read_b32 v163, a59
    v_accvgpr_read_b32 v164, a60
    v_accvgpr_read_b32 v165, a61
    v_accvgpr_read_b32 v166, a62
    v_accvgpr_read_b32 v167, a63
    v_mul_f32 v160, v160, v178
    v_mul_f32 v161, v161, v178
    v_mul_f32 v162, v162, v178
    v_mul_f32 v163, v163, v178
    v_mul_f32 v164, v164, v178
    v_mul_f32 v165, v165, v178
    v_mul_f32 v166, v166, v178
    v_mul_f32 v167, v167, v178
    v_accvgpr_write_b32 a56, v160
    v_accvgpr_write_b32 a57, v161
    v_accvgpr_write_b32 a58, v162
    v_accvgpr_write_b32 a59, v163
    v_accvgpr_write_b32 a60, v164
    v_accvgpr_write_b32 a61, v165
    v_accvgpr_write_b32 a62, v166
    v_accvgpr_write_b32 a63, v167
    v_exp_f32 v160, v32
    v_exp_f32 v161, v33
    v_exp_f32 v162, v34
    v_cvt_pk_bf16_f32 v96, v160, v161
    v_exp_f32 v163, v35
    v_exp_f32 v164, v36
    v_cvt_pk_bf16_f32 v97, v162, v163
    v_exp_f32 v165, v37
    v_exp_f32 v166, v38
    v_cvt_pk_bf16_f32 v98, v164, v165
    v_exp_f32 v167, v39
    v_or3_b32 v174, v96, v97, v98
    v_exp_f32 v160, v40
    v_cvt_pk_bf16_f32 v99, v166, v167
    v_exp_f32 v161, v41
    v_exp_f32 v162, v42
    v_cvt_pk_bf16_f32 v100, v160, v161
    v_exp_f32 v163, v43
    v_or3_b32 v174, v174, v99, v100
    v_exp_f32 v164, v44
    v_cvt_pk_bf16_f32 v101, v162, v163
    v_exp_f32 v165, v45
    v_exp_f32 v166, v46
    v_cvt_pk_bf16_f32 v102, v164, v165
    v_exp_f32 v167, v47
    v_or3_b32 v174, v174, v101, v102
    v_cvt_pk_bf16_f32 v103, v166, v167
    v_or_b32 v174, v174, v103
    v_and_b32 v174, s39, v174
    s_nop 1
    s_branch KB_SL5R
KB_SL6:
    s_nop 15
    v_max3_f32 v176, v48, v49, v50
    v_max3_f32 v176, v176, v51, v52
    v_max3_f32 v176, v176, v53, v54
    v_max_f32 v176, v176, v55
    v_mov_b32 v177, v176
    s_nop 1
    v_permlane32_swap_b32 v176, v177
    v_max_f32 v176, v176, v177
    v_mov_b32 v177, v176
    s_nop 1
    v_permlane16_swap_b32 v176, v177
    v_max_f32 v176, v176, v177
    v_sub_f32 v176, v176, v248
    v_max_f32 v176, 0, v176
    v_exp_f32 v178, -v176
    v_sub_f32 v136, v136, v176
    v_sub_f32 v137, v137, v176
    v_sub_f32 v138, v138, v176
    v_sub_f32 v139, v139, v176
    v_sub_f32 v48, v48, v176
    v_sub_f32 v49, v49, v176
    v_sub_f32 v50, v50, v176
    v_sub_f32 v51, v51, v176
    v_sub_f32 v52, v52, v176
    v_sub_f32 v53, v53, v176
    v_sub_f32 v54, v54, v176
    v_sub_f32 v55, v55, v176
    v_sub_f32 v80, v80, v176
    v_sub_f32 v81, v81, v176
    v_sub_f32 v82, v82, v176
    v_sub_f32 v83, v83, v176
    v_sub_f32 v84, v84, v176
    v_sub_f32 v85, v85, v176
    v_sub_f32 v86, v86, v176
    v_sub_f32 v87, v87, v176
    v_mul_f32 v28, v28, v178
    v_mul_f32 v29, v29, v178
    v_mul_f32 v30, v30, v178
    v_mul_f32 v31, v31, v178
    v_accvgpr_read_b32 v160, a64
    v_accvgpr_read_b32 v161, a65
    v_accvgpr_read_b32 v162, a66
    v_accvgpr_read_b32 v163, a67
    v_accvgpr_read_b32 v164, a68
    v_accvgpr_read_b32 v165, a69
    v_accvgpr_read_b32 v166, a70
    v_accvgpr_read_b32 v167, a71
    v_mul_f32 v160, v160, v178
    v_mul_f32 v161, v161, v178
    v_mul_f32 v162, v162, v178
    v_mul_f32 v163, v163, v178
    v_mul_f32 v164, v164, v178
    v_mul_f32 v165, v165, v178
    v_mul_f32 v166, v166, v178
    v_mul_f32 v167, v167, v178
    v_accvgpr_write_b32 a64, v160
    v_accvgpr_write_b32 a65, v161
    v_accvgpr_write_b32 a66, v162
    v_accvgpr_write_b32 a67, v163
    v_accvgpr_write_b32 a68, v164
    v_accvgpr_write_b32 a69, v165
    v_accvgpr_write_b32 a70, v166
    v_accvgpr_write_b32 a71, v167
    v_accvgpr_read_b32 v160, a72
    v_accvgpr_read_b32 v161, a73
    v_accvgpr_read_b32 v162, a74
    v_accvgpr_read_b32 v163, a75
    v_accvgpr_read_b32 v164, a76
    v_accvgpr_read_b32 v165, a77
    v_accvgpr_read_b32 v166, a78
    v_accvgpr_read_b32 v167, a79
    v_mul_f32 v160, v160, v178
    v_mul_f32 v161, v161, v178
    v_mul_f32 v162, v162, v178
    v_mul_f32 v163, v163, v178
    v_mul_f32 v164, v164, v178
    v_mul_f32 v165, v165, v178
    v_mul_f32 v166, v166, v178
    v_mul_f32 v167, v167, v178
    v_accvgpr_write_b32 a72, v160
    v_accvgpr_write_b32 a73, v161
    v_accvgpr_write_b32 a74, v162
    v_accvgpr_write_b32 a75, v163
    v_accvgpr_write_b32 a76, v164
    v_accvgpr_write_b32 a77, v165
    v_accvgpr_write_b32 a78, v166
    v_accvgpr_write_b32 a79, v167
    v_accvgpr_read_b32 v160, a96
    v_accvgpr_read_b32 v161, a97
    v_accvgpr_read_b32 v162, a98
    v_accvgpr_read_b32 v163, a99
    v_accvgpr_read_b32 v164, a100
    v_accvgpr_read_b32 v165, a101
    v_accvgpr_read_b32 v166, a102
    v_accvgpr_read_b32 v167, a103
    v_mul_f32 v160, v160, v178
    v_mul_f32 v161, v161, v178
    v_mul_f32 v162, v162, v178
    v_mul_f32 v163, v163, v178
    v_mul_f32 v164, v164, v178
    v_mul_f32 v165, v165, v178
    v_mul_f32 v166, v166, v178
    v_mul_f32 v167, v167, v178
    v_accvgpr_write_b32 a96, v160
    v_accvgpr_write_b32 a97, v161
    v_accvgpr_write_b32 a98, v162
    v_accvgpr_write_b32 a99, v163
    v_accvgpr_write_b32 a100, v164
    v_accvgpr_write_b32 a101, v165
    v_accvgpr_write_b32 a102, v166
    v_accvgpr_write_b32 a103, v167
    v_accvgpr_read_b32 v160, a104
    v_accvgpr_read_b32 v161, a105
    v_accvgpr_read_b32 v162, a106
    v_accvgpr_read_b32 v163, a107
    v_accvgpr_read_b32 v164, a108
    v_accvgpr_read_b32 v165, a109
    v_accvgpr_read_b32 v166, a110
    v_accvgpr_read_b32 v167, a111
    v_mul_f32 v160, v160, v178
    v_mul_f32 v161, v161, v178
    v_mul_f32 v162, v162, v178
    v_mul_f32 v163, v163, v178
    v_mul_f32 v164, v164, v178
    v_mul_f32 v165, v165, v178
    v_mul_f32 v166, v166, v178
    v_mul_f32 v167, v167, v178
    v_accvgpr_write_b32 a104, v160
    v_accvgpr_write_b32 a105, v161
    v_accvgpr_write_b32 a106, v162
    v_accvgpr_write_b32 a107, v163
    v_accvgpr_write_b32 a108, v164
    v_accvgpr_write_b32 a109, v165
    v_accvgpr_write_b32 a110, v166
    v_accvgpr_write_b32 a111, v167
    v_max3_f32 v176, v56, v57, v58
    v_max3_f32 v176, v176, v59, v60
    v_max3_f32 v176, v176, v61, v62
    v_max_f32 v176, v176, v63
    v_mov_b32 v177, v176
    s_nop 1
    v_permlane32_swap_b32 v176, v177
    v_max_f32 v176, v176, v177
    v_mov_b32 v177, v176
    s_nop 1
    v_permlane16_swap_b32 v176, v177
    v_max_f32 v176, v176, v177
    v_sub_f32 v176, v176, v248
    v_max_f32 v176, 0, v176
    v_exp_f32 v178, -v176
    v_sub_f32 v140, v140, v176
    v_sub_f32 v141, v141, v176
    v_sub_f32 v142, v142, v176
    v_sub_f32 v143, v143, v176
    v_sub_f32 v56, v56, v176
    v_sub_f32 v57, v57, v176
    v_sub_f32 v58, v58, v176
    v_sub_f32 v59, v59, v176
    v_sub_f32 v60, v60, v176
    v_sub_f32 v61, v61, v176
    v_sub_f32 v62, v62, v176
    v_sub_f32 v63, v63, v176
    v_sub_f32 v88, v88, v176
    v_sub_f32 v89, v89, v176
    v_sub_f32 v90, v90, v176
    v_sub_f32 v91, v91, v176
    v_sub_f32 v92, v92, v176
    v_sub_f32 v93, v93, v176
    v_sub_f32 v94, v94, v176
    v_sub_f32 v95, v95, v176
    v_mul_f32 v168, v168, v178
    v_mul_f32 v169, v169, v178
    v_mul_f32 v170, v170, v178
    v_mul_f32 v171, v171, v178
    v_accvgpr_read_b32 v160, a80
    v_accvgpr_read_b32 v161, a81
    v_accvgpr_read_b32 v162, a82
    v_accvgpr_read_b32 v163, a83
    v_accvgpr_read_b32 v164, a84
    v_accvgpr_read_b32 v165, a85
    v_accvgpr_read_b32 v166, a86
    v_accvgpr_read_b32 v167, a87
    v_mul_f32 v160, v160, v178
    v_mul_f32 v161, v161, v178
    v_mul_f32 v162, v162, v178
    v_mul_f32 v163, v163, v178
    v_mul_f32 v164, v164, v178
    v_mul_f32 v165, v165, v178
    v_mul_f32 v166, v166, v178
    v_mul_f32 v167, v167, v178
    v_accvgpr_write_b32 a80, v160
    v_accvgpr_write_b32 a81, v161
    v_accvgpr_write_b32 a82, v162
    v_accvgpr_write_b32 a83, v163
    v_accvgpr_write_b32 a84, v164
    v_accvgpr_write_b32 a85, v165
    v_accvgpr_write_b32 a86, v166
    v_accvgpr_write_b32 a87, v167
    v_accvgpr_read_b32 v160, a88
    v_accvgpr_read_b32 v161, a89
    v_accvgpr_read_b32 v162, a90
    v_accvgpr_read_b32 v163, a91
    v_accvgpr_read_b32 v164, a92
    v_accvgpr_read_b32 v165, a93
    v_accvgpr_read_b32 v166, a94
    v_accvgpr_read_b32 v167, a95
    v_mul_f32 v160, v160, v178
    v_mul_f32 v161, v161, v178
    v_mul_f32 v162, v162, v178
    v_mul_f32 v163, v163, v178
    v_mul_f32 v164, v164, v178
    v_mul_f32 v165, v165, v178
    v_mul_f32 v166, v166, v178
    v_mul_f32 v167, v167, v178
    v_accvgpr_write_b32 a88, v160
    v_accvgpr_write_b32 a89, v161
    v_accvgpr_write_b32 a90, v162
    v_accvgpr_write_b32 a91, v163
    v_accvgpr_write_b32 a92, v164
    v_accvgpr_write_b32 a93, v165
    v_accvgpr_write_b32 a94, v166
    v_accvgpr_write_b32 a95, v167
    v_accvgpr_read_b32 v160, a112
    v_accvgpr_read_b32 v161, a113
    v_accvgpr_read_b32 v162, a114
    v_accvgpr_read_b32 v163, a115
    v_accvgpr_read_b32 v164, a116
    v_accvgpr_read_b32 v165, a117
    v_accvgpr_read_b32 v166, a118
    v_accvgpr_read_b32 v167, a119
    v_mul_f32 v160, v160, v178
    v_mul_f32 v161, v161, v178
    v_mul_f32 v162, v162, v178
    v_mul_f32 v163, v163, v178
    v_mul_f32 v164, v164, v178
    v_mul_f32 v165, v165, v178
    v_mul_f32 v166, v166, v178
    v_mul_f32 v167, v167, v178
    v_accvgpr_write_b32 a112, v160
    v_accvgpr_write_b32 a113, v161
    v_accvgpr_write_b32 a114, v162
    v_accvgpr_write_b32 a115, v163
    v_accvgpr_write_b32 a116, v164
    v_accvgpr_write_b32 a117, v165
    v_accvgpr_write_b32 a118, v166
    v_accvgpr_write_b32 a119, v167
    v_accvgpr_read_b32 v160, a120
    v_accvgpr_read_b32 v161, a121
    v_accvgpr_read_b32 v162, a122
    v_accvgpr_read_b32 v163, a123
    v_accvgpr_read_b32 v164, a124
    v_accvgpr_read_b32 v165, a125
    v_accvgpr_read_b32 v166, a126
    v_accvgpr_read_b32 v167, a127
    v_mul_f32 v160, v160, v178
    v_mul_f32 v161, v161, v178
    v_mul_f32 v162, v162, v178
    v_mul_f32 v163, v163, v178
    v_mul_f32 v164, v164, v178
    v_mul_f32 v165, v165, v178
    v_mul_f32 v166, v166, v178
    v_mul_f32 v167, v167, v178
    v_accvgpr_write_b32 a120, v160
    v_accvgpr_write_b32 a121, v161
    v_accvgpr_write_b32 a122, v162
    v_accvgpr_write_b32 a123, v163
    v_accvgpr_write_b32 a124, v164
    v_accvgpr_write_b32 a125, v165
    v_accvgpr_write_b32 a126, v166
    v_accvgpr_write_b32 a127, v167
    v_exp_f32 v160, v48
    v_exp_f32 v161, v49
    v_exp_f32 v162, v50
    v_cvt_pk_bf16_f32 v104, v160, v161
    v_exp_f32 v163, v51
    v_exp_f32 v164, v52
    v_cvt_pk_bf16_f32 v105, v162, v163
    v_exp_f32 v165, v53
    v_exp_f32 v166, v54
    v_cvt_pk_bf16_f32 v106, v164, v165
    v_exp_f32 v167, v55
    v_or3_b32 v174, v104, v105, v106
    v_exp_f32 v160, v56
    v_cvt_pk_bf16_f32 v107, v166, v167
    v_exp_f32 v161, v57
    v_exp_f32 v162, v58
    v_cvt_pk_bf16_f32 v108, v160, v161
    v_exp_f32 v163, v59
    v_or3_b32 v174, v174, v107, v108
    v_exp_f32 v164, v60
    v_cvt_pk_bf16_f32 v109, v162, v163
    v_exp_f32 v165, v61
    v_exp_f32 v166, v62
    v_cvt_pk_bf16_f32 v110, v164, v165
    v_exp_f32 v167, v63
    v_or3_b32 v174, v174, v109, v110
    v_cvt_pk_bf16_f32 v111, v166, v167
    v_or_b32 v174, v174, v111
    v_and_b32 v174, s39, v174
    s_nop 1
    s_branch KB_SL6R
KB_SL7:
    s_nop 15
    v_max3_f32 v176, v64, v65, v66
    v_max3_f32 v176, v176, v67, v68
    v_max3_f32 v176, v176, v69, v70
    v_max_f32 v176, v176, v71
    v_mov_b32 v177, v176
    s_nop 1
    v_permlane32_swap_b32 v176, v177
    v_max_f32 v176, v176, v177
    v_mov_b32 v177, v176
    s_nop 1
    v_permlane16_swap_b32 v176, v177
    v_max_f32 v176, v176, v177
    v_sub_f32 v176, v176, v248
    v_max_f32 v176, 0, v176
    v_exp_f32 v178, -v176
    v_sub_f32 v128, v128, v176
    v_sub_f32 v129, v129, v176
    v_sub_f32 v130, v130, v176
    v_sub_f32 v131, v131, v176
    v_sub_f32 v64, v64, v176
    v_sub_f32 v65, v65, v176
    v_sub_f32 v66, v66, v176
    v_sub_f32 v67, v67, v176
    v_sub_f32 v68, v68, v176
    v_sub_f32 v69, v69, v176
    v_sub_f32 v70, v70, v176
    v_sub_f32 v71, v71, v176
    v_mul_f32 v20, v20, v178
    v_mul_f32 v21, v21, v178
    v_mul_f32 v22, v22, v178
    v_mul_f32 v23, v23, v178
    v_accvgpr_read_b32 v160, a0
    v_accvgpr_read_b32 v161, a1
    v_accvgpr_read_b32 v162, a2
    v_accvgpr_read_b32 v163, a3
    v_accvgpr_read_b32 v164, a4
    v_accvgpr_read_b32 v165, a5
    v_accvgpr_read_b32 v166, a6
    v_accvgpr_read_b32 v167, a7
    v_mul_f32 v160, v160, v178
    v_mul_f32 v161, v161, v178
    v_mul_f32 v162, v162, v178
    v_mul_f32 v163, v163, v178
    v_mul_f32 v164, v164, v178
    v_mul_f32 v165, v165, v178
    v_mul_f32 v166, v166, v178
    v_mul_f32 v167, v167, v178
    v_accvgpr_write_b32 a0, v160
    v_accvgpr_write_b32 a1, v161
    v_accvgpr_write_b32 a2, v162
    v_accvgpr_write_b32 a3, v163
    v_accvgpr_write_b32 a4, v164
    v_accvgpr_write_b32 a5, v165
    v_accvgpr_write_b32 a6, v166
    v_accvgpr_write_b32 a7, v167
    v_accvgpr_read_b32 v160, a8
    v_accvgpr_read_b32 v161, a9
    v_accvgpr_read_b32 v162, a10
    v_accvgpr_read_b32 v163, a11
    v_accvgpr_read_b32 v164, a12
    v_accvgpr_read_b32 v165, a13
    v_accvgpr_read_b32 v166, a14
    v_accvgpr_read_b32 v167, a15
    v_mul_f32 v160, v160, v178
    v_mul_f32 v161, v161, v178
    v_mul_f32 v162, v162, v178
    v_mul_f32 v163, v163, v178
    v_mul_f32 v164, v164, v178
    v_mul_f32 v165, v165, v178
    v_mul_f32 v166, v166, v178
    v_mul_f32 v167, v167, v178
    v_accvgpr_write_b32 a8, v160
    v_accvgpr_write_b32 a9, v161
    v_accvgpr_write_b32 a10, v162
    v_accvgpr_write_b32 a11, v163
    v_accvgpr_write_b32 a12, v164
    v_accvgpr_write_b32 a13, v165
    v_accvgpr_write_b32 a14, v166
    v_accvgpr_write_b32 a15, v167
    v_accvgpr_read_b32 v160, a32
    v_accvgpr_read_b32 v161, a33
    v_accvgpr_read_b32 v162, a34
    v_accvgpr_read_b32 v163, a35
    v_accvgpr_read_b32 v164, a36
    v_accvgpr_read_b32 v165, a37
    v_accvgpr_read_b32 v166, a38
    v_accvgpr_read_b32 v167, a39
    v_mul_f32 v160, v160, v178
    v_mul_f32 v161, v161, v178
    v_mul_f32 v162, v162, v178
    v_mul_f32 v163, v163, v178
    v_mul_f32 v164, v164, v178
    v_mul_f32 v165, v165, v178
    v_mul_f32 v166, v166, v178
    v_mul_f32 v167, v167, v178
    v_accvgpr_write_b32 a32, v160
    v_accvgpr_write_b32 a33, v161
    v_accvgpr_write_b32 a34, v162
    v_accvgpr_write_b32 a35, v163
    v_accvgpr_write_b32 a36, v164
    v_accvgpr_write_b32 a37, v165
    v_accvgpr_write_b32 a38, v166
    v_accvgpr_write_b32 a39, v167
    v_accvgpr_read_b32 v160, a40
    v_accvgpr_read_b32 v161, a41
    v_accvgpr_read_b32 v162, a42
    v_accvgpr_read_b32 v163, a43
    v_accvgpr_read_b32 v164, a44
    v_accvgpr_read_b32 v165, a45
    v_accvgpr_read_b32 v166, a46
    v_accvgpr_read_b32 v167, a47
    v_mul_f32 v160, v160, v178
    v_mul_f32 v161, v161, v178
    v_mul_f32 v162, v162, v178
    v_mul_f32 v163, v163, v178
    v_mul_f32 v164, v164, v178
    v_mul_f32 v165, v165, v178
    v_mul_f32 v166, v166, v178
    v_mul_f32 v167, v167, v178
    v_accvgpr_write_b32 a40, v160
    v_accvgpr_write_b32 a41, v161
    v_accvgpr_write_b32 a42, v162
    v_accvgpr_write_b32 a43, v163
    v_accvgpr_write_b32 a44, v164
    v_accvgpr_write_b32 a45, v165
    v_accvgpr_write_b32 a46, v166
    v_accvgpr_write_b32 a47, v167
    v_max3_f32 v176, v72, v73, v74
    v_max3_f32 v176, v176, v75, v76
    v_max3_f32 v176, v176, v77, v78
    v_max_f32 v176, v176, v79
    v_mov_b32 v177, v176
    s_nop 1
    v_permlane32_swap_b32 v176, v177
    v_max_f32 v176, v176, v177
    v_mov_b32 v177, v176
    s_nop 1
    v_permlane16_swap_b32 v176, v177
    v_max_f32 v176, v176, v177
    v_sub_f32 v176, v176, v248
    v_max_f32 v176, 0, v176
    v_exp_f32 v178, -v176
    v_sub_f32 v132, v132, v176
    v_sub_f32 v133, v133, v176
    v_sub_f32 v134, v134, v176
    v_sub_f32 v135, v135, v176
    v_sub_f32 v72, v72, v176
    v_sub_f32 v73, v73, v176
    v_sub_f32 v74, v74, v176
    v_sub_f32 v75, v75, v176
    v_sub_f32 v76, v76, v176
    v_sub_f32 v77, v77, v176
    v_sub_f32 v78, v78, v176
    v_sub_f32 v79, v79, v176
    v_mul_f32 v24, v24, v178
    v_mul_f32 v25, v25, v178
    v_mul_f32 v26, v26, v178
    v_mul_f32 v27, v27, v178
    v_accvgpr_read_b32 v160, a16
    v_accvgpr_read_b32 v161, a17
    v_accvgpr_read_b32 v162, a18
    v_accvgpr_read_b32 v163, a19
    v_accvgpr_read_b32 v164, a20
    v_accvgpr_read_b32 v165, a21
    v_accvgpr_read_b32 v166, a22
    v_accvgpr_read_b32 v167, a23
    v_mul_f32 v160, v160, v178
    v_mul_f32 v161, v161, v178
    v_mul_f32 v162, v162, v178
    v_mul_f32 v163, v163, v178
    v_mul_f32 v164, v164, v178
    v_mul_f32 v165, v165, v178
    v_mul_f32 v166, v166, v178
    v_mul_f32 v167, v167, v178
    v_accvgpr_write_b32 a16, v160
    v_accvgpr_write_b32 a17, v161
    v_accvgpr_write_b32 a18, v162
    v_accvgpr_write_b32 a19, v163
    v_accvgpr_write_b32 a20, v164
    v_accvgpr_write_b32 a21, v165
    v_accvgpr_write_b32 a22, v166
    v_accvgpr_write_b32 a23, v167
    v_accvgpr_read_b32 v160, a24
    v_accvgpr_read_b32 v161, a25
    v_accvgpr_read_b32 v162, a26
    v_accvgpr_read_b32 v163, a27
    v_accvgpr_read_b32 v164, a28
    v_accvgpr_read_b32 v165, a29
    v_accvgpr_read_b32 v166, a30
    v_accvgpr_read_b32 v167, a31
    v_mul_f32 v160, v160, v178
    v_mul_f32 v161, v161, v178
    v_mul_f32 v162, v162, v178
    v_mul_f32 v163, v163, v178
    v_mul_f32 v164, v164, v178
    v_mul_f32 v165, v165, v178
    v_mul_f32 v166, v166, v178
    v_mul_f32 v167, v167, v178
    v_accvgpr_write_b32 a24, v160
    v_accvgpr_write_b32 a25, v161
    v_accvgpr_write_b32 a26, v162
    v_accvgpr_write_b32 a27, v163
    v_accvgpr_write_b32 a28, v164
    v_accvgpr_write_b32 a29, v165
    v_accvgpr_write_b32 a30, v166
    v_accvgpr_write_b32 a31, v167
    v_accvgpr_read_b32 v160, a48
    v_accvgpr_read_b32 v161, a49
    v_accvgpr_read_b32 v162, a50
    v_accvgpr_read_b32 v163, a51
    v_accvgpr_read_b32 v164, a52
    v_accvgpr_read_b32 v165, a53
    v_accvgpr_read_b32 v166, a54
    v_accvgpr_read_b32 v167, a55
    v_mul_f32 v160, v160, v178
    v_mul_f32 v161, v161, v178
    v_mul_f32 v162, v162, v178
    v_mul_f32 v163, v163, v178
    v_mul_f32 v164, v164, v178
    v_mul_f32 v165, v165, v178
    v_mul_f32 v166, v166, v178
    v_mul_f32 v167, v167, v178
    v_accvgpr_write_b32 a48, v160
    v_accvgpr_write_b32 a49, v161
    v_accvgpr_write_b32 a50, v162
    v_accvgpr_write_b32 a51, v163
    v_accvgpr_write_b32 a52, v164
    v_accvgpr_write_b32 a53, v165
    v_accvgpr_write_b32 a54, v166
    v_accvgpr_write_b32 a55, v167
    v_accvgpr_read_b32 v160, a56
    v_accvgpr_read_b32 v161, a57
    v_accvgpr_read_b32 v162, a58
    v_accvgpr_read_b32 v163, a59
    v_accvgpr_read_b32 v164, a60
    v_accvgpr_read_b32 v165, a61
    v_accvgpr_read_b32 v166, a62
    v_accvgpr_read_b32 v167, a63
    v_mul_f32 v160, v160, v178
    v_mul_f32 v161, v161, v178
    v_mul_f32 v162, v162, v178
    v_mul_f32 v163, v163, v178
    v_mul_f32 v164, v164, v178
    v_mul_f32 v165, v165, v178
    v_mul_f32 v166, v166, v178
    v_mul_f32 v167, v167, v178
    v_accvgpr_write_b32 a56, v160
    v_accvgpr_write_b32 a57, v161
    v_accvgpr_write_b32 a58, v162
    v_accvgpr_write_b32 a59, v163
    v_accvgpr_write_b32 a60, v164
    v_accvgpr_write_b32 a61, v165
    v_accvgpr_write_b32 a62, v166
    v_accvgpr_write_b32 a63, v167
    v_exp_f32 v160, v64
    v_exp_f32 v161, v65
    v_exp_f32 v162, v66
    v_cvt_pk_bf16_f32 v112, v160, v161
    v_exp_f32 v163, v67
    v_exp_f32 v164, v68
    v_cvt_pk_bf16_f32 v113, v162, v163
    v_exp_f32 v165, v69
    v_exp_f32 v166, v70
    v_cvt_pk_bf16_f32 v114, v164, v165
    v_exp_f32 v167, v71
    v_or3_b32 v174, v112, v113, v114
    v_exp_f32 v160, v72
    v_cvt_pk_bf16_f32 v115, v166, v167
    v_exp_f32 v161, v73
    v_exp_f32 v162, v74
    v_cvt_pk_bf16_f32 v116, v160, v161
    v_exp_f32 v163, v75
    v_or3_b32 v174, v174, v115, v116
    v_exp_f32 v164, v76
    v_cvt_pk_bf16_f32 v117, v162, v163
    v_exp_f32 v165, v77
    v_exp_f32 v166, v78
    v_cvt_pk_bf16_f32 v118, v164, v165
    v_exp_f32 v167, v79
    v_or3_b32 v174, v174, v117, v118
    v_cvt_pk_bf16_f32 v119, v166, v167
    v_or_b32 v174, v174, v119
    v_and_b32 v174, s39, v174
    s_nop 1
    s_branch KB_SL7R
KB_SL8:
    s_nop 15
    v_max3_f32 v176, v80, v81, v82
    v_max3_f32 v176, v176, v83, v84
    v_max3_f32 v176, v176, v85, v86
    v_max_f32 v176, v176, v87
    v_mov_b32 v177, v176
    s_nop 1
    v_permlane32_swap_b32 v176, v177
    v_max_f32 v176, v176, v177
    v_mov_b32 v177, v176
    s_nop 1
    v_permlane16_swap_b32 v176, v177
    v_max_f32 v176, v176, v177
    v_sub_f32 v176, v176, v248
    v_max_f32 v176, 0, v176
    v_exp_f32 v178, -v176
    v_sub_f32 v136, v136, v176
    v_sub_f32 v137, v137, v176
    v_sub_f32 v138, v138, v176
    v_sub_f32 v139, v139, v176
    v_sub_f32 v80, v80, v176
    v_sub_f32 v81, v81, v176
    v_sub_f32 v82, v82, v176
    v_sub_f32 v83, v83, v176
    v_sub_f32 v84, v84, v176
    v_sub_f32 v85, v85, v176
    v_sub_f32 v86, v86, v176
    v_sub_f32 v87, v87, v176
    v_sub_f32 v48, v48, v176
    v_sub_f32 v49, v49, v176
    v_sub_f32 v50, v50, v176
    v_sub_f32 v51, v51, v176
    v_sub_f32 v52, v52, v176
    v_sub_f32 v53, v53, v176
    v_sub_f32 v54, v54, v176
    v_sub_f32 v55, v55, v176
    v_mul_f32 v28, v28, v178
    v_mul_f32 v29, v29, v178
    v_mul_f32 v30, v30, v178
    v_mul_f32 v31, v31, v178
    v_accvgpr_read_b32 v160, a64
    v_accvgpr_read_b32 v161, a65
    v_accvgpr_read_b32 v162, a66
    v_accvgpr_read_b32 v163, a67
    v_accvgpr_read_b32 v164, a68
    v_accvgpr_read_b32 v165, a69
    v_accvgpr_read_b32 v166, a70
    v_accvgpr_read_b32 v167, a71
    v_mul_f32 v160, v160, v178
    v_mul_f32 v161, v161, v178
    v_mul_f32 v162, v162, v178
    v_mul_f32 v163, v163, v178
    v_mul_f32 v164, v164, v178
    v_mul_f32 v165, v165, v178
    v_mul_f32 v166, v166, v178
    v_mul_f32 v167, v167, v178
    v_accvgpr_write_b32 a64, v160
    v_accvgpr_write_b32 a65, v161
    v_accvgpr_write_b32 a66, v162
    v_accvgpr_write_b32 a67, v163
    v_accvgpr_write_b32 a68, v164
    v_accvgpr_write_b32 a69, v165
    v_accvgpr_write_b32 a70, v166
    v_accvgpr_write_b32 a71, v167
    v_accvgpr_read_b32 v160, a72
    v_accvgpr_read_b32 v161, a73
    v_accvgpr_read_b32 v162, a74
    v_accvgpr_read_b32 v163, a75
    v_accvgpr_read_b32 v164, a76
    v_accvgpr_read_b32 v165, a77
    v_accvgpr_read_b32 v166, a78
    v_accvgpr_read_b32 v167, a79
    v_mul_f32 v160, v160, v178
    v_mul_f32 v161, v161, v178
    v_mul_f32 v162, v162, v178
    v_mul_f32 v163, v163, v178
    v_mul_f32 v164, v164, v178
    v_mul_f32 v165, v165, v178
    v_mul_f32 v166, v166, v178
    v_mul_f32 v167, v167, v178
    v_accvgpr_write_b32 a72, v160
    v_accvgpr_write_b32 a73, v161
    v_accvgpr_write_b32 a74, v162
    v_accvgpr_write_b32 a75, v163
    v_accvgpr_write_b32 a76, v164
    v_accvgpr_write_b32 a77, v165
    v_accvgpr_write_b32 a78, v166
    v_accvgpr_write_b32 a79, v167
    v_accvgpr_read_b32 v160, a96
    v_accvgpr_read_b32 v161, a97
    v_accvgpr_read_b32 v162, a98
    v_accvgpr_read_b32 v163, a99
    v_accvgpr_read_b32 v164, a100
    v_accvgpr_read_b32 v165, a101
    v_accvgpr_read_b32 v166, a102
    v_accvgpr_read_b32 v167, a103
    v_mul_f32 v160, v160, v178
    v_mul_f32 v161, v161, v178
    v_mul_f32 v162, v162, v178
    v_mul_f32 v163, v163, v178
    v_mul_f32 v164, v164, v178
    v_mul_f32 v165, v165, v178
    v_mul_f32 v166, v166, v178
    v_mul_f32 v167, v167, v178
    v_accvgpr_write_b32 a96, v160
    v_accvgpr_write_b32 a97, v161
    v_accvgpr_write_b32 a98, v162
    v_accvgpr_write_b32 a99, v163
    v_accvgpr_write_b32 a100, v164
    v_accvgpr_write_b32 a101, v165
    v_accvgpr_write_b32 a102, v166
    v_accvgpr_write_b32 a103, v167
    v_accvgpr_read_b32 v160, a104
    v_accvgpr_read_b32 v161, a105
    v_accvgpr_read_b32 v162, a106
    v_accvgpr_read_b32 v163, a107
    v_accvgpr_read_b32 v164, a108
    v_accvgpr_read_b32 v165, a109
    v_accvgpr_read_b32 v166, a110
    v_accvgpr_read_b32 v167, a111
    v_mul_f32 v160, v160, v178
    v_mul_f32 v161, v161, v178
    v_mul_f32 v162, v162, v178
    v_mul_f32 v163, v163, v178
    v_mul_f32 v164, v164, v178
    v_mul_f32 v165, v165, v178
    v_mul_f32 v166, v166, v178
    v_mul_f32 v167, v167, v178
    v_accvgpr_write_b32 a104, v160
    v_accvgpr_write_b32 a105, v161
    v_accvgpr_write_b32 a106, v162
    v_accvgpr_write_b32 a107, v163
    v_accvgpr_write_b32 a108, v164
    v_accvgpr_write_b32 a109, v165
    v_accvgpr_write_b32 a110, v166
    v_accvgpr_write_b32 a111, v167
    v_max3_f32 v176, v88, v89, v90
    v_max3_f32 v176, v176, v91, v92
    v_max3_f32 v176, v176, v93, v94
    v_max_f32 v176, v176, v95
    v_mov_b32 v177, v176
    s_nop 1
    v_permlane32_swap_b32 v176, v177
    v_max_f32 v176, v176, v177
    v_mov_b32 v177, v176
    s_nop 1
    v_permlane16_swap_b32 v176, v177
    v_max_f32 v176, v176, v177
    v_sub_f32 v176, v176, v248
    v_max_f32 v176, 0, v176
    v_exp_f32 v178, -v176
    v_sub_f32 v140, v140, v176
    v_sub_f32 v141, v141, v176
    v_sub_f32 v142, v142, v176
    v_sub_f32 v143, v143, v176
    v_sub_f32 v88, v88, v176
    v_sub_f32 v89, v89, v176
    v_sub_f32 v90, v90, v176
    v_sub_f32 v91, v91, v176
    v_sub_f32 v92, v92, v176
    v_sub_f32 v93, v93, v176
    v_sub_f32 v94, v94, v176
    v_sub_f32 v95, v95, v176
    v_sub_f32 v56, v56, v176
    v_sub_f32 v57, v57, v176
    v_sub_f32 v58, v58, v176
    v_sub_f32 v59, v59, v176
    v_sub_f32 v60, v60, v176
    v_sub_f32 v61, v61, v176
    v_sub_f32 v62, v62, v176
    v_sub_f32 v63, v63, v176
    v_mul_f32 v168, v168, v178
    v_mul_f32 v169, v169, v178
    v_mul_f32 v170, v170, v178
    v_mul_f32 v171, v171, v178
    v_accvgpr_read_b32 v160, a80
    v_accvgpr_read_b32 v161, a81
    v_accvgpr_read_b32 v162, a82
    v_accvgpr_read_b32 v163, a83
    v_accvgpr_read_b32 v164, a84
    v_accvgpr_read_b32 v165, a85
    v_accvgpr_read_b32 v166, a86
    v_accvgpr_read_b32 v167, a87
    v_mul_f32 v160, v160, v178
    v_mul_f32 v161, v161, v178
    v_mul_f32 v162, v162, v178
    v_mul_f32 v163, v163, v178
    v_mul_f32 v164, v164, v178
    v_mul_f32 v165, v165, v178
    v_mul_f32 v166, v166, v178
    v_mul_f32 v167, v167, v178
    v_accvgpr_write_b32 a80, v160
    v_accvgpr_write_b32 a81, v161
    v_accvgpr_write_b32 a82, v162
    v_accvgpr_write_b32 a83, v163
    v_accvgpr_write_b32 a84, v164
    v_accvgpr_write_b32 a85, v165
    v_accvgpr_write_b32 a86, v166
    v_accvgpr_write_b32 a87, v167
    v_accvgpr_read_b32 v160, a88
    v_accvgpr_read_b32 v161, a89
    v_accvgpr_read_b32 v162, a90
    v_accvgpr_read_b32 v163, a91
    v_accvgpr_read_b32 v164, a92
    v_accvgpr_read_b32 v165, a93
    v_accvgpr_read_b32 v166, a94
    v_accvgpr_read_b32 v167, a95
    v_mul_f32 v160, v160, v178
    v_mul_f32 v161, v161, v178
    v_mul_f32 v162, v162, v178
    v_mul_f32 v163, v163, v178
    v_mul_f32 v164, v164, v178
    v_mul_f32 v165, v165, v178
    v_mul_f32 v166, v166, v178
    v_mul_f32 v167, v167, v178
    v_accvgpr_write_b32 a88, v160
    v_accvgpr_write_b32 a89, v161
    v_accvgpr_write_b32 a90, v162
    v_accvgpr_write_b32 a91, v163
    v_accvgpr_write_b32 a92, v164
    v_accvgpr_write_b32 a93, v165
    v_accvgpr_write_b32 a94, v166
    v_accvgpr_write_b32 a95, v167
    v_accvgpr_read_b32 v160, a112
    v_accvgpr_read_b32 v161, a113
    v_accvgpr_read_b32 v162, a114
    v_accvgpr_read_b32 v163, a115
    v_accvgpr_read_b32 v164, a116
    v_accvgpr_read_b32 v165, a117
    v_accvgpr_read_b32 v166, a118
    v_accvgpr_read_b32 v167, a119
    v_mul_f32 v160, v160, v178
    v_mul_f32 v161, v161, v178
    v_mul_f32 v162, v162, v178
    v_mul_f32 v163, v163, v178
    v_mul_f32 v164, v164, v178
    v_mul_f32 v165, v165, v178
    v_mul_f32 v166, v166, v178
    v_mul_f32 v167, v167, v178
    v_accvgpr_write_b32 a112, v160
    v_accvgpr_write_b32 a113, v161
    v_accvgpr_write_b32 a114, v162
    v_accvgpr_write_b32 a115, v163
    v_accvgpr_write_b32 a116, v164
    v_accvgpr_write_b32 a117, v165
    v_accvgpr_write_b32 a118, v166
    v_accvgpr_write_b32 a119, v167
    v_accvgpr_read_b32 v160, a120
    v_accvgpr_read_b32 v161, a121
    v_accvgpr_read_b32 v162, a122
    v_accvgpr_read_b32 v163, a123
    v_accvgpr_read_b32 v164, a124
    v_accvgpr_read_b32 v165, a125
    v_accvgpr_read_b32 v166, a126
    v_accvgpr_read_b32 v167, a127
    v_mul_f32 v160, v160, v178
    v_mul_f32 v161, v161, v178
    v_mul_f32 v162, v162, v178
    v_mul_f32 v163, v163, v178
    v_mul_f32 v164, v164, v178
    v_mul_f32 v165, v165, v178
    v_mul_f32 v166, v166, v178
    v_mul_f32 v167, v167, v178
    v_accvgpr_write_b32 a120, v160
    v_accvgpr_write_b32 a121, v161
    v_accvgpr_write_b32 a122, v162
    v_accvgpr_write_b32 a123, v163
    v_accvgpr_write_b32 a124, v164
    v_accvgpr_write_b32 a125, v165
    v_accvgpr_write_b32 a126, v166
    v_accvgpr_write_b32 a127, v167
    v_exp_f32 v160, v80
    v_exp_f32 v161, v81
    v_exp_f32 v162, v82
    v_cvt_pk_bf16_f32 v120, v160, v161
    v_exp_f32 v163, v83
    v_exp_f32 v164, v84
    v_cvt_pk_bf16_f32 v121, v162, v163
    v_exp_f32 v165, v85
    v_exp_f32 v166, v86
    v_cvt_pk_bf16_f32 v122, v164, v165
    v_exp_f32 v167, v87
    v_or3_b32 v174, v120, v121, v122
    v_exp_f32 v160, v88
    v_cvt_pk_bf16_f32 v123, v166, v167
    v_exp_f32 v161, v89
    v_exp_f32 v162, v90
    v_cvt_pk_bf16_f32 v124, v160, v161
    v_exp_f32 v163, v91
    v_or3_b32 v174, v174, v123, v124
    v_exp_f32 v164, v92
    v_cvt_pk_bf16_f32 v125, v162, v163
    v_exp_f32 v165, v93
    v_exp_f32 v166, v94
    v_cvt_pk_bf16_f32 v126, v164, v165
    v_exp_f32 v167, v95
    v_or3_b32 v174, v174, v125, v126
    v_cvt_pk_bf16_f32 v127, v166, v167
    v_or_b32 v174, v174, v127
    v_and_b32 v174, s39, v174
    s_nop 1
    s_branch KB_SL8R
KB_SL9:
    s_nop 15
    v_max3_f32 v176, v32, v33, v34
    v_max3_f32 v176, v176, v35, v36
    v_max3_f32 v176, v176, v37, v38
    v_max_f32 v176, v176, v39
    v_mov_b32 v177, v176
    s_nop 1
    v_permlane32_swap_b32 v176, v177
    v_max_f32 v176, v176, v177
    v_mov_b32 v177, v176
    s_nop 1
    v_permlane16_swap_b32 v176, v177
    v_max_f32 v176, v176, v177
    v_sub_f32 v176, v176, v248
    v_max_f32 v176, 0, v176
    v_exp_f32 v178, -v176
    v_sub_f32 v128, v128, v176
    v_sub_f32 v129, v129, v176
    v_sub_f32 v130, v130, v176
    v_sub_f32 v131, v131, v176
    v_sub_f32 v32, v32, v176
    v_sub_f32 v33, v33, v176
    v_sub_f32 v34, v34, v176
    v_sub_f32 v35, v35, v176
    v_sub_f32 v36, v36, v176
    v_sub_f32 v37, v37, v176
    v_sub_f32 v38, v38, v176
    v_sub_f32 v39, v39, v176
    v_mul_f32 v20, v20, v178
    v_mul_f32 v21, v21, v178
    v_mul_f32 v22, v22, v178
    v_mul_f32 v23, v23, v178
    v_accvgpr_read_b32 v160, a0
    v_accvgpr_read_b32 v161, a1
    v_accvgpr_read_b32 v162, a2
    v_accvgpr_read_b32 v163, a3
    v_accvgpr_read_b32 v164, a4
    v_accvgpr_read_b32 v165, a5
    v_accvgpr_read_b32 v166, a6
    v_accvgpr_read_b32 v167, a7
    v_mul_f32 v160, v160, v178
    v_mul_f32 v161, v161, v178
    v_mul_f32 v162, v162, v178
    v_mul_f32 v163, v163, v178
    v_mul_f32 v164, v164, v178
    v_mul_f32 v165, v165, v178
    v_mul_f32 v166, v166, v178
    v_mul_f32 v167, v167, v178
    v_accvgpr_write_b32 a0, v160
    v_accvgpr_write_b32 a1, v161
    v_accvgpr_write_b32 a2, v162
    v_accvgpr_write_b32 a3, v163
    v_accvgpr_write_b32 a4, v164
    v_accvgpr_write_b32 a5, v165
    v_accvgpr_write_b32 a6, v166
    v_accvgpr_write_b32 a7, v167
    v_accvgpr_read_b32 v160, a8
    v_accvgpr_read_b32 v161, a9
    v_accvgpr_read_b32 v162, a10
    v_accvgpr_read_b32 v163, a11
    v_accvgpr_read_b32 v164, a12
    v_accvgpr_read_b32 v165, a13
    v_accvgpr_read_b32 v166, a14
    v_accvgpr_read_b32 v167, a15
    v_mul_f32 v160, v160, v178
    v_mul_f32 v161, v161, v178
    v_mul_f32 v162, v162, v178
    v_mul_f32 v163, v163, v178
    v_mul_f32 v164, v164, v178
    v_mul_f32 v165, v165, v178
    v_mul_f32 v166, v166, v178
    v_mul_f32 v167, v167, v178
    v_accvgpr_write_b32 a8, v160
    v_accvgpr_write_b32 a9, v161
    v_accvgpr_write_b32 a10, v162
    v_accvgpr_write_b32 a11, v163
    v_accvgpr_write_b32 a12, v164
    v_accvgpr_write_b32 a13, v165
    v_accvgpr_write_b32 a14, v166
    v_accvgpr_write_b32 a15, v167
    v_accvgpr_read_b32 v160, a32
    v_accvgpr_read_b32 v161, a33
    v_accvgpr_read_b32 v162, a34
    v_accvgpr_read_b32 v163, a35
    v_accvgpr_read_b32 v164, a36
    v_accvgpr_read_b32 v165, a37
    v_accvgpr_read_b32 v166, a38
    v_accvgpr_read_b32 v167, a39
    v_mul_f32 v160, v160, v178
    v_mul_f32 v161, v161, v178
    v_mul_f32 v162, v162, v178
    v_mul_f32 v163, v163, v178
    v_mul_f32 v164, v164, v178
    v_mul_f32 v165, v165, v178
    v_mul_f32 v166, v166, v178
    v_mul_f32 v167, v167, v178
    v_accvgpr_write_b32 a32, v160
    v_accvgpr_write_b32 a33, v161
    v_accvgpr_write_b32 a34, v162
    v_accvgpr_write_b32 a35, v163
    v_accvgpr_write_b32 a36, v164
    v_accvgpr_write_b32 a37, v165
    v_accvgpr_write_b32 a38, v166
    v_accvgpr_write_b32 a39, v167
    v_accvgpr_read_b32 v160, a40
    v_accvgpr_read_b32 v161, a41
    v_accvgpr_read_b32 v162, a42
    v_accvgpr_read_b32 v163, a43
    v_accvgpr_read_b32 v164, a44
    v_accvgpr_read_b32 v165, a45
    v_accvgpr_read_b32 v166, a46
    v_accvgpr_read_b32 v167, a47
    v_mul_f32 v160, v160, v178
    v_mul_f32 v161, v161, v178
    v_mul_f32 v162, v162, v178
    v_mul_f32 v163, v163, v178
    v_mul_f32 v164, v164, v178
    v_mul_f32 v165, v165, v178
    v_mul_f32 v166, v166, v178
    v_mul_f32 v167, v167, v178
    v_accvgpr_write_b32 a40, v160
    v_accvgpr_write_b32 a41, v161
    v_accvgpr_write_b32 a42, v162
    v_accvgpr_write_b32 a43, v163
    v_accvgpr_write_b32 a44, v164
    v_accvgpr_write_b32 a45, v165
    v_accvgpr_write_b32 a46, v166
    v_accvgpr_write_b32 a47, v167
    v_max3_f32 v176, v40, v41, v42
    v_max3_f32 v176, v176, v43, v44
    v_max3_f32 v176, v176, v45, v46
    v_max_f32 v176, v176, v47
    v_mov_b32 v177, v176
    s_nop 1
    v_permlane32_swap_b32 v176, v177
    v_max_f32 v176, v176, v177
    v_mov_b32 v177, v176
    s_nop 1
    v_permlane16_swap_b32 v176, v177
    v_max_f32 v176, v176, v177
    v_sub_f32 v176, v176, v248
    v_max_f32 v176, 0, v176
    v_exp_f32 v178, -v176
    v_sub_f32 v132, v132, v176
    v_sub_f32 v133, v133, v176
    v_sub_f32 v134, v134, v176
    v_sub_f32 v135, v135, v176
    v_sub_f32 v40, v40, v176
    v_sub_f32 v41, v41, v176
    v_sub_f32 v42, v42, v176
    v_sub_f32 v43, v43, v176
    v_sub_f32 v44, v44, v176
    v_sub_f32 v45, v45, v176
    v_sub_f32 v46, v46, v176
    v_sub_f32 v47, v47, v176
    v_mul_f32 v24, v24, v178
    v_mul_f32 v25, v25, v178
    v_mul_f32 v26, v26, v178
    v_mul_f32 v27, v27, v178
    v_accvgpr_read_b32 v160, a16
    v_accvgpr_read_b32 v161, a17
    v_accvgpr_read_b32 v162, a18
    v_accvgpr_read_b32 v163, a19
    v_accvgpr_read_b32 v164, a20
    v_accvgpr_read_b32 v165, a21
    v_accvgpr_read_b32 v166, a22
    v_accvgpr_read_b32 v167, a23
    v_mul_f32 v160, v160, v178
    v_mul_f32 v161, v161, v178
    v_mul_f32 v162, v162, v178
    v_mul_f32 v163, v163, v178
    v_mul_f32 v164, v164, v178
    v_mul_f32 v165, v165, v178
    v_mul_f32 v166, v166, v178
    v_mul_f32 v167, v167, v178
    v_accvgpr_write_b32 a16, v160
    v_accvgpr_write_b32 a17, v161
    v_accvgpr_write_b32 a18, v162
    v_accvgpr_write_b32 a19, v163
    v_accvgpr_write_b32 a20, v164
    v_accvgpr_write_b32 a21, v165
    v_accvgpr_write_b32 a22, v166
    v_accvgpr_write_b32 a23, v167
    v_accvgpr_read_b32 v160, a24
    v_accvgpr_read_b32 v161, a25
    v_accvgpr_read_b32 v162, a26
    v_accvgpr_read_b32 v163, a27
    v_accvgpr_read_b32 v164, a28
    v_accvgpr_read_b32 v165, a29
    v_accvgpr_read_b32 v166, a30
    v_accvgpr_read_b32 v167, a31
    v_mul_f32 v160, v160, v178
    v_mul_f32 v161, v161, v178
    v_mul_f32 v162, v162, v178
    v_mul_f32 v163, v163, v178
    v_mul_f32 v164, v164, v178
    v_mul_f32 v165, v165, v178
    v_mul_f32 v166, v166, v178
    v_mul_f32 v167, v167, v178
    v_accvgpr_write_b32 a24, v160
    v_accvgpr_write_b32 a25, v161
    v_accvgpr_write_b32 a26, v162
    v_accvgpr_write_b32 a27, v163
    v_accvgpr_write_b32 a28, v164
    v_accvgpr_write_b32 a29, v165
    v_accvgpr_write_b32 a30, v166
    v_accvgpr_write_b32 a31, v167
    v_accvgpr_read_b32 v160, a48
    v_accvgpr_read_b32 v161, a49
    v_accvgpr_read_b32 v162, a50
    v_accvgpr_read_b32 v163, a51
    v_accvgpr_read_b32 v164, a52
    v_accvgpr_read_b32 v165, a53
    v_accvgpr_read_b32 v166, a54
    v_accvgpr_read_b32 v167, a55
    v_mul_f32 v160, v160, v178
    v_mul_f32 v161, v161, v178
    v_mul_f32 v162, v162, v178
    v_mul_f32 v163, v163, v178
    v_mul_f32 v164, v164, v178
    v_mul_f32 v165, v165, v178
    v_mul_f32 v166, v166, v178
    v_mul_f32 v167, v167, v178
    v_accvgpr_write_b32 a48, v160
    v_accvgpr_write_b32 a49, v161
    v_accvgpr_write_b32 a50, v162
    v_accvgpr_write_b32 a51, v163
    v_accvgpr_write_b32 a52, v164
    v_accvgpr_write_b32 a53, v165
    v_accvgpr_write_b32 a54, v166
    v_accvgpr_write_b32 a55, v167
    v_accvgpr_read_b32 v160, a56
    v_accvgpr_read_b32 v161, a57
    v_accvgpr_read_b32 v162, a58
    v_accvgpr_read_b32 v163, a59
    v_accvgpr_read_b32 v164, a60
    v_accvgpr_read_b32 v165, a61
    v_accvgpr_read_b32 v166, a62
    v_accvgpr_read_b32 v167, a63
    v_mul_f32 v160, v160, v178
    v_mul_f32 v161, v161, v178
    v_mul_f32 v162, v162, v178
    v_mul_f32 v163, v163, v178
    v_mul_f32 v164, v164, v178
    v_mul_f32 v165, v165, v178
    v_mul_f32 v166, v166, v178
    v_mul_f32 v167, v167, v178
    v_accvgpr_write_b32 a56, v160
    v_accvgpr_write_b32 a57, v161
    v_accvgpr_write_b32 a58, v162
    v_accvgpr_write_b32 a59, v163
    v_accvgpr_write_b32 a60, v164
    v_accvgpr_write_b32 a61, v165
    v_accvgpr_write_b32 a62, v166
    v_accvgpr_write_b32 a63, v167
    v_exp_f32 v160, v32
    v_exp_f32 v161, v33
    v_exp_f32 v162, v34
    v_cvt_pk_bf16_f32 v96, v160, v161
    v_exp_f32 v163, v35
    v_exp_f32 v164, v36
    v_cvt_pk_bf16_f32 v97, v162, v163
    v_exp_f32 v165, v37
    v_exp_f32 v166, v38
    v_cvt_pk_bf16_f32 v98, v164, v165
    v_exp_f32 v167, v39
    v_or3_b32 v174, v96, v97, v98
    v_exp_f32 v160, v40
    v_cvt_pk_bf16_f32 v99, v166, v167
    v_exp_f32 v161, v41
    v_exp_f32 v162, v42
    v_cvt_pk_bf16_f32 v100, v160, v161
    v_exp_f32 v163, v43
    v_or3_b32 v174, v174, v99, v100
    v_exp_f32 v164, v44
    v_cvt_pk_bf16_f32 v101, v162, v163
    v_exp_f32 v165, v45
    v_exp_f32 v166, v46
    v_cvt_pk_bf16_f32 v102, v164, v165
    v_exp_f32 v167, v47
    v_or3_b32 v174, v174, v101, v102
    v_cvt_pk_bf16_f32 v103, v166, v167
    v_or_b32 v174, v174, v103
    v_and_b32 v174, s39, v174
    s_nop 1
    s_branch KB_SL9R
KB_SL10:
    s_nop 15
    v_max3_f32 v176, v48, v49, v50
    v_max3_f32 v176, v176, v51, v52
    v_max3_f32 v176, v176, v53, v54
    v_max_f32 v176, v176, v55
    v_mov_b32 v177, v176
    s_nop 1
    v_permlane32_swap_b32 v176, v177
    v_max_f32 v176, v176, v177
    v_mov_b32 v177, v176
    s_nop 1
    v_permlane16_swap_b32 v176, v177
    v_max_f32 v176, v176, v177
    v_sub_f32 v176, v176, v248
    v_max_f32 v176, 0, v176
    v_exp_f32 v178, -v176
    v_sub_f32 v136, v136, v176
    v_sub_f32 v137, v137, v176
    v_sub_f32 v138, v138, v176
    v_sub_f32 v139, v139, v176
    v_sub_f32 v48, v48, v176
    v_sub_f32 v49, v49, v176
    v_sub_f32 v50, v50, v176
    v_sub_f32 v51, v51, v176
    v_sub_f32 v52, v52, v176
    v_sub_f32 v53, v53, v176
    v_sub_f32 v54, v54, v176
    v_sub_f32 v55, v55, v176
    v_sub_f32 v80, v80, v176
    v_sub_f32 v81, v81, v176
    v_sub_f32 v82, v82, v176
    v_sub_f32 v83, v83, v176
    v_sub_f32 v84, v84, v176
    v_sub_f32 v85, v85, v176
    v_sub_f32 v86, v86, v176
    v_sub_f32 v87, v87, v176
    v_mul_f32 v28, v28, v178
    v_mul_f32 v29, v29, v178
    v_mul_f32 v30, v30, v178
    v_mul_f32 v31, v31, v178
    v_accvgpr_read_b32 v160, a64
    v_accvgpr_read_b32 v161, a65
    v_accvgpr_read_b32 v162, a66
    v_accvgpr_read_b32 v163, a67
    v_accvgpr_read_b32 v164, a68
    v_accvgpr_read_b32 v165, a69
    v_accvgpr_read_b32 v166, a70
    v_accvgpr_read_b32 v167, a71
    v_mul_f32 v160, v160, v178
    v_mul_f32 v161, v161, v178
    v_mul_f32 v162, v162, v178
    v_mul_f32 v163, v163, v178
    v_mul_f32 v164, v164, v178
    v_mul_f32 v165, v165, v178
    v_mul_f32 v166, v166, v178
    v_mul_f32 v167, v167, v178
    v_accvgpr_write_b32 a64, v160
    v_accvgpr_write_b32 a65, v161
    v_accvgpr_write_b32 a66, v162
    v_accvgpr_write_b32 a67, v163
    v_accvgpr_write_b32 a68, v164
    v_accvgpr_write_b32 a69, v165
    v_accvgpr_write_b32 a70, v166
    v_accvgpr_write_b32 a71, v167
    v_accvgpr_read_b32 v160, a72
    v_accvgpr_read_b32 v161, a73
    v_accvgpr_read_b32 v162, a74
    v_accvgpr_read_b32 v163, a75
    v_accvgpr_read_b32 v164, a76
    v_accvgpr_read_b32 v165, a77
    v_accvgpr_read_b32 v166, a78
    v_accvgpr_read_b32 v167, a79
    v_mul_f32 v160, v160, v178
    v_mul_f32 v161, v161, v178
    v_mul_f32 v162, v162, v178
    v_mul_f32 v163, v163, v178
    v_mul_f32 v164, v164, v178
    v_mul_f32 v165, v165, v178
    v_mul_f32 v166, v166, v178
    v_mul_f32 v167, v167, v178
    v_accvgpr_write_b32 a72, v160
    v_accvgpr_write_b32 a73, v161
    v_accvgpr_write_b32 a74, v162
    v_accvgpr_write_b32 a75, v163
    v_accvgpr_write_b32 a76, v164
    v_accvgpr_write_b32 a77, v165
    v_accvgpr_write_b32 a78, v166
    v_accvgpr_write_b32 a79, v167
    v_accvgpr_read_b32 v160, a96
    v_accvgpr_read_b32 v161, a97
    v_accvgpr_read_b32 v162, a98
    v_accvgpr_read_b32 v163, a99
    v_accvgpr_read_b32 v164, a100
    v_accvgpr_read_b32 v165, a101
    v_accvgpr_read_b32 v166, a102
    v_accvgpr_read_b32 v167, a103
    v_mul_f32 v160, v160, v178
    v_mul_f32 v161, v161, v178
    v_mul_f32 v162, v162, v178
    v_mul_f32 v163, v163, v178
    v_mul_f32 v164, v164, v178
    v_mul_f32 v165, v165, v178
    v_mul_f32 v166, v166, v178
    v_mul_f32 v167, v167, v178
    v_accvgpr_write_b32 a96, v160
    v_accvgpr_write_b32 a97, v161
    v_accvgpr_write_b32 a98, v162
    v_accvgpr_write_b32 a99, v163
    v_accvgpr_write_b32 a100, v164
    v_accvgpr_write_b32 a101, v165
    v_accvgpr_write_b32 a102, v166
    v_accvgpr_write_b32 a103, v167
    v_accvgpr_read_b32 v160, a104
    v_accvgpr_read_b32 v161, a105
    v_accvgpr_read_b32 v162, a106
    v_accvgpr_read_b32 v163, a107
    v_accvgpr_read_b32 v164, a108
    v_accvgpr_read_b32 v165, a109
    v_accvgpr_read_b32 v166, a110
    v_accvgpr_read_b32 v167, a111
    v_mul_f32 v160, v160, v178
    v_mul_f32 v161, v161, v178
    v_mul_f32 v162, v162, v178
    v_mul_f32 v163, v163, v178
    v_mul_f32 v164, v164, v178
    v_mul_f32 v165, v165, v178
    v_mul_f32 v166, v166, v178
    v_mul_f32 v167, v167, v178
    v_accvgpr_write_b32 a104, v160
    v_accvgpr_write_b32 a105, v161
    v_accvgpr_write_b32 a106, v162
    v_accvgpr_write_b32 a107, v163
    v_accvgpr_write_b32 a108, v164
    v_accvgpr_write_b32 a109, v165
    v_accvgpr_write_b32 a110, v166
    v_accvgpr_write_b32 a111, v167
    v_max3_f32 v176, v56, v57, v58
    v_max3_f32 v176, v176, v59, v60
    v_max3_f32 v176, v176, v61, v62
    v_max_f32 v176, v176, v63
    v_mov_b32 v177, v176
    s_nop 1
    v_permlane32_swap_b32 v176, v177
    v_max_f32 v176, v176, v177
    v_mov_b32 v177, v176
    s_nop 1
    v_permlane16_swap_b32 v176, v177
    v_max_f32 v176, v176, v177
    v_sub_f32 v176, v176, v248
    v_max_f32 v176, 0, v176
    v_exp_f32 v178, -v176
    v_sub_f32 v140, v140, v176
    v_sub_f32 v141, v141, v176
    v_sub_f32 v142, v142, v176
    v_sub_f32 v143, v143, v176
    v_sub_f32 v56, v56, v176
    v_sub_f32 v57, v57, v176
    v_sub_f32 v58, v58, v176
    v_sub_f32 v59, v59, v176
    v_sub_f32 v60, v60, v176
    v_sub_f32 v61, v61, v176
    v_sub_f32 v62, v62, v176
    v_sub_f32 v63, v63, v176
    v_sub_f32 v88, v88, v176
    v_sub_f32 v89, v89, v176
    v_sub_f32 v90, v90, v176
    v_sub_f32 v91, v91, v176
    v_sub_f32 v92, v92, v176
    v_sub_f32 v93, v93, v176
    v_sub_f32 v94, v94, v176
    v_sub_f32 v95, v95, v176
    v_mul_f32 v168, v168, v178
    v_mul_f32 v169, v169, v178
    v_mul_f32 v170, v170, v178
    v_mul_f32 v171, v171, v178
    v_accvgpr_read_b32 v160, a80
    v_accvgpr_read_b32 v161, a81
    v_accvgpr_read_b32 v162, a82
    v_accvgpr_read_b32 v163, a83
    v_accvgpr_read_b32 v164, a84
    v_accvgpr_read_b32 v165, a85
    v_accvgpr_read_b32 v166, a86
    v_accvgpr_read_b32 v167, a87
    v_mul_f32 v160, v160, v178
    v_mul_f32 v161, v161, v178
    v_mul_f32 v162, v162, v178
    v_mul_f32 v163, v163, v178
    v_mul_f32 v164, v164, v178
    v_mul_f32 v165, v165, v178
    v_mul_f32 v166, v166, v178
    v_mul_f32 v167, v167, v178
    v_accvgpr_write_b32 a80, v160
    v_accvgpr_write_b32 a81, v161
    v_accvgpr_write_b32 a82, v162
    v_accvgpr_write_b32 a83, v163
    v_accvgpr_write_b32 a84, v164
    v_accvgpr_write_b32 a85, v165
    v_accvgpr_write_b32 a86, v166
    v_accvgpr_write_b32 a87, v167
    v_accvgpr_read_b32 v160, a88
    v_accvgpr_read_b32 v161, a89
    v_accvgpr_read_b32 v162, a90
    v_accvgpr_read_b32 v163, a91
    v_accvgpr_read_b32 v164, a92
    v_accvgpr_read_b32 v165, a93
    v_accvgpr_read_b32 v166, a94
    v_accvgpr_read_b32 v167, a95
    v_mul_f32 v160, v160, v178
    v_mul_f32 v161, v161, v178
    v_mul_f32 v162, v162, v178
    v_mul_f32 v163, v163, v178
    v_mul_f32 v164, v164, v178
    v_mul_f32 v165, v165, v178
    v_mul_f32 v166, v166, v178
    v_mul_f32 v167, v167, v178
    v_accvgpr_write_b32 a88, v160
    v_accvgpr_write_b32 a89, v161
    v_accvgpr_write_b32 a90, v162
    v_accvgpr_write_b32 a91, v163
    v_accvgpr_write_b32 a92, v164
    v_accvgpr_write_b32 a93, v165
    v_accvgpr_write_b32 a94, v166
    v_accvgpr_write_b32 a95, v167
    v_accvgpr_read_b32 v160, a112
    v_accvgpr_read_b32 v161, a113
    v_accvgpr_read_b32 v162, a114
    v_accvgpr_read_b32 v163, a115
    v_accvgpr_read_b32 v164, a116
    v_accvgpr_read_b32 v165, a117
    v_accvgpr_read_b32 v166, a118
    v_accvgpr_read_b32 v167, a119
    v_mul_f32 v160, v160, v178
    v_mul_f32 v161, v161, v178
    v_mul_f32 v162, v162, v178
    v_mul_f32 v163, v163, v178
    v_mul_f32 v164, v164, v178
    v_mul_f32 v165, v165, v178
    v_mul_f32 v166, v166, v178
    v_mul_f32 v167, v167, v178
    v_accvgpr_write_b32 a112, v160
    v_accvgpr_write_b32 a113, v161
    v_accvgpr_write_b32 a114, v162
    v_accvgpr_write_b32 a115, v163
    v_accvgpr_write_b32 a116, v164
    v_accvgpr_write_b32 a117, v165
    v_accvgpr_write_b32 a118, v166
    v_accvgpr_write_b32 a119, v167
    v_accvgpr_read_b32 v160, a120
    v_accvgpr_read_b32 v161, a121
    v_accvgpr_read_b32 v162, a122
    v_accvgpr_read_b32 v163, a123
    v_accvgpr_read_b32 v164, a124
    v_accvgpr_read_b32 v165, a125
    v_accvgpr_read_b32 v166, a126
    v_accvgpr_read_b32 v167, a127
    v_mul_f32 v160, v160, v178
    v_mul_f32 v161, v161, v178
    v_mul_f32 v162, v162, v178
    v_mul_f32 v163, v163, v178
    v_mul_f32 v164, v164, v178
    v_mul_f32 v165, v165, v178
    v_mul_f32 v166, v166, v178
    v_mul_f32 v167, v167, v178
    v_accvgpr_write_b32 a120, v160
    v_accvgpr_write_b32 a121, v161
    v_accvgpr_write_b32 a122, v162
    v_accvgpr_write_b32 a123, v163
    v_accvgpr_write_b32 a124, v164
    v_accvgpr_write_b32 a125, v165
    v_accvgpr_write_b32 a126, v166
    v_accvgpr_write_b32 a127, v167
    v_exp_f32 v160, v48
    v_exp_f32 v161, v49
    v_exp_f32 v162, v50
    v_cvt_pk_bf16_f32 v104, v160, v161
    v_exp_f32 v163, v51
    v_exp_f32 v164, v52
    v_cvt_pk_bf16_f32 v105, v162, v163
    v_exp_f32 v165, v53
    v_exp_f32 v166, v54
    v_cvt_pk_bf16_f32 v106, v164, v165
    v_exp_f32 v167, v55
    v_or3_b32 v174, v104, v105, v106
    v_exp_f32 v160, v56
    v_cvt_pk_bf16_f32 v107, v166, v167
    v_exp_f32 v161, v57
    v_exp_f32 v162, v58
    v_cvt_pk_bf16_f32 v108, v160, v161
    v_exp_f32 v163, v59
    v_or3_b32 v174, v174, v107, v108
    v_exp_f32 v164, v60
    v_cvt_pk_bf16_f32 v109, v162, v163
    v_exp_f32 v165, v61
    v_exp_f32 v166, v62
    v_cvt_pk_bf16_f32 v110, v164, v165
    v_exp_f32 v167, v63
    v_or3_b32 v174, v174, v109, v110
    v_cvt_pk_bf16_f32 v111, v166, v167
    v_or_b32 v174, v174, v111
    v_and_b32 v174, s39, v174
    s_nop 1
    s_branch KB_SL10R
KB_SL11:
    s_nop 15
    v_max3_f32 v176, v80, v81, v82
    v_max3_f32 v176, v176, v83, v84
    v_max3_f32 v176, v176, v85, v86
    v_max_f32 v176, v176, v87
    v_mov_b32 v177, v176
    s_nop 1
    v_permlane32_swap_b32 v176, v177
    v_max_f32 v176, v176, v177
    v_mov_b32 v177, v176
    s_nop 1
    v_permlane16_swap_b32 v176, v177
    v_max_f32 v176, v176, v177
    v_sub_f32 v176, v176, v248
    v_max_f32 v176, 0, v176
    v_exp_f32 v178, -v176
    v_sub_f32 v136, v136, v176
    v_sub_f32 v137, v137, v176
    v_sub_f32 v138, v138, v176
    v_sub_f32 v139, v139, v176
    v_sub_f32 v80, v80, v176
    v_sub_f32 v81, v81, v176
    v_sub_f32 v82, v82, v176
    v_sub_f32 v83, v83, v176
    v_sub_f32 v84, v84, v176
    v_sub_f32 v85, v85, v176
    v_sub_f32 v86, v86, v176
    v_sub_f32 v87, v87, v176
    v_mul_f32 v28, v28, v178
    v_mul_f32 v29, v29, v178
    v_mul_f32 v30, v30, v178
    v_mul_f32 v31, v31, v178
    v_accvgpr_read_b32 v160, a64
    v_accvgpr_read_b32 v161, a65
    v_accvgpr_read_b32 v162, a66
    v_accvgpr_read_b32 v163, a67
    v_accvgpr_read_b32 v164, a68
    v_accvgpr_read_b32 v165, a69
    v_accvgpr_read_b32 v166, a70
    v_accvgpr_read_b32 v167, a71
    v_mul_f32 v160, v160, v178
    v_mul_f32 v161, v161, v178
    v_mul_f32 v162, v162, v178
    v_mul_f32 v163, v163, v178
    v_mul_f32 v164, v164, v178
    v_mul_f32 v165, v165, v178
    v_mul_f32 v166, v166, v178
    v_mul_f32 v167, v167, v178
    v_accvgpr_write_b32 a64, v160
    v_accvgpr_write_b32 a65, v161
    v_accvgpr_write_b32 a66, v162
    v_accvgpr_write_b32 a67, v163
    v_accvgpr_write_b32 a68, v164
    v_accvgpr_write_b32 a69, v165
    v_accvgpr_write_b32 a70, v166
    v_accvgpr_write_b32 a71, v167
    v_accvgpr_read_b32 v160, a72
    v_accvgpr_read_b32 v161, a73
    v_accvgpr_read_b32 v162, a74
    v_accvgpr_read_b32 v163, a75
    v_accvgpr_read_b32 v164, a76
    v_accvgpr_read_b32 v165, a77
    v_accvgpr_read_b32 v166, a78
    v_accvgpr_read_b32 v167, a79
    v_mul_f32 v160, v160, v178
    v_mul_f32 v161, v161, v178
    v_mul_f32 v162, v162, v178
    v_mul_f32 v163, v163, v178
    v_mul_f32 v164, v164, v178
    v_mul_f32 v165, v165, v178
    v_mul_f32 v166, v166, v178
    v_mul_f32 v167, v167, v178
    v_accvgpr_write_b32 a72, v160
    v_accvgpr_write_b32 a73, v161
    v_accvgpr_write_b32 a74, v162
    v_accvgpr_write_b32 a75, v163
    v_accvgpr_write_b32 a76, v164
    v_accvgpr_write_b32 a77, v165
    v_accvgpr_write_b32 a78, v166
    v_accvgpr_write_b32 a79, v167
    v_accvgpr_read_b32 v160, a96
    v_accvgpr_read_b32 v161, a97
    v_accvgpr_read_b32 v162, a98
    v_accvgpr_read_b32 v163, a99
    v_accvgpr_read_b32 v164, a100
    v_accvgpr_read_b32 v165, a101
    v_accvgpr_read_b32 v166, a102
    v_accvgpr_read_b32 v167, a103
    v_mul_f32 v160, v160, v178
    v_mul_f32 v161, v161, v178
    v_mul_f32 v162, v162, v178
    v_mul_f32 v163, v163, v178
    v_mul_f32 v164, v164, v178
    v_mul_f32 v165, v165, v178
    v_mul_f32 v166, v166, v178
    v_mul_f32 v167, v167, v178
    v_accvgpr_write_b32 a96, v160
    v_accvgpr_write_b32 a97, v161
    v_accvgpr_write_b32 a98, v162
    v_accvgpr_write_b32 a99, v163
    v_accvgpr_write_b32 a100, v164
    v_accvgpr_write_b32 a101, v165
    v_accvgpr_write_b32 a102, v166
    v_accvgpr_write_b32 a103, v167
    v_accvgpr_read_b32 v160, a104
    v_accvgpr_read_b32 v161, a105
    v_accvgpr_read_b32 v162, a106
    v_accvgpr_read_b32 v163, a107
    v_accvgpr_read_b32 v164, a108
    v_accvgpr_read_b32 v165, a109
    v_accvgpr_read_b32 v166, a110
    v_accvgpr_read_b32 v167, a111
    v_mul_f32 v160, v160, v178
    v_mul_f32 v161, v161, v178
    v_mul_f32 v162, v162, v178
    v_mul_f32 v163, v163, v178
    v_mul_f32 v164, v164, v178
    v_mul_f32 v165, v165, v178
    v_mul_f32 v166, v166, v178
    v_mul_f32 v167, v167, v178
    v_accvgpr_write_b32 a104, v160
    v_accvgpr_write_b32 a105, v161
    v_accvgpr_write_b32 a106, v162
    v_accvgpr_write_b32 a107, v163
    v_accvgpr_write_b32 a108, v164
    v_accvgpr_write_b32 a109, v165
    v_accvgpr_write_b32 a110, v166
    v_accvgpr_write_b32 a111, v167
    v_max3_f32 v176, v88, v89, v90
    v_max3_f32 v176, v176, v91, v92
    v_max3_f32 v176, v176, v93, v94
    v_max_f32 v176, v176, v95
    v_mov_b32 v177, v176
    s_nop 1
    v_permlane32_swap_b32 v176, v177
    v_max_f32 v176, v176, v177
    v_mov_b32 v177, v176
    s_nop 1
    v_permlane16_swap_b32 v176, v177
    v_max_f32 v176, v176, v177
    v_sub_f32 v176, v176, v248
    v_max_f32 v176, 0, v176
    v_exp_f32 v178, -v176
    v_sub_f32 v140, v140, v176
    v_sub_f32 v141, v141, v176
    v_sub_f32 v142, v142, v176
    v_sub_f32 v143, v143, v176
    v_sub_f32 v88, v88, v176
    v_sub_f32 v89, v89, v176
    v_sub_f32 v90, v90, v176
    v_sub_f32 v91, v91, v176
    v_sub_f32 v92, v92, v176
    v_sub_f32 v93, v93, v176
    v_sub_f32 v94, v94, v176
    v_sub_f32 v95, v95, v176
    v_mul_f32 v168, v168, v178
    v_mul_f32 v169, v169, v178
    v_mul_f32 v170, v170, v178
    v_mul_f32 v171, v171, v178
    v_accvgpr_read_b32 v160, a80
    v_accvgpr_read_b32 v161, a81
    v_accvgpr_read_b32 v162, a82
    v_accvgpr_read_b32 v163, a83
    v_accvgpr_read_b32 v164, a84
    v_accvgpr_read_b32 v165, a85
    v_accvgpr_read_b32 v166, a86
    v_accvgpr_read_b32 v167, a87
    v_mul_f32 v160, v160, v178
    v_mul_f32 v161, v161, v178
    v_mul_f32 v162, v162, v178
    v_mul_f32 v163, v163, v178
    v_mul_f32 v164, v164, v178
    v_mul_f32 v165, v165, v178
    v_mul_f32 v166, v166, v178
    v_mul_f32 v167, v167, v178
    v_accvgpr_write_b32 a80, v160
    v_accvgpr_write_b32 a81, v161
    v_accvgpr_write_b32 a82, v162
    v_accvgpr_write_b32 a83, v163
    v_accvgpr_write_b32 a84, v164
    v_accvgpr_write_b32 a85, v165
    v_accvgpr_write_b32 a86, v166
    v_accvgpr_write_b32 a87, v167
    v_accvgpr_read_b32 v160, a88
    v_accvgpr_read_b32 v161, a89
    v_accvgpr_read_b32 v162, a90
    v_accvgpr_read_b32 v163, a91
    v_accvgpr_read_b32 v164, a92
    v_accvgpr_read_b32 v165, a93
    v_accvgpr_read_b32 v166, a94
    v_accvgpr_read_b32 v167, a95
    v_mul_f32 v160, v160, v178
    v_mul_f32 v161, v161, v178
    v_mul_f32 v162, v162, v178
    v_mul_f32 v163, v163, v178
    v_mul_f32 v164, v164, v178
    v_mul_f32 v165, v165, v178
    v_mul_f32 v166, v166, v178
    v_mul_f32 v167, v167, v178
    v_accvgpr_write_b32 a88, v160
    v_accvgpr_write_b32 a89, v161
    v_accvgpr_write_b32 a90, v162
    v_accvgpr_write_b32 a91, v163
    v_accvgpr_write_b32 a92, v164
    v_accvgpr_write_b32 a93, v165
    v_accvgpr_write_b32 a94, v166
    v_accvgpr_write_b32 a95, v167
    v_accvgpr_read_b32 v160, a112
    v_accvgpr_read_b32 v161, a113
    v_accvgpr_read_b32 v162, a114
    v_accvgpr_read_b32 v163, a115
    v_accvgpr_read_b32 v164, a116
    v_accvgpr_read_b32 v165, a117
    v_accvgpr_read_b32 v166, a118
    v_accvgpr_read_b32 v167, a119
    v_mul_f32 v160, v160, v178
    v_mul_f32 v161, v161, v178
    v_mul_f32 v162, v162, v178
    v_mul_f32 v163, v163, v178
    v_mul_f32 v164, v164, v178
    v_mul_f32 v165, v165, v178
    v_mul_f32 v166, v166, v178
    v_mul_f32 v167, v167, v178
    v_accvgpr_write_b32 a112, v160
    v_accvgpr_write_b32 a113, v161
    v_accvgpr_write_b32 a114, v162
    v_accvgpr_write_b32 a115, v163
    v_accvgpr_write_b32 a116, v164
    v_accvgpr_write_b32 a117, v165
    v_accvgpr_write_b32 a118, v166
    v_accvgpr_write_b32 a119, v167
    v_accvgpr_read_b32 v160, a120
    v_accvgpr_read_b32 v161, a121
    v_accvgpr_read_b32 v162, a122
    v_accvgpr_read_b32 v163, a123
    v_accvgpr_read_b32 v164, a124
    v_accvgpr_read_b32 v165, a125
    v_accvgpr_read_b32 v166, a126
    v_accvgpr_read_b32 v167, a127
    v_mul_f32 v160, v160, v178
    v_mul_f32 v161, v161, v178
    v_mul_f32 v162, v162, v178
    v_mul_f32 v163, v163, v178
    v_mul_f32 v164, v164, v178
    v_mul_f32 v165, v165, v178
    v_mul_f32 v166, v166, v178
    v_mul_f32 v167, v167, v178
    v_accvgpr_write_b32 a120, v160
    v_accvgpr_write_b32 a121, v161
    v_accvgpr_write_b32 a122, v162
    v_accvgpr_write_b32 a123, v163
    v_accvgpr_write_b32 a124, v164
    v_accvgpr_write_b32 a125, v165
    v_accvgpr_write_b32 a126, v166
    v_accvgpr_write_b32 a127, v167
    v_exp_f32 v160, v80
    v_exp_f32 v161, v81
    v_exp_f32 v162, v82
    v_cvt_pk_bf16_f32 v120, v160, v161
    v_exp_f32 v163, v83
    v_exp_f32 v164, v84
    v_cvt_pk_bf16_f32 v121, v162, v163
    v_exp_f32 v165, v85
    v_exp_f32 v166, v86
    v_cvt_pk_bf16_f32 v122, v164, v165
    v_exp_f32 v167, v87
    v_or3_b32 v174, v120, v121, v122
    v_exp_f32 v160, v88
    v_cvt_pk_bf16_f32 v123, v166, v167
    v_exp_f32 v161, v89
    v_exp_f32 v162, v90
    v_cvt_pk_bf16_f32 v124, v160, v161
    v_exp_f32 v163, v91
    v_or3_b32 v174, v174, v123, v124
    v_exp_f32 v164, v92
    v_cvt_pk_bf16_f32 v125, v162, v163
    v_exp_f32 v165, v93
    v_exp_f32 v166, v94
    v_cvt_pk_bf16_f32 v126, v164, v165
    v_exp_f32 v167, v95
    v_or3_b32 v174, v174, v125, v126
    v_cvt_pk_bf16_f32 v127, v166, v167
    v_or_b32 v174, v174, v127
    v_and_b32 v174, s39, v174
    s_nop 1
    s_branch KB_SL11R
KB_SL12:
    s_nop 15
    v_max3_f32 v176, v32, v33, v34
    v_max3_f32 v176, v176, v35, v36
    v_max3_f32 v176, v176, v37, v38
    v_max_f32 v176, v176, v39
    v_mov_b32 v177, v176
    s_nop 1
    v_permlane32_swap_b32 v176, v177
    v_max_f32 v176, v176, v177
    v_mov_b32 v177, v176
    s_nop 1
    v_permlane16_swap_b32 v176, v177
    v_max_f32 v176, v176, v177
    v_sub_f32 v176, v176, v248
    v_max_f32 v176, 0xf149f2ca, v176
    v_sub_f32 v128, v128, v176
    v_sub_f32 v129, v129, v176
    v_sub_f32 v130, v130, v176
    v_sub_f32 v131, v131, v176
    v_sub_f32 v32, v32, v176
    v_sub_f32 v33, v33, v176
    v_sub_f32 v34, v34, v176
    v_sub_f32 v35, v35, v176
    v_sub_f32 v36, v36, v176
    v_sub_f32 v37, v37, v176
    v_sub_f32 v38, v38, v176
    v_sub_f32 v39, v39, v176
    v_max3_f32 v176, v40, v41, v42
    v_max3_f32 v176, v176, v43, v44
    v_max3_f32 v176, v176, v45, v46
    v_max_f32 v176, v176, v47
    v_mov_b32 v177, v176
    s_nop 1
    v_permlane32_swap_b32 v176, v177
    v_max_f32 v176, v176, v177
    v_mov_b32 v177, v176
    s_nop 1
    v_permlane16_swap_b32 v176, v177
    v_max_f32 v176, v176, v177
    v_sub_f32 v176, v176, v248
    v_max_f32 v176, 0xf149f2ca, v176
    v_sub_f32 v132, v132, v176
    v_sub_f32 v133, v133, v176
    v_sub_f32 v134, v134, v176
    v_sub_f32 v135, v135, v176
    v_sub_f32 v40, v40, v176
    v_sub_f32 v41, v41, v176
    v_sub_f32 v42, v42, v176
    v_sub_f32 v43, v43, v176
    v_sub_f32 v44, v44, v176
    v_sub_f32 v45, v45, v176
    v_sub_f32 v46, v46, v176
    v_sub_f32 v47, v47, v176
    v_exp_f32 v160, v32
    v_exp_f32 v161, v33
    v_exp_f32 v162, v34
    v_cvt_pk_bf16_f32 v96, v160, v161
    v_exp_f32 v163, v35
    v_exp_f32 v164, v36
    v_cvt_pk_bf16_f32 v97, v162, v163
    v_exp_f32 v165, v37
    v_exp_f32 v166, v38
    v_cvt_pk_bf16_f32 v98, v164, v165
    v_exp_f32 v167, v39
    v_or3_b32 v174, v96, v97, v98
    v_exp_f32 v160, v40
    v_cvt_pk_bf16_f32 v99, v166, v167
    v_exp_f32 v161, v41
    v_exp_f32 v162, v42
    v_cvt_pk_bf16_f32 v100, v160, v161
    v_exp_f32 v163, v43
    v_or3_b32 v174, v174, v99, v100
    v_exp_f32 v164, v44
    v_cvt_pk_bf16_f32 v101, v162, v163
    v_exp_f32 v165, v45
    v_exp_f32 v166, v46
    v_cvt_pk_bf16_f32 v102, v164, v165
    v_exp_f32 v167, v47
    v_or3_b32 v174, v174, v101, v102
    v_cvt_pk_bf16_f32 v103, v166, v167
    v_or_b32 v174, v174, v103
    v_and_b32 v174, s39, v174
    s_nop 1
    s_branch KB_SL12R
KB_SL13:
    s_nop 15
    v_max3_f32 v176, v48, v49, v50
    v_max3_f32 v176, v176, v51, v52
    v_max3_f32 v176, v176, v53, v54
    v_max_f32 v176, v176, v55
    v_mov_b32 v177, v176
    s_nop 1
    v_permlane32_swap_b32 v176, v177
    v_max_f32 v176, v176, v177
    v_mov_b32 v177, v176
    s_nop 1
    v_permlane16_swap_b32 v176, v177
    v_max_f32 v176, v176, v177
    v_sub_f32 v176, v176, v248
    v_max_f32 v176, 0xf149f2ca, v176
    v_sub_f32 v136, v136, v176
    v_sub_f32 v137, v137, v176
    v_sub_f32 v138, v138, v176
    v_sub_f32 v139, v139, v176
    v_sub_f32 v48, v48, v176
    v_sub_f32 v49, v49, v176
    v_sub_f32 v50, v50, v176
    v_sub_f32 v51, v51, v176
    v_sub_f32 v52, v52, v176
    v_sub_f32 v53, v53, v176
    v_sub_f32 v54, v54, v176
    v_sub_f32 v55, v55, v176
    v_sub_f32 v80, v80, v176
    v_sub_f32 v81, v81, v176
    v_sub_f32 v82, v82, v176
    v_sub_f32 v83, v83, v176
    v_sub_f32 v84, v84, v176
    v_sub_f32 v85, v85, v176
    v_sub_f32 v86, v86, v176
    v_sub_f32 v87, v87, v176
    v_max3_f32 v176, v56, v57, v58
    v_max3_f32 v176, v176, v59, v60
    v_max3_f32 v176, v176, v61, v62
    v_max_f32 v176, v176, v63
    v_mov_b32 v177, v176
    s_nop 1
    v_permlane32_swap_b32 v176, v177
    v_max_f32 v176, v176, v177
    v_mov_b32 v177, v176
    s_nop 1
    v_permlane16_swap_b32 v176, v177
    v_max_f32 v176, v176, v177
    v_sub_f32 v176, v176, v248
    v_max_f32 v176, 0xf149f2ca, v176
    v_sub_f32 v140, v140, v176
    v_sub_f32 v141, v141, v176
    v_sub_f32 v142, v142, v176
    v_sub_f32 v143, v143, v176
    v_sub_f32 v56, v56, v176
    v_sub_f32 v57, v57, v176
    v_sub_f32 v58, v58, v176
    v_sub_f32 v59, v59, v176
    v_sub_f32 v60, v60, v176
    v_sub_f32 v61, v61, v176
    v_sub_f32 v62, v62, v176
    v_sub_f32 v63, v63, v176
    v_sub_f32 v88, v88, v176
    v_sub_f32 v89, v89, v176
    v_sub_f32 v90, v90, v176
    v_sub_f32 v91, v91, v176
    v_sub_f32 v92, v92, v176
    v_sub_f32 v93, v93, v176
    v_sub_f32 v94, v94, v176
    v_sub_f32 v95, v95, v176
    v_exp_f32 v160, v48
    v_exp_f32 v161, v49
    v_exp_f32 v162, v50
    v_cvt_pk_bf16_f32 v104, v160, v161
    v_exp_f32 v163, v51
    v_exp_f32 v164, v52
    v_cvt_pk_bf16_f32 v105, v162, v163
    v_exp_f32 v165, v53
    v_exp_f32 v166, v54
    v_cvt_pk_bf16_f32 v106, v164, v165
    v_exp_f32 v167, v55
    v_or3_b32 v174, v104, v105, v106
    v_exp_f32 v160, v56
    v_cvt_pk_bf16_f32 v107, v166, v167
    v_exp_f32 v161, v57
    v_exp_f32 v162, v58
    v_cvt_pk_bf16_f32 v108, v160, v161
    v_exp_f32 v163, v59
    v_or3_b32 v174, v174, v107, v108
    v_exp_f32 v164, v60
    v_cvt_pk_bf16_f32 v109, v162, v163
    v_exp_f32 v165, v61
    v_exp_f32 v166, v62
    v_cvt_pk_bf16_f32 v110, v164, v165
    v_exp_f32 v167, v63
    v_or3_b32 v174, v174, v109, v110
    v_cvt_pk_bf16_f32 v111, v166, v167
    v_or_b32 v174, v174, v111
    v_and_b32 v174, s39, v174
    s_nop 1
    s_branch KB_SL13R
KB_SL14:
    s_nop 15
    v_max3_f32 v176, v80, v81, v82
    v_max3_f32 v176, v176, v83, v84
    v_max3_f32 v176, v176, v85, v86
    v_max_f32 v176, v176, v87
    v_mov_b32 v177, v176
    s_nop 1
    v_permlane32_swap_b32 v176, v177
    v_max_f32 v176, v176, v177
    v_mov_b32 v177, v176
    s_nop 1
    v_permlane16_swap_b32 v176, v177
    v_max_f32 v176, v176, v177
    v_sub_f32 v176, v176, v248
    v_max_f32 v176, 0, v176
    v_exp_f32 v178, -v176
    v_sub_f32 v136, v136, v176
    v_sub_f32 v137, v137, v176
    v_sub_f32 v138, v138, v176
    v_sub_f32 v139, v139, v176
    v_sub_f32 v80, v80, v176
    v_sub_f32 v81, v81, v176
    v_sub_f32 v82, v82, v176
    v_sub_f32 v83, v83, v176
    v_sub_f32 v84, v84, v176
    v_sub_f32 v85, v85, v176
    v_sub_f32 v86, v86, v176
    v_sub_f32 v87, v87, v176
    v_mul_f32 v28, v28, v178
    v_mul_f32 v29, v29, v178
    v_mul_f32 v30, v30, v178
    v_mul_f32 v31, v31, v178
    v_accvgpr_read_b32 v160, a64
    v_accvgpr_read_b32 v161, a65
    v_accvgpr_read_b32 v162, a66
    v_accvgpr_read_b32 v163, a67
    v_accvgpr_read_b32 v164, a68
    v_accvgpr_read_b32 v165, a69
    v_accvgpr_read_b32 v166, a70
    v_accvgpr_read_b32 v167, a71
    v_mul_f32 v160, v160, v178
    v_mul_f32 v161, v161, v178
    v_mul_f32 v162, v162, v178
    v_mul_f32 v163, v163, v178
    v_mul_f32 v164, v164, v178
    v_mul_f32 v165, v165, v178
    v_mul_f32 v166, v166, v178
    v_mul_f32 v167, v167, v178
    v_accvgpr_write_b32 a64, v160
    v_accvgpr_write_b32 a65, v161
    v_accvgpr_write_b32 a66, v162
    v_accvgpr_write_b32 a67, v163
    v_accvgpr_write_b32 a68, v164
    v_accvgpr_write_b32 a69, v165
    v_accvgpr_write_b32 a70, v166
    v_accvgpr_write_b32 a71, v167
    v_accvgpr_read_b32 v160, a72
    v_accvgpr_read_b32 v161, a73
    v_accvgpr_read_b32 v162, a74
    v_accvgpr_read_b32 v163, a75
    v_accvgpr_read_b32 v164, a76
    v_accvgpr_read_b32 v165, a77
    v_accvgpr_read_b32 v166, a78
    v_accvgpr_read_b32 v167, a79
    v_mul_f32 v160, v160, v178
    v_mul_f32 v161, v161, v178
    v_mul_f32 v162, v162, v178
    v_mul_f32 v163, v163, v178
    v_mul_f32 v164, v164, v178
    v_mul_f32 v165, v165, v178
    v_mul_f32 v166, v166, v178
    v_mul_f32 v167, v167, v178
    v_accvgpr_write_b32 a72, v160
    v_accvgpr_write_b32 a73, v161
    v_accvgpr_write_b32 a74, v162
    v_accvgpr_write_b32 a75, v163
    v_accvgpr_write_b32 a76, v164
    v_accvgpr_write_b32 a77, v165
    v_accvgpr_write_b32 a78, v166
    v_accvgpr_write_b32 a79, v167
    v_accvgpr_read_b32 v160, a96
    v_accvgpr_read_b32 v161, a97
    v_accvgpr_read_b32 v162, a98
    v_accvgpr_read_b32 v163, a99
    v_accvgpr_read_b32 v164, a100
    v_accvgpr_read_b32 v165, a101
    v_accvgpr_read_b32 v166, a102
    v_accvgpr_read_b32 v167, a103
    v_mul_f32 v160, v160, v178
    v_mul_f32 v161, v161, v178
    v_mul_f32 v162, v162, v178
    v_mul_f32 v163, v163, v178
    v_mul_f32 v164, v164, v178
    v_mul_f32 v165, v165, v178
    v_mul_f32 v166, v166, v178
    v_mul_f32 v167, v167, v178
    v_accvgpr_write_b32 a96, v160
    v_accvgpr_write_b32 a97, v161
    v_accvgpr_write_b32 a98, v162
    v_accvgpr_write_b32 a99, v163
    v_accvgpr_write_b32 a100, v164
    v_accvgpr_write_b32 a101, v165
    v_accvgpr_write_b32 a102, v166
    v_accvgpr_write_b32 a103, v167
    v_accvgpr_read_b32 v160, a104
    v_accvgpr_read_b32 v161, a105
    v_accvgpr_read_b32 v162, a106
    v_accvgpr_read_b32 v163, a107
    v_accvgpr_read_b32 v164, a108
    v_accvgpr_read_b32 v165, a109
    v_accvgpr_read_b32 v166, a110
    v_accvgpr_read_b32 v167, a111
    v_mul_f32 v160, v160, v178
    v_mul_f32 v161, v161, v178
    v_mul_f32 v162, v162, v178
    v_mul_f32 v163, v163, v178
    v_mul_f32 v164, v164, v178
    v_mul_f32 v165, v165, v178
    v_mul_f32 v166, v166, v178
    v_mul_f32 v167, v167, v178
    v_accvgpr_write_b32 a104, v160
    v_accvgpr_write_b32 a105, v161
    v_accvgpr_write_b32 a106, v162
    v_accvgpr_write_b32 a107, v163
    v_accvgpr_write_b32 a108, v164
    v_accvgpr_write_b32 a109, v165
    v_accvgpr_write_b32 a110, v166
    v_accvgpr_write_b32 a111, v167
    v_max3_f32 v176, v88, v89, v90
    v_max3_f32 v176, v176, v91, v92
    v_max3_f32 v176, v176, v93, v94
    v_max_f32 v176, v176, v95
    v_mov_b32 v177, v176
    s_nop 1
    v_permlane32_swap_b32 v176, v177
    v_max_f32 v176, v176, v177
    v_mov_b32 v177, v176
    s_nop 1
    v_permlane16_swap_b32 v176, v177
    v_max_f32 v176, v176, v177
    v_sub_f32 v176, v176, v248
    v_max_f32 v176, 0, v176
    v_exp_f32 v178, -v176
    v_sub_f32 v140, v140, v176
    v_sub_f32 v141, v141, v176
    v_sub_f32 v142, v142, v176
    v_sub_f32 v143, v143, v176
    v_sub_f32 v88, v88, v176
    v_sub_f32 v89, v89, v176
    v_sub_f32 v90, v90, v176
    v_sub_f32 v91, v91, v176
    v_sub_f32 v92, v92, v176
    v_sub_f32 v93, v93, v176
    v_sub_f32 v94, v94, v176
    v_sub_f32 v95, v95, v176
    v_mul_f32 v168, v168, v178
    v_mul_f32 v169, v169, v178
    v_mul_f32 v170, v170, v178
    v_mul_f32 v171, v171, v178
    v_accvgpr_read_b32 v160, a80
    v_accvgpr_read_b32 v161, a81
    v_accvgpr_read_b32 v162, a82
    v_accvgpr_read_b32 v163, a83
    v_accvgpr_read_b32 v164, a84
    v_accvgpr_read_b32 v165, a85
    v_accvgpr_read_b32 v166, a86
    v_accvgpr_read_b32 v167, a87
    v_mul_f32 v160, v160, v178
    v_mul_f32 v161, v161, v178
    v_mul_f32 v162, v162, v178
    v_mul_f32 v163, v163, v178
    v_mul_f32 v164, v164, v178
    v_mul_f32 v165, v165, v178
    v_mul_f32 v166, v166, v178
    v_mul_f32 v167, v167, v178
    v_accvgpr_write_b32 a80, v160
    v_accvgpr_write_b32 a81, v161
    v_accvgpr_write_b32 a82, v162
    v_accvgpr_write_b32 a83, v163
    v_accvgpr_write_b32 a84, v164
    v_accvgpr_write_b32 a85, v165
    v_accvgpr_write_b32 a86, v166
    v_accvgpr_write_b32 a87, v167
    v_accvgpr_read_b32 v160, a88
    v_accvgpr_read_b32 v161, a89
    v_accvgpr_read_b32 v162, a90
    v_accvgpr_read_b32 v163, a91
    v_accvgpr_read_b32 v164, a92
    v_accvgpr_read_b32 v165, a93
    v_accvgpr_read_b32 v166, a94
    v_accvgpr_read_b32 v167, a95
    v_mul_f32 v160, v160, v178
    v_mul_f32 v161, v161, v178
    v_mul_f32 v162, v162, v178
    v_mul_f32 v163, v163, v178
    v_mul_f32 v164, v164, v178
    v_mul_f32 v165, v165, v178
    v_mul_f32 v166, v166, v178
    v_mul_f32 v167, v167, v178
    v_accvgpr_write_b32 a88, v160
    v_accvgpr_write_b32 a89, v161
    v_accvgpr_write_b32 a90, v162
    v_accvgpr_write_b32 a91, v163
    v_accvgpr_write_b32 a92, v164
    v_accvgpr_write_b32 a93, v165
    v_accvgpr_write_b32 a94, v166
    v_accvgpr_write_b32 a95, v167
    v_accvgpr_read_b32 v160, a112
    v_accvgpr_read_b32 v161, a113
    v_accvgpr_read_b32 v162, a114
    v_accvgpr_read_b32 v163, a115
    v_accvgpr_read_b32 v164, a116
    v_accvgpr_read_b32 v165, a117
    v_accvgpr_read_b32 v166, a118
    v_accvgpr_read_b32 v167, a119
    v_mul_f32 v160, v160, v178
    v_mul_f32 v161, v161, v178
    v_mul_f32 v162, v162, v178
    v_mul_f32 v163, v163, v178
    v_mul_f32 v164, v164, v178
    v_mul_f32 v165, v165, v178
    v_mul_f32 v166, v166, v178
    v_mul_f32 v167, v167, v178
    v_accvgpr_write_b32 a112, v160
    v_accvgpr_write_b32 a113, v161
    v_accvgpr_write_b32 a114, v162
    v_accvgpr_write_b32 a115, v163
    v_accvgpr_write_b32 a116, v164
    v_accvgpr_write_b32 a117, v165
    v_accvgpr_write_b32 a118, v166
    v_accvgpr_write_b32 a119, v167
    v_accvgpr_read_b32 v160, a120
    v_accvgpr_read_b32 v161, a121
    v_accvgpr_read_b32 v162, a122
    v_accvgpr_read_b32 v163, a123
    v_accvgpr_read_b32 v164, a124
    v_accvgpr_read_b32 v165, a125
    v_accvgpr_read_b32 v166, a126
    v_accvgpr_read_b32 v167, a127
    v_mul_f32 v160, v160, v178
    v_mul_f32 v161, v161, v178
    v_mul_f32 v162, v162, v178
    v_mul_f32 v163, v163, v178
    v_mul_f32 v164, v164, v178
    v_mul_f32 v165, v165, v178
    v_mul_f32 v166, v166, v178
    v_mul_f32 v167, v167, v178
    v_accvgpr_write_b32 a120, v160
    v_accvgpr_write_b32 a121, v161
    v_accvgpr_write_b32 a122, v162
    v_accvgpr_write_b32 a123, v163
    v_accvgpr_write_b32 a124, v164
    v_accvgpr_write_b32 a125, v165
    v_accvgpr_write_b32 a126, v166
    v_accvgpr_write_b32 a127, v167
    v_exp_f32 v160, v80
    v_exp_f32 v161, v81
    v_exp_f32 v162, v82
    v_cvt_pk_bf16_f32 v120, v160, v161
    v_exp_f32 v163, v83
    v_exp_f32 v164, v84
    v_cvt_pk_bf16_f32 v121, v162, v163
    v_exp_f32 v165, v85
    v_exp_f32 v166, v86
    v_cvt_pk_bf16_f32 v122, v164, v165
    v_exp_f32 v167, v87
    v_or3_b32 v174, v120, v121, v122
    v_exp_f32 v160, v88
    v_cvt_pk_bf16_f32 v123, v166, v167
    v_exp_f32 v161, v89
    v_exp_f32 v162, v90
    v_cvt_pk_bf16_f32 v124, v160, v161
    v_exp_f32 v163, v91
    v_or3_b32 v174, v174, v123, v124
    v_exp_f32 v164, v92
    v_cvt_pk_bf16_f32 v125, v162, v163
    v_exp_f32 v165, v93
    v_exp_f32 v166, v94
    v_cvt_pk_bf16_f32 v126, v164, v165
    v_exp_f32 v167, v95
    v_or3_b32 v174, v174, v125, v126
    v_cvt_pk_bf16_f32 v127, v166, v167
    v_or_b32 v174, v174, v127
    v_and_b32 v174, s39, v174
    s_nop 1
    s_branch KB_SL14R
KB_SL15:
    s_nop 15
    v_max3_f32 v176, v32, v33, v34
    v_max3_f32 v176, v176, v35, v36
    v_max3_f32 v176, v176, v37, v38
    v_max_f32 v176, v176, v39
    v_mov_b32 v177, v176
    s_nop 1
    v_permlane32_swap_b32 v176, v177
    v_max_f32 v176, v176, v177
    v_mov_b32 v177, v176
    s_nop 1
    v_permlane16_swap_b32 v176, v177
    v_max_f32 v176, v176, v177
    v_sub_f32 v176, v176, v248
    v_max_f32 v176, 0, v176
    v_exp_f32 v178, -v176
    v_sub_f32 v128, v128, v176
    v_sub_f32 v129, v129, v176
    v_sub_f32 v130, v130, v176
    v_sub_f32 v131, v131, v176
    v_sub_f32 v32, v32, v176
    v_sub_f32 v33, v33, v176
    v_sub_f32 v34, v34, v176
    v_sub_f32 v35, v35, v176
    v_sub_f32 v36, v36, v176
    v_sub_f32 v37, v37, v176
    v_sub_f32 v38, v38, v176
    v_sub_f32 v39, v39, v176
    v_mul_f32 v20, v20, v178
    v_mul_f32 v21, v21, v178
    v_mul_f32 v22, v22, v178
    v_mul_f32 v23, v23, v178
    v_accvgpr_read_b32 v160, a0
    v_accvgpr_read_b32 v161, a1
    v_accvgpr_read_b32 v162, a2
    v_accvgpr_read_b32 v163, a3
    v_accvgpr_read_b32 v164, a4
    v_accvgpr_read_b32 v165, a5
    v_accvgpr_read_b32 v166, a6
    v_accvgpr_read_b32 v167, a7
    v_mul_f32 v160, v160, v178
    v_mul_f32 v161, v161, v178
    v_mul_f32 v162, v162, v178
    v_mul_f32 v163, v163, v178
    v_mul_f32 v164, v164, v178
    v_mul_f32 v165, v165, v178
    v_mul_f32 v166, v166, v178
    v_mul_f32 v167, v167, v178
    v_accvgpr_write_b32 a0, v160
    v_accvgpr_write_b32 a1, v161
    v_accvgpr_write_b32 a2, v162
    v_accvgpr_write_b32 a3, v163
    v_accvgpr_write_b32 a4, v164
    v_accvgpr_write_b32 a5, v165
    v_accvgpr_write_b32 a6, v166
    v_accvgpr_write_b32 a7, v167
    v_accvgpr_read_b32 v160, a8
    v_accvgpr_read_b32 v161, a9
    v_accvgpr_read_b32 v162, a10
    v_accvgpr_read_b32 v163, a11
    v_accvgpr_read_b32 v164, a12
    v_accvgpr_read_b32 v165, a13
    v_accvgpr_read_b32 v166, a14
    v_accvgpr_read_b32 v167, a15
    v_mul_f32 v160, v160, v178
    v_mul_f32 v161, v161, v178
    v_mul_f32 v162, v162, v178
    v_mul_f32 v163, v163, v178
    v_mul_f32 v164, v164, v178
    v_mul_f32 v165, v165, v178
    v_mul_f32 v166, v166, v178
    v_mul_f32 v167, v167, v178
    v_accvgpr_write_b32 a8, v160
    v_accvgpr_write_b32 a9, v161
    v_accvgpr_write_b32 a10, v162
    v_accvgpr_write_b32 a11, v163
    v_accvgpr_write_b32 a12, v164
    v_accvgpr_write_b32 a13, v165
    v_accvgpr_write_b32 a14, v166
    v_accvgpr_write_b32 a15, v167
    v_accvgpr_read_b32 v160, a32
    v_accvgpr_read_b32 v161, a33
    v_accvgpr_read_b32 v162, a34
    v_accvgpr_read_b32 v163, a35
    v_accvgpr_read_b32 v164, a36
    v_accvgpr_read_b32 v165, a37
    v_accvgpr_read_b32 v166, a38
    v_accvgpr_read_b32 v167, a39
    v_mul_f32 v160, v160, v178
    v_mul_f32 v161, v161, v178
    v_mul_f32 v162, v162, v178
    v_mul_f32 v163, v163, v178
    v_mul_f32 v164, v164, v178
    v_mul_f32 v165, v165, v178
    v_mul_f32 v166, v166, v178
    v_mul_f32 v167, v167, v178
    v_accvgpr_write_b32 a32, v160
    v_accvgpr_write_b32 a33, v161
    v_accvgpr_write_b32 a34, v162
    v_accvgpr_write_b32 a35, v163
    v_accvgpr_write_b32 a36, v164
    v_accvgpr_write_b32 a37, v165
    v_accvgpr_write_b32 a38, v166
    v_accvgpr_write_b32 a39, v167
    v_accvgpr_read_b32 v160, a40
    v_accvgpr_read_b32 v161, a41
    v_accvgpr_read_b32 v162, a42
    v_accvgpr_read_b32 v163, a43
    v_accvgpr_read_b32 v164, a44
    v_accvgpr_read_b32 v165, a45
    v_accvgpr_read_b32 v166, a46
    v_accvgpr_read_b32 v167, a47
    v_mul_f32 v160, v160, v178
    v_mul_f32 v161, v161, v178
    v_mul_f32 v162, v162, v178
    v_mul_f32 v163, v163, v178
    v_mul_f32 v164, v164, v178
    v_mul_f32 v165, v165, v178
    v_mul_f32 v166, v166, v178
    v_mul_f32 v167, v167, v178
    v_accvgpr_write_b32 a40, v160
    v_accvgpr_write_b32 a41, v161
    v_accvgpr_write_b32 a42, v162
    v_accvgpr_write_b32 a43, v163
    v_accvgpr_write_b32 a44, v164
    v_accvgpr_write_b32 a45, v165
    v_accvgpr_write_b32 a46, v166
    v_accvgpr_write_b32 a47, v167
    v_max3_f32 v176, v40, v41, v42
    v_max3_f32 v176, v176, v43, v44
    v_max3_f32 v176, v176, v45, v46
    v_max_f32 v176, v176, v47
    v_mov_b32 v177, v176
    s_nop 1
    v_permlane32_swap_b32 v176, v177
    v_max_f32 v176, v176, v177
    v_mov_b32 v177, v176
    s_nop 1
    v_permlane16_swap_b32 v176, v177
    v_max_f32 v176, v176, v177
    v_sub_f32 v176, v176, v248
    v_max_f32 v176, 0, v176
    v_exp_f32 v178, -v176
    v_sub_f32 v132, v132, v176
    v_sub_f32 v133, v133, v176
    v_sub_f32 v134, v134, v176
    v_sub_f32 v135, v135, v176
    v_sub_f32 v40, v40, v176
    v_sub_f32 v41, v41, v176
    v_sub_f32 v42, v42, v176
    v_sub_f32 v43, v43, v176
    v_sub_f32 v44, v44, v176
    v_sub_f32 v45, v45, v176
    v_sub_f32 v46, v46, v176
    v_sub_f32 v47, v47, v176
    v_mul_f32 v24, v24, v178
    v_mul_f32 v25, v25, v178
    v_mul_f32 v26, v26, v178
    v_mul_f32 v27, v27, v178
    v_accvgpr_read_b32 v160, a16
    v_accvgpr_read_b32 v161, a17
    v_accvgpr_read_b32 v162, a18
    v_accvgpr_read_b32 v163, a19
    v_accvgpr_read_b32 v164, a20
    v_accvgpr_read_b32 v165, a21
    v_accvgpr_read_b32 v166, a22
    v_accvgpr_read_b32 v167, a23
    v_mul_f32 v160, v160, v178
    v_mul_f32 v161, v161, v178
    v_mul_f32 v162, v162, v178
    v_mul_f32 v163, v163, v178
    v_mul_f32 v164, v164, v178
    v_mul_f32 v165, v165, v178
    v_mul_f32 v166, v166, v178
    v_mul_f32 v167, v167, v178
    v_accvgpr_write_b32 a16, v160
    v_accvgpr_write_b32 a17, v161
    v_accvgpr_write_b32 a18, v162
    v_accvgpr_write_b32 a19, v163
    v_accvgpr_write_b32 a20, v164
    v_accvgpr_write_b32 a21, v165
    v_accvgpr_write_b32 a22, v166
    v_accvgpr_write_b32 a23, v167
    v_accvgpr_read_b32 v160, a24
    v_accvgpr_read_b32 v161, a25
    v_accvgpr_read_b32 v162, a26
    v_accvgpr_read_b32 v163, a27
    v_accvgpr_read_b32 v164, a28
    v_accvgpr_read_b32 v165, a29
    v_accvgpr_read_b32 v166, a30
    v_accvgpr_read_b32 v167, a31
    v_mul_f32 v160, v160, v178
    v_mul_f32 v161, v161, v178
    v_mul_f32 v162, v162, v178
    v_mul_f32 v163, v163, v178
    v_mul_f32 v164, v164, v178
    v_mul_f32 v165, v165, v178
    v_mul_f32 v166, v166, v178
    v_mul_f32 v167, v167, v178
    v_accvgpr_write_b32 a24, v160
    v_accvgpr_write_b32 a25, v161
    v_accvgpr_write_b32 a26, v162
    v_accvgpr_write_b32 a27, v163
    v_accvgpr_write_b32 a28, v164
    v_accvgpr_write_b32 a29, v165
    v_accvgpr_write_b32 a30, v166
    v_accvgpr_write_b32 a31, v167
    v_accvgpr_read_b32 v160, a48
    v_accvgpr_read_b32 v161, a49
    v_accvgpr_read_b32 v162, a50
    v_accvgpr_read_b32 v163, a51
    v_accvgpr_read_b32 v164, a52
    v_accvgpr_read_b32 v165, a53
    v_accvgpr_read_b32 v166, a54
    v_accvgpr_read_b32 v167, a55
    v_mul_f32 v160, v160, v178
    v_mul_f32 v161, v161, v178
    v_mul_f32 v162, v162, v178
    v_mul_f32 v163, v163, v178
    v_mul_f32 v164, v164, v178
    v_mul_f32 v165, v165, v178
    v_mul_f32 v166, v166, v178
    v_mul_f32 v167, v167, v178
    v_accvgpr_write_b32 a48, v160
    v_accvgpr_write_b32 a49, v161
    v_accvgpr_write_b32 a50, v162
    v_accvgpr_write_b32 a51, v163
    v_accvgpr_write_b32 a52, v164
    v_accvgpr_write_b32 a53, v165
    v_accvgpr_write_b32 a54, v166
    v_accvgpr_write_b32 a55, v167
    v_accvgpr_read_b32 v160, a56
    v_accvgpr_read_b32 v161, a57
    v_accvgpr_read_b32 v162, a58
    v_accvgpr_read_b32 v163, a59
    v_accvgpr_read_b32 v164, a60
    v_accvgpr_read_b32 v165, a61
    v_accvgpr_read_b32 v166, a62
    v_accvgpr_read_b32 v167, a63
    v_mul_f32 v160, v160, v178
    v_mul_f32 v161, v161, v178
    v_mul_f32 v162, v162, v178
    v_mul_f32 v163, v163, v178
    v_mul_f32 v164, v164, v178
    v_mul_f32 v165, v165, v178
    v_mul_f32 v166, v166, v178
    v_mul_f32 v167, v167, v178
    v_accvgpr_write_b32 a56, v160
    v_accvgpr_write_b32 a57, v161
    v_accvgpr_write_b32 a58, v162
    v_accvgpr_write_b32 a59, v163
    v_accvgpr_write_b32 a60, v164
    v_accvgpr_write_b32 a61, v165
    v_accvgpr_write_b32 a62, v166
    v_accvgpr_write_b32 a63, v167
    v_exp_f32 v160, v32
    v_exp_f32 v161, v33
    v_exp_f32 v162, v34
    v_cvt_pk_bf16_f32 v96, v160, v161
    v_exp_f32 v163, v35
    v_exp_f32 v164, v36
    v_cvt_pk_bf16_f32 v97, v162, v163
    v_exp_f32 v165, v37
    v_exp_f32 v166, v38
    v_cvt_pk_bf16_f32 v98, v164, v165
    v_exp_f32 v167, v39
    v_or3_b32 v174, v96, v97, v98
    v_exp_f32 v160, v40
    v_cvt_pk_bf16_f32 v99, v166, v167
    v_exp_f32 v161, v41
    v_exp_f32 v162, v42
    v_cvt_pk_bf16_f32 v100, v160, v161
    v_exp_f32 v163, v43
    v_or3_b32 v174, v174, v99, v100
    v_exp_f32 v164, v44
    v_cvt_pk_bf16_f32 v101, v162, v163
    v_exp_f32 v165, v45
    v_exp_f32 v166, v46
    v_cvt_pk_bf16_f32 v102, v164, v165
    v_exp_f32 v167, v47
    v_or3_b32 v174, v174, v101, v102
    v_cvt_pk_bf16_f32 v103, v166, v167
    v_or_b32 v174, v174, v103
    v_and_b32 v174, s39, v174
    s_nop 1
    s_branch KB_SL15R
KB_SL16:
    s_nop 15
    v_max3_f32 v176, v48, v49, v50
    v_max3_f32 v176, v176, v51, v52
    v_max3_f32 v176, v176, v53, v54
    v_max_f32 v176, v176, v55
    v_mov_b32 v177, v176
    s_nop 1
    v_permlane32_swap_b32 v176, v177
    v_max_f32 v176, v176, v177
    v_mov_b32 v177, v176
    s_nop 1
    v_permlane16_swap_b32 v176, v177
    v_max_f32 v176, v176, v177
    v_sub_f32 v176, v176, v248
    v_max_f32 v176, 0, v176
    v_exp_f32 v178, -v176
    v_sub_f32 v136, v136, v176
    v_sub_f32 v137, v137, v176
    v_sub_f32 v138, v138, v176
    v_sub_f32 v139, v139, v176
    v_sub_f32 v48, v48, v176
    v_sub_f32 v49, v49, v176
    v_sub_f32 v50, v50, v176
    v_sub_f32 v51, v51, v176
    v_sub_f32 v52, v52, v176
    v_sub_f32 v53, v53, v176
    v_sub_f32 v54, v54, v176
    v_sub_f32 v55, v55, v176
    v_sub_f32 v80, v80, v176
    v_sub_f32 v81, v81, v176
    v_sub_f32 v82, v82, v176
    v_sub_f32 v83, v83, v176
    v_sub_f32 v84, v84, v176
    v_sub_f32 v85, v85, v176
    v_sub_f32 v86, v86, v176
    v_sub_f32 v87, v87, v176
    v_mul_f32 v28, v28, v178
    v_mul_f32 v29, v29, v178
    v_mul_f32 v30, v30, v178
    v_mul_f32 v31, v31, v178
    v_accvgpr_read_b32 v160, a64
    v_accvgpr_read_b32 v161, a65
    v_accvgpr_read_b32 v162, a66
    v_accvgpr_read_b32 v163, a67
    v_accvgpr_read_b32 v164, a68
    v_accvgpr_read_b32 v165, a69
    v_accvgpr_read_b32 v166, a70
    v_accvgpr_read_b32 v167, a71
    v_mul_f32 v160, v160, v178
    v_mul_f32 v161, v161, v178
    v_mul_f32 v162, v162, v178
    v_mul_f32 v163, v163, v178
    v_mul_f32 v164, v164, v178
    v_mul_f32 v165, v165, v178
    v_mul_f32 v166, v166, v178
    v_mul_f32 v167, v167, v178
    v_accvgpr_write_b32 a64, v160
    v_accvgpr_write_b32 a65, v161
    v_accvgpr_write_b32 a66, v162
    v_accvgpr_write_b32 a67, v163
    v_accvgpr_write_b32 a68, v164
    v_accvgpr_write_b32 a69, v165
    v_accvgpr_write_b32 a70, v166
    v_accvgpr_write_b32 a71, v167
    v_accvgpr_read_b32 v160, a72
    v_accvgpr_read_b32 v161, a73
    v_accvgpr_read_b32 v162, a74
    v_accvgpr_read_b32 v163, a75
    v_accvgpr_read_b32 v164, a76
    v_accvgpr_read_b32 v165, a77
    v_accvgpr_read_b32 v166, a78
    v_accvgpr_read_b32 v167, a79
    v_mul_f32 v160, v160, v178
    v_mul_f32 v161, v161, v178
    v_mul_f32 v162, v162, v178
    v_mul_f32 v163, v163, v178
    v_mul_f32 v164, v164, v178
    v_mul_f32 v165, v165, v178
    v_mul_f32 v166, v166, v178
    v_mul_f32 v167, v167, v178
    v_accvgpr_write_b32 a72, v160
    v_accvgpr_write_b32 a73, v161
    v_accvgpr_write_b32 a74, v162
    v_accvgpr_write_b32 a75, v163
    v_accvgpr_write_b32 a76, v164
    v_accvgpr_write_b32 a77, v165
    v_accvgpr_write_b32 a78, v166
    v_accvgpr_write_b32 a79, v167
    v_accvgpr_read_b32 v160, a96
    v_accvgpr_read_b32 v161, a97
    v_accvgpr_read_b32 v162, a98
    v_accvgpr_read_b32 v163, a99
    v_accvgpr_read_b32 v164, a100
    v_accvgpr_read_b32 v165, a101
    v_accvgpr_read_b32 v166, a102
    v_accvgpr_read_b32 v167, a103
    v_mul_f32 v160, v160, v178
    v_mul_f32 v161, v161, v178
    v_mul_f32 v162, v162, v178
    v_mul_f32 v163, v163, v178
    v_mul_f32 v164, v164, v178
    v_mul_f32 v165, v165, v178
    v_mul_f32 v166, v166, v178
    v_mul_f32 v167, v167, v178
    v_accvgpr_write_b32 a96, v160
    v_accvgpr_write_b32 a97, v161
    v_accvgpr_write_b32 a98, v162
    v_accvgpr_write_b32 a99, v163
    v_accvgpr_write_b32 a100, v164
    v_accvgpr_write_b32 a101, v165
    v_accvgpr_write_b32 a102, v166
    v_accvgpr_write_b32 a103, v167
    v_accvgpr_read_b32 v160, a104
    v_accvgpr_read_b32 v161, a105
    v_accvgpr_read_b32 v162, a106
    v_accvgpr_read_b32 v163, a107
    v_accvgpr_read_b32 v164, a108
    v_accvgpr_read_b32 v165, a109
    v_accvgpr_read_b32 v166, a110
    v_accvgpr_read_b32 v167, a111
    v_mul_f32 v160, v160, v178
    v_mul_f32 v161, v161, v178
    v_mul_f32 v162, v162, v178
    v_mul_f32 v163, v163, v178
    v_mul_f32 v164, v164, v178
    v_mul_f32 v165, v165, v178
    v_mul_f32 v166, v166, v178
    v_mul_f32 v167, v167, v178
    v_accvgpr_write_b32 a104, v160
    v_accvgpr_write_b32 a105, v161
    v_accvgpr_write_b32 a106, v162
    v_accvgpr_write_b32 a107, v163
    v_accvgpr_write_b32 a108, v164
    v_accvgpr_write_b32 a109, v165
    v_accvgpr_write_b32 a110, v166
    v_accvgpr_write_b32 a111, v167
    v_max3_f32 v176, v56, v57, v58
    v_max3_f32 v176, v176, v59, v60
    v_max3_f32 v176, v176, v61, v62
    v_max_f32 v176, v176, v63
    v_mov_b32 v177, v176
    s_nop 1
    v_permlane32_swap_b32 v176, v177
    v_max_f32 v176, v176, v177
    v_mov_b32 v177, v176
    s_nop 1
    v_permlane16_swap_b32 v176, v177
    v_max_f32 v176, v176, v177
    v_sub_f32 v176, v176, v248
    v_max_f32 v176, 0, v176
    v_exp_f32 v178, -v176
    v_sub_f32 v140, v140, v176
    v_sub_f32 v141, v141, v176
    v_sub_f32 v142, v142, v176
    v_sub_f32 v143, v143, v176
    v_sub_f32 v56, v56, v176
    v_sub_f32 v57, v57, v176
    v_sub_f32 v58, v58, v176
    v_sub_f32 v59, v59, v176
    v_sub_f32 v60, v60, v176
    v_sub_f32 v61, v61, v176
    v_sub_f32 v62, v62, v176
    v_sub_f32 v63, v63, v176
    v_sub_f32 v88, v88, v176
    v_sub_f32 v89, v89, v176
    v_sub_f32 v90, v90, v176
    v_sub_f32 v91, v91, v176
    v_sub_f32 v92, v92, v176
    v_sub_f32 v93, v93, v176
    v_sub_f32 v94, v94, v176
    v_sub_f32 v95, v95, v176
    v_mul_f32 v168, v168, v178
    v_mul_f32 v169, v169, v178
    v_mul_f32 v170, v170, v178
    v_mul_f32 v171, v171, v178
    v_accvgpr_read_b32 v160, a80
    v_accvgpr_read_b32 v161, a81
    v_accvgpr_read_b32 v162, a82
    v_accvgpr_read_b32 v163, a83
    v_accvgpr_read_b32 v164, a84
    v_accvgpr_read_b32 v165, a85
    v_accvgpr_read_b32 v166, a86
    v_accvgpr_read_b32 v167, a87
    v_mul_f32 v160, v160, v178
    v_mul_f32 v161, v161, v178
    v_mul_f32 v162, v162, v178
    v_mul_f32 v163, v163, v178
    v_mul_f32 v164, v164, v178
    v_mul_f32 v165, v165, v178
    v_mul_f32 v166, v166, v178
    v_mul_f32 v167, v167, v178
    v_accvgpr_write_b32 a80, v160
    v_accvgpr_write_b32 a81, v161
    v_accvgpr_write_b32 a82, v162
    v_accvgpr_write_b32 a83, v163
    v_accvgpr_write_b32 a84, v164
    v_accvgpr_write_b32 a85, v165
    v_accvgpr_write_b32 a86, v166
    v_accvgpr_write_b32 a87, v167
    v_accvgpr_read_b32 v160, a88
    v_accvgpr_read_b32 v161, a89
    v_accvgpr_read_b32 v162, a90
    v_accvgpr_read_b32 v163, a91
    v_accvgpr_read_b32 v164, a92
    v_accvgpr_read_b32 v165, a93
    v_accvgpr_read_b32 v166, a94
    v_accvgpr_read_b32 v167, a95
    v_mul_f32 v160, v160, v178
    v_mul_f32 v161, v161, v178
    v_mul_f32 v162, v162, v178
    v_mul_f32 v163, v163, v178
    v_mul_f32 v164, v164, v178
    v_mul_f32 v165, v165, v178
    v_mul_f32 v166, v166, v178
    v_mul_f32 v167, v167, v178
    v_accvgpr_write_b32 a88, v160
    v_accvgpr_write_b32 a89, v161
    v_accvgpr_write_b32 a90, v162
    v_accvgpr_write_b32 a91, v163
    v_accvgpr_write_b32 a92, v164
    v_accvgpr_write_b32 a93, v165
    v_accvgpr_write_b32 a94, v166
    v_accvgpr_write_b32 a95, v167
    v_accvgpr_read_b32 v160, a112
    v_accvgpr_read_b32 v161, a113
    v_accvgpr_read_b32 v162, a114
    v_accvgpr_read_b32 v163, a115
    v_accvgpr_read_b32 v164, a116
    v_accvgpr_read_b32 v165, a117
    v_accvgpr_read_b32 v166, a118
    v_accvgpr_read_b32 v167, a119
    v_mul_f32 v160, v160, v178
    v_mul_f32 v161, v161, v178
    v_mul_f32 v162, v162, v178
    v_mul_f32 v163, v163, v178
    v_mul_f32 v164, v164, v178
    v_mul_f32 v165, v165, v178
    v_mul_f32 v166, v166, v178
    v_mul_f32 v167, v167, v178
    v_accvgpr_write_b32 a112, v160
    v_accvgpr_write_b32 a113, v161
    v_accvgpr_write_b32 a114, v162
    v_accvgpr_write_b32 a115, v163
    v_accvgpr_write_b32 a116, v164
    v_accvgpr_write_b32 a117, v165
    v_accvgpr_write_b32 a118, v166
    v_accvgpr_write_b32 a119, v167
    v_accvgpr_read_b32 v160, a120
    v_accvgpr_read_b32 v161, a121
    v_accvgpr_read_b32 v162, a122
    v_accvgpr_read_b32 v163, a123
    v_accvgpr_read_b32 v164, a124
    v_accvgpr_read_b32 v165, a125
    v_accvgpr_read_b32 v166, a126
    v_accvgpr_read_b32 v167, a127
    v_mul_f32 v160, v160, v178
    v_mul_f32 v161, v161, v178
    v_mul_f32 v162, v162, v178
    v_mul_f32 v163, v163, v178
    v_mul_f32 v164, v164, v178
    v_mul_f32 v165, v165, v178
    v_mul_f32 v166, v166, v178
    v_mul_f32 v167, v167, v178
    v_accvgpr_write_b32 a120, v160
    v_accvgpr_write_b32 a121, v161
    v_accvgpr_write_b32 a122, v162
    v_accvgpr_write_b32 a123, v163
    v_accvgpr_write_b32 a124, v164
    v_accvgpr_write_b32 a125, v165
    v_accvgpr_write_b32 a126, v166
    v_accvgpr_write_b32 a127, v167
    v_exp_f32 v160, v48
    v_exp_f32 v161, v49
    v_exp_f32 v162, v50
    v_cvt_pk_bf16_f32 v104, v160, v161
    v_exp_f32 v163, v51
    v_exp_f32 v164, v52
    v_cvt_pk_bf16_f32 v105, v162, v163
    v_exp_f32 v165, v53
    v_exp_f32 v166, v54
    v_cvt_pk_bf16_f32 v106, v164, v165
    v_exp_f32 v167, v55
    v_or3_b32 v174, v104, v105, v106
    v_exp_f32 v160, v56
    v_cvt_pk_bf16_f32 v107, v166, v167
    v_exp_f32 v161, v57
    v_exp_f32 v162, v58
    v_cvt_pk_bf16_f32 v108, v160, v161
    v_exp_f32 v163, v59
    v_or3_b32 v174, v174, v107, v108
    v_exp_f32 v164, v60
    v_cvt_pk_bf16_f32 v109, v162, v163
    v_exp_f32 v165, v61
    v_exp_f32 v166, v62
    v_cvt_pk_bf16_f32 v110, v164, v165
    v_exp_f32 v167, v63
    v_or3_b32 v174, v174, v109, v110
    v_cvt_pk_bf16_f32 v111, v166, v167
    v_or_b32 v174, v174, v111
    v_and_b32 v174, s39, v174
    s_nop 1
    s_branch KB_SL16R
KB_SL17:
    s_nop 15
    v_max3_f32 v176, v64, v65, v66
    v_max3_f32 v176, v176, v67, v68
    v_max3_f32 v176, v176, v69, v70
    v_max_f32 v176, v176, v71
    v_mov_b32 v177, v176
    s_nop 1
    v_permlane32_swap_b32 v176, v177
    v_max_f32 v176, v176, v177
    v_mov_b32 v177, v176
    s_nop 1
    v_permlane16_swap_b32 v176, v177
    v_max_f32 v176, v176, v177
    v_sub_f32 v176, v176, v248
    v_max_f32 v176, 0, v176
    v_exp_f32 v178, -v176
    v_sub_f32 v128, v128, v176
    v_sub_f32 v129, v129, v176
    v_sub_f32 v130, v130, v176
    v_sub_f32 v131, v131, v176
    v_sub_f32 v64, v64, v176
    v_sub_f32 v65, v65, v176
    v_sub_f32 v66, v66, v176
    v_sub_f32 v67, v67, v176
    v_sub_f32 v68, v68, v176
    v_sub_f32 v69, v69, v176
    v_sub_f32 v70, v70, v176
    v_sub_f32 v71, v71, v176
    v_mul_f32 v20, v20, v178
    v_mul_f32 v21, v21, v178
    v_mul_f32 v22, v22, v178
    v_mul_f32 v23, v23, v178
    v_accvgpr_read_b32 v160, a0
    v_accvgpr_read_b32 v161, a1
    v_accvgpr_read_b32 v162, a2
    v_accvgpr_read_b32 v163, a3
    v_accvgpr_read_b32 v164, a4
    v_accvgpr_read_b32 v165, a5
    v_accvgpr_read_b32 v166, a6
    v_accvgpr_read_b32 v167, a7
    v_mul_f32 v160, v160, v178
    v_mul_f32 v161, v161, v178
    v_mul_f32 v162, v162, v178
    v_mul_f32 v163, v163, v178
    v_mul_f32 v164, v164, v178
    v_mul_f32 v165, v165, v178
    v_mul_f32 v166, v166, v178
    v_mul_f32 v167, v167, v178
    v_accvgpr_write_b32 a0, v160
    v_accvgpr_write_b32 a1, v161
    v_accvgpr_write_b32 a2, v162
    v_accvgpr_write_b32 a3, v163
    v_accvgpr_write_b32 a4, v164
    v_accvgpr_write_b32 a5, v165
    v_accvgpr_write_b32 a6, v166
    v_accvgpr_write_b32 a7, v167
    v_accvgpr_read_b32 v160, a8
    v_accvgpr_read_b32 v161, a9
    v_accvgpr_read_b32 v162, a10
    v_accvgpr_read_b32 v163, a11
    v_accvgpr_read_b32 v164, a12
    v_accvgpr_read_b32 v165, a13
    v_accvgpr_read_b32 v166, a14
    v_accvgpr_read_b32 v167, a15
    v_mul_f32 v160, v160, v178
    v_mul_f32 v161, v161, v178
    v_mul_f32 v162, v162, v178
    v_mul_f32 v163, v163, v178
    v_mul_f32 v164, v164, v178
    v_mul_f32 v165, v165, v178
    v_mul_f32 v166, v166, v178
    v_mul_f32 v167, v167, v178
    v_accvgpr_write_b32 a8, v160
    v_accvgpr_write_b32 a9, v161
    v_accvgpr_write_b32 a10, v162
    v_accvgpr_write_b32 a11, v163
    v_accvgpr_write_b32 a12, v164
    v_accvgpr_write_b32 a13, v165
    v_accvgpr_write_b32 a14, v166
    v_accvgpr_write_b32 a15, v167
    v_accvgpr_read_b32 v160, a32
    v_accvgpr_read_b32 v161, a33
    v_accvgpr_read_b32 v162, a34
    v_accvgpr_read_b32 v163, a35
    v_accvgpr_read_b32 v164, a36
    v_accvgpr_read_b32 v165, a37
    v_accvgpr_read_b32 v166, a38
    v_accvgpr_read_b32 v167, a39
    v_mul_f32 v160, v160, v178
    v_mul_f32 v161, v161, v178
    v_mul_f32 v162, v162, v178
    v_mul_f32 v163, v163, v178
    v_mul_f32 v164, v164, v178
    v_mul_f32 v165, v165, v178
    v_mul_f32 v166, v166, v178
    v_mul_f32 v167, v167, v178
    v_accvgpr_write_b32 a32, v160
    v_accvgpr_write_b32 a33, v161
    v_accvgpr_write_b32 a34, v162
    v_accvgpr_write_b32 a35, v163
    v_accvgpr_write_b32 a36, v164
    v_accvgpr_write_b32 a37, v165
    v_accvgpr_write_b32 a38, v166
    v_accvgpr_write_b32 a39, v167
    v_accvgpr_read_b32 v160, a40
    v_accvgpr_read_b32 v161, a41
    v_accvgpr_read_b32 v162, a42
    v_accvgpr_read_b32 v163, a43
    v_accvgpr_read_b32 v164, a44
    v_accvgpr_read_b32 v165, a45
    v_accvgpr_read_b32 v166, a46
    v_accvgpr_read_b32 v167, a47
    v_mul_f32 v160, v160, v178
    v_mul_f32 v161, v161, v178
    v_mul_f32 v162, v162, v178
    v_mul_f32 v163, v163, v178
    v_mul_f32 v164, v164, v178
    v_mul_f32 v165, v165, v178
    v_mul_f32 v166, v166, v178
    v_mul_f32 v167, v167, v178
    v_accvgpr_write_b32 a40, v160
    v_accvgpr_write_b32 a41, v161
    v_accvgpr_write_b32 a42, v162
    v_accvgpr_write_b32 a43, v163
    v_accvgpr_write_b32 a44, v164
    v_accvgpr_write_b32 a45, v165
    v_accvgpr_write_b32 a46, v166
    v_accvgpr_write_b32 a47, v167
    v_max3_f32 v176, v72, v73, v74
    v_max3_f32 v176, v176, v75, v76
    v_max3_f32 v176, v176, v77, v78
    v_max_f32 v176, v176, v79
    v_mov_b32 v177, v176
    s_nop 1
    v_permlane32_swap_b32 v176, v177
    v_max_f32 v176, v176, v177
    v_mov_b32 v177, v176
    s_nop 1
    v_permlane16_swap_b32 v176, v177
    v_max_f32 v176, v176, v177
    v_sub_f32 v176, v176, v248
    v_max_f32 v176, 0, v176
    v_exp_f32 v178, -v176
    v_sub_f32 v132, v132, v176
    v_sub_f32 v133, v133, v176
    v_sub_f32 v134, v134, v176
    v_sub_f32 v135, v135, v176
    v_sub_f32 v72, v72, v176
    v_sub_f32 v73, v73, v176
    v_sub_f32 v74, v74, v176
    v_sub_f32 v75, v75, v176
    v_sub_f32 v76, v76, v176
    v_sub_f32 v77, v77, v176
    v_sub_f32 v78, v78, v176
    v_sub_f32 v79, v79, v176
    v_mul_f32 v24, v24, v178
    v_mul_f32 v25, v25, v178
    v_mul_f32 v26, v26, v178
    v_mul_f32 v27, v27, v178
    v_accvgpr_read_b32 v160, a16
    v_accvgpr_read_b32 v161, a17
    v_accvgpr_read_b32 v162, a18
    v_accvgpr_read_b32 v163, a19
    v_accvgpr_read_b32 v164, a20
    v_accvgpr_read_b32 v165, a21
    v_accvgpr_read_b32 v166, a22
    v_accvgpr_read_b32 v167, a23
    v_mul_f32 v160, v160, v178
    v_mul_f32 v161, v161, v178
    v_mul_f32 v162, v162, v178
    v_mul_f32 v163, v163, v178
    v_mul_f32 v164, v164, v178
    v_mul_f32 v165, v165, v178
    v_mul_f32 v166, v166, v178
    v_mul_f32 v167, v167, v178
    v_accvgpr_write_b32 a16, v160
    v_accvgpr_write_b32 a17, v161
    v_accvgpr_write_b32 a18, v162
    v_accvgpr_write_b32 a19, v163
    v_accvgpr_write_b32 a20, v164
    v_accvgpr_write_b32 a21, v165
    v_accvgpr_write_b32 a22, v166
    v_accvgpr_write_b32 a23, v167
    v_accvgpr_read_b32 v160, a24
    v_accvgpr_read_b32 v161, a25
    v_accvgpr_read_b32 v162, a26
    v_accvgpr_read_b32 v163, a27
    v_accvgpr_read_b32 v164, a28
    v_accvgpr_read_b32 v165, a29
    v_accvgpr_read_b32 v166, a30
    v_accvgpr_read_b32 v167, a31
    v_mul_f32 v160, v160, v178
    v_mul_f32 v161, v161, v178
    v_mul_f32 v162, v162, v178
    v_mul_f32 v163, v163, v178
    v_mul_f32 v164, v164, v178
    v_mul_f32 v165, v165, v178
    v_mul_f32 v166, v166, v178
    v_mul_f32 v167, v167, v178
    v_accvgpr_write_b32 a24, v160
    v_accvgpr_write_b32 a25, v161
    v_accvgpr_write_b32 a26, v162
    v_accvgpr_write_b32 a27, v163
    v_accvgpr_write_b32 a28, v164
    v_accvgpr_write_b32 a29, v165
    v_accvgpr_write_b32 a30, v166
    v_accvgpr_write_b32 a31, v167
    v_accvgpr_read_b32 v160, a48
    v_accvgpr_read_b32 v161, a49
    v_accvgpr_read_b32 v162, a50
    v_accvgpr_read_b32 v163, a51
    v_accvgpr_read_b32 v164, a52
    v_accvgpr_read_b32 v165, a53
    v_accvgpr_read_b32 v166, a54
    v_accvgpr_read_b32 v167, a55
    v_mul_f32 v160, v160, v178
    v_mul_f32 v161, v161, v178
    v_mul_f32 v162, v162, v178
    v_mul_f32 v163, v163, v178
    v_mul_f32 v164, v164, v178
    v_mul_f32 v165, v165, v178
    v_mul_f32 v166, v166, v178
    v_mul_f32 v167, v167, v178
    v_accvgpr_write_b32 a48, v160
    v_accvgpr_write_b32 a49, v161
    v_accvgpr_write_b32 a50, v162
    v_accvgpr_write_b32 a51, v163
    v_accvgpr_write_b32 a52, v164
    v_accvgpr_write_b32 a53, v165
    v_accvgpr_write_b32 a54, v166
    v_accvgpr_write_b32 a55, v167
    v_accvgpr_read_b32 v160, a56
    v_accvgpr_read_b32 v161, a57
    v_accvgpr_read_b32 v162, a58
    v_accvgpr_read_b32 v163, a59
    v_accvgpr_read_b32 v164, a60
    v_accvgpr_read_b32 v165, a61
    v_accvgpr_read_b32 v166, a62
    v_accvgpr_read_b32 v167, a63
    v_mul_f32 v160, v160, v178
    v_mul_f32 v161, v161, v178
    v_mul_f32 v162, v162, v178
    v_mul_f32 v163, v163, v178
    v_mul_f32 v164, v164, v178
    v_mul_f32 v165, v165, v178
    v_mul_f32 v166, v166, v178
    v_mul_f32 v167, v167, v178
    v_accvgpr_write_b32 a56, v160
    v_accvgpr_write_b32 a57, v161
    v_accvgpr_write_b32 a58, v162
    v_accvgpr_write_b32 a59, v163
    v_accvgpr_write_b32 a60, v164
    v_accvgpr_write_b32 a61, v165
    v_accvgpr_write_b32 a62, v166
    v_accvgpr_write_b32 a63, v167
    v_exp_f32 v160, v64
    v_exp_f32 v161, v65
    v_exp_f32 v162, v66
    v_cvt_pk_bf16_f32 v112, v160, v161
    v_exp_f32 v163, v67
    v_exp_f32 v164, v68
    v_cvt_pk_bf16_f32 v113, v162, v163
    v_exp_f32 v165, v69
    v_exp_f32 v166, v70
    v_cvt_pk_bf16_f32 v114, v164, v165
    v_exp_f32 v167, v71
    v_or3_b32 v174, v112, v113, v114
    v_exp_f32 v160, v72
    v_cvt_pk_bf16_f32 v115, v166, v167
    v_exp_f32 v161, v73
    v_exp_f32 v162, v74
    v_cvt_pk_bf16_f32 v116, v160, v161
    v_exp_f32 v163, v75
    v_or3_b32 v174, v174, v115, v116
    v_exp_f32 v164, v76
    v_cvt_pk_bf16_f32 v117, v162, v163
    v_exp_f32 v165, v77
    v_exp_f32 v166, v78
    v_cvt_pk_bf16_f32 v118, v164, v165
    v_exp_f32 v167, v79
    v_or3_b32 v174, v174, v117, v118
    v_cvt_pk_bf16_f32 v119, v166, v167
    v_or_b32 v174, v174, v119
    v_and_b32 v174, s39, v174
    s_nop 1
    s_branch KB_SL17R
KB_SL18:
    s_nop 15
    v_max3_f32 v176, v80, v81, v82
    v_max3_f32 v176, v176, v83, v84
    v_max3_f32 v176, v176, v85, v86
    v_max_f32 v176, v176, v87
    v_mov_b32 v177, v176
    s_nop 1
    v_permlane32_swap_b32 v176, v177
    v_max_f32 v176, v176, v177
    v_mov_b32 v177, v176
    s_nop 1
    v_permlane16_swap_b32 v176, v177
    v_max_f32 v176, v176, v177
    v_sub_f32 v176, v176, v248
    v_max_f32 v176, 0, v176
    v_exp_f32 v178, -v176
    v_sub_f32 v136, v136, v176
    v_sub_f32 v137, v137, v176
    v_sub_f32 v138, v138, v176
    v_sub_f32 v139, v139, v176
    v_sub_f32 v80, v80, v176
    v_sub_f32 v81, v81, v176
    v_sub_f32 v82, v82, v176
    v_sub_f32 v83, v83, v176
    v_sub_f32 v84, v84, v176
    v_sub_f32 v85, v85, v176
    v_sub_f32 v86, v86, v176
    v_sub_f32 v87, v87, v176
    v_sub_f32 v48, v48, v176
    v_sub_f32 v49, v49, v176
    v_sub_f32 v50, v50, v176
    v_sub_f32 v51, v51, v176
    v_sub_f32 v52, v52, v176
    v_sub_f32 v53, v53, v176
    v_sub_f32 v54, v54, v176
    v_sub_f32 v55, v55, v176
    v_mul_f32 v28, v28, v178
    v_mul_f32 v29, v29, v178
    v_mul_f32 v30, v30, v178
    v_mul_f32 v31, v31, v178
    v_accvgpr_read_b32 v160, a64
    v_accvgpr_read_b32 v161, a65
    v_accvgpr_read_b32 v162, a66
    v_accvgpr_read_b32 v163, a67
    v_accvgpr_read_b32 v164, a68
    v_accvgpr_read_b32 v165, a69
    v_accvgpr_read_b32 v166, a70
    v_accvgpr_read_b32 v167, a71
    v_mul_f32 v160, v160, v178
    v_mul_f32 v161, v161, v178
    v_mul_f32 v162, v162, v178
    v_mul_f32 v163, v163, v178
    v_mul_f32 v164, v164, v178
    v_mul_f32 v165, v165, v178
    v_mul_f32 v166, v166, v178
    v_mul_f32 v167, v167, v178
    v_accvgpr_write_b32 a64, v160
    v_accvgpr_write_b32 a65, v161
    v_accvgpr_write_b32 a66, v162
    v_accvgpr_write_b32 a67, v163
    v_accvgpr_write_b32 a68, v164
    v_accvgpr_write_b32 a69, v165
    v_accvgpr_write_b32 a70, v166
    v_accvgpr_write_b32 a71, v167
    v_accvgpr_read_b32 v160, a72
    v_accvgpr_read_b32 v161, a73
    v_accvgpr_read_b32 v162, a74
    v_accvgpr_read_b32 v163, a75
    v_accvgpr_read_b32 v164, a76
    v_accvgpr_read_b32 v165, a77
    v_accvgpr_read_b32 v166, a78
    v_accvgpr_read_b32 v167, a79
    v_mul_f32 v160, v160, v178
    v_mul_f32 v161, v161, v178
    v_mul_f32 v162, v162, v178
    v_mul_f32 v163, v163, v178
    v_mul_f32 v164, v164, v178
    v_mul_f32 v165, v165, v178
    v_mul_f32 v166, v166, v178
    v_mul_f32 v167, v167, v178
    v_accvgpr_write_b32 a72, v160
    v_accvgpr_write_b32 a73, v161
    v_accvgpr_write_b32 a74, v162
    v_accvgpr_write_b32 a75, v163
    v_accvgpr_write_b32 a76, v164
    v_accvgpr_write_b32 a77, v165
    v_accvgpr_write_b32 a78, v166
    v_accvgpr_write_b32 a79, v167
    v_accvgpr_read_b32 v160, a96
    v_accvgpr_read_b32 v161, a97
    v_accvgpr_read_b32 v162, a98
    v_accvgpr_read_b32 v163, a99
    v_accvgpr_read_b32 v164, a100
    v_accvgpr_read_b32 v165, a101
    v_accvgpr_read_b32 v166, a102
    v_accvgpr_read_b32 v167, a103
    v_mul_f32 v160, v160, v178
    v_mul_f32 v161, v161, v178
    v_mul_f32 v162, v162, v178
    v_mul_f32 v163, v163, v178
    v_mul_f32 v164, v164, v178
    v_mul_f32 v165, v165, v178
    v_mul_f32 v166, v166, v178
    v_mul_f32 v167, v167, v178
    v_accvgpr_write_b32 a96, v160
    v_accvgpr_write_b32 a97, v161
    v_accvgpr_write_b32 a98, v162
    v_accvgpr_write_b32 a99, v163
    v_accvgpr_write_b32 a100, v164
    v_accvgpr_write_b32 a101, v165
    v_accvgpr_write_b32 a102, v166
    v_accvgpr_write_b32 a103, v167
    v_accvgpr_read_b32 v160, a104
    v_accvgpr_read_b32 v161, a105
    v_accvgpr_read_b32 v162, a106
    v_accvgpr_read_b32 v163, a107
    v_accvgpr_read_b32 v164, a108
    v_accvgpr_read_b32 v165, a109
    v_accvgpr_read_b32 v166, a110
    v_accvgpr_read_b32 v167, a111
    v_mul_f32 v160, v160, v178
    v_mul_f32 v161, v161, v178
    v_mul_f32 v162, v162, v178
    v_mul_f32 v163, v163, v178
    v_mul_f32 v164, v164, v178
    v_mul_f32 v165, v165, v178
    v_mul_f32 v166, v166, v178
    v_mul_f32 v167, v167, v178
    v_accvgpr_write_b32 a104, v160
    v_accvgpr_write_b32 a105, v161
    v_accvgpr_write_b32 a106, v162
    v_accvgpr_write_b32 a107, v163
    v_accvgpr_write_b32 a108, v164
    v_accvgpr_write_b32 a109, v165
    v_accvgpr_write_b32 a110, v166
    v_accvgpr_write_b32 a111, v167
    v_max3_f32 v176, v88, v89, v90
    v_max3_f32 v176, v176, v91, v92
    v_max3_f32 v176, v176, v93, v94
    v_max_f32 v176, v176, v95
    v_mov_b32 v177, v176
    s_nop 1
    v_permlane32_swap_b32 v176, v177
    v_max_f32 v176, v176, v177
    v_mov_b32 v177, v176
    s_nop 1
    v_permlane16_swap_b32 v176, v177
    v_max_f32 v176, v176, v177
    v_sub_f32 v176, v176, v248
    v_max_f32 v176, 0, v176
    v_exp_f32 v178, -v176
    v_sub_f32 v140, v140, v176
    v_sub_f32 v141, v141, v176
    v_sub_f32 v142, v142, v176
    v_sub_f32 v143, v143, v176
    v_sub_f32 v88, v88, v176
    v_sub_f32 v89, v89, v176
    v_sub_f32 v90, v90, v176
    v_sub_f32 v91, v91, v176
    v_sub_f32 v92, v92, v176
    v_sub_f32 v93, v93, v176
    v_sub_f32 v94, v94, v176
    v_sub_f32 v95, v95, v176
    v_sub_f32 v56, v56, v176
    v_sub_f32 v57, v57, v176
    v_sub_f32 v58, v58, v176
    v_sub_f32 v59, v59, v176
    v_sub_f32 v60, v60, v176
    v_sub_f32 v61, v61, v176
    v_sub_f32 v62, v62, v176
    v_sub_f32 v63, v63, v176
    v_mul_f32 v168, v168, v178
    v_mul_f32 v169, v169, v178
    v_mul_f32 v170, v170, v178
    v_mul_f32 v171, v171, v178
    v_accvgpr_read_b32 v160, a80
    v_accvgpr_read_b32 v161, a81
    v_accvgpr_read_b32 v162, a82
    v_accvgpr_read_b32 v163, a83
    v_accvgpr_read_b32 v164, a84
    v_accvgpr_read_b32 v165, a85
    v_accvgpr_read_b32 v166, a86
    v_accvgpr_read_b32 v167, a87
    v_mul_f32 v160, v160, v178
    v_mul_f32 v161, v161, v178
    v_mul_f32 v162, v162, v178
    v_mul_f32 v163, v163, v178
    v_mul_f32 v164, v164, v178
    v_mul_f32 v165, v165, v178
    v_mul_f32 v166, v166, v178
    v_mul_f32 v167, v167, v178
    v_accvgpr_write_b32 a80, v160
    v_accvgpr_write_b32 a81, v161
    v_accvgpr_write_b32 a82, v162
    v_accvgpr_write_b32 a83, v163
    v_accvgpr_write_b32 a84, v164
    v_accvgpr_write_b32 a85, v165
    v_accvgpr_write_b32 a86, v166
    v_accvgpr_write_b32 a87, v167
    v_accvgpr_read_b32 v160, a88
    v_accvgpr_read_b32 v161, a89
    v_accvgpr_read_b32 v162, a90
    v_accvgpr_read_b32 v163, a91
    v_accvgpr_read_b32 v164, a92
    v_accvgpr_read_b32 v165, a93
    v_accvgpr_read_b32 v166, a94
    v_accvgpr_read_b32 v167, a95
    v_mul_f32 v160, v160, v178
    v_mul_f32 v161, v161, v178
    v_mul_f32 v162, v162, v178
    v_mul_f32 v163, v163, v178
    v_mul_f32 v164, v164, v178
    v_mul_f32 v165, v165, v178
    v_mul_f32 v166, v166, v178
    v_mul_f32 v167, v167, v178
    v_accvgpr_write_b32 a88, v160
    v_accvgpr_write_b32 a89, v161
    v_accvgpr_write_b32 a90, v162
    v_accvgpr_write_b32 a91, v163
    v_accvgpr_write_b32 a92, v164
    v_accvgpr_write_b32 a93, v165
    v_accvgpr_write_b32 a94, v166
    v_accvgpr_write_b32 a95, v167
    v_accvgpr_read_b32 v160, a112
    v_accvgpr_read_b32 v161, a113
    v_accvgpr_read_b32 v162, a114
    v_accvgpr_read_b32 v163, a115
    v_accvgpr_read_b32 v164, a116
    v_accvgpr_read_b32 v165, a117
    v_accvgpr_read_b32 v166, a118
    v_accvgpr_read_b32 v167, a119
    v_mul_f32 v160, v160, v178
    v_mul_f32 v161, v161, v178
    v_mul_f32 v162, v162, v178
    v_mul_f32 v163, v163, v178
    v_mul_f32 v164, v164, v178
    v_mul_f32 v165, v165, v178
    v_mul_f32 v166, v166, v178
    v_mul_f32 v167, v167, v178
    v_accvgpr_write_b32 a112, v160
    v_accvgpr_write_b32 a113, v161
    v_accvgpr_write_b32 a114, v162
    v_accvgpr_write_b32 a115, v163
    v_accvgpr_write_b32 a116, v164
    v_accvgpr_write_b32 a117, v165
    v_accvgpr_write_b32 a118, v166
    v_accvgpr_write_b32 a119, v167
    v_accvgpr_read_b32 v160, a120
    v_accvgpr_read_b32 v161, a121
    v_accvgpr_read_b32 v162, a122
    v_accvgpr_read_b32 v163, a123
    v_accvgpr_read_b32 v164, a124
    v_accvgpr_read_b32 v165, a125
    v_accvgpr_read_b32 v166, a126
    v_accvgpr_read_b32 v167, a127
    v_mul_f32 v160, v160, v178
    v_mul_f32 v161, v161, v178
    v_mul_f32 v162, v162, v178
    v_mul_f32 v163, v163, v178
    v_mul_f32 v164, v164, v178
    v_mul_f32 v165, v165, v178
    v_mul_f32 v166, v166, v178
    v_mul_f32 v167, v167, v178
    v_accvgpr_write_b32 a120, v160
    v_accvgpr_write_b32 a121, v161
    v_accvgpr_write_b32 a122, v162
    v_accvgpr_write_b32 a123, v163
    v_accvgpr_write_b32 a124, v164
    v_accvgpr_write_b32 a125, v165
    v_accvgpr_write_b32 a126, v166
    v_accvgpr_write_b32 a127, v167
    v_exp_f32 v160, v80
    v_exp_f32 v161, v81
    v_exp_f32 v162, v82
    v_cvt_pk_bf16_f32 v120, v160, v161
    v_exp_f32 v163, v83
    v_exp_f32 v164, v84
    v_cvt_pk_bf16_f32 v121, v162, v163
    v_exp_f32 v165, v85
    v_exp_f32 v166, v86
    v_cvt_pk_bf16_f32 v122, v164, v165
    v_exp_f32 v167, v87
    v_or3_b32 v174, v120, v121, v122
    v_exp_f32 v160, v88
    v_cvt_pk_bf16_f32 v123, v166, v167
    v_exp_f32 v161, v89
    v_exp_f32 v162, v90
    v_cvt_pk_bf16_f32 v124, v160, v161
    v_exp_f32 v163, v91
    v_or3_b32 v174, v174, v123, v124
    v_exp_f32 v164, v92
    v_cvt_pk_bf16_f32 v125, v162, v163
    v_exp_f32 v165, v93
    v_exp_f32 v166, v94
    v_cvt_pk_bf16_f32 v126, v164, v165
    v_exp_f32 v167, v95
    v_or3_b32 v174, v174, v125, v126
    v_cvt_pk_bf16_f32 v127, v166, v167
    v_or_b32 v174, v174, v127
    v_and_b32 v174, s39, v174
    s_nop 1
    s_branch KB_SL18R
KB_SL19:
    s_nop 15
    v_max3_f32 v176, v32, v33, v34
    v_max3_f32 v176, v176, v35, v36
    v_max3_f32 v176, v176, v37, v38
    v_max_f32 v176, v176, v39
    v_mov_b32 v177, v176
    s_nop 1
    v_permlane32_swap_b32 v176, v177
    v_max_f32 v176, v176, v177
    v_mov_b32 v177, v176
    s_nop 1
    v_permlane16_swap_b32 v176, v177
    v_max_f32 v176, v176, v177
    v_sub_f32 v176, v176, v248
    v_max_f32 v176, 0, v176
    v_exp_f32 v178, -v176
    v_sub_f32 v128, v128, v176
    v_sub_f32 v129, v129, v176
    v_sub_f32 v130, v130, v176
    v_sub_f32 v131, v131, v176
    v_sub_f32 v32, v32, v176
    v_sub_f32 v33, v33, v176
    v_sub_f32 v34, v34, v176
    v_sub_f32 v35, v35, v176
    v_sub_f32 v36, v36, v176
    v_sub_f32 v37, v37, v176
    v_sub_f32 v38, v38, v176
    v_sub_f32 v39, v39, v176
    v_mul_f32 v20, v20, v178
    v_mul_f32 v21, v21, v178
    v_mul_f32 v22, v22, v178
    v_mul_f32 v23, v23, v178
    v_accvgpr_read_b32 v160, a0
    v_accvgpr_read_b32 v161, a1
    v_accvgpr_read_b32 v162, a2
    v_accvgpr_read_b32 v163, a3
    v_accvgpr_read_b32 v164, a4
    v_accvgpr_read_b32 v165, a5
    v_accvgpr_read_b32 v166, a6
    v_accvgpr_read_b32 v167, a7
    v_mul_f32 v160, v160, v178
    v_mul_f32 v161, v161, v178
    v_mul_f32 v162, v162, v178
    v_mul_f32 v163, v163, v178
    v_mul_f32 v164, v164, v178
    v_mul_f32 v165, v165, v178
    v_mul_f32 v166, v166, v178
    v_mul_f32 v167, v167, v178
    v_accvgpr_write_b32 a0, v160
    v_accvgpr_write_b32 a1, v161
    v_accvgpr_write_b32 a2, v162
    v_accvgpr_write_b32 a3, v163
    v_accvgpr_write_b32 a4, v164
    v_accvgpr_write_b32 a5, v165
    v_accvgpr_write_b32 a6, v166
    v_accvgpr_write_b32 a7, v167
    v_accvgpr_read_b32 v160, a8
    v_accvgpr_read_b32 v161, a9
    v_accvgpr_read_b32 v162, a10
    v_accvgpr_read_b32 v163, a11
    v_accvgpr_read_b32 v164, a12
    v_accvgpr_read_b32 v165, a13
    v_accvgpr_read_b32 v166, a14
    v_accvgpr_read_b32 v167, a15
    v_mul_f32 v160, v160, v178
    v_mul_f32 v161, v161, v178
    v_mul_f32 v162, v162, v178
    v_mul_f32 v163, v163, v178
    v_mul_f32 v164, v164, v178
    v_mul_f32 v165, v165, v178
    v_mul_f32 v166, v166, v178
    v_mul_f32 v167, v167, v178
    v_accvgpr_write_b32 a8, v160
    v_accvgpr_write_b32 a9, v161
    v_accvgpr_write_b32 a10, v162
    v_accvgpr_write_b32 a11, v163
    v_accvgpr_write_b32 a12, v164
    v_accvgpr_write_b32 a13, v165
    v_accvgpr_write_b32 a14, v166
    v_accvgpr_write_b32 a15, v167
    v_accvgpr_read_b32 v160, a32
    v_accvgpr_read_b32 v161, a33
    v_accvgpr_read_b32 v162, a34
    v_accvgpr_read_b32 v163, a35
    v_accvgpr_read_b32 v164, a36
    v_accvgpr_read_b32 v165, a37
    v_accvgpr_read_b32 v166, a38
    v_accvgpr_read_b32 v167, a39
    v_mul_f32 v160, v160, v178
    v_mul_f32 v161, v161, v178
    v_mul_f32 v162, v162, v178
    v_mul_f32 v163, v163, v178
    v_mul_f32 v164, v164, v178
    v_mul_f32 v165, v165, v178
    v_mul_f32 v166, v166, v178
    v_mul_f32 v167, v167, v178
    v_accvgpr_write_b32 a32, v160
    v_accvgpr_write_b32 a33, v161
    v_accvgpr_write_b32 a34, v162
    v_accvgpr_write_b32 a35, v163
    v_accvgpr_write_b32 a36, v164
    v_accvgpr_write_b32 a37, v165
    v_accvgpr_write_b32 a38, v166
    v_accvgpr_write_b32 a39, v167
    v_accvgpr_read_b32 v160, a40
    v_accvgpr_read_b32 v161, a41
    v_accvgpr_read_b32 v162, a42
    v_accvgpr_read_b32 v163, a43
    v_accvgpr_read_b32 v164, a44
    v_accvgpr_read_b32 v165, a45
    v_accvgpr_read_b32 v166, a46
    v_accvgpr_read_b32 v167, a47
    v_mul_f32 v160, v160, v178
    v_mul_f32 v161, v161, v178
    v_mul_f32 v162, v162, v178
    v_mul_f32 v163, v163, v178
    v_mul_f32 v164, v164, v178
    v_mul_f32 v165, v165, v178
    v_mul_f32 v166, v166, v178
    v_mul_f32 v167, v167, v178
    v_accvgpr_write_b32 a40, v160
    v_accvgpr_write_b32 a41, v161
    v_accvgpr_write_b32 a42, v162
    v_accvgpr_write_b32 a43, v163
    v_accvgpr_write_b32 a44, v164
    v_accvgpr_write_b32 a45, v165
    v_accvgpr_write_b32 a46, v166
    v_accvgpr_write_b32 a47, v167
    v_max3_f32 v176, v40, v41, v42
    v_max3_f32 v176, v176, v43, v44
    v_max3_f32 v176, v176, v45, v46
    v_max_f32 v176, v176, v47
    v_mov_b32 v177, v176
    s_nop 1
    v_permlane32_swap_b32 v176, v177
    v_max_f32 v176, v176, v177
    v_mov_b32 v177, v176
    s_nop 1
    v_permlane16_swap_b32 v176, v177
    v_max_f32 v176, v176, v177
    v_sub_f32 v176, v176, v248
    v_max_f32 v176, 0, v176
    v_exp_f32 v178, -v176
    v_sub_f32 v132, v132, v176
    v_sub_f32 v133, v133, v176
    v_sub_f32 v134, v134, v176
    v_sub_f32 v135, v135, v176
    v_sub_f32 v40, v40, v176
    v_sub_f32 v41, v41, v176
    v_sub_f32 v42, v42, v176
    v_sub_f32 v43, v43, v176
    v_sub_f32 v44, v44, v176
    v_sub_f32 v45, v45, v176
    v_sub_f32 v46, v46, v176
    v_sub_f32 v47, v47, v176
    v_mul_f32 v24, v24, v178
    v_mul_f32 v25, v25, v178
    v_mul_f32 v26, v26, v178
    v_mul_f32 v27, v27, v178
    v_accvgpr_read_b32 v160, a16
    v_accvgpr_read_b32 v161, a17
    v_accvgpr_read_b32 v162, a18
    v_accvgpr_read_b32 v163, a19
    v_accvgpr_read_b32 v164, a20
    v_accvgpr_read_b32 v165, a21
    v_accvgpr_read_b32 v166, a22
    v_accvgpr_read_b32 v167, a23
    v_mul_f32 v160, v160, v178
    v_mul_f32 v161, v161, v178
    v_mul_f32 v162, v162, v178
    v_mul_f32 v163, v163, v178
    v_mul_f32 v164, v164, v178
    v_mul_f32 v165, v165, v178
    v_mul_f32 v166, v166, v178
    v_mul_f32 v167, v167, v178
    v_accvgpr_write_b32 a16, v160
    v_accvgpr_write_b32 a17, v161
    v_accvgpr_write_b32 a18, v162
    v_accvgpr_write_b32 a19, v163
    v_accvgpr_write_b32 a20, v164
    v_accvgpr_write_b32 a21, v165
    v_accvgpr_write_b32 a22, v166
    v_accvgpr_write_b32 a23, v167
    v_accvgpr_read_b32 v160, a24
    v_accvgpr_read_b32 v161, a25
    v_accvgpr_read_b32 v162, a26
    v_accvgpr_read_b32 v163, a27
    v_accvgpr_read_b32 v164, a28
    v_accvgpr_read_b32 v165, a29
    v_accvgpr_read_b32 v166, a30
    v_accvgpr_read_b32 v167, a31
    v_mul_f32 v160, v160, v178
    v_mul_f32 v161, v161, v178
    v_mul_f32 v162, v162, v178
    v_mul_f32 v163, v163, v178
    v_mul_f32 v164, v164, v178
    v_mul_f32 v165, v165, v178
    v_mul_f32 v166, v166, v178
    v_mul_f32 v167, v167, v178
    v_accvgpr_write_b32 a24, v160
    v_accvgpr_write_b32 a25, v161
    v_accvgpr_write_b32 a26, v162
    v_accvgpr_write_b32 a27, v163
    v_accvgpr_write_b32 a28, v164
    v_accvgpr_write_b32 a29, v165
    v_accvgpr_write_b32 a30, v166
    v_accvgpr_write_b32 a31, v167
    v_accvgpr_read_b32 v160, a48
    v_accvgpr_read_b32 v161, a49
    v_accvgpr_read_b32 v162, a50
    v_accvgpr_read_b32 v163, a51
    v_accvgpr_read_b32 v164, a52
    v_accvgpr_read_b32 v165, a53
    v_accvgpr_read_b32 v166, a54
    v_accvgpr_read_b32 v167, a55
    v_mul_f32 v160, v160, v178
    v_mul_f32 v161, v161, v178
    v_mul_f32 v162, v162, v178
    v_mul_f32 v163, v163, v178
    v_mul_f32 v164, v164, v178
    v_mul_f32 v165, v165, v178
    v_mul_f32 v166, v166, v178
    v_mul_f32 v167, v167, v178
    v_accvgpr_write_b32 a48, v160
    v_accvgpr_write_b32 a49, v161
    v_accvgpr_write_b32 a50, v162
    v_accvgpr_write_b32 a51, v163
    v_accvgpr_write_b32 a52, v164
    v_accvgpr_write_b32 a53, v165
    v_accvgpr_write_b32 a54, v166
    v_accvgpr_write_b32 a55, v167
    v_accvgpr_read_b32 v160, a56
    v_accvgpr_read_b32 v161, a57
    v_accvgpr_read_b32 v162, a58
    v_accvgpr_read_b32 v163, a59
    v_accvgpr_read_b32 v164, a60
    v_accvgpr_read_b32 v165, a61
    v_accvgpr_read_b32 v166, a62
    v_accvgpr_read_b32 v167, a63
    v_mul_f32 v160, v160, v178
    v_mul_f32 v161, v161, v178
    v_mul_f32 v162, v162, v178
    v_mul_f32 v163, v163, v178
    v_mul_f32 v164, v164, v178
    v_mul_f32 v165, v165, v178
    v_mul_f32 v166, v166, v178
    v_mul_f32 v167, v167, v178
    v_accvgpr_write_b32 a56, v160
    v_accvgpr_write_b32 a57, v161
    v_accvgpr_write_b32 a58, v162
    v_accvgpr_write_b32 a59, v163
    v_accvgpr_write_b32 a60, v164
    v_accvgpr_write_b32 a61, v165
    v_accvgpr_write_b32 a62, v166
    v_accvgpr_write_b32 a63, v167
    v_exp_f32 v160, v32
    v_exp_f32 v161, v33
    v_exp_f32 v162, v34
    v_cvt_pk_bf16_f32 v96, v160, v161
    v_exp_f32 v163, v35
    v_exp_f32 v164, v36
    v_cvt_pk_bf16_f32 v97, v162, v163
    v_exp_f32 v165, v37
    v_exp_f32 v166, v38
    v_cvt_pk_bf16_f32 v98, v164, v165
    v_exp_f32 v167, v39
    v_or3_b32 v174, v96, v97, v98
    v_exp_f32 v160, v40
    v_cvt_pk_bf16_f32 v99, v166, v167
    v_exp_f32 v161, v41
    v_exp_f32 v162, v42
    v_cvt_pk_bf16_f32 v100, v160, v161
    v_exp_f32 v163, v43
    v_or3_b32 v174, v174, v99, v100
    v_exp_f32 v164, v44
    v_cvt_pk_bf16_f32 v101, v162, v163
    v_exp_f32 v165, v45
    v_exp_f32 v166, v46
    v_cvt_pk_bf16_f32 v102, v164, v165
    v_exp_f32 v167, v47
    v_or3_b32 v174, v174, v101, v102
    v_cvt_pk_bf16_f32 v103, v166, v167
    v_or_b32 v174, v174, v103
    v_and_b32 v174, s39, v174
    s_nop 1
    s_branch KB_SL19R
KB_SL20:
    s_nop 15
    v_max3_f32 v176, v48, v49, v50
    v_max3_f32 v176, v176, v51, v52
    v_max3_f32 v176, v176, v53, v54
    v_max_f32 v176, v176, v55
    v_mov_b32 v177, v176
    s_nop 1
    v_permlane32_swap_b32 v176, v177
    v_max_f32 v176, v176, v177
    v_mov_b32 v177, v176
    s_nop 1
    v_permlane16_swap_b32 v176, v177
    v_max_f32 v176, v176, v177
    v_sub_f32 v176, v176, v248
    v_max_f32 v176, 0, v176
    v_exp_f32 v178, -v176
    v_sub_f32 v136, v136, v176
    v_sub_f32 v137, v137, v176
    v_sub_f32 v138, v138, v176
    v_sub_f32 v139, v139, v176
    v_sub_f32 v48, v48, v176
    v_sub_f32 v49, v49, v176
    v_sub_f32 v50, v50, v176
    v_sub_f32 v51, v51, v176
    v_sub_f32 v52, v52, v176
    v_sub_f32 v53, v53, v176
    v_sub_f32 v54, v54, v176
    v_sub_f32 v55, v55, v176
    v_sub_f32 v80, v80, v176
    v_sub_f32 v81, v81, v176
    v_sub_f32 v82, v82, v176
    v_sub_f32 v83, v83, v176
    v_sub_f32 v84, v84, v176
    v_sub_f32 v85, v85, v176
    v_sub_f32 v86, v86, v176
    v_sub_f32 v87, v87, v176
    v_mul_f32 v28, v28, v178
    v_mul_f32 v29, v29, v178
    v_mul_f32 v30, v30, v178
    v_mul_f32 v31, v31, v178
    v_accvgpr_read_b32 v160, a64
    v_accvgpr_read_b32 v161, a65
    v_accvgpr_read_b32 v162, a66
    v_accvgpr_read_b32 v163, a67
    v_accvgpr_read_b32 v164, a68
    v_accvgpr_read_b32 v165, a69
    v_accvgpr_read_b32 v166, a70
    v_accvgpr_read_b32 v167, a71
    v_mul_f32 v160, v160, v178
    v_mul_f32 v161, v161, v178
    v_mul_f32 v162, v162, v178
    v_mul_f32 v163, v163, v178
    v_mul_f32 v164, v164, v178
    v_mul_f32 v165, v165, v178
    v_mul_f32 v166, v166, v178
    v_mul_f32 v167, v167, v178
    v_accvgpr_write_b32 a64, v160
    v_accvgpr_write_b32 a65, v161
    v_accvgpr_write_b32 a66, v162
    v_accvgpr_write_b32 a67, v163
    v_accvgpr_write_b32 a68, v164
    v_accvgpr_write_b32 a69, v165
    v_accvgpr_write_b32 a70, v166
    v_accvgpr_write_b32 a71, v167
    v_accvgpr_read_b32 v160, a72
    v_accvgpr_read_b32 v161, a73
    v_accvgpr_read_b32 v162, a74
    v_accvgpr_read_b32 v163, a75
    v_accvgpr_read_b32 v164, a76
    v_accvgpr_read_b32 v165, a77
    v_accvgpr_read_b32 v166, a78
    v_accvgpr_read_b32 v167, a79
    v_mul_f32 v160, v160, v178
    v_mul_f32 v161, v161, v178
    v_mul_f32 v162, v162, v178
    v_mul_f32 v163, v163, v178
    v_mul_f32 v164, v164, v178
    v_mul_f32 v165, v165, v178
    v_mul_f32 v166, v166, v178
    v_mul_f32 v167, v167, v178
    v_accvgpr_write_b32 a72, v160
    v_accvgpr_write_b32 a73, v161
    v_accvgpr_write_b32 a74, v162
    v_accvgpr_write_b32 a75, v163
    v_accvgpr_write_b32 a76, v164
    v_accvgpr_write_b32 a77, v165
    v_accvgpr_write_b32 a78, v166
    v_accvgpr_write_b32 a79, v167
    v_accvgpr_read_b32 v160, a96
    v_accvgpr_read_b32 v161, a97
    v_accvgpr_read_b32 v162, a98
    v_accvgpr_read_b32 v163, a99
    v_accvgpr_read_b32 v164, a100
    v_accvgpr_read_b32 v165, a101
    v_accvgpr_read_b32 v166, a102
    v_accvgpr_read_b32 v167, a103
    v_mul_f32 v160, v160, v178
    v_mul_f32 v161, v161, v178
    v_mul_f32 v162, v162, v178
    v_mul_f32 v163, v163, v178
    v_mul_f32 v164, v164, v178
    v_mul_f32 v165, v165, v178
    v_mul_f32 v166, v166, v178
    v_mul_f32 v167, v167, v178
    v_accvgpr_write_b32 a96, v160
    v_accvgpr_write_b32 a97, v161
    v_accvgpr_write_b32 a98, v162
    v_accvgpr_write_b32 a99, v163
    v_accvgpr_write_b32 a100, v164
    v_accvgpr_write_b32 a101, v165
    v_accvgpr_write_b32 a102, v166
    v_accvgpr_write_b32 a103, v167
    v_accvgpr_read_b32 v160, a104
    v_accvgpr_read_b32 v161, a105
    v_accvgpr_read_b32 v162, a106
    v_accvgpr_read_b32 v163, a107
    v_accvgpr_read_b32 v164, a108
    v_accvgpr_read_b32 v165, a109
    v_accvgpr_read_b32 v166, a110
    v_accvgpr_read_b32 v167, a111
    v_mul_f32 v160, v160, v178
    v_mul_f32 v161, v161, v178
    v_mul_f32 v162, v162, v178
    v_mul_f32 v163, v163, v178
    v_mul_f32 v164, v164, v178
    v_mul_f32 v165, v165, v178
    v_mul_f32 v166, v166, v178
    v_mul_f32 v167, v167, v178
    v_accvgpr_write_b32 a104, v160
    v_accvgpr_write_b32 a105, v161
    v_accvgpr_write_b32 a106, v162
    v_accvgpr_write_b32 a107, v163
    v_accvgpr_write_b32 a108, v164
    v_accvgpr_write_b32 a109, v165
    v_accvgpr_write_b32 a110, v166
    v_accvgpr_write_b32 a111, v167
    v_max3_f32 v176, v56, v57, v58
    v_max3_f32 v176, v176, v59, v60
    v_max3_f32 v176, v176, v61, v62
    v_max_f32 v176, v176, v63
    v_mov_b32 v177, v176
    s_nop 1
    v_permlane32_swap_b32 v176, v177
    v_max_f32 v176, v176, v177
    v_mov_b32 v177, v176
    s_nop 1
    v_permlane16_swap_b32 v176, v177
    v_max_f32 v176, v176, v177
    v_sub_f32 v176, v176, v248
    v_max_f32 v176, 0, v176
    v_exp_f32 v178, -v176
    v_sub_f32 v140, v140, v176
    v_sub_f32 v141, v141, v176
    v_sub_f32 v142, v142, v176
    v_sub_f32 v143, v143, v176
    v_sub_f32 v56, v56, v176
    v_sub_f32 v57, v57, v176
    v_sub_f32 v58, v58, v176
    v_sub_f32 v59, v59, v176
    v_sub_f32 v60, v60, v176
    v_sub_f32 v61, v61, v176
    v_sub_f32 v62, v62, v176
    v_sub_f32 v63, v63, v176
    v_sub_f32 v88, v88, v176
    v_sub_f32 v89, v89, v176
    v_sub_f32 v90, v90, v176
    v_sub_f32 v91, v91, v176
    v_sub_f32 v92, v92, v176
    v_sub_f32 v93, v93, v176
    v_sub_f32 v94, v94, v176
    v_sub_f32 v95, v95, v176
    v_mul_f32 v168, v168, v178
    v_mul_f32 v169, v169, v178
    v_mul_f32 v170, v170, v178
    v_mul_f32 v171, v171, v178
    v_accvgpr_read_b32 v160, a80
    v_accvgpr_read_b32 v161, a81
    v_accvgpr_read_b32 v162, a82
    v_accvgpr_read_b32 v163, a83
    v_accvgpr_read_b32 v164, a84
    v_accvgpr_read_b32 v165, a85
    v_accvgpr_read_b32 v166, a86
    v_accvgpr_read_b32 v167, a87
    v_mul_f32 v160, v160, v178
    v_mul_f32 v161, v161, v178
    v_mul_f32 v162, v162, v178
    v_mul_f32 v163, v163, v178
    v_mul_f32 v164, v164, v178
    v_mul_f32 v165, v165, v178
    v_mul_f32 v166, v166, v178
    v_mul_f32 v167, v167, v178
    v_accvgpr_write_b32 a80, v160
    v_accvgpr_write_b32 a81, v161
    v_accvgpr_write_b32 a82, v162
    v_accvgpr_write_b32 a83, v163
    v_accvgpr_write_b32 a84, v164
    v_accvgpr_write_b32 a85, v165
    v_accvgpr_write_b32 a86, v166
    v_accvgpr_write_b32 a87, v167
    v_accvgpr_read_b32 v160, a88
    v_accvgpr_read_b32 v161, a89
    v_accvgpr_read_b32 v162, a90
    v_accvgpr_read_b32 v163, a91
    v_accvgpr_read_b32 v164, a92
    v_accvgpr_read_b32 v165, a93
    v_accvgpr_read_b32 v166, a94
    v_accvgpr_read_b32 v167, a95
    v_mul_f32 v160, v160, v178
    v_mul_f32 v161, v161, v178
    v_mul_f32 v162, v162, v178
    v_mul_f32 v163, v163, v178
    v_mul_f32 v164, v164, v178
    v_mul_f32 v165, v165, v178
    v_mul_f32 v166, v166, v178
    v_mul_f32 v167, v167, v178
    v_accvgpr_write_b32 a88, v160
    v_accvgpr_write_b32 a89, v161
    v_accvgpr_write_b32 a90, v162
    v_accvgpr_write_b32 a91, v163
    v_accvgpr_write_b32 a92, v164
    v_accvgpr_write_b32 a93, v165
    v_accvgpr_write_b32 a94, v166
    v_accvgpr_write_b32 a95, v167
    v_accvgpr_read_b32 v160, a112
    v_accvgpr_read_b32 v161, a113
    v_accvgpr_read_b32 v162, a114
    v_accvgpr_read_b32 v163, a115
    v_accvgpr_read_b32 v164, a116
    v_accvgpr_read_b32 v165, a117
    v_accvgpr_read_b32 v166, a118
    v_accvgpr_read_b32 v167, a119
    v_mul_f32 v160, v160, v178
    v_mul_f32 v161, v161, v178
    v_mul_f32 v162, v162, v178
    v_mul_f32 v163, v163, v178
    v_mul_f32 v164, v164, v178
    v_mul_f32 v165, v165, v178
    v_mul_f32 v166, v166, v178
    v_mul_f32 v167, v167, v178
    v_accvgpr_write_b32 a112, v160
    v_accvgpr_write_b32 a113, v161
    v_accvgpr_write_b32 a114, v162
    v_accvgpr_write_b32 a115, v163
    v_accvgpr_write_b32 a116, v164
    v_accvgpr_write_b32 a117, v165
    v_accvgpr_write_b32 a118, v166
    v_accvgpr_write_b32 a119, v167
    v_accvgpr_read_b32 v160, a120
    v_accvgpr_read_b32 v161, a121
    v_accvgpr_read_b32 v162, a122
    v_accvgpr_read_b32 v163, a123
    v_accvgpr_read_b32 v164, a124
    v_accvgpr_read_b32 v165, a125
    v_accvgpr_read_b32 v166, a126
    v_accvgpr_read_b32 v167, a127
    v_mul_f32 v160, v160, v178
    v_mul_f32 v161, v161, v178
    v_mul_f32 v162, v162, v178
    v_mul_f32 v163, v163, v178
    v_mul_f32 v164, v164, v178
    v_mul_f32 v165, v165, v178
    v_mul_f32 v166, v166, v178
    v_mul_f32 v167, v167, v178
    v_accvgpr_write_b32 a120, v160
    v_accvgpr_write_b32 a121, v161
    v_accvgpr_write_b32 a122, v162
    v_accvgpr_write_b32 a123, v163
    v_accvgpr_write_b32 a124, v164
    v_accvgpr_write_b32 a125, v165
    v_accvgpr_write_b32 a126, v166
    v_accvgpr_write_b32 a127, v167
    v_exp_f32 v160, v48
    v_exp_f32 v161, v49
    v_exp_f32 v162, v50
    v_cvt_pk_bf16_f32 v104, v160, v161
    v_exp_f32 v163, v51
    v_exp_f32 v164, v52
    v_cvt_pk_bf16_f32 v105, v162, v163
    v_exp_f32 v165, v53
    v_exp_f32 v166, v54
    v_cvt_pk_bf16_f32 v106, v164, v165
    v_exp_f32 v167, v55
    v_or3_b32 v174, v104, v105, v106
    v_exp_f32 v160, v56
    v_cvt_pk_bf16_f32 v107, v166, v167
    v_exp_f32 v161, v57
    v_exp_f32 v162, v58
    v_cvt_pk_bf16_f32 v108, v160, v161
    v_exp_f32 v163, v59
    v_or3_b32 v174, v174, v107, v108
    v_exp_f32 v164, v60
    v_cvt_pk_bf16_f32 v109, v162, v163
    v_exp_f32 v165, v61
    v_exp_f32 v166, v62
    v_cvt_pk_bf16_f32 v110, v164, v165
    v_exp_f32 v167, v63
    v_or3_b32 v174, v174, v109, v110
    v_cvt_pk_bf16_f32 v111, v166, v167
    v_or_b32 v174, v174, v111
    v_and_b32 v174, s39, v174
    s_nop 1
    s_branch KB_SL20R
KB_SL21:
    s_nop 15
    v_max3_f32 v176, v80, v81, v82
    v_max3_f32 v176, v176, v83, v84
    v_max3_f32 v176, v176, v85, v86
    v_max_f32 v176, v176, v87
    v_mov_b32 v177, v176
    s_nop 1
    v_permlane32_swap_b32 v176, v177
    v_max_f32 v176, v176, v177
    v_mov_b32 v177, v176
    s_nop 1
    v_permlane16_swap_b32 v176, v177
    v_max_f32 v176, v176, v177
    v_sub_f32 v176, v176, v248
    v_max_f32 v176, 0, v176
    v_exp_f32 v178, -v176
    v_sub_f32 v136, v136, v176
    v_sub_f32 v137, v137, v176
    v_sub_f32 v138, v138, v176
    v_sub_f32 v139, v139, v176
    v_sub_f32 v80, v80, v176
    v_sub_f32 v81, v81, v176
    v_sub_f32 v82, v82, v176
    v_sub_f32 v83, v83, v176
    v_sub_f32 v84, v84, v176
    v_sub_f32 v85, v85, v176
    v_sub_f32 v86, v86, v176
    v_sub_f32 v87, v87, v176
    v_mul_f32 v28, v28, v178
    v_mul_f32 v29, v29, v178
    v_mul_f32 v30, v30, v178
    v_mul_f32 v31, v31, v178
    v_accvgpr_read_b32 v160, a64
    v_accvgpr_read_b32 v161, a65
    v_accvgpr_read_b32 v162, a66
    v_accvgpr_read_b32 v163, a67
    v_accvgpr_read_b32 v164, a68
    v_accvgpr_read_b32 v165, a69
    v_accvgpr_read_b32 v166, a70
    v_accvgpr_read_b32 v167, a71
    v_mul_f32 v160, v160, v178
    v_mul_f32 v161, v161, v178
    v_mul_f32 v162, v162, v178
    v_mul_f32 v163, v163, v178
    v_mul_f32 v164, v164, v178
    v_mul_f32 v165, v165, v178
    v_mul_f32 v166, v166, v178
    v_mul_f32 v167, v167, v178
    v_accvgpr_write_b32 a64, v160
    v_accvgpr_write_b32 a65, v161
    v_accvgpr_write_b32 a66, v162
    v_accvgpr_write_b32 a67, v163
    v_accvgpr_write_b32 a68, v164
    v_accvgpr_write_b32 a69, v165
    v_accvgpr_write_b32 a70, v166
    v_accvgpr_write_b32 a71, v167
    v_accvgpr_read_b32 v160, a72
    v_accvgpr_read_b32 v161, a73
    v_accvgpr_read_b32 v162, a74
    v_accvgpr_read_b32 v163, a75
    v_accvgpr_read_b32 v164, a76
    v_accvgpr_read_b32 v165, a77
    v_accvgpr_read_b32 v166, a78
    v_accvgpr_read_b32 v167, a79
    v_mul_f32 v160, v160, v178
    v_mul_f32 v161, v161, v178
    v_mul_f32 v162, v162, v178
    v_mul_f32 v163, v163, v178
    v_mul_f32 v164, v164, v178
    v_mul_f32 v165, v165, v178
    v_mul_f32 v166, v166, v178
    v_mul_f32 v167, v167, v178
    v_accvgpr_write_b32 a72, v160
    v_accvgpr_write_b32 a73, v161
    v_accvgpr_write_b32 a74, v162
    v_accvgpr_write_b32 a75, v163
    v_accvgpr_write_b32 a76, v164
    v_accvgpr_write_b32 a77, v165
    v_accvgpr_write_b32 a78, v166
    v_accvgpr_write_b32 a79, v167
    v_accvgpr_read_b32 v160, a96
    v_accvgpr_read_b32 v161, a97
    v_accvgpr_read_b32 v162, a98
    v_accvgpr_read_b32 v163, a99
    v_accvgpr_read_b32 v164, a100
    v_accvgpr_read_b32 v165, a101
    v_accvgpr_read_b32 v166, a102
    v_accvgpr_read_b32 v167, a103
    v_mul_f32 v160, v160, v178
    v_mul_f32 v161, v161, v178
    v_mul_f32 v162, v162, v178
    v_mul_f32 v163, v163, v178
    v_mul_f32 v164, v164, v178
    v_mul_f32 v165, v165, v178
    v_mul_f32 v166, v166, v178
    v_mul_f32 v167, v167, v178
    v_accvgpr_write_b32 a96, v160
    v_accvgpr_write_b32 a97, v161
    v_accvgpr_write_b32 a98, v162
    v_accvgpr_write_b32 a99, v163
    v_accvgpr_write_b32 a100, v164
    v_accvgpr_write_b32 a101, v165
    v_accvgpr_write_b32 a102, v166
    v_accvgpr_write_b32 a103, v167
    v_accvgpr_read_b32 v160, a104
    v_accvgpr_read_b32 v161, a105
    v_accvgpr_read_b32 v162, a106
    v_accvgpr_read_b32 v163, a107
    v_accvgpr_read_b32 v164, a108
    v_accvgpr_read_b32 v165, a109
    v_accvgpr_read_b32 v166, a110
    v_accvgpr_read_b32 v167, a111
    v_mul_f32 v160, v160, v178
    v_mul_f32 v161, v161, v178
    v_mul_f32 v162, v162, v178
    v_mul_f32 v163, v163, v178
    v_mul_f32 v164, v164, v178
    v_mul_f32 v165, v165, v178
    v_mul_f32 v166, v166, v178
    v_mul_f32 v167, v167, v178
    v_accvgpr_write_b32 a104, v160
    v_accvgpr_write_b32 a105, v161
    v_accvgpr_write_b32 a106, v162
    v_accvgpr_write_b32 a107, v163
    v_accvgpr_write_b32 a108, v164
    v_accvgpr_write_b32 a109, v165
    v_accvgpr_write_b32 a110, v166
    v_accvgpr_write_b32 a111, v167
    v_max3_f32 v176, v88, v89, v90
    v_max3_f32 v176, v176, v91, v92
    v_max3_f32 v176, v176, v93, v94
    v_max_f32 v176, v176, v95
    v_mov_b32 v177, v176
    s_nop 1
    v_permlane32_swap_b32 v176, v177
    v_max_f32 v176, v176, v177
    v_mov_b32 v177, v176
    s_nop 1
    v_permlane16_swap_b32 v176, v177
    v_max_f32 v176, v176, v177
    v_sub_f32 v176, v176, v248
    v_max_f32 v176, 0, v176
    v_exp_f32 v178, -v176
    v_sub_f32 v140, v140, v176
    v_sub_f32 v141, v141, v176
    v_sub_f32 v142, v142, v176
    v_sub_f32 v143, v143, v176
    v_sub_f32 v88, v88, v176
    v_sub_f32 v89, v89, v176
    v_sub_f32 v90, v90, v176
    v_sub_f32 v91, v91, v176
    v_sub_f32 v92, v92, v176
    v_sub_f32 v93, v93, v176
    v_sub_f32 v94, v94, v176
    v_sub_f32 v95, v95, v176
    v_mul_f32 v168, v168, v178
    v_mul_f32 v169, v169, v178
    v_mul_f32 v170, v170, v178
    v_mul_f32 v171, v171, v178
    v_accvgpr_read_b32 v160, a80
    v_accvgpr_read_b32 v161, a81
    v_accvgpr_read_b32 v162, a82
    v_accvgpr_read_b32 v163, a83
    v_accvgpr_read_b32 v164, a84
    v_accvgpr_read_b32 v165, a85
    v_accvgpr_read_b32 v166, a86
    v_accvgpr_read_b32 v167, a87
    v_mul_f32 v160, v160, v178
    v_mul_f32 v161, v161, v178
    v_mul_f32 v162, v162, v178
    v_mul_f32 v163, v163, v178
    v_mul_f32 v164, v164, v178
    v_mul_f32 v165, v165, v178
    v_mul_f32 v166, v166, v178
    v_mul_f32 v167, v167, v178
    v_accvgpr_write_b32 a80, v160
    v_accvgpr_write_b32 a81, v161
    v_accvgpr_write_b32 a82, v162
    v_accvgpr_write_b32 a83, v163
    v_accvgpr_write_b32 a84, v164
    v_accvgpr_write_b32 a85, v165
    v_accvgpr_write_b32 a86, v166
    v_accvgpr_write_b32 a87, v167
    v_accvgpr_read_b32 v160, a88
    v_accvgpr_read_b32 v161, a89
    v_accvgpr_read_b32 v162, a90
    v_accvgpr_read_b32 v163, a91
    v_accvgpr_read_b32 v164, a92
    v_accvgpr_read_b32 v165, a93
    v_accvgpr_read_b32 v166, a94
    v_accvgpr_read_b32 v167, a95
    v_mul_f32 v160, v160, v178
    v_mul_f32 v161, v161, v178
    v_mul_f32 v162, v162, v178
    v_mul_f32 v163, v163, v178
    v_mul_f32 v164, v164, v178
    v_mul_f32 v165, v165, v178
    v_mul_f32 v166, v166, v178
    v_mul_f32 v167, v167, v178
    v_accvgpr_write_b32 a88, v160
    v_accvgpr_write_b32 a89, v161
    v_accvgpr_write_b32 a90, v162
    v_accvgpr_write_b32 a91, v163
    v_accvgpr_write_b32 a92, v164
    v_accvgpr_write_b32 a93, v165
    v_accvgpr_write_b32 a94, v166
    v_accvgpr_write_b32 a95, v167
    v_accvgpr_read_b32 v160, a112
    v_accvgpr_read_b32 v161, a113
    v_accvgpr_read_b32 v162, a114
    v_accvgpr_read_b32 v163, a115
    v_accvgpr_read_b32 v164, a116
    v_accvgpr_read_b32 v165, a117
    v_accvgpr_read_b32 v166, a118
    v_accvgpr_read_b32 v167, a119
    v_mul_f32 v160, v160, v178
    v_mul_f32 v161, v161, v178
    v_mul_f32 v162, v162, v178
    v_mul_f32 v163, v163, v178
    v_mul_f32 v164, v164, v178
    v_mul_f32 v165, v165, v178
    v_mul_f32 v166, v166, v178
    v_mul_f32 v167, v167, v178
    v_accvgpr_write_b32 a112, v160
    v_accvgpr_write_b32 a113, v161
    v_accvgpr_write_b32 a114, v162
    v_accvgpr_write_b32 a115, v163
    v_accvgpr_write_b32 a116, v164
    v_accvgpr_write_b32 a117, v165
    v_accvgpr_write_b32 a118, v166
    v_accvgpr_write_b32 a119, v167
    v_accvgpr_read_b32 v160, a120
    v_accvgpr_read_b32 v161, a121
    v_accvgpr_read_b32 v162, a122
    v_accvgpr_read_b32 v163, a123
    v_accvgpr_read_b32 v164, a124
    v_accvgpr_read_b32 v165, a125
    v_accvgpr_read_b32 v166, a126
    v_accvgpr_read_b32 v167, a127
    v_mul_f32 v160, v160, v178
    v_mul_f32 v161, v161, v178
    v_mul_f32 v162, v162, v178
    v_mul_f32 v163, v163, v178
    v_mul_f32 v164, v164, v178
    v_mul_f32 v165, v165, v178
    v_mul_f32 v166, v166, v178
    v_mul_f32 v167, v167, v178
    v_accvgpr_write_b32 a120, v160
    v_accvgpr_write_b32 a121, v161
    v_accvgpr_write_b32 a122, v162
    v_accvgpr_write_b32 a123, v163
    v_accvgpr_write_b32 a124, v164
    v_accvgpr_write_b32 a125, v165
    v_accvgpr_write_b32 a126, v166
    v_accvgpr_write_b32 a127, v167
    v_exp_f32 v160, v80
    v_exp_f32 v161, v81
    v_exp_f32 v162, v82
    v_cvt_pk_bf16_f32 v120, v160, v161
    v_exp_f32 v163, v83
    v_exp_f32 v164, v84
    v_cvt_pk_bf16_f32 v121, v162, v163
    v_exp_f32 v165, v85
    v_exp_f32 v166, v86
    v_cvt_pk_bf16_f32 v122, v164, v165
    v_exp_f32 v167, v87
    v_or3_b32 v174, v120, v121, v122
    v_exp_f32 v160, v88
    v_cvt_pk_bf16_f32 v123, v166, v167
    v_exp_f32 v161, v89
    v_exp_f32 v162, v90
    v_cvt_pk_bf16_f32 v124, v160, v161
    v_exp_f32 v163, v91
    v_or3_b32 v174, v174, v123, v124
    v_exp_f32 v164, v92
    v_cvt_pk_bf16_f32 v125, v162, v163
    v_exp_f32 v165, v93
    v_exp_f32 v166, v94
    v_cvt_pk_bf16_f32 v126, v164, v165
    v_exp_f32 v167, v95
    v_or3_b32 v174, v174, v125, v126
    v_cvt_pk_bf16_f32 v127, v166, v167
    v_or_b32 v174, v174, v127
    v_and_b32 v174, s39, v174
    s_nop 1
    s_branch KB_SL21R
KB_END:
    s_endpgm
.section .rodata,"a"
.p2align 6
.amdhsa_kernel sequential_preLN__compressed_kv_cla__glu_gated_bilinear__prompt_kernel
  .amdhsa_next_free_vgpr 512
  .amdhsa_next_free_sgpr 102
  .amdhsa_accum_offset 256
  .amdhsa_group_segment_fixed_size 0
  .amdhsa_kernarg_size 104
  .amdhsa_user_sgpr_count 2
  .amdhsa_user_sgpr_kernarg_segment_ptr 1
  .amdhsa_system_sgpr_workgroup_id_x 1
.end_amdhsa_kernel
```
